```python
import torch

def _softmax(x, axis=-1):
    return torch.softmax(x, dim=axis)

def _gelu(x):
    return torch.nn.functional.gelu(x, approximate='tanh')

def _silu(x):
    return torch.nn.functional.silu(x)

def _sigmoid(x):
    return torch.sigmoid(x)

def _layernorm(x, axis=-1, eps=1e-05):
    m = x.mean(dim=axis, keepdim=True)
    v = x.var(dim=axis, keepdim=True, unbiased=False)
    return (x - m) / torch.sqrt(v + eps)

def _scatter_add(tgt, idx, src, axis=0):
    return tgt.clone().index_add_(axis, idx, src)

def _segment_sum(src, seg, n):
    out = torch.zeros((n,) + src.shape[1:], dtype=src.dtype)
    return out.index_add_(0, seg, src)

def _pad(x, pw):
    flat = tuple((v for pair in reversed(pw) for v in pair))
    return torch.nn.functional.pad(x, flat)
kernel_name = 'recurrent_scan__linear_attn_block__mixer_gmlp__prompt'

def setup_inputs():

    _w = lambda a: (lambda t: t.to(torch.bfloat16) if t.is_floating_point() else t)(torch.as_tensor(a))

    def _A_setup():
        B, S, D = (1, 2048, 512)
        return {'x': _w((lambda *s: torch.randn(*s, dtype=torch.bfloat16) * 0.05)(B, S, D)), 'wqkv': _w((lambda *s: torch.randn(*s, dtype=torch.bfloat16) * 0.05)(D, 3 * D)), 'wo': _w((lambda *s: torch.randn(*s, dtype=torch.bfloat16) * 0.05)(D, D))}
    _A_in = _A_setup()

    def _B_setup():
        B, S, D, F = (1, 2048, 512, 1376)
        Fh = F // 2
        return {'x': _w((lambda *s: torch.randn(*s, dtype=torch.bfloat16) * 0.05)(B, S, D)), 'w_in': _w((lambda *s: torch.randn(*s, dtype=torch.bfloat16) * 0.4)(D, 2 * Fh)), 'w_sp': _w(0.01 * (lambda *s: torch.randn(*s, dtype=torch.bfloat16) * 0.4)(S, S)), 'b_sp': _w(1.0 + 0.01 * (lambda *s: torch.randn(*s, dtype=torch.bfloat16) * 0.05)(S)), 'w_out': _w((lambda *s: torch.randn(*s, dtype=torch.bfloat16) * 0.05)(Fh, D))}
    _B_in = _B_setup()
    return {'A_x': _A_in['x'], 'A_wqkv': _A_in['wqkv'], 'A_wo': _A_in['wo'], 'B_x': _B_in['x'], 'B_w_in': _B_in['w_in'], 'B_w_sp': _B_in['w_sp'], 'B_b_sp': _B_in['b_sp'], 'B_w_out': _B_in['w_out']}

def reference(A_x, A_wqkv, A_wo, B_x, B_w_in, B_w_sp, B_b_sp, B_w_out):

    def _A_ref(x, wqkv, wo):
        B, S, D = x.shape
        H = 32
        Dh = D // H
        qkv = (lambda x, *d: x.permute(*d))((x @ wqkv).reshape(B, S, 3, H, Dh), 2, 0, 3, 1, 4)
        q, k, v = (qkv[0], qkv[1], qkv[2])
        phi = lambda t: torch.where(t > 0, t + 1, torch.exp(t)) + 1e-06
        pq, pk = (phi(q), phi(k))
        kv = torch.einsum('bhsd,bhse->bhde', pk, v)
        z = torch.einsum('bhsd->bhd', pk)
        num = torch.einsum('bhqd,bhde->bhqe', pq, kv)
        den = torch.einsum('bhqd,bhd->bhq', pq, z)[..., None] + 1e-06
        o = num / den
        return (lambda x, *d: x.permute(*d))(o, 0, 2, 1, 3).reshape(B, S, D) @ wo

    def _B_ref(x, w_in, w_sp, b_sp, w_out):
        B, S, D = x.shape
        F = w_in.shape[-1]
        Fh = F // 2
        z = _gelu(torch.einsum('bsd,df->bsf', x, w_in))
        z1 = z[..., :Fh].clone()
        z2 = _layernorm(z[..., Fh:], axis=-1)
        g = torch.einsum('ts,bsf->btf', w_sp, z2) + b_sp[None, :, None]
        return torch.einsum('bsf,fd->bsd', z1 * g, w_out)
    x = A_x
    xn = _layernorm(x, axis=-1)
    s = _A_ref(xn, A_wqkv, A_wo)
    g = _silu(_B_ref(xn, B_w_in, B_w_sp, B_b_sp, B_w_out))
    return x + s * g
```

```asm
; @launch grid=(256,1,1) block=(256,1,1) lds=163840
.amdgcn_target "amdgcn-amd-amdhsa--gfx950"
.set CODE_SLICES, 10
.text
.globl recurrent_scan__linear_attn_block__mixer_gmlp__prompt_kernel
.p2align 8
.type recurrent_scan__linear_attn_block__mixer_gmlp__prompt_kernel,@function
recurrent_scan__linear_attn_block__mixer_gmlp__prompt_kernel:
s_cmp_ge_u32 s2, 256
s_cbranch_scc1 L_end
s_memrealtime s[100:101]
s_load_dwordx16 s[64:79], s[0:1], 0
s_load_dwordx4 s[80:83], s[0:1], 64
s_load_dwordx2 s[84:85], s[0:1], 80
v_lshrrev_b32 v5, 6, v0
v_and_b32 v0, 63, v0
v_readfirstlane_b32 s44, v5
s_lshr_b32 s53, s2, 3
s_and_b32 s54, s2, 7
s_lshr_b32 s55, s54, 1
s_and_b32 s54, s54, 1
s_lshl_b32 s45, s55, 2
s_and_b32 s56, s53, 3
s_add_u32 s45, s45, s56
s_lshl_b32 s56, s56, 1
s_lshr_b32 s46, s53, 2
s_add_u32 s49, s46, s56
s_and_b32 s49, s49, 7
s_lshl_b32 s49, s49, 7
s_lshl_b32 s56, s44, 5
s_add_u32 s56, s56, s53
s_cmp_lt_u32 s56, CODE_SLICES
s_cbranch_scc0 L_nopf
s_getpc_b64 s[88:89]
L_pc:
s_lshl_b32 s56, s56, 13
v_lshlrev_b32 v6, 7, v0
v_add_u32 v6, s56, v6
v_min_u32 v6, L_end-L_pc, v6
global_load_dword v13, v6, s[88:89]
L_nopf:
v_lshrrev_b32 v1, 3, v0
v_and_b32 v2, 7, v0
v_lshrrev_b32 v3, 4, v0
v_and_b32 v4, 15, v0
v_lshlrev_b32 v32, 4, v0
v_xor_b32 v12, v2, v3
v_lshlrev_b32 v12, 4, v12
s_lshl_b32 s96, s45, 2
s_add_u32 s96, s96, s44
s_lshl_b32 s56, s96, 15
v_lshl_add_u32 v6, v1, 10, v12
v_add_u32 v104, s56, v6
v_xor_b32 v7, 64, v104
v_add_u32 v105, 7168, v7
v_add_u32 v106, 14336, v104
v_add_u32 v107, 21504, v7
s_lshl_b32 s57, s44, 12
s_lshl_b32 s58, s44, 11
s_lshl_b32 s47, s55, 3
s_and_b32 s56, s53, 7
s_add_u32 s47, s47, s56
s_lshr_b32 s48, s53, 3
s_lshl_b32 s50, s48, 1
s_add_u32 s50, s50, s56
s_and_b32 s50, s50, 7
s_lshl_b32 s56, s54, 2
s_add_u32 s48, s48, s56
s_cmp_eq_u32 s54, 0
s_mov_b32 s55, 0xFECA7654
s_cselect_b32 s55, 0xDB983210, s55
s_lshl_b32 s46, s46, 2
s_lshr_b32 s46, s55, s46
s_and_b32 s46, s46, 15
s_lshl_b32 s53, s46, 7
s_add_u32 s88, s53, 1344
s_cmp_eq_u32 s46, 13
s_cselect_b32 s88, 1280, s88
s_cmp_ge_u32 s46, 14
s_cselect_b32 s88, 0x40000000, s88
s_sub_u32 s54, s46, 11
s_sub_u32 s55, s53, 640
s_cmp_lt_u32 s54, 2
s_cselect_b32 s88, s55, s88
s_mov_b32 s51, 2752
s_cselect_b32 s51, 3072, s51
s_cselect_b32 s91, 1, 0
s_lshl_b32 s56, s44, 4
v_add_u32 v6, s56, v1
v_mul_lo_u32 v6, v6, s51
v_and_b32 v7, 1, v3
v_lshlrev_b32 v7, 2, v7
v_xor_b32 v7, v7, v2
v_lshl_add_u32 v6, v7, 4, v6
v_add_u32 v120, s88, v6
s_lshl_b32 s55, s51, 3
s_sub_u32 s55, s55, 1024
v_add_u32 v121, s55, v120
s_lshr_b32 s51, s51, 1
v_mov_b32 v14, 0
s_lshl_b32 s55, s45, 4
s_add_u32 s55, s55, s46
s_lshl_b32 s55, s55, 2
s_add_u32 s98, s55, s44
s_lshl_b32 s55, s98, 11
s_mov_b32 s6, 0x200000
s_mov_b32 s7, 0x20000
s_waitcnt lgkmcnt(0)
s_mov_b32 s4, s64
s_mov_b32 s5, s65
buffer_load_dwordx4 v[88:91], v32, s[4:7], s55 offen offset:0
buffer_load_dwordx4 v[92:95], v32, s[4:7], s55 offen offset:1024
s_mov_b32 s42, 0x100
s_mov_b32 s43, 0x20000
s_mov_b32 s40, s82
s_mov_b32 s41, s83
buffer_load_dwordx2 v[96:97], v14, s[40:43], 0 offen sc1
s_cmp_eq_u32 s91, 1
s_mov_b32 s10, 1409024
s_cselect_b32 s10, 1572864, s10
s_mov_b32 s11, 0x20000
s_cselect_b32 s8, s66, s72
s_cselect_b32 s9, s67, s73
s_or_b32 s56, s2, s44
s_cmp_eq_u32 s56, 0
s_cbranch_scc0 L_noinit
v_mov_b32 v26, s100
v_mov_b32 v27, s101
v_or_b32 v26, 1, v26
v_xor_b32 v27, 0x5bd1e994, v27
v_and_b32 v27, -2, v27
s_mov_b64 exec, 1
buffer_store_dwordx2 v[26:27], v14, s[40:43], 0 offen sc1
s_mov_b64 exec, -1
L_noinit:
s_mov_b32 s94, s49
s_add_u32 m0, s57, 0
s_mul_i32 s87, s49, s51
buffer_load_dwordx4 v104, s[4:7], s49 offen lds
buffer_load_dwordx4 v105, s[4:7], s49 offen offset:1024 lds
buffer_load_dwordx4 v106, s[4:7], s49 offen offset:2048 lds
buffer_load_dwordx4 v107, s[4:7], s49 offen offset:3072 lds
s_add_u32 m0, s58, 65536
s_add_u32 s49, s49, 128
s_and_b32 s49, s49, 1023
buffer_load_dwordx4 v120, s[8:11], s87 offen lds
buffer_load_dwordx4 v121, s[8:11], s87 offen offset:1024 lds
s_add_u32 m0, s57, 16384
s_mul_i32 s87, s49, s51
buffer_load_dwordx4 v104, s[4:7], s49 offen lds
buffer_load_dwordx4 v105, s[4:7], s49 offen offset:1024 lds
buffer_load_dwordx4 v106, s[4:7], s49 offen offset:2048 lds
buffer_load_dwordx4 v107, s[4:7], s49 offen offset:3072 lds
s_add_u32 m0, s58, 73728
s_add_u32 s49, s49, 128
s_and_b32 s49, s49, 1023
buffer_load_dwordx4 v120, s[8:11], s87 offen lds
buffer_load_dwordx4 v121, s[8:11], s87 offen offset:1024 lds
s_add_u32 m0, s57, 32768
s_mul_i32 s87, s49, s51
buffer_load_dwordx4 v104, s[4:7], s49 offen lds
buffer_load_dwordx4 v105, s[4:7], s49 offen offset:1024 lds
buffer_load_dwordx4 v106, s[4:7], s49 offen offset:2048 lds
buffer_load_dwordx4 v107, s[4:7], s49 offen offset:3072 lds
s_add_u32 m0, s58, 81920
s_add_u32 s49, s49, 128
s_and_b32 s49, s49, 1023
buffer_load_dwordx4 v120, s[8:11], s87 offen lds
buffer_load_dwordx4 v121, s[8:11], s87 offen offset:1024 lds
v_and_b32 v6, 31, v0
v_lshlrev_b32 v6, 7, v6
v_add_u32 v6, s57, v6
v_bfe_u32 v7, v0, 1, 3
v_lshrrev_b32 v8, 5, v0
v_xor_b32 v7, v7, v8
v_lshl_add_u32 v16, v7, 4, v6
v_xor_b32 v17, 32, v16
v_xor_b32 v18, 64, v16
v_xor_b32 v19, 96, v16
v_xor_b32 v108, 4096, v16
v_xor_b32 v109, 4096, v17
v_xor_b32 v110, 4096, v18
v_xor_b32 v111, 4096, v19
v_lshrrev_b32 v6, 2, v4
v_lshl_add_u32 v7, v8, 3, v6
v_and_b32 v8, 16, v0
v_lshlrev_b32 v8, 1, v8
v_and_b32 v5, 3, v0
v_lshl_add_u32 v8, v5, 3, v8
v_lshl_add_u32 v122, v7, 7, v8
v_and_b32 v5, 8, v0
v_lshlrev_b32 v5, 3, v5
s_and_b32 s55, s44, 1
s_lshl_b32 s55, s55, 6
v_xor_b32 v5, s55, v5
v_add_u32 v122, v122, v5
v_add_u32 v122, 65536, v122
v_xor_b32 v123, 64, v122
v_lshl_add_u32 v34, v7, 8, v8
v_xor_b32 v5, s44, v6
v_lshl_add_u32 v34, v5, 6, v34
v_add_u32 v34, 98304, v34
v_xor_b32 v35, 128, v34
s_mov_b32 s60, 0x3f803f80
v_xor_b32 v5, v0, v3
v_and_b32 v5, 1, v5
v_cmp_eq_u32 vcc, 0, v5
v_mov_b32 v6, s60
s_nop 0
v_cndmask_b32 v36, 0, v6, vcc
v_mov_b32 v37, v36
v_mov_b32 v38, v36
v_mov_b32 v39, v36
buffer_load_dwordx2 v[26:27], v14, s[40:43], 0 offen sc1
v_mov_b32 v112, 0
v_mov_b32 v113, 0
v_mov_b32 v114, 0
v_mov_b32 v115, 0
s_waitcnt vmcnt(21)
v_dot2_f32_bf16 v112, v88, s60, v112
v_dot2_f32_bf16 v113, v88, v88, v113
s_waitcnt vmcnt(20)
v_dot2_f32_bf16 v114, v92, s60, v114
v_dot2_f32_bf16 v115, v92, v92, v115
v_dot2_f32_bf16 v112, v89, s60, v112
v_dot2_f32_bf16 v113, v89, v89, v113
v_dot2_f32_bf16 v114, v93, s60, v114
v_dot2_f32_bf16 v115, v93, v93, v115
v_dot2_f32_bf16 v112, v90, s60, v112
v_dot2_f32_bf16 v113, v90, v90, v113
v_dot2_f32_bf16 v114, v94, s60, v114
v_dot2_f32_bf16 v115, v94, v94, v115
v_dot2_f32_bf16 v112, v91, s60, v112
v_dot2_f32_bf16 v113, v91, v91, v113
v_dot2_f32_bf16 v114, v95, s60, v114
v_dot2_f32_bf16 v115, v95, v95, v115
s_mov_b32 s22, 0xd00000
s_mov_b32 s23, 0x20000
s_mov_b32 s20, s84
s_mov_b32 s21, s85
s_waitcnt vmcnt(13)
s_barrier
ds_read_b64_tr_b16 v[224:225], v122 offset:0
ds_read_b64_tr_b16 v[226:227], v122 offset:512
ds_read_b128 a[0:3], v16 offset:0
ds_read_b64_tr_b16 v[228:229], v123 offset:0
ds_read_b64_tr_b16 v[230:231], v123 offset:512
ds_read_b128 a[4:7], v108 offset:0
ds_read_b64_tr_b16 v[232:233], v122 offset:2048
ds_read_b64_tr_b16 v[234:235], v122 offset:2560
ds_read_b128 a[8:11], v17 offset:0
ds_read_b64_tr_b16 v[236:237], v123 offset:2048
ds_read_b64_tr_b16 v[238:239], v123 offset:2560
ds_read_b128 a[12:15], v109 offset:0
s_waitcnt lgkmcnt(9)
v_mfma_f32_32x32x16_bf16 v[56:71], v[224:227], a[0:3], 0
ds_read_b64_tr_b16 v[240:241], v122 offset:4096
ds_read_b64_tr_b16 v[242:243], v122 offset:4608
ds_read_b128 a[16:19], v18 offset:0
ds_read_b64_tr_b16 v[244:245], v123 offset:4096
ds_read_b64_tr_b16 v[246:247], v123 offset:4608
v_permlane32_swap_b32 v112, v114
s_waitcnt lgkmcnt(12)
v_mfma_f32_32x32x16_bf16 v[72:87], v[228:231], a[0:3], 0
ds_read_b128 a[20:23], v110 offset:0
ds_read_b64_tr_b16 v[248:249], v122 offset:6144
ds_read_b64_tr_b16 v[250:251], v122 offset:6656
ds_read_b128 a[24:27], v19 offset:0
s_add_u32 m0, s57, 49152
v_mfma_f32_16x16x32_bf16 v[116:119], v[36:39], v[224:227], 0
v_permlane32_swap_b32 v113, v115
s_mul_i32 s87, s49, s51
s_waitcnt lgkmcnt(12)
v_mfma_f32_32x32x16_bf16 v[56:71], v[232:235], a[8:11], v[56:71]
ds_read_b64_tr_b16 v[252:253], v123 offset:6144
ds_read_b64_tr_b16 v[254:255], v123 offset:6656
v_add_f32 v112, v112, v114
v_add_f32 v113, v113, v115
s_nop 0
v_add_f32_dpp v112, v112, v112 row_ror:8 row_mask:0xf bank_mask:0xf
v_add_f32_dpp v113, v113, v113 row_ror:8 row_mask:0xf bank_mask:0xf
s_waitcnt lgkmcnt(12)
v_mfma_f32_32x32x16_bf16 v[72:87], v[236:239], a[8:11], v[72:87]
ds_read_b128 a[28:31], v111 offset:0
buffer_load_dwordx4 v104, s[4:7], s49 offen lds
v_mfma_f32_16x16x32_bf16 v[116:119], v[36:39], v[232:235], v[116:119]
s_nop 0
v_add_f32_dpp v112, v112, v112 row_ror:4 row_mask:0xf bank_mask:0xf
buffer_load_dwordx4 v105, s[4:7], s49 offen offset:1024 lds
buffer_load_dwordx4 v106, s[4:7], s49 offen offset:2048 lds
buffer_load_dwordx4 v107, s[4:7], s49 offen offset:3072 lds
s_add_u32 m0, s58, 90112
s_add_u32 s49, s49, 128
s_and_b32 s49, s49, 1023
buffer_load_dwordx4 v120, s[8:11], s87 offen lds
buffer_load_dwordx4 v121, s[8:11], s87 offen offset:1024 lds
s_waitcnt vmcnt(13)
s_waitcnt lgkmcnt(0)
s_barrier
v_mfma_f32_32x32x16_bf16 v[56:71], v[240:243], a[16:19], v[56:71]
ds_read_b64_tr_b16 v[224:225], v122 offset:8192
ds_read_b64_tr_b16 v[226:227], v122 offset:8704
ds_read_b128 a[32:35], v16 offset:16384
v_add_f32_dpp v113, v113, v113 row_ror:4 row_mask:0xf bank_mask:0xf
s_nop 0
v_add_f32_dpp v112, v112, v112 row_ror:2 row_mask:0xf bank_mask:0xf
v_mfma_f32_32x32x16_bf16 v[72:87], v[244:247], a[16:19], v[72:87]
ds_read_b64_tr_b16 v[228:229], v123 offset:8192
ds_read_b64_tr_b16 v[230:231], v123 offset:8704
ds_read_b128 a[36:39], v108 offset:16384
v_add_f32_dpp v113, v113, v113 row_ror:2 row_mask:0xf bank_mask:0xf
s_add_u32 m0, s57, 0
v_mfma_f32_16x16x32_bf16 v[116:119], v[36:39], v[240:243], v[116:119]
s_nop 0
v_add_f32_dpp v112, v112, v112 row_ror:1 row_mask:0xf bank_mask:0xf
v_mfma_f32_32x32x16_bf16 v[56:71], v[248:251], a[24:27], v[56:71]
ds_read_b64_tr_b16 v[232:233], v122 offset:10240
ds_read_b64_tr_b16 v[234:235], v122 offset:10752
ds_read_b128 a[40:43], v17 offset:16384
ds_read_b64_tr_b16 v[236:237], v123 offset:10240
ds_read_b64_tr_b16 v[238:239], v123 offset:10752
s_mul_i32 s87, s49, s51
v_mfma_f32_32x32x16_bf16 v[72:87], v[252:255], a[24:27], v[72:87]
ds_read_b128 a[44:47], v109 offset:16384
ds_read_b64_tr_b16 v[240:241], v122 offset:12288
ds_read_b64_tr_b16 v[242:243], v122 offset:12800
ds_read_b128 a[48:51], v18 offset:16384
v_add_f32_dpp v113, v113, v113 row_ror:1 row_mask:0xf bank_mask:0xf
v_mfma_f32_16x16x32_bf16 v[116:119], v[36:39], v[248:251], v[116:119]
s_nop 0
v_mov_b32 v114, v112
s_waitcnt lgkmcnt(12)
v_mfma_f32_32x32x16_bf16 v[56:71], v[224:227], a[32:35], v[56:71]
ds_read_b64_tr_b16 v[244:245], v123 offset:12288
ds_read_b64_tr_b16 v[246:247], v123 offset:12800
ds_read_b128 a[52:55], v110 offset:16384
ds_read_b64_tr_b16 v[248:249], v122 offset:14336
ds_read_b64_tr_b16 v[250:251], v122 offset:14848
s_waitcnt lgkmcnt(15)
v_mfma_f32_32x32x16_bf16 v[72:87], v[228:231], a[32:35], v[72:87]
ds_read_b128 a[56:59], v19 offset:16384
ds_read_b64_tr_b16 v[252:253], v123 offset:14336
ds_read_b64_tr_b16 v[254:255], v123 offset:14848
ds_read_b128 a[60:63], v111 offset:16384
v_mov_b32 v115, v113
v_mfma_f32_16x16x32_bf16 v[116:119], v[36:39], v[224:227], v[116:119]
buffer_load_dwordx4 v104, s[4:7], s49 offen lds
s_waitcnt lgkmcnt(15)
v_mfma_f32_32x32x16_bf16 v[56:71], v[232:235], a[40:43], v[56:71]
v_permlane16_swap_b32 v112, v114
v_permlane16_swap_b32 v113, v115
v_add_f32 v112, v112, v114
v_add_f32 v113, v113, v115
s_waitcnt lgkmcnt(13)
v_mfma_f32_32x32x16_bf16 v[72:87], v[236:239], a[40:43], v[72:87]
v_mul_f32 v112, 0x3b000000, v112
v_mul_f32 v114, v112, v112
buffer_load_dwordx4 v105, s[4:7], s49 offen offset:1024 lds
v_mfma_f32_16x16x32_bf16 v[116:119], v[36:39], v[232:235], v[116:119]
v_mov_b32 v115, 0x3b000000
v_fma_f32 v113, v113, v115, -v114
buffer_load_dwordx4 v106, s[4:7], s49 offen offset:2048 lds
buffer_load_dwordx4 v107, s[4:7], s49 offen offset:3072 lds
s_add_u32 m0, s58, 65536
s_add_u32 s49, s49, 128
s_and_b32 s49, s49, 1023
buffer_load_dwordx4 v120, s[8:11], s87 offen lds
buffer_load_dwordx4 v121, s[8:11], s87 offen offset:1024 lds
s_waitcnt vmcnt(13)
s_waitcnt lgkmcnt(0)
s_barrier
v_mfma_f32_32x32x16_bf16 v[56:71], v[240:243], a[48:51], v[56:71]
ds_read_b64_tr_b16 v[224:225], v122 offset:16384
ds_read_b64_tr_b16 v[226:227], v122 offset:16896
ds_read_b128 a[64:67], v16 offset:32768
v_max_f32 v113, 0, v113
v_add_f32 v113, 0x3727c5ac, v113
v_rsq_f32 v88, v113
v_mfma_f32_32x32x16_bf16 v[72:87], v[244:247], a[48:51], v[72:87]
ds_read_b64_tr_b16 v[228:229], v123 offset:16384
ds_read_b64_tr_b16 v[230:231], v123 offset:16896
ds_read_b128 a[68:71], v108 offset:32768
v_mul_f32_e64 v89, -v112, v88
v_mfma_f32_16x16x32_bf16 v[116:119], v[36:39], v[240:243], v[116:119]
v_lshrrev_b32 v9, 5, v0
s_add_u32 m0, s57, 16384
v_mfma_f32_32x32x16_bf16 v[56:71], v[248:251], a[56:59], v[56:71]
ds_read_b64_tr_b16 v[232:233], v122 offset:18432
ds_read_b64_tr_b16 v[234:235], v122 offset:18944
ds_read_b128 a[72:75], v17 offset:32768
ds_read_b64_tr_b16 v[236:237], v123 offset:18432
ds_read_b64_tr_b16 v[238:239], v123 offset:18944
v_lshlrev_b32 v9, 4, v9
v_mfma_f32_32x32x16_bf16 v[72:87], v[252:255], a[56:59], v[72:87]
ds_read_b128 a[76:79], v109 offset:32768
ds_read_b64_tr_b16 v[240:241], v122 offset:20480
ds_read_b64_tr_b16 v[242:243], v122 offset:20992
ds_read_b128 a[80:83], v18 offset:32768
s_mul_i32 s87, s49, s51
v_mfma_f32_16x16x32_bf16 v[116:119], v[36:39], v[248:251], v[116:119]
s_lshl_b32 s98, s98, 5
s_add_u32 s98, s98, 8192
s_waitcnt lgkmcnt(12)
v_mfma_f32_32x32x16_bf16 v[56:71], v[224:227], a[64:67], v[56:71]
ds_read_b64_tr_b16 v[244:245], v123 offset:20480
ds_read_b64_tr_b16 v[246:247], v123 offset:20992
ds_read_b128 a[84:87], v110 offset:32768
ds_read_b64_tr_b16 v[248:249], v122 offset:22528
ds_read_b64_tr_b16 v[250:251], v122 offset:23040
s_waitcnt lgkmcnt(15)
v_mfma_f32_32x32x16_bf16 v[72:87], v[228:231], a[64:67], v[72:87]
ds_read_b128 a[88:91], v19 offset:32768
ds_read_b64_tr_b16 v[252:253], v123 offset:22528
ds_read_b64_tr_b16 v[254:255], v123 offset:23040
ds_read_b128 a[92:95], v111 offset:32768
v_mfma_f32_16x16x32_bf16 v[116:119], v[36:39], v[224:227], v[116:119]
buffer_load_dwordx4 v104, s[4:7], s49 offen lds
s_waitcnt lgkmcnt(15)
v_mfma_f32_32x32x16_bf16 v[56:71], v[232:235], a[72:75], v[56:71]
buffer_load_dwordx4 v105, s[4:7], s49 offen offset:1024 lds
s_waitcnt lgkmcnt(13)
v_mfma_f32_32x32x16_bf16 v[72:87], v[236:239], a[72:75], v[72:87]
v_cmp_eq_u32 vcc, 0, v96
s_nop 3
s_cbranch_vccz L_nn_3
s_waitcnt vmcnt(14)
v_cmp_eq_u32 vcc, 0, v26
s_nop 3
s_cbranch_vccz L_ok_5
s_mov_b32 s62, 4000
L_sp_4:
s_sleep 3
buffer_load_dwordx2 v[26:27], v14, s[40:43], 0 offen sc1
s_waitcnt vmcnt(0)
v_cmp_eq_u32 vcc, 0, v26
s_sub_u32 s62, s62, 1
s_cbranch_scc1 L_ok_5
s_nop 1
s_cbranch_vccnz L_sp_4
L_ok_5:
s_waitcnt vmcnt(0)
v_mov_b32 v96, v26
v_mov_b32 v97, v27
L_nn_3:
v_mfma_f32_16x16x32_bf16 v[116:119], v[36:39], v[232:235], v[116:119]
buffer_load_dwordx4 v106, s[4:7], s49 offen offset:2048 lds
buffer_load_dwordx4 v107, s[4:7], s49 offen offset:3072 lds
s_add_u32 m0, s58, 73728
s_add_u32 s49, s49, 128
s_and_b32 s49, s49, 1023
buffer_load_dwordx4 v120, s[8:11], s87 offen lds
buffer_load_dwordx4 v121, s[8:11], s87 offen offset:1024 lds
s_waitcnt vmcnt(12)
s_waitcnt lgkmcnt(0)
s_barrier
v_mfma_f32_32x32x16_bf16 v[56:71], v[240:243], a[80:83], v[56:71]
ds_read_b64_tr_b16 v[224:225], v122 offset:24576
ds_read_b64_tr_b16 v[226:227], v122 offset:25088
ds_read_b128 a[96:99], v16 offset:49152
s_add_u32 m0, s57, 32768
v_mov_b32 v90, v96
s_mul_i32 s87, s49, s51
v_mfma_f32_32x32x16_bf16 v[72:87], v[244:247], a[80:83], v[72:87]
ds_read_b64_tr_b16 v[228:229], v123 offset:24576
ds_read_b64_tr_b16 v[230:231], v123 offset:25088
ds_read_b128 a[100:103], v108 offset:49152
v_mov_b32 v91, v97
v_mfma_f32_16x16x32_bf16 v[116:119], v[36:39], v[240:243], v[116:119]
s_mov_b32 exec_lo, 1
s_mov_b32 exec_hi, 1
buffer_store_dwordx4 v[88:91], v9, s[20:23], s98 offen sc1
s_mov_b64 exec, -1
v_mfma_f32_32x32x16_bf16 v[56:71], v[248:251], a[88:91], v[56:71]
ds_read_b64_tr_b16 v[232:233], v122 offset:26624
ds_read_b64_tr_b16 v[234:235], v122 offset:27136
ds_read_b128 a[104:107], v17 offset:49152
ds_read_b64_tr_b16 v[236:237], v123 offset:26624
ds_read_b64_tr_b16 v[238:239], v123 offset:27136
v_mfma_f32_32x32x16_bf16 v[72:87], v[252:255], a[88:91], v[72:87]
ds_read_b128 a[108:111], v109 offset:49152
ds_read_b64_tr_b16 v[240:241], v122 offset:28672
ds_read_b64_tr_b16 v[242:243], v122 offset:29184
ds_read_b128 a[112:115], v18 offset:49152
v_mfma_f32_16x16x32_bf16 v[116:119], v[36:39], v[248:251], v[116:119]
s_waitcnt lgkmcnt(12)
v_mfma_f32_32x32x16_bf16 v[56:71], v[224:227], a[96:99], v[56:71]
ds_read_b64_tr_b16 v[244:245], v123 offset:28672
ds_read_b64_tr_b16 v[246:247], v123 offset:29184
ds_read_b128 a[116:119], v110 offset:49152
ds_read_b64_tr_b16 v[248:249], v122 offset:30720
ds_read_b64_tr_b16 v[250:251], v122 offset:31232
s_waitcnt lgkmcnt(15)
v_mfma_f32_32x32x16_bf16 v[72:87], v[228:231], a[96:99], v[72:87]
ds_read_b128 a[120:123], v19 offset:49152
ds_read_b64_tr_b16 v[252:253], v123 offset:30720
ds_read_b64_tr_b16 v[254:255], v123 offset:31232
ds_read_b128 a[124:127], v111 offset:49152
v_mfma_f32_16x16x32_bf16 v[116:119], v[36:39], v[224:227], v[116:119]
buffer_load_dwordx4 v104, s[4:7], s49 offen lds
s_waitcnt lgkmcnt(15)
v_mfma_f32_32x32x16_bf16 v[56:71], v[232:235], a[104:107], v[56:71]
s_lshl_b32 s0, s46, 7
buffer_load_dwordx4 v105, s[4:7], s49 offen offset:1024 lds
s_waitcnt lgkmcnt(13)
v_mfma_f32_32x32x16_bf16 v[72:87], v[236:239], a[104:107], v[72:87]
s_sub_u32 s1, s46, 11
s_lshl_b32 s1, s1, 8
s_sub_u32 s3, s46, 8
s_lshl_b32 s3, s3, 8
s_mov_b32 s52, 3072
v_mfma_f32_16x16x32_bf16 v[116:119], v[36:39], v[232:235], v[116:119]
s_cmp_ge_u32 s46, 11
s_cselect_b32 s89, s1, s3
s_cselect_b32 s52, 2752, s52
s_cselect_b32 s92, 0, 1
buffer_load_dwordx4 v106, s[4:7], s49 offen offset:2048 lds
buffer_load_dwordx4 v107, s[4:7], s49 offen offset:3072 lds
s_add_u32 m0, s58, 81920
s_add_u32 s49, s49, 128
s_and_b32 s49, s49, 1023
buffer_load_dwordx4 v120, s[8:11], s87 offen lds
buffer_load_dwordx4 v121, s[8:11], s87 offen offset:1024 lds
s_waitcnt vmcnt(13)
s_waitcnt lgkmcnt(0)
s_barrier
v_mfma_f32_32x32x16_bf16 v[56:71], v[240:243], a[112:115], v[56:71]
ds_read_b64_tr_b16 v[224:225], v122 offset:0
ds_read_b64_tr_b16 v[226:227], v122 offset:512
ds_read_b128 a[128:131], v16 offset:0
s_add_u32 m0, s57, 49152
s_add_u32 s90, s89, 128
s_mul_i32 s87, s49, s51
v_mfma_f32_32x32x16_bf16 v[72:87], v[244:247], a[112:115], v[72:87]
ds_read_b64_tr_b16 v[228:229], v123 offset:0
ds_read_b64_tr_b16 v[230:231], v123 offset:512
ds_read_b128 a[132:135], v108 offset:0
s_add_u32 s1, s0, 1024
s_add_u32 s3, s0, 2048
v_mfma_f32_16x16x32_bf16 v[116:119], v[36:39], v[240:243], v[116:119]
buffer_load_dwordx4 v104, s[4:7], s49 offen lds
v_mfma_f32_32x32x16_bf16 v[56:71], v[248:251], a[120:123], v[56:71]
ds_read_b64_tr_b16 v[232:233], v122 offset:2048
ds_read_b64_tr_b16 v[234:235], v122 offset:2560
ds_read_b128 a[136:139], v17 offset:0
ds_read_b64_tr_b16 v[236:237], v123 offset:2048
ds_read_b64_tr_b16 v[238:239], v123 offset:2560
v_mfma_f32_32x32x16_bf16 v[72:87], v[252:255], a[120:123], v[72:87]
ds_read_b128 a[140:143], v109 offset:0
ds_read_b64_tr_b16 v[240:241], v122 offset:4096
ds_read_b64_tr_b16 v[242:243], v122 offset:4608
ds_read_b128 a[144:147], v18 offset:0
v_mfma_f32_16x16x32_bf16 v[116:119], v[36:39], v[248:251], v[116:119]
s_cmp_lt_u32 s46, 8
s_cselect_b32 s89, s1, s89
s_cselect_b32 s90, s3, s90
s_waitcnt lgkmcnt(12)
v_mfma_f32_32x32x16_bf16 v[56:71], v[224:227], a[128:131], v[56:71]
ds_read_b64_tr_b16 v[244:245], v123 offset:4096
ds_read_b64_tr_b16 v[246:247], v123 offset:4608
ds_read_b128 a[148:151], v110 offset:0
ds_read_b64_tr_b16 v[248:249], v122 offset:6144
ds_read_b64_tr_b16 v[250:251], v122 offset:6656
s_waitcnt lgkmcnt(15)
v_mfma_f32_32x32x16_bf16 v[72:87], v[228:231], a[128:131], v[72:87]
ds_read_b128 a[152:155], v19 offset:0
ds_read_b64_tr_b16 v[252:253], v123 offset:6144
ds_read_b64_tr_b16 v[254:255], v123 offset:6656
ds_read_b128 a[156:159], v111 offset:0
v_mfma_f32_16x16x32_bf16 v[116:119], v[36:39], v[224:227], v[116:119]
v_lshl_add_u32 v10, v1, 12, v12
s_and_b32 s1, s44, 1
s_waitcnt lgkmcnt(15)
v_mfma_f32_32x32x16_bf16 v[56:71], v[232:235], a[136:139], v[56:71]
s_lshl_b32 s1, s1, 16
v_add_u32 v20, s1, v10
s_xor_b32 s1, s1, 0x10000
buffer_load_dwordx4 v105, s[4:7], s49 offen offset:1024 lds
s_waitcnt lgkmcnt(13)
v_mfma_f32_32x32x16_bf16 v[72:87], v[236:239], a[136:139], v[72:87]
v_add_u32 v22, s1, v10
v_xor_b32 v11, 64, v20
v_add_u32 v21, 31744, v11
v_xor_b32 v11, 64, v22
v_add_u32 v23, 31744, v11
v_mfma_f32_16x16x32_bf16 v[116:119], v[36:39], v[232:235], v[116:119]
s_lshl_b32 s0, s44, 4
v_add_u32 v10, s0, v3
buffer_load_dwordx4 v106, s[4:7], s49 offen offset:2048 lds
buffer_load_dwordx4 v107, s[4:7], s49 offen offset:3072 lds
s_add_u32 m0, s58, 90112
s_add_u32 s49, s49, 128
s_and_b32 s49, s49, 1023
buffer_load_dwordx4 v120, s[8:11], s87 offen lds
buffer_load_dwordx4 v121, s[8:11], s87 offen offset:1024 lds
s_waitcnt vmcnt(13)
s_waitcnt lgkmcnt(0)
s_barrier
v_mul_lo_u32 v10, v10, s52
v_lshlrev_b32 v11, 2, v3
v_xor_b32 v11, v11, v4
v_mov_b32 v12, s90
v_mov_b32 v40, s89
v_cmp_gt_u32 vcc, 8, v11
s_nop 1
v_cndmask_b32 v12, v12, v40, vcc
v_and_b32 v11, 7, v11
v_lshl_add_u32 v10, v11, 4, v10
v_add_u32 v40, v10, v12
s_lshl_b32 s1, s52, 2
s_sub_u32 s1, s1, 1024
v_add_u32 v41, s1, v40
v_add_u32 v42, s1, v41
v_add_u32 v43, s1, v42
s_lshr_b32 s52, s52, 1
s_cmp_eq_u32 s92, 1
s_mov_b32 s14, 1409024
s_cselect_b32 s14, 1572864, s14
s_mov_b32 s15, 0x20000
s_cselect_b32 s12, s66, s72
s_cselect_b32 s13, s67, s73
s_mov_b32 s26, 0x80000
s_mov_b32 s27, 0x20000
s_mov_b32 s24, s68
s_mov_b32 s25, s69
s_mov_b32 s30, 0xac000
s_mov_b32 s31, 0x20000
s_mov_b32 s28, s78
s_mov_b32 s29, s79
s_mov_b32 s18, 0x800000
s_mov_b32 s19, 0x20000
s_mov_b32 s16, s74
s_mov_b32 s17, s75
s_mov_b32 s34, 0x200000
s_mov_b32 s35, 0x20000
s_mov_b32 s32, s80
s_mov_b32 s33, s81
s_mov_b32 s38, 0x1000
s_mov_b32 s39, 0x20000
s_mov_b32 s36, s76
s_mov_b32 s37, s77
v_mov_b32 v26, v96
v_mov_b32 v27, v97
s_lshl_b32 s59, s44, 13
s_lshl_b32 s0, s47, 18
s_lshl_b32 s1, s44, 10
s_add_u32 s0, s0, s1
s_lshr_b32 s1, s44, 1
s_lshl_b32 s1, s1, 17
s_add_u32 s64, s0, s1
s_xor_b32 s1, s1, 0x20000
s_add_u32 s65, s0, s1
s_lshl_b32 s61, s50, 7
s_mov_b32 s66, 0xFFFF0000
s_mov_b32 s67, 0xFFFF0000
v_lshlrev_b32 v10, 1, v3
v_xor_b32 v10, v10, v2
v_lshlrev_b32 v10, 4, v10
v_lshl_add_u32 v10, v1, 10, v10
s_lshl_b32 s0, s48, 7
v_add_u32 v28, s0, v10
v_add_u32 v29, 7168, v28
v_add_u32 v30, 14336, v28
v_add_u32 v31, 21504, v28
v_mov_b32 v52, 0xbdd2d3e8
v_mov_b32 v53, 0xc0135761
v_mov_b32 v24, 0x3fb8aa3b
v_mov_b32 v25, 0x358637bd
v_and_b32 v54, 31, v0
v_lshlrev_b32 v54, 2, v54
v_add_u32 v54, 159744, v54
s_mul_i32 s88, s48, 3
s_cmp_eq_u32 s48, 7
s_cselect_b32 s88, 20, s88
s_cmp_ge_u32 s48, 6
s_cselect_b32 s89, 2, 3
s_and_b32 s91, s44, 1
s_mul_i32 s93, s44, 720896
s_add_u32 s93, s93, 262144
s_mov_b32 s92, s50
v_and_b32 v9, 31, v0
v_lshlrev_b32 v9, 4, v9
s_lshl_b32 s98, s96, 9
s_add_u32 s98, s98, 8192
buffer_load_dwordx4 v[48:51], v9, s[20:23], s98 offen sc1
v_mfma_f32_32x32x16_bf16 v[56:71], v[240:243], a[144:147], v[56:71]
ds_read_b64_tr_b16 v[224:225], v122 offset:8192
ds_read_b64_tr_b16 v[226:227], v122 offset:8704
ds_read_b128 a[160:163], v16 offset:16384
s_add_u32 m0, s57, 98304
s_mul_i32 s87, s94, s52
v_mfma_f32_32x32x16_bf16 v[72:87], v[244:247], a[144:147], v[72:87]
ds_read_b64_tr_b16 v[228:229], v123 offset:8192
ds_read_b64_tr_b16 v[230:231], v123 offset:8704
ds_read_b128 a[164:167], v108 offset:16384
buffer_load_dwordx4 v40, s[12:15], s87 offen lds
v_mfma_f32_16x16x32_bf16 v[116:119], v[36:39], v[240:243], v[116:119]
v_mfma_f32_32x32x16_bf16 v[56:71], v[248:251], a[152:155], v[56:71]
ds_read_b64_tr_b16 v[232:233], v122 offset:10240
ds_read_b64_tr_b16 v[234:235], v122 offset:10752
ds_read_b128 a[168:171], v17 offset:16384
ds_read_b64_tr_b16 v[236:237], v123 offset:10240
ds_read_b64_tr_b16 v[238:239], v123 offset:10752
v_mfma_f32_32x32x16_bf16 v[72:87], v[252:255], a[152:155], v[72:87]
ds_read_b128 a[172:175], v109 offset:16384
ds_read_b64_tr_b16 v[240:241], v122 offset:12288
ds_read_b64_tr_b16 v[242:243], v122 offset:12800
ds_read_b128 a[176:179], v18 offset:16384
v_mfma_f32_16x16x32_bf16 v[116:119], v[36:39], v[248:251], v[116:119]
buffer_load_dwordx4 v41, s[12:15], s87 offen offset:1024 lds
s_waitcnt lgkmcnt(12)
v_mfma_f32_32x32x16_bf16 v[56:71], v[224:227], a[160:163], v[56:71]
ds_read_b64_tr_b16 v[244:245], v123 offset:12288
ds_read_b64_tr_b16 v[246:247], v123 offset:12800
ds_read_b128 a[180:183], v110 offset:16384
ds_read_b64_tr_b16 v[248:249], v122 offset:14336
ds_read_b64_tr_b16 v[250:251], v122 offset:14848
s_waitcnt lgkmcnt(15)
v_mfma_f32_32x32x16_bf16 v[72:87], v[228:231], a[160:163], v[72:87]
ds_read_b128 a[184:187], v19 offset:16384
ds_read_b64_tr_b16 v[252:253], v123 offset:14336
ds_read_b64_tr_b16 v[254:255], v123 offset:14848
ds_read_b128 a[188:191], v111 offset:16384
v_mfma_f32_16x16x32_bf16 v[116:119], v[36:39], v[224:227], v[116:119]
buffer_load_dwordx4 v42, s[12:15], s87 offen offset:2048 lds
s_waitcnt lgkmcnt(15)
v_mfma_f32_32x32x16_bf16 v[56:71], v[232:235], a[168:171], v[56:71]
buffer_load_dwordx4 v43, s[12:15], s87 offen offset:3072 lds
s_waitcnt lgkmcnt(13)
v_mfma_f32_32x32x16_bf16 v[72:87], v[236:239], a[168:171], v[72:87]
s_add_u32 s94, s94, 128
s_and_b32 s94, s94, 1023
v_mfma_f32_16x16x32_bf16 v[116:119], v[36:39], v[232:235], v[116:119]
s_waitcnt vmcnt(11)
s_waitcnt lgkmcnt(0)
s_barrier
v_mfma_f32_32x32x16_bf16 v[56:71], v[240:243], a[176:179], v[56:71]
ds_read_b64_tr_b16 v[224:225], v122 offset:16384
ds_read_b64_tr_b16 v[226:227], v122 offset:16896
ds_read_b128 a[192:195], v16 offset:32768
v_lshlrev_b32 v10, 7, v0
s_lshl_b32 s0, s2, 2
s_add_u32 s0, s0, s44
v_mfma_f32_32x32x16_bf16 v[72:87], v[244:247], a[176:179], v[72:87]
ds_read_b64_tr_b16 v[228:229], v123 offset:16384
ds_read_b64_tr_b16 v[230:231], v123 offset:16896
ds_read_b128 a[196:199], v108 offset:32768
s_lshl_b32 s1, s0, 9
s_mul_i32 s0, s0, 768
v_mfma_f32_16x16x32_bf16 v[116:119], v[36:39], v[240:243], v[116:119]
s_mov_b64 exec, 15
buffer_load_dword v13, v10, s[24:27], s1 offen
s_mov_b64 exec, 63
buffer_load_dword v13, v10, s[28:31], s0 offen
s_mov_b64 exec, -1
v_mfma_f32_32x32x16_bf16 v[56:71], v[248:251], a[184:187], v[56:71]
ds_read_b64_tr_b16 v[232:233], v122 offset:18432
ds_read_b64_tr_b16 v[234:235], v122 offset:18944
ds_read_b128 a[200:203], v17 offset:32768
ds_read_b64_tr_b16 v[236:237], v123 offset:18432
ds_read_b64_tr_b16 v[238:239], v123 offset:18944
v_mfma_f32_32x32x16_bf16 v[72:87], v[252:255], a[184:187], v[72:87]
ds_read_b128 a[204:207], v109 offset:32768
ds_read_b64_tr_b16 v[240:241], v122 offset:20480
ds_read_b64_tr_b16 v[242:243], v122 offset:20992
ds_read_b128 a[208:211], v18 offset:32768
v_mfma_f32_16x16x32_bf16 v[116:119], v[36:39], v[248:251], v[116:119]
s_waitcnt lgkmcnt(12)
v_mfma_f32_32x32x16_bf16 v[56:71], v[224:227], a[192:195], v[56:71]
ds_read_b64_tr_b16 v[244:245], v123 offset:20480
ds_read_b64_tr_b16 v[246:247], v123 offset:20992
ds_read_b128 a[212:215], v110 offset:32768
ds_read_b64_tr_b16 v[248:249], v122 offset:22528
ds_read_b64_tr_b16 v[250:251], v122 offset:23040
s_waitcnt lgkmcnt(15)
v_mfma_f32_32x32x16_bf16 v[72:87], v[228:231], a[192:195], v[72:87]
ds_read_b128 a[216:219], v19 offset:32768
ds_read_b64_tr_b16 v[252:253], v123 offset:22528
ds_read_b64_tr_b16 v[254:255], v123 offset:23040
ds_read_b128 a[220:223], v111 offset:32768
v_mfma_f32_16x16x32_bf16 v[116:119], v[36:39], v[224:227], v[116:119]
s_waitcnt lgkmcnt(15)
v_mfma_f32_32x32x16_bf16 v[56:71], v[232:235], a[200:203], v[56:71]
s_waitcnt lgkmcnt(13)
v_mfma_f32_32x32x16_bf16 v[72:87], v[236:239], a[200:203], v[72:87]
v_mfma_f32_16x16x32_bf16 v[116:119], v[36:39], v[232:235], v[116:119]
s_waitcnt vmcnt(7)
s_waitcnt lgkmcnt(0)
s_barrier
v_mfma_f32_32x32x16_bf16 v[56:71], v[240:243], a[208:211], v[56:71]
ds_read_b64_tr_b16 v[224:225], v122 offset:24576
ds_read_b64_tr_b16 v[226:227], v122 offset:25088
ds_read_b128 a[224:227], v16 offset:49152
v_mfma_f32_32x32x16_bf16 v[72:87], v[244:247], a[208:211], v[72:87]
ds_read_b64_tr_b16 v[228:229], v123 offset:24576
ds_read_b64_tr_b16 v[230:231], v123 offset:25088
ds_read_b128 a[228:231], v108 offset:49152
v_mfma_f32_16x16x32_bf16 v[116:119], v[36:39], v[240:243], v[116:119]
v_mfma_f32_32x32x16_bf16 v[56:71], v[248:251], a[216:219], v[56:71]
ds_read_b64_tr_b16 v[232:233], v122 offset:26624
ds_read_b64_tr_b16 v[234:235], v122 offset:27136
ds_read_b128 a[232:235], v17 offset:49152
ds_read_b64_tr_b16 v[236:237], v123 offset:26624
ds_read_b64_tr_b16 v[238:239], v123 offset:27136
v_mfma_f32_32x32x16_bf16 v[72:87], v[252:255], a[216:219], v[72:87]
ds_read_b128 a[236:239], v109 offset:49152
ds_read_b64_tr_b16 v[240:241], v122 offset:28672
ds_read_b64_tr_b16 v[242:243], v122 offset:29184
ds_read_b128 a[240:243], v18 offset:49152
v_mfma_f32_16x16x32_bf16 v[116:119], v[36:39], v[248:251], v[116:119]
s_waitcnt lgkmcnt(12)
v_mfma_f32_32x32x16_bf16 v[56:71], v[224:227], a[224:227], v[56:71]
ds_read_b64_tr_b16 v[244:245], v123 offset:28672
ds_read_b64_tr_b16 v[246:247], v123 offset:29184
ds_read_b128 a[244:247], v110 offset:49152
ds_read_b64_tr_b16 v[248:249], v122 offset:30720
ds_read_b64_tr_b16 v[250:251], v122 offset:31232
s_waitcnt lgkmcnt(15)
v_mfma_f32_32x32x16_bf16 v[72:87], v[228:231], a[224:227], v[72:87]
ds_read_b128 a[248:251], v19 offset:49152
ds_read_b64_tr_b16 v[252:253], v123 offset:30720
ds_read_b64_tr_b16 v[254:255], v123 offset:31232
ds_read_b128 a[252:255], v111 offset:49152
v_mfma_f32_16x16x32_bf16 v[116:119], v[36:39], v[224:227], v[116:119]
s_waitcnt lgkmcnt(15)
v_mfma_f32_32x32x16_bf16 v[56:71], v[232:235], a[232:235], v[56:71]
s_waitcnt lgkmcnt(13)
v_mfma_f32_32x32x16_bf16 v[72:87], v[236:239], a[232:235], v[72:87]
v_mfma_f32_16x16x32_bf16 v[116:119], v[36:39], v[232:235], v[116:119]
s_waitcnt lgkmcnt(9)
v_mfma_f32_32x32x16_bf16 v[56:71], v[240:243], a[240:243], v[56:71]
s_waitcnt vmcnt(6)
v_cmp_ne_u64 vcc, v[50:51], v[26:27]
s_nop 3
s_cbranch_vccz L_ok_9
s_mov_b32 s62, 4000
L_sp_8:
s_sleep 3
buffer_load_dwordx4 v[48:51], v9, s[20:23], s98 offen sc1
s_waitcnt vmcnt(0)
v_cmp_ne_u64 vcc, v[50:51], v[26:27]
s_sub_u32 s62, s62, 1
s_cbranch_scc1 L_ok_9
s_nop 1
s_cbranch_vccnz L_sp_8
L_ok_9:
s_waitcnt lgkmcnt(7)
v_mfma_f32_32x32x16_bf16 v[72:87], v[244:247], a[240:243], v[72:87]
v_mfma_f32_16x16x32_bf16 v[116:119], v[36:39], v[240:243], v[116:119]
s_lshl_b32 s0, s44, 7
s_waitcnt lgkmcnt(3)
v_mfma_f32_32x32x16_bf16 v[56:71], v[248:251], a[248:251], v[56:71]
v_add_u32 v10, s0, v54
s_waitcnt vmcnt(0)
ds_write_b32 v10, v48 offset:0
ds_write_b32 v10, v49 offset:512
s_lshl_b32 s0, s91, 7
s_waitcnt lgkmcnt(3)
v_mfma_f32_32x32x16_bf16 v[72:87], v[252:255], a[248:251], v[72:87]
v_add_u32 v10, s0, v54
v_bfe_u32 v11, v0, 1, 3
v_xor_b32 v11, v11, v3
v_lshlrev_b32 v11, 4, v11
v_lshl_add_u32 v11, v4, 7, v11
v_add_u32 v16, s59, v11
v_mfma_f32_16x16x32_bf16 v[116:119], v[36:39], v[248:251], v[116:119]
v_xor_b32 v17, 64, v16
v_add_u32 v124, 0x10000, v16
v_add_u32 v125, 0x10000, v17
v_subrev_u32 v110, 98304, v34
v_subrev_u32 v111, 98304, v35
s_nop 2
v_cndmask_b32 v7, v116, v117, s[66:67]
ds_write_b32 v10, v7 offset:1024
s_waitcnt lgkmcnt(0)
s_barrier
s_cmp_lt_u32 s46, 8
s_cbranch_scc0 L_notP
s_add_u32 m0, s57, 114688
s_mul_i32 s87, s94, s52
buffer_load_dwordx4 v40, s[12:15], s87 offen lds
buffer_load_dwordx4 v41, s[12:15], s87 offen offset:1024 lds
buffer_load_dwordx4 v42, s[12:15], s87 offen offset:2048 lds
buffer_load_dwordx4 v43, s[12:15], s87 offen offset:3072 lds
s_add_u32 s94, s94, 128
s_and_b32 s94, s94, 1023
s_lshl_b32 s53, s91, 7
v_lshrrev_b32 v5, 5, v0
v_lshlrev_b32 v5, 4, v5
v_add_u32 v5, s53, v5
v_add_u32 v5, 160768, v5
ds_read_b128 v[192:195], v5 offset:0
ds_read_b128 v[196:199], v5 offset:32
ds_read_b128 v[200:203], v5 offset:64
ds_read_b128 v[204:207], v5 offset:96
v_mov_b32 v112, 0
v_mov_b32 v113, 0
v_mov_b32 v114, 0
v_mov_b32 v115, 0
s_or_b32 s53, s91, s46
s_cmp_eq_u32 s53, 0
s_cselect_b32 s68, 0, -1
s_xor_b32 s54, s91, 1
s_or_b32 s53, s54, s46
s_cmp_eq_u32 s53, 0
s_cselect_b32 s69, 0, -1
s_lshl_b32 s54, s54, 7
s_mul_i32 s95, s96, 6144
s_add_u32 s95, s95, 12320768
s_lshl_b32 s53, s46, 9
s_add_u32 s63, s95, s53
s_waitcnt lgkmcnt(3)
v_pk_mul_f32 v[208:209], v[192:193], v[48:49] op_sel:[0,1] op_sel_hi:[1,1]
v_pk_mul_f32 v[210:211], v[194:195], v[48:49] op_sel:[0,1] op_sel_hi:[1,1]
s_waitcnt lgkmcnt(2)
v_pk_mul_f32 v[212:213], v[196:197], v[48:49] op_sel:[0,1] op_sel_hi:[1,1]
v_pk_mul_f32 v[214:215], v[198:199], v[48:49] op_sel:[0,1] op_sel_hi:[1,1]
v_pk_fma_f32 v[208:209], v[56:57], v[48:49], v[208:209] op_sel:[0,0,0] op_sel_hi:[1,0,1]
v_pk_fma_f32 v[210:211], v[58:59], v[48:49], v[210:211] op_sel:[0,0,0] op_sel_hi:[1,0,1]
v_pk_fma_f32 v[212:213], v[60:61], v[48:49], v[212:213] op_sel:[0,0,0] op_sel_hi:[1,0,1]
v_pk_fma_f32 v[214:215], v[62:63], v[48:49], v[214:215] op_sel:[0,0,0] op_sel_hi:[1,0,1]
v_pk_mul_f32 v[216:217], v[208:209], v[208:209]
v_pk_mul_f32 v[218:219], v[210:211], v[210:211]
v_pk_mul_f32 v[220:221], v[212:213], v[212:213]
v_pk_mul_f32 v[222:223], v[214:215], v[214:215]
v_pk_fma_f32 v[216:217], v[216:217], v[52:53], v[52:53] op_sel:[0,0,1] op_sel_hi:[1,0,1]
v_pk_fma_f32 v[218:219], v[218:219], v[52:53], v[52:53] op_sel:[0,0,1] op_sel_hi:[1,0,1]
v_pk_fma_f32 v[220:221], v[220:221], v[52:53], v[52:53] op_sel:[0,0,1] op_sel_hi:[1,0,1]
v_pk_fma_f32 v[222:223], v[222:223], v[52:53], v[52:53] op_sel:[0,0,1] op_sel_hi:[1,0,1]
v_pk_mul_f32 v[216:217], v[216:217], v[208:209]
v_pk_mul_f32 v[218:219], v[218:219], v[210:211]
v_pk_mul_f32 v[220:221], v[220:221], v[212:213]
v_pk_mul_f32 v[222:223], v[222:223], v[214:215]
v_exp_f32 v216, v216
v_exp_f32 v217, v217
v_exp_f32 v218, v218
v_exp_f32 v219, v219
v_exp_f32 v220, v220
v_exp_f32 v221, v221
v_exp_f32 v222, v222
v_exp_f32 v223, v223
v_pk_add_f32 v[216:217], v[216:217], 1.0 op_sel_hi:[1,0]
v_pk_add_f32 v[218:219], v[218:219], 1.0 op_sel_hi:[1,0]
v_pk_add_f32 v[220:221], v[220:221], 1.0 op_sel_hi:[1,0]
v_pk_add_f32 v[222:223], v[222:223], 1.0 op_sel_hi:[1,0]
v_rcp_f32 v216, v216
v_rcp_f32 v217, v217
v_rcp_f32 v218, v218
v_rcp_f32 v219, v219
v_rcp_f32 v220, v220
v_rcp_f32 v221, v221
v_rcp_f32 v222, v222
v_rcp_f32 v223, v223
v_pk_mul_f32 v[208:209], v[208:209], v[216:217]
v_pk_mul_f32 v[210:211], v[210:211], v[218:219]
v_pk_mul_f32 v[212:213], v[212:213], v[220:221]
v_pk_mul_f32 v[214:215], v[214:215], v[222:223]
v_cvt_pk_bf16_f32 v88, v208, v209
v_cvt_pk_bf16_f32 v89, v210, v211
v_cvt_pk_bf16_f32 v90, v212, v213
v_cvt_pk_bf16_f32 v91, v214, v215
s_waitcnt lgkmcnt(1)
v_pk_mul_f32 v[208:209], v[200:201], v[48:49] op_sel:[0,1] op_sel_hi:[1,1]
v_pk_mul_f32 v[210:211], v[202:203], v[48:49] op_sel:[0,1] op_sel_hi:[1,1]
s_waitcnt lgkmcnt(0)
v_pk_mul_f32 v[212:213], v[204:205], v[48:49] op_sel:[0,1] op_sel_hi:[1,1]
v_pk_mul_f32 v[214:215], v[206:207], v[48:49] op_sel:[0,1] op_sel_hi:[1,1]
v_pk_fma_f32 v[208:209], v[64:65], v[48:49], v[208:209] op_sel:[0,0,0] op_sel_hi:[1,0,1]
v_pk_fma_f32 v[210:211], v[66:67], v[48:49], v[210:211] op_sel:[0,0,0] op_sel_hi:[1,0,1]
v_pk_fma_f32 v[212:213], v[68:69], v[48:49], v[212:213] op_sel:[0,0,0] op_sel_hi:[1,0,1]
v_pk_fma_f32 v[214:215], v[70:71], v[48:49], v[214:215] op_sel:[0,0,0] op_sel_hi:[1,0,1]
v_pk_mul_f32 v[216:217], v[208:209], v[208:209]
v_pk_mul_f32 v[218:219], v[210:211], v[210:211]
v_pk_mul_f32 v[220:221], v[212:213], v[212:213]
v_pk_mul_f32 v[222:223], v[214:215], v[214:215]
v_pk_fma_f32 v[216:217], v[216:217], v[52:53], v[52:53] op_sel:[0,0,1] op_sel_hi:[1,0,1]
v_pk_fma_f32 v[218:219], v[218:219], v[52:53], v[52:53] op_sel:[0,0,1] op_sel_hi:[1,0,1]
v_pk_fma_f32 v[220:221], v[220:221], v[52:53], v[52:53] op_sel:[0,0,1] op_sel_hi:[1,0,1]
v_pk_fma_f32 v[222:223], v[222:223], v[52:53], v[52:53] op_sel:[0,0,1] op_sel_hi:[1,0,1]
v_pk_mul_f32 v[216:217], v[216:217], v[208:209]
v_pk_mul_f32 v[218:219], v[218:219], v[210:211]
v_pk_mul_f32 v[220:221], v[220:221], v[212:213]
v_pk_mul_f32 v[222:223], v[222:223], v[214:215]
v_exp_f32 v216, v216
v_exp_f32 v217, v217
v_exp_f32 v218, v218
v_exp_f32 v219, v219
v_exp_f32 v220, v220
v_exp_f32 v221, v221
v_exp_f32 v222, v222
v_exp_f32 v223, v223
v_pk_add_f32 v[216:217], v[216:217], 1.0 op_sel_hi:[1,0]
v_pk_add_f32 v[218:219], v[218:219], 1.0 op_sel_hi:[1,0]
v_pk_add_f32 v[220:221], v[220:221], 1.0 op_sel_hi:[1,0]
v_pk_add_f32 v[222:223], v[222:223], 1.0 op_sel_hi:[1,0]
v_rcp_f32 v216, v216
v_rcp_f32 v217, v217
v_rcp_f32 v218, v218
v_rcp_f32 v219, v219
v_rcp_f32 v220, v220
v_rcp_f32 v221, v221
v_rcp_f32 v222, v222
v_rcp_f32 v223, v223
v_pk_mul_f32 v[208:209], v[208:209], v[216:217]
v_pk_mul_f32 v[210:211], v[210:211], v[218:219]
v_pk_mul_f32 v[212:213], v[212:213], v[220:221]
v_pk_mul_f32 v[214:215], v[214:215], v[222:223]
v_cvt_pk_bf16_f32 v92, v208, v209
v_cvt_pk_bf16_f32 v93, v210, v211
v_cvt_pk_bf16_f32 v94, v212, v213
v_cvt_pk_bf16_f32 v95, v214, v215
v_lshrrev_b32 v5, 5, v0
v_lshlrev_b32 v5, 4, v5
v_add_u32 v5, s54, v5
v_add_u32 v5, 160768, v5
ds_read_b128 v[192:195], v5 offset:0
ds_read_b128 v[196:199], v5 offset:32
ds_read_b128 v[200:203], v5 offset:64
ds_read_b128 v[204:207], v5 offset:96
v_and_b32 v88, s68, v88
v_and_b32 v89, s68, v89
v_and_b32 v90, s68, v90
v_and_b32 v91, s68, v91
v_dot2_f32_bf16 v112, v88, s60, v112
v_dot2_f32_bf16 v113, v88, v88, v113
v_dot2_f32_bf16 v114, v89, s60, v114
v_dot2_f32_bf16 v115, v89, v89, v115
v_dot2_f32_bf16 v112, v90, s60, v112
v_dot2_f32_bf16 v113, v90, v90, v113
v_dot2_f32_bf16 v114, v91, s60, v114
v_dot2_f32_bf16 v115, v91, v91, v115
v_dot2_f32_bf16 v112, v92, s60, v112
v_dot2_f32_bf16 v113, v92, v92, v113
v_dot2_f32_bf16 v114, v93, s60, v114
v_dot2_f32_bf16 v115, v93, v93, v115
v_dot2_f32_bf16 v112, v94, s60, v112
v_dot2_f32_bf16 v113, v94, v94, v113
v_dot2_f32_bf16 v114, v95, s60, v114
v_dot2_f32_bf16 v115, v95, v95, v115
s_waitcnt lgkmcnt(3)
v_pk_mul_f32 v[208:209], v[192:193], v[48:49] op_sel:[0,1] op_sel_hi:[1,1]
v_pk_mul_f32 v[210:211], v[194:195], v[48:49] op_sel:[0,1] op_sel_hi:[1,1]
s_waitcnt lgkmcnt(2)
v_pk_mul_f32 v[212:213], v[196:197], v[48:49] op_sel:[0,1] op_sel_hi:[1,1]
v_pk_mul_f32 v[214:215], v[198:199], v[48:49] op_sel:[0,1] op_sel_hi:[1,1]
v_pk_fma_f32 v[208:209], v[72:73], v[48:49], v[208:209] op_sel:[0,0,0] op_sel_hi:[1,0,1]
v_pk_fma_f32 v[210:211], v[74:75], v[48:49], v[210:211] op_sel:[0,0,0] op_sel_hi:[1,0,1]
v_pk_fma_f32 v[212:213], v[76:77], v[48:49], v[212:213] op_sel:[0,0,0] op_sel_hi:[1,0,1]
v_pk_fma_f32 v[214:215], v[78:79], v[48:49], v[214:215] op_sel:[0,0,0] op_sel_hi:[1,0,1]
v_pk_mul_f32 v[216:217], v[208:209], v[208:209]
v_pk_mul_f32 v[218:219], v[210:211], v[210:211]
v_pk_mul_f32 v[220:221], v[212:213], v[212:213]
v_pk_mul_f32 v[222:223], v[214:215], v[214:215]
v_pk_fma_f32 v[216:217], v[216:217], v[52:53], v[52:53] op_sel:[0,0,1] op_sel_hi:[1,0,1]
v_pk_fma_f32 v[218:219], v[218:219], v[52:53], v[52:53] op_sel:[0,0,1] op_sel_hi:[1,0,1]
v_pk_fma_f32 v[220:221], v[220:221], v[52:53], v[52:53] op_sel:[0,0,1] op_sel_hi:[1,0,1]
v_pk_fma_f32 v[222:223], v[222:223], v[52:53], v[52:53] op_sel:[0,0,1] op_sel_hi:[1,0,1]
v_pk_mul_f32 v[216:217], v[216:217], v[208:209]
v_pk_mul_f32 v[218:219], v[218:219], v[210:211]
v_pk_mul_f32 v[220:221], v[220:221], v[212:213]
v_pk_mul_f32 v[222:223], v[222:223], v[214:215]
v_exp_f32 v216, v216
v_exp_f32 v217, v217
v_exp_f32 v218, v218
v_exp_f32 v219, v219
v_exp_f32 v220, v220
v_exp_f32 v221, v221
v_exp_f32 v222, v222
v_exp_f32 v223, v223
v_pk_add_f32 v[216:217], v[216:217], 1.0 op_sel_hi:[1,0]
v_pk_add_f32 v[218:219], v[218:219], 1.0 op_sel_hi:[1,0]
v_pk_add_f32 v[220:221], v[220:221], 1.0 op_sel_hi:[1,0]
v_pk_add_f32 v[222:223], v[222:223], 1.0 op_sel_hi:[1,0]
v_rcp_f32 v216, v216
v_rcp_f32 v217, v217
v_rcp_f32 v218, v218
v_rcp_f32 v219, v219
v_rcp_f32 v220, v220
v_rcp_f32 v221, v221
v_rcp_f32 v222, v222
v_rcp_f32 v223, v223
v_pk_mul_f32 v[208:209], v[208:209], v[216:217]
v_pk_mul_f32 v[210:211], v[210:211], v[218:219]
v_pk_mul_f32 v[212:213], v[212:213], v[220:221]
v_pk_mul_f32 v[214:215], v[214:215], v[222:223]
v_cvt_pk_bf16_f32 v96, v208, v209
v_cvt_pk_bf16_f32 v97, v210, v211
v_cvt_pk_bf16_f32 v98, v212, v213
v_cvt_pk_bf16_f32 v99, v214, v215
s_waitcnt lgkmcnt(1)
v_pk_mul_f32 v[208:209], v[200:201], v[48:49] op_sel:[0,1] op_sel_hi:[1,1]
v_pk_mul_f32 v[210:211], v[202:203], v[48:49] op_sel:[0,1] op_sel_hi:[1,1]
s_waitcnt lgkmcnt(0)
v_pk_mul_f32 v[212:213], v[204:205], v[48:49] op_sel:[0,1] op_sel_hi:[1,1]
v_pk_mul_f32 v[214:215], v[206:207], v[48:49] op_sel:[0,1] op_sel_hi:[1,1]
v_pk_fma_f32 v[208:209], v[80:81], v[48:49], v[208:209] op_sel:[0,0,0] op_sel_hi:[1,0,1]
v_pk_fma_f32 v[210:211], v[82:83], v[48:49], v[210:211] op_sel:[0,0,0] op_sel_hi:[1,0,1]
v_pk_fma_f32 v[212:213], v[84:85], v[48:49], v[212:213] op_sel:[0,0,0] op_sel_hi:[1,0,1]
v_pk_fma_f32 v[214:215], v[86:87], v[48:49], v[214:215] op_sel:[0,0,0] op_sel_hi:[1,0,1]
v_pk_mul_f32 v[216:217], v[208:209], v[208:209]
v_pk_mul_f32 v[218:219], v[210:211], v[210:211]
v_pk_mul_f32 v[220:221], v[212:213], v[212:213]
v_pk_mul_f32 v[222:223], v[214:215], v[214:215]
v_pk_fma_f32 v[216:217], v[216:217], v[52:53], v[52:53] op_sel:[0,0,1] op_sel_hi:[1,0,1]
v_pk_fma_f32 v[218:219], v[218:219], v[52:53], v[52:53] op_sel:[0,0,1] op_sel_hi:[1,0,1]
v_pk_fma_f32 v[220:221], v[220:221], v[52:53], v[52:53] op_sel:[0,0,1] op_sel_hi:[1,0,1]
v_pk_fma_f32 v[222:223], v[222:223], v[52:53], v[52:53] op_sel:[0,0,1] op_sel_hi:[1,0,1]
v_pk_mul_f32 v[216:217], v[216:217], v[208:209]
v_pk_mul_f32 v[218:219], v[218:219], v[210:211]
v_pk_mul_f32 v[220:221], v[220:221], v[212:213]
v_pk_mul_f32 v[222:223], v[222:223], v[214:215]
v_exp_f32 v216, v216
v_exp_f32 v217, v217
v_exp_f32 v218, v218
v_exp_f32 v219, v219
v_exp_f32 v220, v220
v_exp_f32 v221, v221
v_exp_f32 v222, v222
v_exp_f32 v223, v223
v_pk_add_f32 v[216:217], v[216:217], 1.0 op_sel_hi:[1,0]
v_pk_add_f32 v[218:219], v[218:219], 1.0 op_sel_hi:[1,0]
v_pk_add_f32 v[220:221], v[220:221], 1.0 op_sel_hi:[1,0]
v_pk_add_f32 v[222:223], v[222:223], 1.0 op_sel_hi:[1,0]
v_rcp_f32 v216, v216
v_rcp_f32 v217, v217
v_rcp_f32 v218, v218
v_rcp_f32 v219, v219
v_rcp_f32 v220, v220
v_rcp_f32 v221, v221
v_rcp_f32 v222, v222
v_rcp_f32 v223, v223
v_pk_mul_f32 v[208:209], v[208:209], v[216:217]
v_pk_mul_f32 v[210:211], v[210:211], v[218:219]
v_pk_mul_f32 v[212:213], v[212:213], v[220:221]
v_pk_mul_f32 v[214:215], v[214:215], v[222:223]
v_cvt_pk_bf16_f32 v100, v208, v209
v_cvt_pk_bf16_f32 v101, v210, v211
v_cvt_pk_bf16_f32 v102, v212, v213
v_cvt_pk_bf16_f32 v103, v214, v215
v_and_b32 v96, s69, v96
v_and_b32 v97, s69, v97
v_and_b32 v98, s69, v98
v_and_b32 v99, s69, v99
v_dot2_f32_bf16 v112, v96, s60, v112
v_dot2_f32_bf16 v113, v96, v96, v113
v_dot2_f32_bf16 v114, v97, s60, v114
v_dot2_f32_bf16 v115, v97, v97, v115
v_dot2_f32_bf16 v112, v98, s60, v112
v_dot2_f32_bf16 v113, v98, v98, v113
v_dot2_f32_bf16 v114, v99, s60, v114
v_dot2_f32_bf16 v115, v99, v99, v115
v_dot2_f32_bf16 v112, v100, s60, v112
v_dot2_f32_bf16 v113, v100, v100, v113
v_dot2_f32_bf16 v114, v101, s60, v114
v_dot2_f32_bf16 v115, v101, v101, v115
v_dot2_f32_bf16 v112, v102, s60, v112
v_dot2_f32_bf16 v113, v102, v102, v113
v_dot2_f32_bf16 v114, v103, s60, v114
v_dot2_f32_bf16 v115, v103, v103, v115
s_nop 1
v_add_f32 v112, v112, v114
v_add_f32 v113, v113, v115
v_mov_b32 v114, v112
v_mov_b32 v115, v113
s_nop 0
v_permlane32_swap_b32 v112, v114
v_permlane32_swap_b32 v113, v115
v_add_f32 v112, v112, v114
v_add_f32 v113, v113, v115
v_mov_b32 v114, v26
v_mov_b32 v115, v27
s_mov_b32 exec_hi, 0
buffer_store_dwordx4 v[112:115], v32, s[20:23], s63 offen sc1
s_mov_b64 exec, -1
s_barrier
ds_read_b64_tr_b16 v[224:225], v34 offset:0
ds_read_b64_tr_b16 v[226:227], v34 offset:1024
ds_read_b64_tr_b16 v[228:229], v35 offset:0
ds_read_b64_tr_b16 v[230:231], v35 offset:1024
ds_read_b64_tr_b16 v[232:233], v34 offset:4096
ds_read_b64_tr_b16 v[234:235], v34 offset:5120
ds_read_b64_tr_b16 v[236:237], v35 offset:4096
ds_read_b64_tr_b16 v[238:239], v35 offset:5120
s_waitcnt lgkmcnt(6)
v_mfma_f32_32x32x16_bf16 v[128:143], a[0:3], v[224:227], 0
ds_read_b64_tr_b16 v[240:241], v34 offset:8192
ds_read_b64_tr_b16 v[242:243], v34 offset:9216
s_add_u32 m0, s57, 131072
v_and_b32 v11, 31, v0
s_mul_i32 s87, s94, s52
v_mul_u32_u24 v11, 72, v11
v_lshrrev_b32 v10, 5, v0
v_lshl_add_u32 v11, v10, 3, v11
v_mfma_f32_32x32x16_bf16 v[160:175], a[4:7], v[224:227], 0
ds_read_b64_tr_b16 v[244:245], v35 offset:8192
ds_read_b64_tr_b16 v[246:247], v35 offset:9216
buffer_load_dwordx4 v40, s[12:15], s87 offen lds
s_mul_i32 s3, s44, 2304
s_add_u32 s3, s3, 147456
s_waitcnt lgkmcnt(8)
v_mfma_f32_32x32x16_bf16 v[144:159], a[0:3], v[228:231], 0
ds_read_b64_tr_b16 v[248:249], v34 offset:12288
ds_read_b64_tr_b16 v[250:251], v34 offset:13312
v_add_u32 v11, s3, v11
v_bfe_u32 v9, v0, 2, 2
v_lshl_add_u32 v9, v3, 3, v9
v_mul_u32_u24 v9, 72, v9
v_and_b32 v10, 3, v0
v_lshl_add_u32 v9, v10, 3, v9
v_mfma_f32_32x32x16_bf16 v[176:191], a[4:7], v[228:231], 0
ds_read_b64_tr_b16 v[252:253], v35 offset:12288
ds_read_b64_tr_b16 v[254:255], v35 offset:13312
buffer_load_dwordx4 v41, s[12:15], s87 offen offset:1024 lds
v_add_u32 v9, s3, v9
s_lshr_b32 s0, s96, 1
v_mfma_f32_16x16x32_bf16 v[44:47], v[36:39], v[224:227], 0
s_mul_i32 s0, s0, 22
s_lshl_b32 s1, s46, 1
s_waitcnt lgkmcnt(10)
v_mfma_f32_32x32x16_bf16 v[128:143], a[8:11], v[232:235], v[128:143]
s_add_u32 s0, s0, s1
s_lshl_b32 s0, s0, 12
s_lshl_b32 s1, s91, 10
buffer_load_dwordx4 v42, s[12:15], s87 offen offset:2048 lds
s_add_u32 s0, s0, s1
v_mfma_f32_32x32x16_bf16 v[160:175], a[12:15], v[232:235], v[160:175]
s_add_u32 s0, s0, 262144
s_lshl_b32 s1, s91, 12
s_add_u32 s0, s0, s1
s_xor_b32 s1, s0, 4096
s_lshl_b32 s86, s45, 4
s_add_u32 s86, s86, s46
s_lshl_b32 s86, s86, 2
s_add_u32 s86, s86, s44
s_waitcnt lgkmcnt(8)
v_mfma_f32_32x32x16_bf16 v[144:159], a[8:11], v[236:239], v[144:159]
buffer_load_dwordx4 v43, s[12:15], s87 offen offset:3072 lds
s_lshl_b32 s86, s86, 7
s_add_u32 s86, s86, 65536
s_add_u32 s94, s94, 128
v_mfma_f32_32x32x16_bf16 v[176:191], a[12:15], v[236:239], v[176:191]
s_and_b32 s94, s94, 1023
s_add_u32 m0, s57, 0
s_mul_i32 s87, s94, s52
buffer_load_dwordx4 v40, s[12:15], s87 offen lds
v_mfma_f32_16x16x32_bf16 v[44:47], v[36:39], v[232:235], v[44:47]
buffer_load_dwordx4 v41, s[12:15], s87 offen offset:1024 lds
s_waitcnt vmcnt(7)
s_waitcnt lgkmcnt(0)
s_barrier
v_mfma_f32_32x32x16_bf16 v[128:143], a[16:19], v[240:243], v[128:143]
ds_read_b64_tr_b16 v[224:225], v34 offset:16384
buffer_load_dwordx4 v42, s[12:15], s87 offen offset:2048 lds
v_mfma_f32_32x32x16_bf16 v[160:175], a[20:23], v[240:243], v[160:175]
ds_read_b64_tr_b16 v[226:227], v34 offset:17408
buffer_load_dwordx4 v43, s[12:15], s87 offen offset:3072 lds
s_add_u32 s94, s94, 128
s_and_b32 s94, s94, 1023
s_add_u32 m0, s57, 16384
v_mfma_f32_32x32x16_bf16 v[144:159], a[16:19], v[244:247], v[144:159]
ds_read_b64_tr_b16 v[228:229], v35 offset:16384
s_mul_i32 s87, s94, s52
buffer_load_dwordx4 v40, s[12:15], s87 offen lds
v_mfma_f32_32x32x16_bf16 v[176:191], a[20:23], v[244:247], v[176:191]
ds_read_b64_tr_b16 v[230:231], v35 offset:17408
buffer_load_dwordx4 v41, s[12:15], s87 offen offset:1024 lds
buffer_load_dwordx4 v42, s[12:15], s87 offen offset:2048 lds
v_mfma_f32_16x16x32_bf16 v[44:47], v[36:39], v[240:243], v[44:47]
v_mfma_f32_32x32x16_bf16 v[128:143], a[24:27], v[248:251], v[128:143]
ds_read_b64_tr_b16 v[232:233], v34 offset:20480
buffer_load_dwordx4 v43, s[12:15], s87 offen offset:3072 lds
s_add_u32 s94, s94, 128
s_and_b32 s94, s94, 1023
s_add_u32 m0, s57, 32768
v_mfma_f32_32x32x16_bf16 v[160:175], a[28:31], v[248:251], v[160:175]
ds_read_b64_tr_b16 v[234:235], v34 offset:21504
s_mul_i32 s87, s94, s52
buffer_load_dwordx4 v40, s[12:15], s87 offen lds
v_mfma_f32_32x32x16_bf16 v[144:159], a[24:27], v[252:255], v[144:159]
ds_read_b64_tr_b16 v[236:237], v35 offset:20480
buffer_load_dwordx4 v41, s[12:15], s87 offen offset:1024 lds
buffer_load_dwordx4 v42, s[12:15], s87 offen offset:2048 lds
v_mfma_f32_32x32x16_bf16 v[176:191], a[28:31], v[252:255], v[176:191]
ds_read_b64_tr_b16 v[238:239], v35 offset:21504
buffer_load_dwordx4 v43, s[12:15], s87 offen offset:3072 lds
s_add_u32 s94, s94, 128
s_and_b32 s94, s94, 1023
v_mfma_f32_16x16x32_bf16 v[44:47], v[36:39], v[248:251], v[44:47]
s_add_u32 m0, s57, 49152
s_mul_i32 s87, s94, s52
s_waitcnt lgkmcnt(6)
v_mfma_f32_32x32x16_bf16 v[128:143], a[32:35], v[224:227], v[128:143]
ds_read_b64_tr_b16 v[240:241], v34 offset:24576
ds_read_b64_tr_b16 v[242:243], v34 offset:25600
buffer_load_dwordx4 v40, s[12:15], s87 offen lds
v_mfma_f32_32x32x16_bf16 v[160:175], a[36:39], v[224:227], v[160:175]
ds_read_b64_tr_b16 v[244:245], v35 offset:24576
ds_read_b64_tr_b16 v[246:247], v35 offset:25600
buffer_load_dwordx4 v41, s[12:15], s87 offen offset:1024 lds
s_waitcnt lgkmcnt(8)
v_mfma_f32_32x32x16_bf16 v[144:159], a[32:35], v[228:231], v[144:159]
ds_read_b64_tr_b16 v[248:249], v34 offset:28672
ds_read_b64_tr_b16 v[250:251], v34 offset:29696
buffer_load_dwordx4 v42, s[12:15], s87 offen offset:2048 lds
v_mfma_f32_32x32x16_bf16 v[176:191], a[36:39], v[228:231], v[176:191]
ds_read_b64_tr_b16 v[252:253], v35 offset:28672
ds_read_b64_tr_b16 v[254:255], v35 offset:29696
buffer_load_dwordx4 v43, s[12:15], s87 offen offset:3072 lds
s_add_u32 s94, s94, 128
s_and_b32 s94, s94, 1023
v_mfma_f32_16x16x32_bf16 v[44:47], v[36:39], v[224:227], v[44:47]
s_waitcnt lgkmcnt(10)
v_mfma_f32_32x32x16_bf16 v[128:143], a[40:43], v[232:235], v[128:143]
v_mfma_f32_32x32x16_bf16 v[160:175], a[44:47], v[232:235], v[160:175]
s_waitcnt lgkmcnt(8)
v_mfma_f32_32x32x16_bf16 v[144:159], a[40:43], v[236:239], v[144:159]
v_mfma_f32_32x32x16_bf16 v[176:191], a[44:47], v[236:239], v[176:191]
v_mfma_f32_16x16x32_bf16 v[44:47], v[36:39], v[232:235], v[44:47]
s_waitcnt vmcnt(16)
s_waitcnt lgkmcnt(0)
s_barrier
v_mfma_f32_32x32x16_bf16 v[128:143], a[48:51], v[240:243], v[128:143]
ds_read_b64_tr_b16 v[224:225], v34 offset:32768
v_mfma_f32_32x32x16_bf16 v[160:175], a[52:55], v[240:243], v[160:175]
ds_read_b64_tr_b16 v[226:227], v34 offset:33792
v_mfma_f32_32x32x16_bf16 v[144:159], a[48:51], v[244:247], v[144:159]
ds_read_b64_tr_b16 v[228:229], v35 offset:32768
v_mfma_f32_32x32x16_bf16 v[176:191], a[52:55], v[244:247], v[176:191]
ds_read_b64_tr_b16 v[230:231], v35 offset:33792
v_mfma_f32_16x16x32_bf16 v[44:47], v[36:39], v[240:243], v[44:47]
v_mfma_f32_32x32x16_bf16 v[128:143], a[56:59], v[248:251], v[128:143]
ds_read_b64_tr_b16 v[232:233], v34 offset:36864
v_mov_b32 v76, 0
v_mov_b32 v77, 0
v_mov_b32 v78, v26
v_mov_b32 v79, v27
s_add_u32 s97, s95, 4096
v_mfma_f32_32x32x16_bf16 v[160:175], a[60:63], v[248:251], v[160:175]
ds_read_b64_tr_b16 v[234:235], v34 offset:37888
buffer_load_dwordx4 v[56:59], v32, s[20:23], s95 offen offset:0 sc1
buffer_load_dwordx4 v[60:63], v32, s[20:23], s95 offen offset:1024 sc1
v_mfma_f32_32x32x16_bf16 v[144:159], a[56:59], v[252:255], v[144:159]
ds_read_b64_tr_b16 v[236:237], v35 offset:36864
buffer_load_dwordx4 v[64:67], v32, s[20:23], s95 offen offset:2048 sc1
v_mfma_f32_32x32x16_bf16 v[176:191], a[60:63], v[252:255], v[176:191]
ds_read_b64_tr_b16 v[238:239], v35 offset:37888
buffer_load_dwordx4 v[68:71], v32, s[20:23], s95 offen offset:3072 sc1
buffer_load_dwordx4 v[72:75], v32, s[20:23], s97 offen offset:0 sc1
v_mfma_f32_16x16x32_bf16 v[44:47], v[36:39], v[248:251], v[44:47]
s_waitcnt lgkmcnt(6)
v_mfma_f32_32x32x16_bf16 v[128:143], a[64:67], v[224:227], v[128:143]
ds_read_b64_tr_b16 v[240:241], v34 offset:40960
ds_read_b64_tr_b16 v[242:243], v34 offset:41984
s_mov_b32 exec_hi, 0
buffer_load_dwordx4 v[76:79], v32, s[20:23], s97 offen offset:1024 sc1
s_mov_b64 exec, -1
v_mfma_f32_32x32x16_bf16 v[160:175], a[68:71], v[224:227], v[160:175]
ds_read_b64_tr_b16 v[244:245], v35 offset:40960
ds_read_b64_tr_b16 v[246:247], v35 offset:41984
s_waitcnt lgkmcnt(8)
v_mfma_f32_32x32x16_bf16 v[144:159], a[64:67], v[228:231], v[144:159]
ds_read_b64_tr_b16 v[248:249], v34 offset:45056
ds_read_b64_tr_b16 v[250:251], v34 offset:46080
v_mfma_f32_32x32x16_bf16 v[176:191], a[68:71], v[228:231], v[176:191]
ds_read_b64_tr_b16 v[252:253], v35 offset:45056
ds_read_b64_tr_b16 v[254:255], v35 offset:46080
v_mfma_f32_16x16x32_bf16 v[44:47], v[36:39], v[224:227], v[44:47]
s_waitcnt lgkmcnt(10)
v_mfma_f32_32x32x16_bf16 v[128:143], a[72:75], v[232:235], v[128:143]
v_mfma_f32_32x32x16_bf16 v[160:175], a[76:79], v[232:235], v[160:175]
s_waitcnt lgkmcnt(8)
v_mfma_f32_32x32x16_bf16 v[144:159], a[72:75], v[236:239], v[144:159]
v_mfma_f32_32x32x16_bf16 v[176:191], a[76:79], v[236:239], v[176:191]
v_mfma_f32_16x16x32_bf16 v[44:47], v[36:39], v[232:235], v[44:47]
s_waitcnt vmcnt(18)
s_waitcnt lgkmcnt(0)
s_barrier
v_mfma_f32_32x32x16_bf16 v[128:143], a[80:83], v[240:243], v[128:143]
ds_read_b64_tr_b16 v[224:225], v110 offset:0
s_add_u32 m0, s57, 131072
s_mul_i32 s87, s94, s52
buffer_load_dwordx4 v40, s[12:15], s87 offen lds
v_mfma_f32_32x32x16_bf16 v[160:175], a[84:87], v[240:243], v[160:175]
ds_read_b64_tr_b16 v[226:227], v110 offset:1024
buffer_load_dwordx4 v41, s[12:15], s87 offen offset:1024 lds
buffer_load_dwordx4 v42, s[12:15], s87 offen offset:2048 lds
v_mfma_f32_32x32x16_bf16 v[144:159], a[80:83], v[244:247], v[144:159]
ds_read_b64_tr_b16 v[228:229], v111 offset:0
buffer_load_dwordx4 v43, s[12:15], s87 offen offset:3072 lds
s_add_u32 s94, s94, 128
s_and_b32 s94, s94, 1023
v_mfma_f32_32x32x16_bf16 v[176:191], a[84:87], v[244:247], v[176:191]
ds_read_b64_tr_b16 v[230:231], v111 offset:1024
v_mfma_f32_16x16x32_bf16 v[44:47], v[36:39], v[240:243], v[44:47]
v_mfma_f32_32x32x16_bf16 v[128:143], a[88:91], v[248:251], v[128:143]
ds_read_b64_tr_b16 v[232:233], v110 offset:4096
s_waitcnt vmcnt(9)
v_xor_b32 v81, v58, v26
v_xor_b32 v82, v59, v27
v_or_b32 v80, v81, v82
s_waitcnt vmcnt(8)
v_xor_b32 v81, v62, v26
v_xor_b32 v82, v63, v27
v_or3_b32 v80, v80, v81, v82
s_waitcnt vmcnt(7)
v_xor_b32 v81, v66, v26
v_xor_b32 v82, v67, v27
v_or3_b32 v80, v80, v81, v82
s_waitcnt vmcnt(6)
v_xor_b32 v81, v70, v26
v_xor_b32 v82, v71, v27
v_or3_b32 v80, v80, v81, v82
s_waitcnt vmcnt(5)
v_xor_b32 v81, v74, v26
v_xor_b32 v82, v75, v27
v_or3_b32 v80, v80, v81, v82
s_waitcnt vmcnt(4)
v_xor_b32 v81, v78, v26
v_xor_b32 v82, v79, v27
v_or3_b32 v80, v80, v81, v82
v_cmp_ne_u32 vcc, 0, v80
s_nop 3
s_cbranch_vccz L_ok_12
s_mov_b32 s62, 4000
L_sp_11:
s_sleep 3
s_add_u32 s97, s95, 4096
buffer_load_dwordx4 v[56:59], v32, s[20:23], s95 offen offset:0 sc1
buffer_load_dwordx4 v[60:63], v32, s[20:23], s95 offen offset:1024 sc1
buffer_load_dwordx4 v[64:67], v32, s[20:23], s95 offen offset:2048 sc1
buffer_load_dwordx4 v[68:71], v32, s[20:23], s95 offen offset:3072 sc1
buffer_load_dwordx4 v[72:75], v32, s[20:23], s97 offen offset:0 sc1
s_mov_b32 exec_hi, 0
buffer_load_dwordx4 v[76:79], v32, s[20:23], s97 offen offset:1024 sc1
s_mov_b64 exec, -1
s_waitcnt vmcnt(0)
v_xor_b32 v81, v58, v26
v_xor_b32 v82, v59, v27
v_or_b32 v80, v81, v82
v_xor_b32 v81, v62, v26
v_xor_b32 v82, v63, v27
v_or3_b32 v80, v80, v81, v82
v_xor_b32 v81, v66, v26
v_xor_b32 v82, v67, v27
v_or3_b32 v80, v80, v81, v82
v_xor_b32 v81, v70, v26
v_xor_b32 v82, v71, v27
v_or3_b32 v80, v80, v81, v82
v_xor_b32 v81, v74, v26
v_xor_b32 v82, v75, v27
v_or3_b32 v80, v80, v81, v82
v_xor_b32 v81, v78, v26
v_xor_b32 v82, v79, v27
v_or3_b32 v80, v80, v81, v82
v_cmp_ne_u32 vcc, 0, v80
s_sub_u32 s62, s62, 1
s_cbranch_scc1 L_ok_12
s_nop 1
s_cbranch_vccnz L_sp_11
L_ok_12:
v_mfma_f32_32x32x16_bf16 v[160:175], a[92:95], v[248:251], v[160:175]
ds_read_b64_tr_b16 v[234:235], v110 offset:5120
v_mfma_f32_32x32x16_bf16 v[144:159], a[88:91], v[252:255], v[144:159]
ds_read_b64_tr_b16 v[236:237], v111 offset:4096
v_mfma_f32_32x32x16_bf16 v[176:191], a[92:95], v[252:255], v[176:191]
ds_read_b64_tr_b16 v[238:239], v111 offset:5120
s_add_u32 m0, s59, 65536
s_add_u32 s87, s61, s64
buffer_load_dwordx4 v20, s[16:19], s87 offen lds
v_mfma_f32_16x16x32_bf16 v[44:47], v[36:39], v[248:251], v[44:47]
s_waitcnt vmcnt(1)
v_add_f32 v56, v56, v60
s_waitcnt lgkmcnt(6)
v_mfma_f32_32x32x16_bf16 v[128:143], a[96:99], v[224:227], v[128:143]
ds_read_b64_tr_b16 v[240:241], v110 offset:8192
ds_read_b64_tr_b16 v[242:243], v110 offset:9216
buffer_load_dwordx4 v21, s[16:19], s87 offen offset:1024 lds
s_add_u32 m0, m0, 2048
s_nop 0
v_mfma_f32_32x32x16_bf16 v[160:175], a[100:103], v[224:227], v[160:175]
ds_read_b64_tr_b16 v[244:245], v111 offset:8192
ds_read_b64_tr_b16 v[246:247], v111 offset:9216
buffer_load_dwordx4 v22, s[16:19], s87 offen lds
v_add_f32 v57, v57, v61
s_waitcnt vmcnt(3)
v_add_f32 v56, v56, v64
s_waitcnt lgkmcnt(8)
v_mfma_f32_32x32x16_bf16 v[144:159], a[96:99], v[228:231], v[144:159]
ds_read_b64_tr_b16 v[248:249], v110 offset:12288
ds_read_b64_tr_b16 v[250:251], v110 offset:13312
buffer_load_dwordx4 v23, s[16:19], s87 offen offset:1024 lds
s_add_u32 m0, s59, 69632
v_mfma_f32_32x32x16_bf16 v[176:191], a[100:103], v[228:231], v[176:191]
ds_read_b64_tr_b16 v[252:253], v111 offset:12288
ds_read_b64_tr_b16 v[254:255], v111 offset:13312
s_add_u32 s87, s61, s65
buffer_load_dwordx4 v20, s[16:19], s87 offen lds
v_add_f32 v57, v57, v65
v_mfma_f32_16x16x32_bf16 v[44:47], v[36:39], v[224:227], v[44:47]
buffer_load_dwordx4 v21, s[16:19], s87 offen offset:1024 lds
s_waitcnt lgkmcnt(10)
v_mfma_f32_32x32x16_bf16 v[128:143], a[104:107], v[232:235], v[128:143]
s_add_u32 m0, m0, 2048
s_nop 0
buffer_load_dwordx4 v22, s[16:19], s87 offen lds
v_mfma_f32_32x32x16_bf16 v[160:175], a[108:111], v[232:235], v[160:175]
buffer_load_dwordx4 v23, s[16:19], s87 offen offset:1024 lds
s_waitcnt vmcnt(8)
v_add_f32 v56, v56, v68
s_add_u32 s61, s61, 128
v_add_f32 v57, v57, v69
s_waitcnt lgkmcnt(8)
v_mfma_f32_32x32x16_bf16 v[144:159], a[104:107], v[236:239], v[144:159]
s_waitcnt vmcnt(8)
v_add_f32 v56, v56, v72
s_and_b32 s61, s61, 1023
v_add_f32 v57, v57, v73
s_waitcnt vmcnt(8)
v_add_f32 v56, v56, v76
v_add_f32 v57, v57, v77
v_mov_b32 v58, v56
v_mov_b32 v59, v57
s_nop 0
v_permlane32_swap_b32 v56, v58
v_mfma_f32_32x32x16_bf16 v[176:191], a[108:111], v[236:239], v[176:191]
v_permlane32_swap_b32 v57, v59
v_add_f32 v56, v56, v58
v_add_f32 v57, v57, v59
v_mul_f32 v56, 0x3abe82fa, v56
v_mul_f32 v58, v56, v56
v_mov_b32 v59, 0x3abe82fa
v_fma_f32 v57, v57, v59, -v58
v_max_f32 v57, 0, v57
v_mfma_f32_16x16x32_bf16 v[44:47], v[36:39], v[232:235], v[44:47]
v_add_f32 v57, 0x3727c5ac, v57
v_rsq_f32 v60, v57
s_waitcnt lgkmcnt(0)
s_barrier
v_mfma_f32_32x32x16_bf16 v[128:143], a[112:115], v[240:243], v[128:143]
ds_read_b64_tr_b16 v[224:225], v110 offset:16384
s_add_u32 m0, s59, 98304
s_add_u32 s87, s61, s64
v_mul_f32_e64 v61, -v56, v60
v_lshlrev_b32 v80, 16, v88
v_and_b32 v81, 0xffff0000, v88
v_lshlrev_b32 v82, 16, v89
v_mfma_f32_32x32x16_bf16 v[160:175], a[116:119], v[240:243], v[160:175]
ds_read_b64_tr_b16 v[226:227], v110 offset:17408
buffer_load_dwordx4 v20, s[16:19], s87 offen lds
v_and_b32 v83, 0xffff0000, v89
v_lshlrev_b32 v84, 16, v90
v_and_b32 v85, 0xffff0000, v90
v_mfma_f32_32x32x16_bf16 v[144:159], a[112:115], v[244:247], v[144:159]
ds_read_b64_tr_b16 v[228:229], v111 offset:16384
v_lshlrev_b32 v86, 16, v91
v_and_b32 v87, 0xffff0000, v91
v_fma_f32 v80, v80, v60, v61
buffer_load_dwordx4 v21, s[16:19], s87 offen offset:1024 lds
v_mfma_f32_32x32x16_bf16 v[176:191], a[116:119], v[244:247], v[176:191]
ds_read_b64_tr_b16 v[230:231], v111 offset:17408
v_fma_f32 v81, v81, v60, v61
v_fma_f32 v82, v82, v60, v61
v_fma_f32 v83, v83, v60, v61
v_fma_f32 v84, v84, v60, v61
v_fma_f32 v85, v85, v60, v61
v_fma_f32 v86, v86, v60, v61
v_fma_f32 v87, v87, v60, v61
v_mfma_f32_16x16x32_bf16 v[44:47], v[36:39], v[240:243], v[44:47]
v_cvt_pk_bf16_f32 v104, v80, v81
s_add_u32 m0, m0, 2048
v_mfma_f32_32x32x16_bf16 v[128:143], a[120:123], v[248:251], v[128:143]
ds_read_b64_tr_b16 v[232:233], v110 offset:20480
v_cvt_pk_bf16_f32 v105, v82, v83
v_cvt_pk_bf16_f32 v106, v84, v85
s_nop 0
v_cvt_pk_bf16_f32 v107, v86, v87
v_and_b32 v104, s68, v104
v_and_b32 v105, s68, v105
v_and_b32 v106, s68, v106
v_mfma_f32_32x32x16_bf16 v[160:175], a[124:127], v[248:251], v[160:175]
ds_read_b64_tr_b16 v[234:235], v110 offset:21504
buffer_load_dwordx4 v22, s[16:19], s87 offen lds
v_and_b32 v107, s68, v107
ds_write_b64 v11, v[104:105] offset:0
v_mfma_f32_32x32x16_bf16 v[144:159], a[120:123], v[252:255], v[144:159]
ds_read_b64_tr_b16 v[236:237], v111 offset:20480
ds_write_b64 v11, v[106:107] offset:16
v_lshlrev_b32 v80, 16, v92
buffer_load_dwordx4 v23, s[16:19], s87 offen offset:1024 lds
v_mfma_f32_32x32x16_bf16 v[176:191], a[124:127], v[252:255], v[176:191]
ds_read_b64_tr_b16 v[238:239], v111 offset:21504
v_and_b32 v81, 0xffff0000, v92
v_lshlrev_b32 v82, 16, v93
v_and_b32 v83, 0xffff0000, v93
v_lshlrev_b32 v84, 16, v94
v_and_b32 v85, 0xffff0000, v94
v_lshlrev_b32 v86, 16, v95
v_mfma_f32_16x16x32_bf16 v[44:47], v[36:39], v[248:251], v[44:47]
v_and_b32 v87, 0xffff0000, v95
v_fma_f32 v80, v80, v60, v61
s_waitcnt lgkmcnt(8)
v_mfma_f32_32x32x16_bf16 v[128:143], a[128:131], v[224:227], v[128:143]
ds_read_b64_tr_b16 v[240:241], v110 offset:24576
ds_read_b64_tr_b16 v[242:243], v110 offset:25600
s_add_u32 m0, s59, 102400
v_fma_f32 v81, v81, v60, v61
s_add_u32 s87, s61, s65
v_fma_f32 v82, v82, v60, v61
v_fma_f32 v83, v83, v60, v61
v_fma_f32 v84, v84, v60, v61
v_mfma_f32_32x32x16_bf16 v[160:175], a[132:135], v[224:227], v[160:175]
ds_read_b64_tr_b16 v[244:245], v111 offset:24576
ds_read_b64_tr_b16 v[246:247], v111 offset:25600
buffer_load_dwordx4 v20, s[16:19], s87 offen lds
v_fma_f32 v85, v85, v60, v61
v_fma_f32 v86, v86, v60, v61
s_waitcnt lgkmcnt(10)
v_mfma_f32_32x32x16_bf16 v[144:159], a[128:131], v[228:231], v[144:159]
ds_read_b64_tr_b16 v[248:249], v110 offset:28672
ds_read_b64_tr_b16 v[250:251], v110 offset:29696
v_fma_f32 v87, v87, v60, v61
v_cvt_pk_bf16_f32 v104, v80, v81
v_cvt_pk_bf16_f32 v105, v82, v83
v_cvt_pk_bf16_f32 v106, v84, v85
v_cvt_pk_bf16_f32 v107, v86, v87
ds_write_b64 v11, v[104:105] offset:32
v_mfma_f32_32x32x16_bf16 v[176:191], a[132:135], v[228:231], v[176:191]
ds_read_b64_tr_b16 v[252:253], v111 offset:28672
ds_read_b64_tr_b16 v[254:255], v111 offset:29696
buffer_load_dwordx4 v21, s[16:19], s87 offen offset:1024 lds
ds_write_b64 v11, v[106:107] offset:48
v_mfma_f32_16x16x32_bf16 v[44:47], v[36:39], v[224:227], v[44:47]
ds_read_b64_tr_b16 v[88:89], v9 offset:0
s_waitcnt lgkmcnt(15)
v_mfma_f32_32x32x16_bf16 v[128:143], a[136:139], v[232:235], v[128:143]
ds_read_b64_tr_b16 v[90:91], v9 offset:288
ds_read_b64_tr_b16 v[92:93], v9 offset:32
ds_read_b64_tr_b16 v[94:95], v9 offset:320
s_add_u32 m0, m0, 2048
v_lshlrev_b32 v80, 16, v96
v_and_b32 v81, 0xffff0000, v96
s_nop 0
v_lshlrev_b32 v82, 16, v97
v_mfma_f32_32x32x16_bf16 v[160:175], a[140:143], v[232:235], v[160:175]
v_and_b32 v83, 0xffff0000, v97
buffer_load_dwordx4 v22, s[16:19], s87 offen lds
v_lshlrev_b32 v84, 16, v98
v_and_b32 v85, 0xffff0000, v98
v_lshlrev_b32 v86, 16, v99
s_waitcnt lgkmcnt(14)
v_mfma_f32_32x32x16_bf16 v[144:159], a[136:139], v[236:239], v[144:159]
v_and_b32 v87, 0xffff0000, v99
v_fma_f32 v80, v80, v60, v61
v_fma_f32 v81, v81, v60, v61
v_fma_f32 v82, v82, v60, v61
v_fma_f32 v83, v83, v60, v61
buffer_load_dwordx4 v23, s[16:19], s87 offen offset:1024 lds
v_mfma_f32_32x32x16_bf16 v[176:191], a[140:143], v[236:239], v[176:191]
v_fma_f32 v84, v84, v60, v61
v_fma_f32 v85, v85, v60, v61
v_fma_f32 v86, v86, v60, v61
v_fma_f32 v87, v87, v60, v61
v_cvt_pk_bf16_f32 v104, v80, v81
v_cvt_pk_bf16_f32 v105, v82, v83
v_mfma_f32_16x16x32_bf16 v[44:47], v[36:39], v[232:235], v[44:47]
v_cvt_pk_bf16_f32 v106, v84, v85
v_cvt_pk_bf16_f32 v107, v86, v87
s_waitcnt lgkmcnt(0)
s_barrier
v_mfma_f32_32x32x16_bf16 v[128:143], a[144:147], v[240:243], v[128:143]
ds_read_b64_tr_b16 v[224:225], v110 offset:32768
s_add_u32 s61, s61, 128
v_and_b32 v104, s69, v104
s_and_b32 s61, s61, 1023
v_and_b32 v105, s69, v105
v_and_b32 v106, s69, v106
v_and_b32 v107, s69, v107
ds_write_b64 v11, v[104:105] offset:0
v_mfma_f32_32x32x16_bf16 v[160:175], a[148:151], v[240:243], v[160:175]
ds_read_b64_tr_b16 v[226:227], v110 offset:33792
ds_write_b64 v11, v[106:107] offset:16
v_lshlrev_b32 v80, 16, v100
v_and_b32 v81, 0xffff0000, v100
v_lshlrev_b32 v82, 16, v101
v_and_b32 v83, 0xffff0000, v101
v_mfma_f32_32x32x16_bf16 v[144:159], a[144:147], v[244:247], v[144:159]
ds_read_b64_tr_b16 v[228:229], v111 offset:32768
v_lshlrev_b32 v84, 16, v102
v_and_b32 v85, 0xffff0000, v102
v_lshlrev_b32 v86, 16, v103
v_and_b32 v87, 0xffff0000, v103
v_fma_f32 v80, v80, v60, v61
v_fma_f32 v81, v81, v60, v61
v_fma_f32 v82, v82, v60, v61
v_mfma_f32_32x32x16_bf16 v[176:191], a[148:151], v[244:247], v[176:191]
ds_read_b64_tr_b16 v[230:231], v111 offset:33792
v_fma_f32 v83, v83, v60, v61
v_fma_f32 v84, v84, v60, v61
v_fma_f32 v85, v85, v60, v61
v_fma_f32 v86, v86, v60, v61
v_fma_f32 v87, v87, v60, v61
v_cvt_pk_bf16_f32 v104, v80, v81
v_cvt_pk_bf16_f32 v105, v82, v83
v_mfma_f32_16x16x32_bf16 v[44:47], v[36:39], v[240:243], v[44:47]
v_cvt_pk_bf16_f32 v106, v84, v85
v_cvt_pk_bf16_f32 v107, v86, v87
v_mfma_f32_32x32x16_bf16 v[128:143], a[152:155], v[248:251], v[128:143]
ds_read_b64_tr_b16 v[232:233], v110 offset:36864
ds_write_b64 v11, v[104:105] offset:32
ds_write_b64 v11, v[106:107] offset:48
ds_read_b64_tr_b16 v[96:97], v9 offset:0
ds_read_b64_tr_b16 v[98:99], v9 offset:288
ds_read_b64_tr_b16 v[100:101], v9 offset:32
v_mfma_f32_32x32x16_bf16 v[160:175], a[156:159], v[248:251], v[160:175]
ds_read_b64_tr_b16 v[234:235], v110 offset:37888
ds_read_b64_tr_b16 v[102:103], v9 offset:320
s_nop 7
buffer_store_dwordx4 v[88:91], v32, s[20:23], s0 offen offset:0 sc1
v_mfma_f32_32x32x16_bf16 v[144:159], a[152:155], v[252:255], v[144:159]
ds_read_b64_tr_b16 v[236:237], v111 offset:36864
buffer_store_dwordx4 v[92:95], v32, s[20:23], s0 offen offset:2048 sc1
s_waitcnt lgkmcnt(4)
buffer_store_dwordx4 v[96:99], v32, s[20:23], s1 offen offset:0 sc1
v_mfma_f32_32x32x16_bf16 v[176:191], a[156:159], v[252:255], v[176:191]
ds_read_b64_tr_b16 v[238:239], v111 offset:37888
s_waitcnt lgkmcnt(2)
buffer_store_dwordx4 v[100:103], v32, s[20:23], s1 offen offset:2048 sc1
v_mfma_f32_16x16x32_bf16 v[44:47], v[36:39], v[248:251], v[44:47]
v_mfma_f32_32x32x16_bf16 v[128:143], a[160:163], v[224:227], v[128:143]
ds_read_b64_tr_b16 v[240:241], v110 offset:40960
ds_read_b64_tr_b16 v[242:243], v110 offset:41984
v_mfma_f32_32x32x16_bf16 v[160:175], a[164:167], v[224:227], v[160:175]
ds_read_b64_tr_b16 v[244:245], v111 offset:40960
ds_read_b64_tr_b16 v[246:247], v111 offset:41984
v_mfma_f32_32x32x16_bf16 v[144:159], a[160:163], v[228:231], v[144:159]
ds_read_b64_tr_b16 v[248:249], v110 offset:45056
ds_read_b64_tr_b16 v[250:251], v110 offset:46080
v_mfma_f32_32x32x16_bf16 v[176:191], a[164:167], v[228:231], v[176:191]
ds_read_b64_tr_b16 v[252:253], v111 offset:45056
ds_read_b64_tr_b16 v[254:255], v111 offset:46080
v_mfma_f32_16x16x32_bf16 v[44:47], v[36:39], v[224:227], v[44:47]
v_mfma_f32_32x32x16_bf16 v[128:143], a[168:171], v[232:235], v[128:143]
s_waitcnt vmcnt(12)
ds_read_b128 a[0:3], v124 offset:0
ds_read_b128 a[4:7], v124 offset:2048
ds_read_b128 a[8:11], v124 offset:4096
ds_read_b128 a[12:15], v124 offset:6144
ds_read_b128 a[16:19], v125 offset:0
v_mfma_f32_32x32x16_bf16 v[160:175], a[172:175], v[232:235], v[160:175]
ds_read_b128 a[20:23], v125 offset:2048
ds_read_b128 a[24:27], v125 offset:4096
ds_read_b128 a[28:31], v125 offset:6144
s_waitcnt lgkmcnt(0)
s_add_u32 m0, s59, 65536
s_add_u32 s87, s61, s64
v_mfma_f32_32x32x16_bf16 v[144:159], a[168:171], v[236:239], v[144:159]
buffer_load_dwordx4 v20, s[16:19], s87 offen lds
buffer_load_dwordx4 v21, s[16:19], s87 offen offset:1024 lds
v_mfma_f32_32x32x16_bf16 v[176:191], a[172:175], v[236:239], v[176:191]
s_add_u32 m0, m0, 2048
s_nop 0
buffer_load_dwordx4 v22, s[16:19], s87 offen lds
v_mfma_f32_16x16x32_bf16 v[44:47], v[36:39], v[232:235], v[44:47]
buffer_load_dwordx4 v23, s[16:19], s87 offen offset:1024 lds
s_waitcnt lgkmcnt(0)
s_barrier
v_mfma_f32_32x32x16_bf16 v[128:143], a[176:179], v[240:243], v[128:143]
ds_read_b64_tr_b16 v[224:225], v110 offset:49152
s_add_u32 m0, s59, 69632
s_add_u32 s87, s61, s65
buffer_load_dwordx4 v20, s[16:19], s87 offen lds
v_mfma_f32_32x32x16_bf16 v[160:175], a[180:183], v[240:243], v[160:175]
ds_read_b64_tr_b16 v[226:227], v110 offset:50176
buffer_load_dwordx4 v21, s[16:19], s87 offen offset:1024 lds
s_add_u32 m0, m0, 2048
s_nop 0
v_mfma_f32_32x32x16_bf16 v[144:159], a[176:179], v[244:247], v[144:159]
ds_read_b64_tr_b16 v[228:229], v111 offset:49152
buffer_load_dwordx4 v22, s[16:19], s87 offen lds
v_mfma_f32_32x32x16_bf16 v[176:191], a[180:183], v[244:247], v[176:191]
ds_read_b64_tr_b16 v[230:231], v111 offset:50176
buffer_load_dwordx4 v23, s[16:19], s87 offen offset:1024 lds
s_add_u32 s61, s61, 128
s_and_b32 s61, s61, 1023
v_mfma_f32_16x16x32_bf16 v[44:47], v[36:39], v[240:243], v[44:47]
v_mfma_f32_32x32x16_bf16 v[128:143], a[184:187], v[248:251], v[128:143]
ds_read_b64_tr_b16 v[232:233], v110 offset:53248
v_mfma_f32_32x32x16_bf16 v[160:175], a[188:191], v[248:251], v[160:175]
ds_read_b64_tr_b16 v[234:235], v110 offset:54272
v_mfma_f32_32x32x16_bf16 v[144:159], a[184:187], v[252:255], v[144:159]
ds_read_b64_tr_b16 v[236:237], v111 offset:53248
v_mfma_f32_32x32x16_bf16 v[176:191], a[188:191], v[252:255], v[176:191]
ds_read_b64_tr_b16 v[238:239], v111 offset:54272
v_mfma_f32_16x16x32_bf16 v[44:47], v[36:39], v[248:251], v[44:47]
s_waitcnt lgkmcnt(6)
v_mfma_f32_32x32x16_bf16 v[128:143], a[192:195], v[224:227], v[128:143]
ds_read_b64_tr_b16 v[240:241], v110 offset:57344
ds_read_b64_tr_b16 v[242:243], v110 offset:58368
s_waitcnt vmcnt(8)
ds_read_b128 a[32:35], v124 offset:32768
ds_read_b128 a[36:39], v124 offset:34816
ds_read_b128 a[40:43], v124 offset:36864
v_mfma_f32_32x32x16_bf16 v[160:175], a[196:199], v[224:227], v[160:175]
ds_read_b64_tr_b16 v[244:245], v111 offset:57344
ds_read_b64_tr_b16 v[246:247], v111 offset:58368
s_mov_b64 exec, 1
buffer_store_dwordx2 v[26:27], v14, s[20:23], s86 offen sc1
s_mov_b64 exec, -1
s_waitcnt lgkmcnt(11)
v_mfma_f32_32x32x16_bf16 v[144:159], a[192:195], v[228:231], v[144:159]
ds_read_b64_tr_b16 v[248:249], v110 offset:61440
ds_read_b64_tr_b16 v[250:251], v110 offset:62464
ds_read_b128 a[44:47], v124 offset:38912
ds_read_b128 a[48:51], v125 offset:32768
ds_read_b128 a[52:55], v125 offset:34816
ds_read_b128 a[56:59], v125 offset:36864
v_mfma_f32_32x32x16_bf16 v[176:191], a[196:199], v[228:231], v[176:191]
ds_read_b64_tr_b16 v[252:253], v111 offset:61440
ds_read_b64_tr_b16 v[254:255], v111 offset:62464
ds_read_b128 a[60:63], v125 offset:38912
s_waitcnt lgkmcnt(0)
s_add_u32 m0, s59, 98304
s_add_u32 s87, s61, s64
v_mfma_f32_16x16x32_bf16 v[44:47], v[36:39], v[224:227], v[44:47]
buffer_load_dwordx4 v20, s[16:19], s87 offen lds
v_mfma_f32_32x32x16_bf16 v[128:143], a[200:203], v[232:235], v[128:143]
buffer_load_dwordx4 v21, s[16:19], s87 offen offset:1024 lds
s_add_u32 m0, m0, 2048
s_nop 0
v_mfma_f32_32x32x16_bf16 v[160:175], a[204:207], v[232:235], v[160:175]
buffer_load_dwordx4 v22, s[16:19], s87 offen lds
buffer_load_dwordx4 v23, s[16:19], s87 offen offset:1024 lds
v_mfma_f32_32x32x16_bf16 v[144:159], a[200:203], v[236:239], v[144:159]
s_add_u32 m0, s59, 102400
s_add_u32 s87, s61, s65
buffer_load_dwordx4 v20, s[16:19], s87 offen lds
v_mfma_f32_32x32x16_bf16 v[176:191], a[204:207], v[236:239], v[176:191]
buffer_load_dwordx4 v21, s[16:19], s87 offen offset:1024 lds
s_add_u32 m0, m0, 2048
s_nop 0
v_mfma_f32_16x16x32_bf16 v[44:47], v[36:39], v[232:235], v[44:47]
buffer_load_dwordx4 v22, s[16:19], s87 offen lds
s_waitcnt lgkmcnt(0)
s_barrier
v_mfma_f32_32x32x16_bf16 v[128:143], a[208:211], v[240:243], v[128:143]
ds_read_b64_tr_b16 v[224:225], v34 offset:32768
buffer_load_dwordx4 v23, s[16:19], s87 offen offset:1024 lds
s_add_u32 s61, s61, 128
v_mfma_f32_32x32x16_bf16 v[160:175], a[212:215], v[240:243], v[160:175]
ds_read_b64_tr_b16 v[226:227], v34 offset:33792
s_and_b32 s61, s61, 1023
v_mfma_f32_32x32x16_bf16 v[144:159], a[208:211], v[244:247], v[144:159]
ds_read_b64_tr_b16 v[228:229], v35 offset:32768
v_mfma_f32_32x32x16_bf16 v[176:191], a[212:215], v[244:247], v[176:191]
ds_read_b64_tr_b16 v[230:231], v35 offset:33792
v_mfma_f32_16x16x32_bf16 v[44:47], v[36:39], v[240:243], v[44:47]
v_mfma_f32_32x32x16_bf16 v[128:143], a[216:219], v[248:251], v[128:143]
ds_read_b64_tr_b16 v[232:233], v34 offset:36864
s_waitcnt vmcnt(9)
ds_read_b128 a[64:67], v124 offset:0
ds_read_b128 a[68:71], v124 offset:2048
ds_read_b128 a[72:75], v124 offset:4096
ds_read_b128 a[76:79], v124 offset:6144
v_mfma_f32_32x32x16_bf16 v[160:175], a[220:223], v[248:251], v[160:175]
ds_read_b64_tr_b16 v[234:235], v34 offset:37888
ds_read_b128 a[80:83], v125 offset:0
ds_read_b128 a[84:87], v125 offset:2048
ds_read_b128 a[88:91], v125 offset:4096
ds_read_b128 a[92:95], v125 offset:6144
s_add_u32 m0, s59, 0
v_mfma_f32_32x32x16_bf16 v[144:159], a[216:219], v[252:255], v[144:159]
ds_read_b64_tr_b16 v[236:237], v35 offset:36864
s_add_u32 s87, s61, s64
buffer_load_dwordx4 v20, s[16:19], s87 offen lds
v_mfma_f32_32x32x16_bf16 v[176:191], a[220:223], v[252:255], v[176:191]
ds_read_b64_tr_b16 v[238:239], v35 offset:37888
buffer_load_dwordx4 v21, s[16:19], s87 offen offset:1024 lds
s_add_u32 m0, m0, 2048
s_nop 0
v_mfma_f32_16x16x32_bf16 v[44:47], v[36:39], v[248:251], v[44:47]
buffer_load_dwordx4 v22, s[16:19], s87 offen lds
s_waitcnt lgkmcnt(14)
v_mfma_f32_32x32x16_bf16 v[128:143], a[224:227], v[224:227], v[128:143]
ds_read_b64_tr_b16 v[240:241], v34 offset:40960
ds_read_b64_tr_b16 v[242:243], v34 offset:41984
buffer_load_dwordx4 v23, s[16:19], s87 offen offset:1024 lds
v_mfma_f32_32x32x16_bf16 v[160:175], a[228:231], v[224:227], v[160:175]
ds_read_b64_tr_b16 v[244:245], v35 offset:40960
ds_read_b64_tr_b16 v[246:247], v35 offset:41984
s_add_u32 m0, s59, 4096
s_add_u32 s87, s61, s65
buffer_load_dwordx4 v20, s[16:19], s87 offen lds
s_waitcnt lgkmcnt(15)
v_mfma_f32_32x32x16_bf16 v[144:159], a[224:227], v[228:231], v[144:159]
ds_read_b64_tr_b16 v[248:249], v34 offset:45056
ds_read_b64_tr_b16 v[250:251], v34 offset:46080
buffer_load_dwordx4 v21, s[16:19], s87 offen offset:1024 lds
s_add_u32 m0, m0, 2048
v_mfma_f32_32x32x16_bf16 v[176:191], a[228:231], v[228:231], v[176:191]
ds_read_b64_tr_b16 v[252:253], v35 offset:45056
ds_read_b64_tr_b16 v[254:255], v35 offset:46080
s_nop 0
buffer_load_dwordx4 v22, s[16:19], s87 offen lds
v_mfma_f32_16x16x32_bf16 v[44:47], v[36:39], v[224:227], v[44:47]
buffer_load_dwordx4 v23, s[16:19], s87 offen offset:1024 lds
s_waitcnt lgkmcnt(14)
v_mfma_f32_32x32x16_bf16 v[128:143], a[232:235], v[232:235], v[128:143]
s_add_u32 s61, s61, 128
s_and_b32 s61, s61, 1023
v_mfma_f32_32x32x16_bf16 v[160:175], a[236:239], v[232:235], v[160:175]
s_waitcnt lgkmcnt(8)
v_mfma_f32_32x32x16_bf16 v[144:159], a[232:235], v[236:239], v[144:159]
v_mfma_f32_32x32x16_bf16 v[176:191], a[236:239], v[236:239], v[176:191]
v_mfma_f32_16x16x32_bf16 v[44:47], v[36:39], v[232:235], v[44:47]
s_waitcnt lgkmcnt(6)
v_mfma_f32_32x32x16_bf16 v[128:143], a[240:243], v[240:243], v[128:143]
s_waitcnt vmcnt(8)
ds_read_b128 a[96:99], v124 offset:32768
ds_read_b128 a[100:103], v124 offset:34816
ds_read_b128 a[104:107], v124 offset:36864
ds_read_b128 a[108:111], v124 offset:38912
ds_read_b128 a[112:115], v125 offset:32768
v_mfma_f32_32x32x16_bf16 v[160:175], a[244:247], v[240:243], v[160:175]
ds_read_b128 a[116:119], v125 offset:34816
ds_read_b128 a[120:123], v125 offset:36864
ds_read_b128 a[124:127], v125 offset:38912
s_add_u32 m0, s59, 32768
s_add_u32 s87, s61, s64
s_waitcnt lgkmcnt(12)
v_mfma_f32_32x32x16_bf16 v[144:159], a[240:243], v[244:247], v[144:159]
buffer_load_dwordx4 v20, s[16:19], s87 offen lds
buffer_load_dwordx4 v21, s[16:19], s87 offen offset:1024 lds
v_mfma_f32_32x32x16_bf16 v[176:191], a[244:247], v[244:247], v[176:191]
s_add_u32 m0, m0, 2048
s_nop 0
buffer_load_dwordx4 v22, s[16:19], s87 offen lds
v_mfma_f32_16x16x32_bf16 v[44:47], v[36:39], v[240:243], v[44:47]
buffer_load_dwordx4 v23, s[16:19], s87 offen offset:1024 lds
s_waitcnt lgkmcnt(10)
v_mfma_f32_32x32x16_bf16 v[128:143], a[248:251], v[248:251], v[128:143]
s_add_u32 m0, s59, 36864
s_add_u32 s87, s61, s65
buffer_load_dwordx4 v20, s[16:19], s87 offen lds
v_mfma_f32_32x32x16_bf16 v[160:175], a[252:255], v[248:251], v[160:175]
buffer_load_dwordx4 v21, s[16:19], s87 offen offset:1024 lds
s_add_u32 m0, m0, 2048
s_nop 0
s_waitcnt lgkmcnt(8)
v_mfma_f32_32x32x16_bf16 v[144:159], a[248:251], v[252:255], v[144:159]
buffer_load_dwordx4 v22, s[16:19], s87 offen lds
buffer_load_dwordx4 v23, s[16:19], s87 offen offset:1024 lds
v_mfma_f32_32x32x16_bf16 v[176:191], a[252:255], v[252:255], v[176:191]
s_add_u32 s61, s61, 128
s_and_b32 s61, s61, 1023
v_mfma_f32_16x16x32_bf16 v[44:47], v[36:39], v[248:251], v[44:47]
s_nop 7
v_cndmask_b32 v7, v44, v45, s[66:67]
s_lshl_b32 s53, s44, 7
v_add_u32 v6, s53, v54
ds_write_b32 v6, v7 offset:1280
s_add_u32 s54, s88, 0
s_lshl_b32 s54, s54, 12
v_add_u32 v33, s54, v32
s_add_u32 s54, s88, 1
s_lshl_b32 s54, s54, 12
v_add_u32 v47, s54, v32
s_add_u32 s54, s88, 2
s_lshl_b32 s54, s54, 12
s_cmp_eq_u32 s89, 3
s_cselect_b32 s54, s54, 0x40000000
v_add_u32 v55, s54, v32
s_mov_b32 s99, 0
s_waitcnt lgkmcnt(0)
s_barrier
s_lshl_b32 s87, s44, 2
s_add_u32 s87, s87, s47
s_add_u32 s87, s87, 0
s_and_b32 s87, s87, 15
s_lshl_b32 m0, s87, 12
s_add_u32 m0, m0, 73728
s_lshl_b32 s87, s87, 15
buffer_load_dwordx4 v28, s[24:27], s87 offen lds
buffer_load_dwordx4 v29, s[24:27], s87 offen offset:1024 lds
buffer_load_dwordx4 v30, s[24:27], s87 offen offset:2048 lds
buffer_load_dwordx4 v31, s[24:27], s87 offen offset:3072 lds
s_lshl_b32 s87, s44, 2
s_add_u32 s87, s87, s47
s_add_u32 s87, s87, 1
s_and_b32 s87, s87, 15
s_lshl_b32 m0, s87, 12
s_add_u32 m0, m0, 73728
s_lshl_b32 s87, s87, 15
buffer_load_dwordx4 v28, s[24:27], s87 offen lds
buffer_load_dwordx4 v29, s[24:27], s87 offen offset:1024 lds
buffer_load_dwordx4 v30, s[24:27], s87 offen offset:2048 lds
buffer_load_dwordx4 v31, s[24:27], s87 offen offset:3072 lds
s_lshl_b32 s53, s91, 7
v_add_u32 v6, s53, v54
ds_read_b32 v120, v6 offset:1280
ds_read_b32 v121, v6 offset:1536
s_xor_b32 s53, s44, 0
s_lshl_b32 s53, s53, 7
v_lshrrev_b32 v5, 5, v0
v_lshlrev_b32 v5, 4, v5
v_add_u32 v5, s53, v5
v_add_u32 v5, 159744, v5
ds_read_b128 v[104:107], v5 offset:512
ds_read_b128 v[192:195], v5 offset:0
ds_read_b128 v[108:111], v5 offset:544
ds_read_b128 v[196:199], v5 offset:32
ds_read_b128 v[112:115], v5 offset:576
ds_read_b128 v[200:203], v5 offset:64
ds_read_b128 v[116:119], v5 offset:608
ds_read_b128 v[204:207], v5 offset:96
s_cmp_lt_u32 s44, 2
s_cbranch_scc1 L_sw_14
v_swap_b32 v128, v144
v_swap_b32 v129, v145
v_swap_b32 v130, v146
v_swap_b32 v131, v147
v_swap_b32 v132, v148
v_swap_b32 v133, v149
v_swap_b32 v134, v150
v_swap_b32 v135, v151
v_swap_b32 v136, v152
v_swap_b32 v137, v153
v_swap_b32 v138, v154
v_swap_b32 v139, v155
v_swap_b32 v140, v156
v_swap_b32 v141, v157
v_swap_b32 v142, v158
v_swap_b32 v143, v159
v_swap_b32 v160, v176
v_swap_b32 v161, v177
v_swap_b32 v162, v178
v_swap_b32 v163, v179
v_swap_b32 v164, v180
v_swap_b32 v165, v181
v_swap_b32 v166, v182
v_swap_b32 v167, v183
v_swap_b32 v168, v184
v_swap_b32 v169, v185
v_swap_b32 v170, v186
v_swap_b32 v171, v187
v_swap_b32 v172, v188
v_swap_b32 v173, v189
v_swap_b32 v174, v190
v_swap_b32 v175, v191
L_sw_14:
s_waitcnt lgkmcnt(7)
v_pk_mul_f32 v[208:209], v[104:105], v[120:121] op_sel:[0,0] op_sel_hi:[1,0]
v_pk_mul_f32 v[210:211], v[106:107], v[120:121] op_sel:[0,0] op_sel_hi:[1,0]
s_waitcnt lgkmcnt(5)
v_pk_mul_f32 v[212:213], v[108:109], v[120:121] op_sel:[0,0] op_sel_hi:[1,0]
v_pk_mul_f32 v[214:215], v[110:111], v[120:121] op_sel:[0,0] op_sel_hi:[1,0]
v_pk_fma_f32 v[208:209], v[128:129], v[192:193], v[208:209]
v_pk_fma_f32 v[210:211], v[130:131], v[194:195], v[210:211]
s_waitcnt lgkmcnt(4)
v_pk_fma_f32 v[212:213], v[132:133], v[196:197], v[212:213]
v_pk_fma_f32 v[214:215], v[134:135], v[198:199], v[214:215]
v_pk_mul_f32 v[216:217], v[208:209], v[24:25] op_sel:[0,0] op_sel_hi:[1,0]
v_pk_mul_f32 v[218:219], v[210:211], v[24:25] op_sel:[0,0] op_sel_hi:[1,0]
v_pk_mul_f32 v[220:221], v[212:213], v[24:25] op_sel:[0,0] op_sel_hi:[1,0]
v_pk_mul_f32 v[222:223], v[214:215], v[24:25] op_sel:[0,0] op_sel_hi:[1,0]
v_exp_f32_e64 v216, v216 clamp
v_exp_f32_e64 v217, v217 clamp
v_exp_f32_e64 v218, v218 clamp
v_exp_f32_e64 v219, v219 clamp
v_exp_f32_e64 v220, v220 clamp
v_exp_f32_e64 v221, v221 clamp
v_exp_f32_e64 v222, v222 clamp
v_exp_f32_e64 v223, v223 clamp
v_max_f32 v208, 0, v208
v_max_f32 v209, 0, v209
v_max_f32 v210, 0, v210
v_max_f32 v211, 0, v211
v_max_f32 v212, 0, v212
v_max_f32 v213, 0, v213
v_max_f32 v214, 0, v214
v_max_f32 v215, 0, v215
v_pk_add_f32 v[216:217], v[216:217], v[24:25] op_sel:[0,1] op_sel_hi:[1,1]
v_pk_add_f32 v[218:219], v[218:219], v[24:25] op_sel:[0,1] op_sel_hi:[1,1]
v_pk_add_f32 v[220:221], v[220:221], v[24:25] op_sel:[0,1] op_sel_hi:[1,1]
v_pk_add_f32 v[222:223], v[222:223], v[24:25] op_sel:[0,1] op_sel_hi:[1,1]
v_pk_add_f32 v[208:209], v[208:209], v[216:217]
v_pk_add_f32 v[210:211], v[210:211], v[218:219]
v_pk_add_f32 v[212:213], v[212:213], v[220:221]
v_pk_add_f32 v[214:215], v[214:215], v[222:223]
v_cvt_pk_bf16_f32 v224, v208, v209
v_cvt_pk_bf16_f32 v225, v210, v211
v_cvt_pk_bf16_f32 v226, v212, v213
v_cvt_pk_bf16_f32 v227, v214, v215
s_waitcnt vmcnt(16)
ds_read_b128 a[128:131], v16 offset:0
ds_read_b128 a[132:135], v16 offset:2048
ds_read_b128 a[136:139], v16 offset:4096
ds_read_b128 a[140:143], v16 offset:6144
ds_read_b128 a[144:147], v17 offset:0
ds_read_b128 a[148:151], v17 offset:2048
ds_read_b128 a[152:155], v17 offset:4096
ds_read_b128 a[156:159], v17 offset:6144
s_waitcnt lgkmcnt(0)
s_add_u32 m0, s59, 0
v_pk_mul_f32 v[208:209], v[112:113], v[120:121] op_sel:[0,0] op_sel_hi:[1,0]
v_pk_mul_f32 v[210:211], v[114:115], v[120:121] op_sel:[0,0] op_sel_hi:[1,0]
v_pk_mul_f32 v[212:213], v[116:117], v[120:121] op_sel:[0,0] op_sel_hi:[1,0]
v_pk_mul_f32 v[214:215], v[118:119], v[120:121] op_sel:[0,0] op_sel_hi:[1,0]
v_pk_fma_f32 v[208:209], v[136:137], v[200:201], v[208:209]
v_pk_fma_f32 v[210:211], v[138:139], v[202:203], v[210:211]
v_pk_fma_f32 v[212:213], v[140:141], v[204:205], v[212:213]
v_pk_fma_f32 v[214:215], v[142:143], v[206:207], v[214:215]
v_pk_mul_f32 v[216:217], v[208:209], v[24:25] op_sel:[0,0] op_sel_hi:[1,0]
v_pk_mul_f32 v[218:219], v[210:211], v[24:25] op_sel:[0,0] op_sel_hi:[1,0]
v_pk_mul_f32 v[220:221], v[212:213], v[24:25] op_sel:[0,0] op_sel_hi:[1,0]
v_pk_mul_f32 v[222:223], v[214:215], v[24:25] op_sel:[0,0] op_sel_hi:[1,0]
v_exp_f32_e64 v216, v216 clamp
v_exp_f32_e64 v217, v217 clamp
v_exp_f32_e64 v218, v218 clamp
v_exp_f32_e64 v219, v219 clamp
v_exp_f32_e64 v220, v220 clamp
v_exp_f32_e64 v221, v221 clamp
v_exp_f32_e64 v222, v222 clamp
v_exp_f32_e64 v223, v223 clamp
v_max_f32 v208, 0, v208
v_max_f32 v209, 0, v209
v_max_f32 v210, 0, v210
v_max_f32 v211, 0, v211
v_max_f32 v212, 0, v212
v_max_f32 v213, 0, v213
v_max_f32 v214, 0, v214
v_max_f32 v215, 0, v215
v_pk_add_f32 v[216:217], v[216:217], v[24:25] op_sel:[0,1] op_sel_hi:[1,1]
v_pk_add_f32 v[218:219], v[218:219], v[24:25] op_sel:[0,1] op_sel_hi:[1,1]
v_pk_add_f32 v[220:221], v[220:221], v[24:25] op_sel:[0,1] op_sel_hi:[1,1]
v_pk_add_f32 v[222:223], v[222:223], v[24:25] op_sel:[0,1] op_sel_hi:[1,1]
v_pk_add_f32 v[208:209], v[208:209], v[216:217]
v_pk_add_f32 v[210:211], v[210:211], v[218:219]
v_pk_add_f32 v[212:213], v[212:213], v[220:221]
v_pk_add_f32 v[214:215], v[214:215], v[222:223]
v_cvt_pk_bf16_f32 v228, v208, v209
v_cvt_pk_bf16_f32 v229, v210, v211
v_cvt_pk_bf16_f32 v230, v212, v213
v_cvt_pk_bf16_f32 v231, v214, v215
s_add_u32 s87, s61, s64
buffer_load_dwordx4 v20, s[16:19], s87 offen lds
buffer_load_dwordx4 v21, s[16:19], s87 offen offset:1024 lds
s_add_u32 m0, m0, 2048
s_nop 0
buffer_load_dwordx4 v22, s[16:19], s87 offen lds
v_pk_mul_f32 v[208:209], v[104:105], v[120:121] op_sel:[0,1] op_sel_hi:[1,1]
v_pk_mul_f32 v[210:211], v[106:107], v[120:121] op_sel:[0,1] op_sel_hi:[1,1]
v_pk_mul_f32 v[212:213], v[108:109], v[120:121] op_sel:[0,1] op_sel_hi:[1,1]
v_pk_mul_f32 v[214:215], v[110:111], v[120:121] op_sel:[0,1] op_sel_hi:[1,1]
v_pk_fma_f32 v[208:209], v[144:145], v[192:193], v[208:209]
v_pk_fma_f32 v[210:211], v[146:147], v[194:195], v[210:211]
v_pk_fma_f32 v[212:213], v[148:149], v[196:197], v[212:213]
v_pk_fma_f32 v[214:215], v[150:151], v[198:199], v[214:215]
v_cvt_pk_bf16_f32 v240, v208, v209
v_cvt_pk_bf16_f32 v241, v210, v211
v_cvt_pk_bf16_f32 v242, v212, v213
v_cvt_pk_bf16_f32 v243, v214, v215
v_pk_mul_f32 v[208:209], v[112:113], v[120:121] op_sel:[0,1] op_sel_hi:[1,1]
v_pk_mul_f32 v[210:211], v[114:115], v[120:121] op_sel:[0,1] op_sel_hi:[1,1]
v_pk_mul_f32 v[212:213], v[116:117], v[120:121] op_sel:[0,1] op_sel_hi:[1,1]
v_pk_mul_f32 v[214:215], v[118:119], v[120:121] op_sel:[0,1] op_sel_hi:[1,1]
v_pk_fma_f32 v[208:209], v[152:153], v[200:201], v[208:209]
v_pk_fma_f32 v[210:211], v[154:155], v[202:203], v[210:211]
v_pk_fma_f32 v[212:213], v[156:157], v[204:205], v[212:213]
v_pk_fma_f32 v[214:215], v[158:159], v[206:207], v[214:215]
v_cvt_pk_bf16_f32 v244, v208, v209
v_cvt_pk_bf16_f32 v245, v210, v211
v_cvt_pk_bf16_f32 v246, v212, v213
v_cvt_pk_bf16_f32 v247, v214, v215
s_lshr_b32 s3, s88, 1
v_lshlrev_b32 v11, 13, v3
s_and_b32 s97, s89, 1
s_lshl_b32 s97, s97, 3
v_and_b32 v12, s97, v0
v_lshl_add_u32 v11, v12, 6, v11
v_and_b32 v12, 6, v0
v_lshl_add_u32 v11, v12, 6, v11
buffer_load_dwordx4 v23, s[16:19], s87 offen offset:1024 lds
s_lshl_b32 s97, s44, 6
s_add_u32 s97, s97, s3
s_lshl_b32 s97, s97, 9
s_xor_b32 s53, s44, 1
s_lshl_b32 s53, s53, 7
v_lshrrev_b32 v5, 5, v0
v_lshlrev_b32 v5, 4, v5
v_add_u32 v5, s53, v5
v_add_u32 v5, 159744, v5
ds_read_b128 v[104:107], v5 offset:512
ds_read_b128 v[192:195], v5 offset:0
ds_read_b128 v[108:111], v5 offset:544
ds_read_b128 v[196:199], v5 offset:32
ds_read_b128 v[112:115], v5 offset:576
ds_read_b128 v[200:203], v5 offset:64
ds_read_b128 v[116:119], v5 offset:608
ds_read_b128 v[204:207], v5 offset:96
s_waitcnt lgkmcnt(7)
v_pk_mul_f32 v[208:209], v[104:105], v[120:121] op_sel:[0,0] op_sel_hi:[1,0]
v_pk_mul_f32 v[210:211], v[106:107], v[120:121] op_sel:[0,0] op_sel_hi:[1,0]
s_waitcnt lgkmcnt(5)
v_pk_mul_f32 v[212:213], v[108:109], v[120:121] op_sel:[0,0] op_sel_hi:[1,0]
v_pk_mul_f32 v[214:215], v[110:111], v[120:121] op_sel:[0,0] op_sel_hi:[1,0]
v_pk_fma_f32 v[208:209], v[160:161], v[192:193], v[208:209]
v_pk_fma_f32 v[210:211], v[162:163], v[194:195], v[210:211]
s_waitcnt lgkmcnt(4)
v_pk_fma_f32 v[212:213], v[164:165], v[196:197], v[212:213]
v_pk_fma_f32 v[214:215], v[166:167], v[198:199], v[214:215]
v_pk_mul_f32 v[216:217], v[208:209], v[24:25] op_sel:[0,0] op_sel_hi:[1,0]
v_pk_mul_f32 v[218:219], v[210:211], v[24:25] op_sel:[0,0] op_sel_hi:[1,0]
v_pk_mul_f32 v[220:221], v[212:213], v[24:25] op_sel:[0,0] op_sel_hi:[1,0]
v_pk_mul_f32 v[222:223], v[214:215], v[24:25] op_sel:[0,0] op_sel_hi:[1,0]
v_exp_f32_e64 v216, v216 clamp
v_exp_f32_e64 v217, v217 clamp
v_exp_f32_e64 v218, v218 clamp
v_exp_f32_e64 v219, v219 clamp
v_exp_f32_e64 v220, v220 clamp
v_exp_f32_e64 v221, v221 clamp
v_exp_f32_e64 v222, v222 clamp
v_exp_f32_e64 v223, v223 clamp
v_max_f32 v208, 0, v208
v_max_f32 v209, 0, v209
v_max_f32 v210, 0, v210
v_max_f32 v211, 0, v211
v_max_f32 v212, 0, v212
v_max_f32 v213, 0, v213
v_max_f32 v214, 0, v214
v_max_f32 v215, 0, v215
v_pk_add_f32 v[216:217], v[216:217], v[24:25] op_sel:[0,1] op_sel_hi:[1,1]
v_pk_add_f32 v[218:219], v[218:219], v[24:25] op_sel:[0,1] op_sel_hi:[1,1]
v_pk_add_f32 v[220:221], v[220:221], v[24:25] op_sel:[0,1] op_sel_hi:[1,1]
v_pk_add_f32 v[222:223], v[222:223], v[24:25] op_sel:[0,1] op_sel_hi:[1,1]
v_pk_add_f32 v[208:209], v[208:209], v[216:217]
v_pk_add_f32 v[210:211], v[210:211], v[218:219]
v_pk_add_f32 v[212:213], v[212:213], v[220:221]
v_pk_add_f32 v[214:215], v[214:215], v[222:223]
v_cvt_pk_bf16_f32 v232, v208, v209
v_cvt_pk_bf16_f32 v233, v210, v211
v_cvt_pk_bf16_f32 v234, v212, v213
v_cvt_pk_bf16_f32 v235, v214, v215
s_add_u32 s97, s97, 65536
buffer_load_dwordx2 v[34:35], v11, s[20:23], s97 offen sc1
s_add_u32 m0, s59, 4096
s_add_u32 s87, s61, s65
buffer_load_dwordx4 v20, s[16:19], s87 offen lds
buffer_load_dwordx4 v21, s[16:19], s87 offen offset:1024 lds
s_add_u32 m0, m0, 2048
s_nop 0
buffer_load_dwordx4 v22, s[16:19], s87 offen lds
buffer_load_dwordx4 v23, s[16:19], s87 offen offset:1024 lds
s_add_u32 s61, s61, 128
s_and_b32 s61, s61, 1023
s_cmp_eq_u32 s99, 1
s_cbranch_scc1 L_tb_16
s_waitcnt vmcnt(4)
v_cmp_ne_u64 vcc, v[34:35], v[26:27]
s_nop 3
s_cbranch_vccnz L_tb_17
s_mul_i32 s90, s92, 90112
s_add_u32 s92, s92, 1
s_add_u32 s90, s90, s93
s_and_b32 s92, s92, 7
buffer_load_dwordx4 v[56:59], v33, s[20:23], s90 offen offset:0 sc1
buffer_load_dwordx4 v[60:63], v33, s[20:23], s90 offen offset:2048 sc1
buffer_load_dwordx4 v[64:67], v47, s[20:23], s90 offen offset:0 sc1
buffer_load_dwordx4 v[68:71], v47, s[20:23], s90 offen offset:2048 sc1
buffer_load_dwordx4 v[72:75], v55, s[20:23], s90 offen offset:0 sc1
buffer_load_dwordx4 v[76:79], v55, s[20:23], s90 offen offset:2048 sc1
buffer_load_dwordx4 v[80:83], v33, s[20:23], s90 offen offset:1024 sc1
buffer_load_dwordx4 v[84:87], v33, s[20:23], s90 offen offset:3072 sc1
buffer_load_dwordx4 v[88:91], v47, s[20:23], s90 offen offset:1024 sc1
buffer_load_dwordx4 v[92:95], v47, s[20:23], s90 offen offset:3072 sc1
buffer_load_dwordx4 v[96:99], v55, s[20:23], s90 offen offset:1024 sc1
buffer_load_dwordx4 v[100:103], v55, s[20:23], s90 offen offset:3072 sc1
s_mov_b32 s99, 1
s_branch L_tb_16
L_tb_17:
buffer_load_dwordx2 v[34:35], v11, s[20:23], s97 offen sc1
L_tb_16:
s_waitcnt lgkmcnt(3)
v_pk_mul_f32 v[208:209], v[112:113], v[120:121] op_sel:[0,0] op_sel_hi:[1,0]
v_pk_mul_f32 v[210:211], v[114:115], v[120:121] op_sel:[0,0] op_sel_hi:[1,0]
s_waitcnt lgkmcnt(1)
v_pk_mul_f32 v[212:213], v[116:117], v[120:121] op_sel:[0,0] op_sel_hi:[1,0]
v_pk_mul_f32 v[214:215], v[118:119], v[120:121] op_sel:[0,0] op_sel_hi:[1,0]
v_pk_fma_f32 v[208:209], v[168:169], v[200:201], v[208:209]
v_pk_fma_f32 v[210:211], v[170:171], v[202:203], v[210:211]
s_waitcnt lgkmcnt(0)
v_pk_fma_f32 v[212:213], v[172:173], v[204:205], v[212:213]
v_pk_fma_f32 v[214:215], v[174:175], v[206:207], v[214:215]
v_pk_mul_f32 v[216:217], v[208:209], v[24:25] op_sel:[0,0] op_sel_hi:[1,0]
v_pk_mul_f32 v[218:219], v[210:211], v[24:25] op_sel:[0,0] op_sel_hi:[1,0]
v_pk_mul_f32 v[220:221], v[212:213], v[24:25] op_sel:[0,0] op_sel_hi:[1,0]
v_pk_mul_f32 v[222:223], v[214:215], v[24:25] op_sel:[0,0] op_sel_hi:[1,0]
v_exp_f32_e64 v216, v216 clamp
v_exp_f32_e64 v217, v217 clamp
v_exp_f32_e64 v218, v218 clamp
v_exp_f32_e64 v219, v219 clamp
v_exp_f32_e64 v220, v220 clamp
v_exp_f32_e64 v221, v221 clamp
v_exp_f32_e64 v222, v222 clamp
v_exp_f32_e64 v223, v223 clamp
v_max_f32 v208, 0, v208
v_max_f32 v209, 0, v209
v_max_f32 v210, 0, v210
v_max_f32 v211, 0, v211
v_max_f32 v212, 0, v212
v_max_f32 v213, 0, v213
v_max_f32 v214, 0, v214
v_max_f32 v215, 0, v215
v_pk_add_f32 v[216:217], v[216:217], v[24:25] op_sel:[0,1] op_sel_hi:[1,1]
v_pk_add_f32 v[218:219], v[218:219], v[24:25] op_sel:[0,1] op_sel_hi:[1,1]
v_pk_add_f32 v[220:221], v[220:221], v[24:25] op_sel:[0,1] op_sel_hi:[1,1]
v_pk_add_f32 v[222:223], v[222:223], v[24:25] op_sel:[0,1] op_sel_hi:[1,1]
v_pk_add_f32 v[208:209], v[208:209], v[216:217]
v_pk_add_f32 v[210:211], v[210:211], v[218:219]
v_pk_add_f32 v[212:213], v[212:213], v[220:221]
v_pk_add_f32 v[214:215], v[214:215], v[222:223]
v_cvt_pk_bf16_f32 v236, v208, v209
v_cvt_pk_bf16_f32 v237, v210, v211
v_cvt_pk_bf16_f32 v238, v212, v213
v_cvt_pk_bf16_f32 v239, v214, v215
s_waitcnt vmcnt(17)
ds_read_b128 a[160:163], v16 offset:32768
ds_read_b128 a[164:167], v16 offset:34816
ds_read_b128 a[168:171], v16 offset:36864
ds_read_b128 a[172:175], v16 offset:38912
ds_read_b128 a[176:179], v17 offset:32768
ds_read_b128 a[180:183], v17 offset:34816
ds_read_b128 a[184:187], v17 offset:36864
ds_read_b128 a[188:191], v17 offset:38912
v_pk_mul_f32 v[208:209], v[104:105], v[120:121] op_sel:[0,1] op_sel_hi:[1,1]
v_pk_mul_f32 v[210:211], v[106:107], v[120:121] op_sel:[0,1] op_sel_hi:[1,1]
v_pk_mul_f32 v[212:213], v[108:109], v[120:121] op_sel:[0,1] op_sel_hi:[1,1]
v_pk_mul_f32 v[214:215], v[110:111], v[120:121] op_sel:[0,1] op_sel_hi:[1,1]
v_pk_fma_f32 v[208:209], v[176:177], v[192:193], v[208:209]
v_pk_fma_f32 v[210:211], v[178:179], v[194:195], v[210:211]
v_pk_fma_f32 v[212:213], v[180:181], v[196:197], v[212:213]
v_pk_fma_f32 v[214:215], v[182:183], v[198:199], v[214:215]
v_cvt_pk_bf16_f32 v248, v208, v209
v_cvt_pk_bf16_f32 v249, v210, v211
v_cvt_pk_bf16_f32 v250, v212, v213
v_cvt_pk_bf16_f32 v251, v214, v215
v_pk_mul_f32 v[208:209], v[112:113], v[120:121] op_sel:[0,1] op_sel_hi:[1,1]
v_pk_mul_f32 v[210:211], v[114:115], v[120:121] op_sel:[0,1] op_sel_hi:[1,1]
v_pk_mul_f32 v[212:213], v[116:117], v[120:121] op_sel:[0,1] op_sel_hi:[1,1]
v_pk_mul_f32 v[214:215], v[118:119], v[120:121] op_sel:[0,1] op_sel_hi:[1,1]
v_pk_fma_f32 v[208:209], v[184:185], v[200:201], v[208:209]
v_pk_fma_f32 v[210:211], v[186:187], v[202:203], v[210:211]
v_pk_fma_f32 v[212:213], v[188:189], v[204:205], v[212:213]
v_pk_fma_f32 v[214:215], v[190:191], v[206:207], v[214:215]
v_cvt_pk_bf16_f32 v252, v208, v209
v_cvt_pk_bf16_f32 v253, v210, v211
v_cvt_pk_bf16_f32 v254, v212, v213
v_cvt_pk_bf16_f32 v255, v214, v215
s_waitcnt vmcnt(0)
ds_read_b128 a[192:195], v16 offset:0
ds_read_b128 a[196:199], v16 offset:2048
ds_read_b128 a[200:203], v16 offset:4096
ds_read_b128 a[204:207], v16 offset:6144
ds_read_b128 a[208:211], v17 offset:0
ds_read_b128 a[212:215], v17 offset:2048
ds_read_b128 a[216:219], v17 offset:4096
ds_read_b128 a[220:223], v17 offset:6144
v_mov_b32 v160, s60
v_mov_b32 v161, s60
v_mov_b32 v162, s60
v_mov_b32 v163, s60
v_mfma_f32_32x32x16_bf16 v[128:143], v[224:227], v[240:243], 0
s_lshl_b32 s53, s46, 1
s_add_u32 s98, s53, s91
s_lshl_b32 s53, s98, 6
v_mfma_f32_32x32x16_bf16 v[144:159], v[224:227], v[160:163], 0
s_lshr_b32 s56, s96, 1
s_add_u32 s53, s53, s56
s_lshl_b32 s54, s53, 10
v_mfma_f32_32x32x16_bf16 v[128:143], v[228:231], v[244:247], v[128:143]
s_add_u32 s54, s54, 8126464
s_lshl_b32 s55, s53, 7
s_add_u32 s55, s55, 9175040
v_mfma_f32_32x32x16_bf16 v[144:159], v[228:231], v[160:163], v[144:159]
v_bfe_u32 v5, v0, 4, 1
v_lshrrev_b32 v6, 5, v0
v_lshlrev_b32 v7, 15, v5
v_mfma_f32_32x32x16_bf16 v[128:143], v[232:235], v[248:251], v[128:143]
v_lshl_add_u32 v7, v6, 8, v7
v_lshl_add_u32 v7, v4, 4, v7
v_lshlrev_b32 v8, 12, v5
v_mfma_f32_32x32x16_bf16 v[144:159], v[232:235], v[160:163], v[144:159]
v_lshl_add_u32 v8, v6, 4, v8
v_lshl_add_u32 v8, v4, 5, v8
s_lshl_b32 s98, s98, 4
v_mfma_f32_32x32x16_bf16 v[128:143], v[236:239], v[252:255], v[128:143]
s_add_u32 s98, s98, s45
s_lshl_b32 s98, s98, 1
s_lshr_b32 s56, s44, 1
v_mfma_f32_32x32x16_bf16 v[144:159], v[236:239], v[160:163], v[144:159]
s_add_u32 s98, s98, s56
s_lshl_b32 s98, s98, 7
s_add_u32 s98, s98, 12713984
v_cmp_eq_u32 vcc, 1, v4
s_nop 3
v_cndmask_b32 v208, v128, v136, s[66:67]
v_cndmask_b32 v209, v129, v137, s[66:67]
v_cndmask_b32 v210, v130, v138, s[66:67]
v_cndmask_b32 v211, v131, v139, s[66:67]
v_cndmask_b32 v212, v132, v140, s[66:67]
v_cndmask_b32 v213, v133, v141, s[66:67]
v_cndmask_b32 v214, v134, v142, s[66:67]
v_cndmask_b32 v215, v135, v143, s[66:67]
buffer_store_dwordx4 v[208:211], v7, s[20:23], s54 offen sc1
buffer_store_dwordx4 v[212:215], v7, s[20:23], s54 offen offset:512 sc1
v_cndmask_b32 v216, v144, v152, s[66:67]
v_cndmask_b32 v217, v145, v153, s[66:67]
v_cndmask_b32 v218, v146, v154, s[66:67]
v_cndmask_b32 v219, v147, v155, s[66:67]
v_cndmask_b32 v220, v148, v156, s[66:67]
v_cndmask_b32 v221, v149, v157, s[66:67]
v_cndmask_b32 v222, v150, v158, s[66:67]
v_cndmask_b32 v223, v151, v159, s[66:67]
v_cndmask_b32 v216, v216, v220, vcc
v_cndmask_b32 v217, v217, v221, vcc
v_cndmask_b32 v218, v218, v222, vcc
v_cndmask_b32 v219, v219, v223, vcc
s_mov_b32 exec_lo, 0x000f000f
s_mov_b32 exec_hi, 0x000f000f
buffer_store_dwordx4 v[216:219], v8, s[20:23], s55 offen sc1
s_mov_b64 exec, -1
v_lshrrev_b32 v6, 2, v0
v_bfe_u32 v7, v0, 3, 2
v_and_b32 v8, 3, v0
v_lshlrev_b32 v6, 7, v6
v_lshl_add_u32 v6, v8, 3, v6
v_lshl_add_u32 v40, v7, 5, v6
v_add_u32 v40, 73728, v40
v_xor_b32 v41, 32, v40
v_xor_b32 v42, 64, v40
v_xor_b32 v43, 96, v40
s_cmp_eq_u32 s99, 1
s_cbranch_scc1 L_bd_19
s_waitcnt vmcnt(3)
v_cmp_ne_u64 vcc, v[34:35], v[26:27]
s_nop 3
s_cbranch_vccz L_ok_22
s_mov_b32 s62, 4000
L_sp_21:
s_sleep 3
buffer_load_dwordx2 v[34:35], v11, s[20:23], s97 offen sc1
s_waitcnt vmcnt(0)
v_cmp_ne_u64 vcc, v[34:35], v[26:27]
s_sub_u32 s62, s62, 1
s_cbranch_scc1 L_ok_22
s_nop 1
s_cbranch_vccnz L_sp_21
L_ok_22:
s_mul_i32 s90, s92, 90112
s_add_u32 s92, s92, 1
s_add_u32 s90, s90, s93
s_and_b32 s92, s92, 7
buffer_load_dwordx4 v[56:59], v33, s[20:23], s90 offen offset:0 sc1
buffer_load_dwordx4 v[60:63], v33, s[20:23], s90 offen offset:2048 sc1
buffer_load_dwordx4 v[64:67], v47, s[20:23], s90 offen offset:0 sc1
buffer_load_dwordx4 v[68:71], v47, s[20:23], s90 offen offset:2048 sc1
buffer_load_dwordx4 v[72:75], v55, s[20:23], s90 offen offset:0 sc1
buffer_load_dwordx4 v[76:79], v55, s[20:23], s90 offen offset:2048 sc1
buffer_load_dwordx4 v[80:83], v33, s[20:23], s90 offen offset:1024 sc1
buffer_load_dwordx4 v[84:87], v33, s[20:23], s90 offen offset:3072 sc1
buffer_load_dwordx4 v[88:91], v47, s[20:23], s90 offen offset:1024 sc1
buffer_load_dwordx4 v[92:95], v47, s[20:23], s90 offen offset:3072 sc1
buffer_load_dwordx4 v[96:99], v55, s[20:23], s90 offen offset:1024 sc1
buffer_load_dwordx4 v[100:103], v55, s[20:23], s90 offen offset:3072 sc1
L_bd_19:
s_mul_i32 s90, s92, 90112
s_add_u32 s92, s92, 1
s_add_u32 s90, s90, s93
s_and_b32 s92, s92, 7
buffer_load_dwordx4 v[104:107], v33, s[20:23], s90 offen offset:0 sc1
buffer_load_dwordx4 v[108:111], v33, s[20:23], s90 offen offset:2048 sc1
buffer_load_dwordx4 v[112:115], v47, s[20:23], s90 offen offset:0 sc1
s_waitcnt vmcnt(14)
v_mfma_f32_16x16x32_bf16 v[128:131], v[56:59], a[0:3], 0
s_waitcnt lgkmcnt(0)
s_add_u32 m0, s59, 0
s_add_u32 s87, s61, s64
v_mfma_f32_16x16x32_bf16 v[152:155], v[56:59], a[4:7], 0
s_mov_b64 exec, 1
buffer_store_dwordx2 v[26:27], v14, s[20:23], s98 offen sc1
s_mov_b64 exec, -1
v_mfma_f32_16x16x32_bf16 v[176:179], v[56:59], a[8:11], 0
v_mfma_f32_16x16x32_bf16 v[200:203], v[56:59], a[12:15], 0
buffer_load_dwordx4 v[56:59], v47, s[20:23], s90 offen offset:2048 sc1
s_waitcnt vmcnt(15)
v_mfma_f32_16x16x32_bf16 v[132:135], v[60:63], a[0:3], 0
buffer_load_dwordx4 v20, s[16:19], s87 offen lds
v_mfma_f32_16x16x32_bf16 v[156:159], v[60:63], a[4:7], 0
v_mfma_f32_16x16x32_bf16 v[180:183], v[60:63], a[8:11], 0
buffer_load_dwordx4 v21, s[16:19], s87 offen offset:1024 lds
v_mfma_f32_16x16x32_bf16 v[204:207], v[60:63], a[12:15], 0
buffer_load_dwordx4 v[60:63], v55, s[20:23], s90 offen offset:0 sc1
s_waitcnt vmcnt(17)
v_mfma_f32_16x16x32_bf16 v[136:139], v[64:67], a[0:3], 0
s_add_u32 m0, m0, 2048
s_nop 0
v_mfma_f32_16x16x32_bf16 v[160:163], v[64:67], a[4:7], 0
buffer_load_dwordx4 v22, s[16:19], s87 offen lds
v_mfma_f32_16x16x32_bf16 v[184:187], v[64:67], a[8:11], 0
buffer_load_dwordx4 v23, s[16:19], s87 offen offset:1024 lds
v_mfma_f32_16x16x32_bf16 v[208:211], v[64:67], a[12:15], 0
buffer_load_dwordx4 v[64:67], v55, s[20:23], s90 offen offset:2048 sc1
s_waitcnt vmcnt(19)
v_mfma_f32_16x16x32_bf16 v[140:143], v[68:71], a[0:3], 0
s_add_u32 m0, s59, 4096
s_add_u32 s87, s61, s65
v_mfma_f32_16x16x32_bf16 v[164:167], v[68:71], a[4:7], 0
buffer_load_dwordx4 v20, s[16:19], s87 offen lds
v_mfma_f32_16x16x32_bf16 v[188:191], v[68:71], a[8:11], 0
v_mfma_f32_16x16x32_bf16 v[212:215], v[68:71], a[12:15], 0
buffer_load_dwordx4 v[68:71], v33, s[20:23], s90 offen offset:1024 sc1
s_waitcnt vmcnt(20)
v_mfma_f32_16x16x32_bf16 v[144:147], v[72:75], a[0:3], 0
buffer_load_dwordx4 v21, s[16:19], s87 offen offset:1024 lds
v_mfma_f32_16x16x32_bf16 v[168:171], v[72:75], a[4:7], 0
s_add_u32 m0, m0, 2048
s_nop 0
v_mfma_f32_16x16x32_bf16 v[192:195], v[72:75], a[8:11], 0
buffer_load_dwordx4 v22, s[16:19], s87 offen lds
v_mfma_f32_16x16x32_bf16 v[216:219], v[72:75], a[12:15], 0
buffer_load_dwordx4 v[72:75], v33, s[20:23], s90 offen offset:3072 sc1
s_waitcnt vmcnt(22)
v_mfma_f32_16x16x32_bf16 v[148:151], v[76:79], a[0:3], 0
v_mfma_f32_16x16x32_bf16 v[172:175], v[76:79], a[4:7], 0
buffer_load_dwordx4 v23, s[16:19], s87 offen offset:1024 lds
v_mfma_f32_16x16x32_bf16 v[196:199], v[76:79], a[8:11], 0
s_add_u32 s61, s61, 128
s_and_b32 s61, s61, 1023
v_mfma_f32_16x16x32_bf16 v[220:223], v[76:79], a[12:15], 0
buffer_load_dwordx4 v[76:79], v47, s[20:23], s90 offen offset:1024 sc1
s_waitcnt vmcnt(23)
v_mfma_f32_16x16x32_bf16 v[128:131], v[80:83], a[16:19], v[128:131]
s_waitcnt vmcnt(1)
ds_read_b128 a[224:227], v16 offset:0
ds_read_b128 a[228:231], v16 offset:2048
v_mfma_f32_16x16x32_bf16 v[152:155], v[80:83], a[20:23], v[152:155]
ds_read_b128 a[232:235], v16 offset:4096
ds_read_b128 a[236:239], v16 offset:6144
v_mfma_f32_16x16x32_bf16 v[176:179], v[80:83], a[24:27], v[176:179]
ds_read_b128 a[240:243], v17 offset:0
ds_read_b128 a[244:247], v17 offset:2048
v_mfma_f32_16x16x32_bf16 v[200:203], v[80:83], a[28:31], v[200:203]
buffer_load_dwordx4 v[80:83], v47, s[20:23], s90 offen offset:3072 sc1
v_mfma_f32_16x16x32_bf16 v[132:135], v[84:87], a[16:19], v[132:135]
ds_read_b128 a[248:251], v17 offset:4096
ds_read_b128 a[252:255], v17 offset:6144
v_mfma_f32_16x16x32_bf16 v[156:159], v[84:87], a[20:23], v[156:159]
v_mfma_f32_16x16x32_bf16 v[180:183], v[84:87], a[24:27], v[180:183]
v_mfma_f32_16x16x32_bf16 v[204:207], v[84:87], a[28:31], v[204:207]
buffer_load_dwordx4 v[84:87], v55, s[20:23], s90 offen offset:1024 sc1
v_mfma_f32_16x16x32_bf16 v[136:139], v[88:91], a[16:19], v[136:139]
v_mfma_f32_16x16x32_bf16 v[160:163], v[88:91], a[20:23], v[160:163]
v_mfma_f32_16x16x32_bf16 v[184:187], v[88:91], a[24:27], v[184:187]
v_mfma_f32_16x16x32_bf16 v[208:211], v[88:91], a[28:31], v[208:211]
buffer_load_dwordx4 v[88:91], v55, s[20:23], s90 offen offset:3072 sc1
v_mfma_f32_16x16x32_bf16 v[140:143], v[92:95], a[16:19], v[140:143]
s_lshl_b32 s87, s44, 2
s_add_u32 s87, s87, s47
s_add_u32 s87, s87, 2
v_mfma_f32_16x16x32_bf16 v[164:167], v[92:95], a[20:23], v[164:167]
s_and_b32 s87, s87, 15
s_lshl_b32 m0, s87, 12
s_add_u32 m0, m0, 73728
s_lshl_b32 s87, s87, 15
v_mfma_f32_16x16x32_bf16 v[188:191], v[92:95], a[24:27], v[188:191]
buffer_load_dwordx4 v28, s[24:27], s87 offen lds
v_mfma_f32_16x16x32_bf16 v[212:215], v[92:95], a[28:31], v[212:215]
s_mul_i32 s90, s92, 90112
s_add_u32 s92, s92, 1
s_add_u32 s90, s90, s93
s_and_b32 s92, s92, 7
buffer_load_dwordx4 v[92:95], v33, s[20:23], s90 offen offset:0 sc1
v_mfma_f32_16x16x32_bf16 v[144:147], v[96:99], a[16:19], v[144:147]
v_mfma_f32_16x16x32_bf16 v[168:171], v[96:99], a[20:23], v[168:171]
v_mfma_f32_16x16x32_bf16 v[192:195], v[96:99], a[24:27], v[192:195]
buffer_load_dwordx4 v29, s[24:27], s87 offen offset:1024 lds
v_mfma_f32_16x16x32_bf16 v[216:219], v[96:99], a[28:31], v[216:219]
buffer_load_dwordx4 v[96:99], v33, s[20:23], s90 offen offset:2048 sc1
v_mfma_f32_16x16x32_bf16 v[148:151], v[100:103], a[16:19], v[148:151]
v_mfma_f32_16x16x32_bf16 v[172:175], v[100:103], a[20:23], v[172:175]
buffer_load_dwordx4 v30, s[24:27], s87 offen offset:2048 lds
v_mfma_f32_16x16x32_bf16 v[196:199], v[100:103], a[24:27], v[196:199]
buffer_load_dwordx4 v31, s[24:27], s87 offen offset:3072 lds
v_mfma_f32_16x16x32_bf16 v[220:223], v[100:103], a[28:31], v[220:223]
buffer_load_dwordx4 v[100:103], v47, s[20:23], s90 offen offset:0 sc1
v_mfma_f32_16x16x32_bf16 v[128:131], v[104:107], a[32:35], v[128:131]
s_lshl_b32 s87, s44, 2
s_add_u32 s87, s87, s47
v_mfma_f32_16x16x32_bf16 v[152:155], v[104:107], a[36:39], v[152:155]
s_add_u32 s87, s87, 3
s_and_b32 s87, s87, 15
s_lshl_b32 m0, s87, 12
v_mfma_f32_16x16x32_bf16 v[176:179], v[104:107], a[40:43], v[176:179]
s_add_u32 m0, m0, 73728
s_lshl_b32 s87, s87, 15
v_mfma_f32_16x16x32_bf16 v[200:203], v[104:107], a[44:47], v[200:203]
buffer_load_dwordx4 v[104:107], v47, s[20:23], s90 offen offset:2048 sc1
v_mfma_f32_16x16x32_bf16 v[132:135], v[108:111], a[32:35], v[132:135]
buffer_load_dwordx4 v28, s[24:27], s87 offen lds
v_mfma_f32_16x16x32_bf16 v[156:159], v[108:111], a[36:39], v[156:159]
v_mfma_f32_16x16x32_bf16 v[180:183], v[108:111], a[40:43], v[180:183]
buffer_load_dwordx4 v29, s[24:27], s87 offen offset:1024 lds
v_mfma_f32_16x16x32_bf16 v[204:207], v[108:111], a[44:47], v[204:207]
buffer_load_dwordx4 v[108:111], v55, s[20:23], s90 offen offset:0 sc1
v_mfma_f32_16x16x32_bf16 v[136:139], v[112:115], a[32:35], v[136:139]
v_mfma_f32_16x16x32_bf16 v[160:163], v[112:115], a[36:39], v[160:163]
buffer_load_dwordx4 v30, s[24:27], s87 offen offset:2048 lds
v_mfma_f32_16x16x32_bf16 v[184:187], v[112:115], a[40:43], v[184:187]
buffer_load_dwordx4 v31, s[24:27], s87 offen offset:3072 lds
v_mfma_f32_16x16x32_bf16 v[208:211], v[112:115], a[44:47], v[208:211]
buffer_load_dwordx4 v[112:115], v55, s[20:23], s90 offen offset:2048 sc1
v_mfma_f32_16x16x32_bf16 v[140:143], v[56:59], a[32:35], v[140:143]
v_mfma_f32_16x16x32_bf16 v[164:167], v[56:59], a[36:39], v[164:167]
v_mfma_f32_16x16x32_bf16 v[188:191], v[56:59], a[40:43], v[188:191]
v_mfma_f32_16x16x32_bf16 v[212:215], v[56:59], a[44:47], v[212:215]
buffer_load_dwordx4 v[56:59], v33, s[20:23], s90 offen offset:1024 sc1
v_mfma_f32_16x16x32_bf16 v[144:147], v[60:63], a[32:35], v[144:147]
v_mfma_f32_16x16x32_bf16 v[168:171], v[60:63], a[36:39], v[168:171]
v_mfma_f32_16x16x32_bf16 v[192:195], v[60:63], a[40:43], v[192:195]
v_mfma_f32_16x16x32_bf16 v[216:219], v[60:63], a[44:47], v[216:219]
buffer_load_dwordx4 v[60:63], v33, s[20:23], s90 offen offset:3072 sc1
v_mfma_f32_16x16x32_bf16 v[148:151], v[64:67], a[32:35], v[148:151]
v_mfma_f32_16x16x32_bf16 v[172:175], v[64:67], a[36:39], v[172:175]
v_mfma_f32_16x16x32_bf16 v[196:199], v[64:67], a[40:43], v[196:199]
v_mfma_f32_16x16x32_bf16 v[220:223], v[64:67], a[44:47], v[220:223]
buffer_load_dwordx4 v[64:67], v47, s[20:23], s90 offen offset:1024 sc1
v_mfma_f32_16x16x32_bf16 v[128:131], v[68:71], a[48:51], v[128:131]
v_mfma_f32_16x16x32_bf16 v[152:155], v[68:71], a[52:55], v[152:155]
v_mfma_f32_16x16x32_bf16 v[176:179], v[68:71], a[56:59], v[176:179]
v_mfma_f32_16x16x32_bf16 v[200:203], v[68:71], a[60:63], v[200:203]
buffer_load_dwordx4 v[68:71], v47, s[20:23], s90 offen offset:3072 sc1
v_mfma_f32_16x16x32_bf16 v[132:135], v[72:75], a[48:51], v[132:135]
v_mfma_f32_16x16x32_bf16 v[156:159], v[72:75], a[52:55], v[156:159]
v_mfma_f32_16x16x32_bf16 v[180:183], v[72:75], a[56:59], v[180:183]
v_mfma_f32_16x16x32_bf16 v[204:207], v[72:75], a[60:63], v[204:207]
buffer_load_dwordx4 v[72:75], v55, s[20:23], s90 offen offset:1024 sc1
s_waitcnt vmcnt(22)
v_mfma_f32_16x16x32_bf16 v[136:139], v[76:79], a[48:51], v[136:139]
v_mfma_f32_16x16x32_bf16 v[160:163], v[76:79], a[52:55], v[160:163]
v_mfma_f32_16x16x32_bf16 v[184:187], v[76:79], a[56:59], v[184:187]
v_mfma_f32_16x16x32_bf16 v[208:211], v[76:79], a[60:63], v[208:211]
buffer_load_dwordx4 v[76:79], v55, s[20:23], s90 offen offset:3072 sc1
s_waitcnt vmcnt(22)
v_mfma_f32_16x16x32_bf16 v[140:143], v[80:83], a[48:51], v[140:143]
v_mfma_f32_16x16x32_bf16 v[164:167], v[80:83], a[52:55], v[164:167]
v_mfma_f32_16x16x32_bf16 v[188:191], v[80:83], a[56:59], v[188:191]
v_mfma_f32_16x16x32_bf16 v[212:215], v[80:83], a[60:63], v[212:215]
s_mul_i32 s90, s92, 90112
s_add_u32 s92, s92, 1
s_add_u32 s90, s90, s93
s_and_b32 s92, s92, 7
buffer_load_dwordx4 v[80:83], v33, s[20:23], s90 offen offset:0 sc1
s_waitcnt vmcnt(22)
v_mfma_f32_16x16x32_bf16 v[144:147], v[84:87], a[48:51], v[144:147]
v_mfma_f32_16x16x32_bf16 v[168:171], v[84:87], a[52:55], v[168:171]
v_mfma_f32_16x16x32_bf16 v[192:195], v[84:87], a[56:59], v[192:195]
v_mfma_f32_16x16x32_bf16 v[216:219], v[84:87], a[60:63], v[216:219]
buffer_load_dwordx4 v[84:87], v33, s[20:23], s90 offen offset:2048 sc1
s_waitcnt vmcnt(22)
v_mfma_f32_16x16x32_bf16 v[148:151], v[88:91], a[48:51], v[148:151]
v_mfma_f32_16x16x32_bf16 v[172:175], v[88:91], a[52:55], v[172:175]
v_mfma_f32_16x16x32_bf16 v[196:199], v[88:91], a[56:59], v[196:199]
v_mfma_f32_16x16x32_bf16 v[220:223], v[88:91], a[60:63], v[220:223]
buffer_load_dwordx4 v[88:91], v47, s[20:23], s90 offen offset:0 sc1
s_waitcnt vmcnt(21)
v_mfma_f32_16x16x32_bf16 v[128:131], v[92:95], a[64:67], v[128:131]
v_mfma_f32_16x16x32_bf16 v[152:155], v[92:95], a[68:71], v[152:155]
v_mfma_f32_16x16x32_bf16 v[176:179], v[92:95], a[72:75], v[176:179]
v_mfma_f32_16x16x32_bf16 v[200:203], v[92:95], a[76:79], v[200:203]
buffer_load_dwordx4 v[92:95], v47, s[20:23], s90 offen offset:2048 sc1
s_waitcnt vmcnt(20)
v_mfma_f32_16x16x32_bf16 v[132:135], v[96:99], a[64:67], v[132:135]
v_mfma_f32_16x16x32_bf16 v[156:159], v[96:99], a[68:71], v[156:159]
v_mfma_f32_16x16x32_bf16 v[180:183], v[96:99], a[72:75], v[180:183]
v_mfma_f32_16x16x32_bf16 v[204:207], v[96:99], a[76:79], v[204:207]
buffer_load_dwordx4 v[96:99], v55, s[20:23], s90 offen offset:0 sc1
s_waitcnt vmcnt(18)
v_mfma_f32_16x16x32_bf16 v[136:139], v[100:103], a[64:67], v[136:139]
v_mfma_f32_16x16x32_bf16 v[160:163], v[100:103], a[68:71], v[160:163]
v_mfma_f32_16x16x32_bf16 v[184:187], v[100:103], a[72:75], v[184:187]
v_mfma_f32_16x16x32_bf16 v[208:211], v[100:103], a[76:79], v[208:211]
buffer_load_dwordx4 v[100:103], v55, s[20:23], s90 offen offset:2048 sc1
s_waitcnt vmcnt(18)
v_mfma_f32_16x16x32_bf16 v[140:143], v[104:107], a[64:67], v[140:143]
v_mfma_f32_16x16x32_bf16 v[164:167], v[104:107], a[68:71], v[164:167]
v_mfma_f32_16x16x32_bf16 v[188:191], v[104:107], a[72:75], v[188:191]
v_mfma_f32_16x16x32_bf16 v[212:215], v[104:107], a[76:79], v[212:215]
buffer_load_dwordx4 v[104:107], v33, s[20:23], s90 offen offset:1024 sc1
s_waitcnt vmcnt(16)
v_mfma_f32_16x16x32_bf16 v[144:147], v[108:111], a[64:67], v[144:147]
v_mfma_f32_16x16x32_bf16 v[168:171], v[108:111], a[68:71], v[168:171]
v_mfma_f32_16x16x32_bf16 v[192:195], v[108:111], a[72:75], v[192:195]
v_mfma_f32_16x16x32_bf16 v[216:219], v[108:111], a[76:79], v[216:219]
buffer_load_dwordx4 v[108:111], v33, s[20:23], s90 offen offset:3072 sc1
s_waitcnt vmcnt(14)
v_mfma_f32_16x16x32_bf16 v[148:151], v[112:115], a[64:67], v[148:151]
v_mfma_f32_16x16x32_bf16 v[172:175], v[112:115], a[68:71], v[172:175]
v_mfma_f32_16x16x32_bf16 v[196:199], v[112:115], a[72:75], v[196:199]
v_mfma_f32_16x16x32_bf16 v[220:223], v[112:115], a[76:79], v[220:223]
buffer_load_dwordx4 v[112:115], v47, s[20:23], s90 offen offset:1024 sc1
s_waitcnt vmcnt(14)
v_mfma_f32_16x16x32_bf16 v[128:131], v[56:59], a[80:83], v[128:131]
v_mfma_f32_16x16x32_bf16 v[152:155], v[56:59], a[84:87], v[152:155]
v_mfma_f32_16x16x32_bf16 v[176:179], v[56:59], a[88:91], v[176:179]
v_mfma_f32_16x16x32_bf16 v[200:203], v[56:59], a[92:95], v[200:203]
buffer_load_dwordx4 v[56:59], v47, s[20:23], s90 offen offset:3072 sc1
s_waitcnt vmcnt(14)
v_mfma_f32_16x16x32_bf16 v[132:135], v[60:63], a[80:83], v[132:135]
v_mfma_f32_16x16x32_bf16 v[156:159], v[60:63], a[84:87], v[156:159]
v_mfma_f32_16x16x32_bf16 v[180:183], v[60:63], a[88:91], v[180:183]
v_mfma_f32_16x16x32_bf16 v[204:207], v[60:63], a[92:95], v[204:207]
buffer_load_dwordx4 v[60:63], v55, s[20:23], s90 offen offset:1024 sc1
s_waitcnt vmcnt(14)
v_mfma_f32_16x16x32_bf16 v[136:139], v[64:67], a[80:83], v[136:139]
v_mfma_f32_16x16x32_bf16 v[160:163], v[64:67], a[84:87], v[160:163]
v_mfma_f32_16x16x32_bf16 v[184:187], v[64:67], a[88:91], v[184:187]
v_mfma_f32_16x16x32_bf16 v[208:211], v[64:67], a[92:95], v[208:211]
buffer_load_dwordx4 v[64:67], v55, s[20:23], s90 offen offset:3072 sc1
s_waitcnt vmcnt(14)
v_mfma_f32_16x16x32_bf16 v[140:143], v[68:71], a[80:83], v[140:143]
v_mfma_f32_16x16x32_bf16 v[164:167], v[68:71], a[84:87], v[164:167]
v_mfma_f32_16x16x32_bf16 v[188:191], v[68:71], a[88:91], v[188:191]
v_mfma_f32_16x16x32_bf16 v[212:215], v[68:71], a[92:95], v[212:215]
s_mul_i32 s90, s92, 90112
s_add_u32 s92, s92, 1
s_add_u32 s90, s90, s93
s_and_b32 s92, s92, 7
buffer_load_dwordx4 v[68:71], v33, s[20:23], s90 offen offset:0 sc1
s_waitcnt vmcnt(14)
v_mfma_f32_16x16x32_bf16 v[144:147], v[72:75], a[80:83], v[144:147]
v_mfma_f32_16x16x32_bf16 v[168:171], v[72:75], a[84:87], v[168:171]
v_mfma_f32_16x16x32_bf16 v[192:195], v[72:75], a[88:91], v[192:195]
v_mfma_f32_16x16x32_bf16 v[216:219], v[72:75], a[92:95], v[216:219]
buffer_load_dwordx4 v[72:75], v33, s[20:23], s90 offen offset:2048 sc1
s_waitcnt vmcnt(14)
v_mfma_f32_16x16x32_bf16 v[148:151], v[76:79], a[80:83], v[148:151]
v_mfma_f32_16x16x32_bf16 v[172:175], v[76:79], a[84:87], v[172:175]
v_mfma_f32_16x16x32_bf16 v[196:199], v[76:79], a[88:91], v[196:199]
v_mfma_f32_16x16x32_bf16 v[220:223], v[76:79], a[92:95], v[220:223]
buffer_load_dwordx4 v[76:79], v47, s[20:23], s90 offen offset:0 sc1
s_waitcnt lgkmcnt(0)
s_barrier
s_waitcnt vmcnt(14)
v_mfma_f32_16x16x32_bf16 v[128:131], v[80:83], a[96:99], v[128:131]
v_mfma_f32_16x16x32_bf16 v[152:155], v[80:83], a[100:103], v[152:155]
v_mfma_f32_16x16x32_bf16 v[176:179], v[80:83], a[104:107], v[176:179]
v_mfma_f32_16x16x32_bf16 v[200:203], v[80:83], a[108:111], v[200:203]
buffer_load_dwordx4 v[80:83], v47, s[20:23], s90 offen offset:2048 sc1
s_waitcnt vmcnt(14)
v_mfma_f32_16x16x32_bf16 v[132:135], v[84:87], a[96:99], v[132:135]
v_mfma_f32_16x16x32_bf16 v[156:159], v[84:87], a[100:103], v[156:159]
v_mfma_f32_16x16x32_bf16 v[180:183], v[84:87], a[104:107], v[180:183]
v_mfma_f32_16x16x32_bf16 v[204:207], v[84:87], a[108:111], v[204:207]
buffer_load_dwordx4 v[84:87], v55, s[20:23], s90 offen offset:0 sc1
s_waitcnt vmcnt(14)
v_mfma_f32_16x16x32_bf16 v[136:139], v[88:91], a[96:99], v[136:139]
v_mfma_f32_16x16x32_bf16 v[160:163], v[88:91], a[100:103], v[160:163]
v_mfma_f32_16x16x32_bf16 v[184:187], v[88:91], a[104:107], v[184:187]
v_mfma_f32_16x16x32_bf16 v[208:211], v[88:91], a[108:111], v[208:211]
buffer_load_dwordx4 v[88:91], v55, s[20:23], s90 offen offset:2048 sc1
s_waitcnt vmcnt(14)
v_mfma_f32_16x16x32_bf16 v[140:143], v[92:95], a[96:99], v[140:143]
s_lshl_b32 s97, s47, 2
ds_read_b64_tr_b16 a[64:65], v40 offset:0
s_add_u32 s97, s97, s44
v_mfma_f32_16x16x32_bf16 v[164:167], v[92:95], a[100:103], v[164:167]
ds_read_b64_tr_b16 a[66:67], v40 offset:2048
s_mul_i32 s0, s97, 43
s_lshl_b32 s1, s88, 1
ds_read_b64_tr_b16 a[68:69], v41 offset:0
v_mfma_f32_16x16x32_bf16 v[188:191], v[92:95], a[104:107], v[188:191]
s_add_u32 s0, s0, s1
s_lshl_b32 s0, s0, 9
ds_read_b64_tr_b16 a[70:71], v41 offset:2048
v_mfma_f32_16x16x32_bf16 v[212:215], v[92:95], a[108:111], v[212:215]
buffer_load_dwordx4 v[92:95], v33, s[20:23], s90 offen offset:1024 sc1
s_waitcnt vmcnt(14)
v_mfma_f32_16x16x32_bf16 v[144:147], v[96:99], a[96:99], v[144:147]
s_add_u32 s70, s0, 3145216
s_mul_i32 s0, s97, 22
ds_read_b64_tr_b16 a[72:73], v42 offset:0
v_mfma_f32_16x16x32_bf16 v[168:171], v[96:99], a[100:103], v[168:171]
s_add_u32 s0, s0, s88
s_lshl_b32 s0, s0, 10
ds_read_b64_tr_b16 a[74:75], v42 offset:2048
v_mfma_f32_16x16x32_bf16 v[192:195], v[96:99], a[104:107], v[192:195]
s_add_u32 s71, s0, 9437184
s_cmp_eq_u32 s89, 3
s_cselect_b32 s72, s71, 0x40000000
ds_read_b64_tr_b16 a[76:77], v43 offset:0
v_mfma_f32_16x16x32_bf16 v[216:219], v[96:99], a[108:111], v[216:219]
buffer_load_dwordx4 v[96:99], v33, s[20:23], s90 offen offset:3072 sc1
s_waitcnt vmcnt(14)
v_mfma_f32_16x16x32_bf16 v[148:151], v[100:103], a[96:99], v[148:151]
s_cmp_eq_u32 s48, 0
s_cselect_b32 s68, 0, -1
ds_read_b64_tr_b16 a[78:79], v43 offset:2048
v_mfma_f32_16x16x32_bf16 v[172:175], v[100:103], a[100:103], v[172:175]
v_lshlrev_b32 v10, 1, v4
s_lshl_b32 s86, s97, 5
v_mfma_f32_16x16x32_bf16 v[196:199], v[100:103], a[104:107], v[196:199]
buffer_load_ushort v39, v10, s[36:39], s86 offen
v_mfma_f32_16x16x32_bf16 v[220:223], v[100:103], a[108:111], v[220:223]
buffer_load_dwordx4 v[100:103], v47, s[20:23], s90 offen offset:1024 sc1
s_waitcnt vmcnt(15)
v_mfma_f32_16x16x32_bf16 v[128:131], v[104:107], a[112:115], v[128:131]
ds_read_b64_tr_b16 a[80:81], v40 offset:4096
ds_read_b64_tr_b16 a[82:83], v40 offset:6144
v_mfma_f32_16x16x32_bf16 v[152:155], v[104:107], a[116:119], v[152:155]
ds_read_b64_tr_b16 a[84:85], v41 offset:4096
s_xor_b32 s0, s44, 2
s_mul_i32 s0, s0, 12288
ds_read_b64_tr_b16 a[86:87], v41 offset:6144
v_mfma_f32_16x16x32_bf16 v[176:179], v[104:107], a[120:123], v[176:179]
s_add_u32 s0, s0, 65536
v_add_u32 v20, s0, v32
ds_read_b64_tr_b16 a[88:89], v42 offset:4096
v_mfma_f32_16x16x32_bf16 v[200:203], v[104:107], a[124:127], v[200:203]
buffer_load_dwordx4 v[104:107], v47, s[20:23], s90 offen offset:3072 sc1
s_waitcnt vmcnt(15)
v_mfma_f32_16x16x32_bf16 v[132:135], v[108:111], a[112:115], v[132:135]
s_xor_b32 s0, s44, 0
s_mul_i32 s0, s0, 12288
ds_read_b64_tr_b16 a[90:91], v42 offset:6144
v_mfma_f32_16x16x32_bf16 v[156:159], v[108:111], a[116:119], v[156:159]
s_add_u32 s0, s0, 65536
ds_read_b64_tr_b16 a[92:93], v43 offset:4096
v_add_u32 v21, s0, v32
s_xor_b32 s0, s44, 1
v_mfma_f32_16x16x32_bf16 v[180:183], v[108:111], a[120:123], v[180:183]
ds_read_b64_tr_b16 a[94:95], v43 offset:6144
s_mul_i32 s0, s0, 12288
s_add_u32 s0, s0, 65536
v_mfma_f32_16x16x32_bf16 v[204:207], v[108:111], a[124:127], v[204:207]
buffer_load_dwordx4 v[108:111], v55, s[20:23], s90 offen offset:1024 sc1
s_waitcnt vmcnt(15)
v_mfma_f32_16x16x32_bf16 v[136:139], v[112:115], a[112:115], v[136:139]
v_add_u32 v22, s0, v32
s_lshl_b32 s97, s97, 10
s_add_u32 s73, s97, 12779520
v_mfma_f32_16x16x32_bf16 v[160:163], v[112:115], a[116:119], v[160:163]
s_lshl_b32 s1, s48, 7
s_add_u32 s98, s1, s73
s_lshl_b32 s0, s47, 2
v_mfma_f32_16x16x32_bf16 v[184:187], v[112:115], a[120:123], v[184:187]
s_add_u32 s74, s0, s44
v_lshlrev_b32 v52, 10, v4
v_lshl_add_u32 v52, v3, 3, v52
s_lshl_b32 s0, s74, 14
v_mfma_f32_16x16x32_bf16 v[208:211], v[112:115], a[124:127], v[208:211]
buffer_load_dwordx4 v[112:115], v55, s[20:23], s90 offen offset:3072 sc1
s_waitcnt vmcnt(15)
v_mfma_f32_16x16x32_bf16 v[140:143], v[56:59], a[112:115], v[140:143]
ds_read_b64_tr_b16 a[96:97], v40 offset:8192
s_lshl_b32 s1, s48, 7
ds_read_b64_tr_b16 a[98:99], v40 offset:10240
v_mfma_f32_16x16x32_bf16 v[164:167], v[56:59], a[116:119], v[164:167]
s_add_u32 s0, s0, s1
v_add_u32 v52, s0, v52
ds_read_b64_tr_b16 a[100:101], v41 offset:8192
v_mfma_f32_16x16x32_bf16 v[188:191], v[56:59], a[120:123], v[188:191]
s_mul_i32 s74, s74, 22528
s_add_u32 s74, s74, 9437184
ds_read_b64_tr_b16 a[102:103], v41 offset:10240
v_subrev_u32 v48, 73728, v40
v_mfma_f32_16x16x32_bf16 v[212:215], v[56:59], a[124:127], v[212:215]
s_mul_i32 s90, s92, 90112
s_add_u32 s92, s92, 1
s_add_u32 s90, s90, s93
s_and_b32 s92, s92, 7
buffer_load_dwordx4 v[56:59], v33, s[20:23], s90 offen offset:0 sc1
s_waitcnt vmcnt(15)
v_mfma_f32_16x16x32_bf16 v[144:147], v[60:63], a[112:115], v[144:147]
v_mfma_f32_16x16x32_bf16 v[168:171], v[60:63], a[116:119], v[168:171]
v_subrev_u32 v49, 73728, v41
ds_read_b64_tr_b16 a[104:105], v42 offset:8192
v_mfma_f32_16x16x32_bf16 v[192:195], v[60:63], a[120:123], v[192:195]
v_subrev_u32 v50, 73728, v42
v_subrev_u32 v51, 73728, v43
ds_read_b64_tr_b16 a[106:107], v42 offset:10240
v_mfma_f32_16x16x32_bf16 v[216:219], v[60:63], a[124:127], v[216:219]
buffer_load_dwordx4 v[60:63], v33, s[20:23], s90 offen offset:2048 sc1
s_waitcnt vmcnt(15)
v_mfma_f32_16x16x32_bf16 v[148:151], v[64:67], a[112:115], v[148:151]
v_add_u32 v16, 65536, v48
v_add_u32 v17, 65536, v49
ds_read_b64_tr_b16 a[108:109], v43 offset:8192
v_mfma_f32_16x16x32_bf16 v[172:175], v[64:67], a[116:119], v[172:175]
v_add_u32 v18, 65536, v50
v_add_u32 v19, 65536, v51
ds_read_b64_tr_b16 a[110:111], v43 offset:10240
v_and_b32 v9, 1, v0
v_mfma_f32_16x16x32_bf16 v[196:199], v[64:67], a[120:123], v[196:199]
v_lshlrev_b32 v9, 6, v9
v_lshl_add_u32 v9, v3, 4, v9
v_add_u32 v53, 155648, v9
v_mfma_f32_16x16x32_bf16 v[220:223], v[64:67], a[124:127], v[220:223]
buffer_load_dwordx4 v[64:67], v47, s[20:23], s90 offen offset:0 sc1
s_waitcnt vmcnt(15)
v_mfma_f32_16x16x32_bf16 v[128:131], v[68:71], a[128:131], v[128:131]
s_lshl_b32 s87, s44, 2
v_add_u32 v242, 139264, v32
s_add_u32 s87, s87, s47
v_mfma_f32_16x16x32_bf16 v[152:155], v[68:71], a[132:135], v[152:155]
v_lshlrev_b32 v243, 7, v1
v_add_u32 v23, s57, v242
s_add_u32 s87, s87, 0
v_mfma_f32_16x16x32_bf16 v[176:179], v[68:71], a[136:139], v[176:179]
v_lshlrev_b32 v10, 3, v0
s_lshl_b32 s0, s44, 9
s_and_b32 s87, s87, 15
s_add_u32 s0, s0, 155648
v_mfma_f32_16x16x32_bf16 v[200:203], v[68:71], a[140:143], v[200:203]
buffer_load_dwordx4 v[68:71], v47, s[20:23], s90 offen offset:2048 sc1
s_waitcnt vmcnt(15)
v_mfma_f32_16x16x32_bf16 v[132:135], v[72:75], a[128:131], v[132:135]
v_add_u32 v38, s0, v10
s_lshl_b32 m0, s87, 12
s_lshl_b32 s87, s87, 15
v_mfma_f32_16x16x32_bf16 v[156:159], v[72:75], a[132:135], v[156:159]
s_sub_u32 s56, s87, 16384
s_cselect_b32 s56, 0x40000000, s56
v_mfma_f32_16x16x32_bf16 v[180:183], v[72:75], a[136:139], v[180:183]
buffer_load_dwordx4 v28, s[28:31], s56 offen lds
v_mfma_f32_16x16x32_bf16 v[204:207], v[72:75], a[140:143], v[204:207]
buffer_load_dwordx4 v[72:75], v55, s[20:23], s90 offen offset:0 sc1
s_waitcnt vmcnt(16)
v_mfma_f32_16x16x32_bf16 v[136:139], v[76:79], a[128:131], v[136:139]
v_mfma_f32_16x16x32_bf16 v[160:163], v[76:79], a[132:135], v[160:163]
buffer_load_dwordx4 v29, s[28:31], s56 offen offset:1024 lds
v_mfma_f32_16x16x32_bf16 v[184:187], v[76:79], a[136:139], v[184:187]
s_add_u32 m0, m0, 2048
s_nop 0
v_mfma_f32_16x16x32_bf16 v[208:211], v[76:79], a[140:143], v[208:211]
buffer_load_dwordx4 v[76:79], v55, s[20:23], s90 offen offset:2048 sc1
s_waitcnt vmcnt(17)
v_mfma_f32_16x16x32_bf16 v[140:143], v[80:83], a[128:131], v[140:143]
buffer_load_dwordx4 v28, s[28:31], s87 offen lds
v_mfma_f32_16x16x32_bf16 v[164:167], v[80:83], a[132:135], v[164:167]
v_mfma_f32_16x16x32_bf16 v[188:191], v[80:83], a[136:139], v[188:191]
buffer_load_dwordx4 v29, s[28:31], s87 offen offset:1024 lds
v_mfma_f32_16x16x32_bf16 v[212:215], v[80:83], a[140:143], v[212:215]
buffer_load_dwordx4 v[80:83], v33, s[20:23], s90 offen offset:1024 sc1
s_waitcnt vmcnt(19)
v_mfma_f32_16x16x32_bf16 v[144:147], v[84:87], a[128:131], v[144:147]
v_mfma_f32_16x16x32_bf16 v[168:171], v[84:87], a[132:135], v[168:171]
v_mfma_f32_16x16x32_bf16 v[192:195], v[84:87], a[136:139], v[192:195]
v_mfma_f32_16x16x32_bf16 v[216:219], v[84:87], a[140:143], v[216:219]
buffer_load_dwordx4 v[84:87], v33, s[20:23], s90 offen offset:3072 sc1
s_waitcnt vmcnt(19)
v_mfma_f32_16x16x32_bf16 v[148:151], v[88:91], a[128:131], v[148:151]
v_mfma_f32_16x16x32_bf16 v[172:175], v[88:91], a[132:135], v[172:175]
v_mfma_f32_16x16x32_bf16 v[196:199], v[88:91], a[136:139], v[196:199]
v_mfma_f32_16x16x32_bf16 v[220:223], v[88:91], a[140:143], v[220:223]
buffer_load_dwordx4 v[88:91], v47, s[20:23], s90 offen offset:1024 sc1
s_waitcnt vmcnt(19)
v_mfma_f32_16x16x32_bf16 v[128:131], v[92:95], a[144:147], v[128:131]
v_lshrrev_b32 v11, 3, v0
s_lshl_b32 s87, s44, 2
v_lshlrev_b32 v11, 8, v11
v_mfma_f32_16x16x32_bf16 v[152:155], v[92:95], a[148:151], v[152:155]
s_add_u32 s87, s87, s47
v_bfe_u32 v12, v0, 2, 1
v_lshl_add_u32 v11, v12, 7, v11
s_add_u32 s87, s87, 1
v_mfma_f32_16x16x32_bf16 v[176:179], v[92:95], a[152:155], v[176:179]
s_lshl_b32 s86, s47, 11
s_add_u32 s86, s86, 196608
s_and_b32 s87, s87, 15
v_mfma_f32_16x16x32_bf16 v[200:203], v[92:95], a[156:159], v[200:203]
buffer_load_dwordx4 v[92:95], v47, s[20:23], s90 offen offset:3072 sc1
s_waitcnt vmcnt(19)
v_mfma_f32_16x16x32_bf16 v[132:135], v[96:99], a[144:147], v[132:135]
buffer_load_dwordx2 v[34:35], v11, s[20:23], s86 offen sc1
v_mfma_f32_16x16x32_bf16 v[156:159], v[96:99], a[148:151], v[156:159]
s_lshl_b32 m0, s87, 12
s_lshl_b32 s87, s87, 15
v_mfma_f32_16x16x32_bf16 v[180:183], v[96:99], a[152:155], v[180:183]
s_sub_u32 s56, s87, 16384
s_cselect_b32 s56, 0x40000000, s56
v_mfma_f32_16x16x32_bf16 v[204:207], v[96:99], a[156:159], v[204:207]
buffer_load_dwordx4 v[96:99], v55, s[20:23], s90 offen offset:1024 sc1
s_waitcnt vmcnt(19)
v_mfma_f32_16x16x32_bf16 v[136:139], v[100:103], a[144:147], v[136:139]
buffer_load_dwordx4 v28, s[28:31], s56 offen lds
v_mfma_f32_16x16x32_bf16 v[160:163], v[100:103], a[148:151], v[160:163]
v_mfma_f32_16x16x32_bf16 v[184:187], v[100:103], a[152:155], v[184:187]
buffer_load_dwordx4 v29, s[28:31], s56 offen offset:1024 lds
v_mfma_f32_16x16x32_bf16 v[208:211], v[100:103], a[156:159], v[208:211]
buffer_load_dwordx4 v[100:103], v55, s[20:23], s90 offen offset:3072 sc1
s_waitcnt vmcnt(21)
v_mfma_f32_16x16x32_bf16 v[140:143], v[104:107], a[144:147], v[140:143]
s_add_u32 m0, m0, 2048
s_nop 0
v_mfma_f32_16x16x32_bf16 v[164:167], v[104:107], a[148:151], v[164:167]
buffer_load_dwordx4 v28, s[28:31], s87 offen lds
v_mfma_f32_16x16x32_bf16 v[188:191], v[104:107], a[152:155], v[188:191]
buffer_load_dwordx4 v29, s[28:31], s87 offen offset:1024 lds
v_mfma_f32_16x16x32_bf16 v[212:215], v[104:107], a[156:159], v[212:215]
s_mul_i32 s90, s92, 90112
s_add_u32 s92, s92, 1
s_add_u32 s90, s90, s93
s_and_b32 s92, s92, 7
buffer_load_dwordx4 v[104:107], v33, s[20:23], s90 offen offset:0 sc1
s_waitcnt vmcnt(23)
v_mfma_f32_16x16x32_bf16 v[144:147], v[108:111], a[144:147], v[144:147]
v_mfma_f32_16x16x32_bf16 v[168:171], v[108:111], a[148:151], v[168:171]
v_mfma_f32_16x16x32_bf16 v[192:195], v[108:111], a[152:155], v[192:195]
v_mfma_f32_16x16x32_bf16 v[216:219], v[108:111], a[156:159], v[216:219]
buffer_load_dwordx4 v[108:111], v33, s[20:23], s90 offen offset:2048 sc1
s_waitcnt vmcnt(23)
v_mfma_f32_16x16x32_bf16 v[148:151], v[112:115], a[144:147], v[148:151]
v_mfma_f32_16x16x32_bf16 v[172:175], v[112:115], a[148:151], v[172:175]
v_mfma_f32_16x16x32_bf16 v[196:199], v[112:115], a[152:155], v[196:199]
v_mfma_f32_16x16x32_bf16 v[220:223], v[112:115], a[156:159], v[220:223]
buffer_load_dwordx4 v[112:115], v47, s[20:23], s90 offen offset:0 sc1
s_waitcnt vmcnt(23)
v_mfma_f32_16x16x32_bf16 v[128:131], v[56:59], a[160:163], v[128:131]
s_lshl_b32 s87, s44, 2
s_add_u32 s87, s87, s47
s_add_u32 s87, s87, 2
v_mfma_f32_16x16x32_bf16 v[152:155], v[56:59], a[164:167], v[152:155]
s_and_b32 s87, s87, 15
s_lshl_b32 m0, s87, 12
s_lshl_b32 s87, s87, 15
s_sub_u32 s56, s87, 16384
s_cselect_b32 s56, 0x40000000, s56
v_mfma_f32_16x16x32_bf16 v[176:179], v[56:59], a[168:171], v[176:179]
v_mfma_f32_16x16x32_bf16 v[200:203], v[56:59], a[172:175], v[200:203]
buffer_load_dwordx4 v[56:59], v47, s[20:23], s90 offen offset:2048 sc1
s_waitcnt vmcnt(23)
v_mfma_f32_16x16x32_bf16 v[132:135], v[60:63], a[160:163], v[132:135]
buffer_load_dwordx4 v28, s[28:31], s56 offen lds
v_mfma_f32_16x16x32_bf16 v[156:159], v[60:63], a[164:167], v[156:159]
v_mfma_f32_16x16x32_bf16 v[180:183], v[60:63], a[168:171], v[180:183]
buffer_load_dwordx4 v29, s[28:31], s56 offen offset:1024 lds
v_mfma_f32_16x16x32_bf16 v[204:207], v[60:63], a[172:175], v[204:207]
buffer_load_dwordx4 v[60:63], v55, s[20:23], s90 offen offset:0 sc1
s_waitcnt vmcnt(25)
v_mfma_f32_16x16x32_bf16 v[136:139], v[64:67], a[160:163], v[136:139]
s_add_u32 m0, m0, 2048
s_nop 0
v_mfma_f32_16x16x32_bf16 v[160:163], v[64:67], a[164:167], v[160:163]
buffer_load_dwordx4 v28, s[28:31], s87 offen lds
v_mfma_f32_16x16x32_bf16 v[184:187], v[64:67], a[168:171], v[184:187]
buffer_load_dwordx4 v29, s[28:31], s87 offen offset:1024 lds
v_mfma_f32_16x16x32_bf16 v[208:211], v[64:67], a[172:175], v[208:211]
buffer_load_dwordx4 v[64:67], v55, s[20:23], s90 offen offset:2048 sc1
s_waitcnt vmcnt(27)
v_mfma_f32_16x16x32_bf16 v[140:143], v[68:71], a[160:163], v[140:143]
ds_read_b64_tr_b16 a[112:113], v40 offset:12288
ds_read_b64_tr_b16 a[114:115], v40 offset:14336
v_mfma_f32_16x16x32_bf16 v[164:167], v[68:71], a[164:167], v[164:167]
s_waitcnt vmcnt(16)
v_cmp_ne_u64 vcc, v[34:35], v[26:27]
s_nop 3
s_cbranch_vccz L_ok_25
s_mov_b32 s62, 4000
L_sp_24:
s_sleep 3
v_lshrrev_b32 v11, 3, v0
v_lshlrev_b32 v11, 8, v11
v_bfe_u32 v12, v0, 2, 1
v_lshl_add_u32 v11, v12, 7, v11
s_lshl_b32 s86, s47, 11
s_add_u32 s86, s86, 196608
buffer_load_dwordx2 v[34:35], v11, s[20:23], s86 offen sc1
s_waitcnt vmcnt(0)
v_cmp_ne_u64 vcc, v[34:35], v[26:27]
s_sub_u32 s62, s62, 1
s_cbranch_scc1 L_ok_25
s_nop 1
s_cbranch_vccnz L_sp_24
L_ok_25:
v_mfma_f32_16x16x32_bf16 v[188:191], v[68:71], a[168:171], v[188:191]
v_mfma_f32_16x16x32_bf16 v[212:215], v[68:71], a[172:175], v[212:215]
buffer_load_dwordx4 v[68:71], v33, s[20:23], s90 offen offset:1024 sc1
v_mfma_f32_16x16x32_bf16 v[144:147], v[72:75], a[160:163], v[144:147]
v_mfma_f32_16x16x32_bf16 v[168:171], v[72:75], a[164:167], v[168:171]
v_mfma_f32_16x16x32_bf16 v[192:195], v[72:75], a[168:171], v[192:195]
v_mfma_f32_16x16x32_bf16 v[216:219], v[72:75], a[172:175], v[216:219]
buffer_load_dwordx4 v[72:75], v33, s[20:23], s90 offen offset:3072 sc1
v_mfma_f32_16x16x32_bf16 v[148:151], v[76:79], a[160:163], v[148:151]
v_mfma_f32_16x16x32_bf16 v[172:175], v[76:79], a[164:167], v[172:175]
ds_read_b64_tr_b16 a[116:117], v41 offset:12288
ds_read_b64_tr_b16 a[118:119], v41 offset:14336
ds_read_b64_tr_b16 a[120:121], v42 offset:12288
ds_read_b64_tr_b16 a[122:123], v42 offset:14336
v_mfma_f32_16x16x32_bf16 v[196:199], v[76:79], a[168:171], v[196:199]
ds_read_b64_tr_b16 a[124:125], v43 offset:12288
v_lshlrev_b32 v10, 3, v0
ds_read_b64_tr_b16 a[126:127], v43 offset:14336
v_mfma_f32_16x16x32_bf16 v[220:223], v[76:79], a[172:175], v[220:223]
buffer_load_dwordx4 v[76:79], v47, s[20:23], s90 offen offset:1024 sc1
v_mfma_f32_16x16x32_bf16 v[128:131], v[80:83], a[176:179], v[128:131]
buffer_load_dwordx2 v[116:117], v10, s[20:23], s70 offen offset:0 sc1
v_mfma_f32_16x16x32_bf16 v[152:155], v[80:83], a[180:183], v[152:155]
s_lshl_b32 s87, s44, 2
s_add_u32 s87, s87, s47
v_mfma_f32_16x16x32_bf16 v[176:179], v[80:83], a[184:187], v[176:179]
buffer_load_dwordx2 v[118:119], v10, s[20:23], s70 offen offset:512 sc1
v_mfma_f32_16x16x32_bf16 v[200:203], v[80:83], a[188:191], v[200:203]
buffer_load_dwordx4 v[80:83], v47, s[20:23], s90 offen offset:3072 sc1
v_mfma_f32_16x16x32_bf16 v[132:135], v[84:87], a[176:179], v[132:135]
s_add_u32 s87, s87, 3
s_and_b32 s87, s87, 15
v_mfma_f32_16x16x32_bf16 v[156:159], v[84:87], a[180:183], v[156:159]
buffer_load_dwordx2 v[120:121], v10, s[20:23], s70 offen offset:1024 sc1
v_mfma_f32_16x16x32_bf16 v[180:183], v[84:87], a[184:187], v[180:183]
s_lshl_b32 m0, s87, 12
s_lshl_b32 s87, s87, 15
s_sub_u32 s56, s87, 16384
s_cselect_b32 s56, 0x40000000, s56
v_mfma_f32_16x16x32_bf16 v[204:207], v[84:87], a[188:191], v[204:207]
buffer_load_dwordx4 v[84:87], v55, s[20:23], s90 offen offset:1024 sc1
v_mfma_f32_16x16x32_bf16 v[136:139], v[88:91], a[176:179], v[136:139]
v_mfma_f32_16x16x32_bf16 v[160:163], v[88:91], a[180:183], v[160:163]
buffer_load_dwordx2 v[122:123], v10, s[20:23], s70 offen offset:1536 sc1
v_mfma_f32_16x16x32_bf16 v[184:187], v[88:91], a[184:187], v[184:187]
buffer_load_dwordx2 v[124:125], v10, s[20:23], s70 offen offset:2048 sc1
v_mfma_f32_16x16x32_bf16 v[208:211], v[88:91], a[188:191], v[208:211]
buffer_load_dwordx4 v[88:91], v55, s[20:23], s90 offen offset:3072 sc1
v_mfma_f32_16x16x32_bf16 v[140:143], v[92:95], a[176:179], v[140:143]
v_mfma_f32_16x16x32_bf16 v[164:167], v[92:95], a[180:183], v[164:167]
buffer_load_dwordx4 v28, s[28:31], s56 offen lds
v_mfma_f32_16x16x32_bf16 v[188:191], v[92:95], a[184:187], v[188:191]
buffer_load_dwordx2 v[126:127], v10, s[20:23], s70 offen offset:2560 sc1
v_mfma_f32_16x16x32_bf16 v[212:215], v[92:95], a[188:191], v[212:215]
s_mul_i32 s90, s92, 90112
s_add_u32 s92, s92, 1
s_add_u32 s90, s90, s93
s_and_b32 s92, s92, 7
buffer_load_dwordx4 v[92:95], v33, s[20:23], s90 offen offset:0 sc1
s_waitcnt vmcnt(29)
v_mfma_f32_16x16x32_bf16 v[144:147], v[96:99], a[176:179], v[144:147]
v_mfma_f32_16x16x32_bf16 v[168:171], v[96:99], a[180:183], v[168:171]
v_mfma_f32_16x16x32_bf16 v[192:195], v[96:99], a[184:187], v[192:195]
buffer_load_dwordx4 v29, s[28:31], s56 offen offset:1024 lds
v_mfma_f32_16x16x32_bf16 v[216:219], v[96:99], a[188:191], v[216:219]
buffer_load_dwordx4 v[96:99], v33, s[20:23], s90 offen offset:2048 sc1
s_waitcnt vmcnt(28)
v_mfma_f32_16x16x32_bf16 v[148:151], v[100:103], a[176:179], v[148:151]
s_add_u32 m0, m0, 2048
s_nop 0
v_mfma_f32_16x16x32_bf16 v[172:175], v[100:103], a[180:183], v[172:175]
buffer_load_dwordx4 v28, s[28:31], s87 offen lds
v_mfma_f32_16x16x32_bf16 v[196:199], v[100:103], a[184:187], v[196:199]
buffer_load_dwordx4 v29, s[28:31], s87 offen offset:1024 lds
v_mfma_f32_16x16x32_bf16 v[220:223], v[100:103], a[188:191], v[220:223]
buffer_load_dwordx4 v[100:103], v47, s[20:23], s90 offen offset:0 sc1
s_waitcnt vmcnt(28)
v_mfma_f32_16x16x32_bf16 v[128:131], v[104:107], a[192:195], v[128:131]
ds_read_b64_tr_b16 a[128:129], v40 offset:16384
ds_read_b64_tr_b16 a[130:131], v40 offset:18432
v_mfma_f32_16x16x32_bf16 v[152:155], v[104:107], a[196:199], v[152:155]
ds_read_b64_tr_b16 a[132:133], v41 offset:16384
ds_read_b64_tr_b16 a[134:135], v41 offset:18432
ds_read_b64_tr_b16 a[136:137], v42 offset:16384
v_mfma_f32_16x16x32_bf16 v[176:179], v[104:107], a[200:203], v[176:179]
ds_read_b64_tr_b16 a[138:139], v42 offset:18432
ds_read_b64_tr_b16 a[140:141], v43 offset:16384
ds_read_b64_tr_b16 a[142:143], v43 offset:18432
v_mfma_f32_16x16x32_bf16 v[200:203], v[104:107], a[204:207], v[200:203]
buffer_load_dwordx4 v[104:107], v47, s[20:23], s90 offen offset:2048 sc1
s_waitcnt vmcnt(28)
v_mfma_f32_16x16x32_bf16 v[132:135], v[108:111], a[192:195], v[132:135]
v_mfma_f32_16x16x32_bf16 v[156:159], v[108:111], a[196:199], v[156:159]
v_mfma_f32_16x16x32_bf16 v[180:183], v[108:111], a[200:203], v[180:183]
v_mfma_f32_16x16x32_bf16 v[204:207], v[108:111], a[204:207], v[204:207]
buffer_load_dwordx4 v[108:111], v55, s[20:23], s90 offen offset:0 sc1
s_waitcnt vmcnt(28)
v_mfma_f32_16x16x32_bf16 v[136:139], v[112:115], a[192:195], v[136:139]
v_mfma_f32_16x16x32_bf16 v[160:163], v[112:115], a[196:199], v[160:163]
v_mfma_f32_16x16x32_bf16 v[184:187], v[112:115], a[200:203], v[184:187]
v_mfma_f32_16x16x32_bf16 v[208:211], v[112:115], a[204:207], v[208:211]
buffer_load_dwordx4 v[112:115], v55, s[20:23], s90 offen offset:2048 sc1
s_waitcnt vmcnt(28)
v_mfma_f32_16x16x32_bf16 v[140:143], v[56:59], a[192:195], v[140:143]
ds_read_b64_tr_b16 a[144:145], v40 offset:20480
ds_read_b64_tr_b16 a[146:147], v40 offset:22528
ds_read_b64_tr_b16 a[148:149], v41 offset:20480
v_mfma_f32_16x16x32_bf16 v[164:167], v[56:59], a[196:199], v[164:167]
ds_read_b64_tr_b16 a[150:151], v41 offset:22528
ds_read_b64_tr_b16 a[152:153], v42 offset:20480
ds_read_b64_tr_b16 a[154:155], v42 offset:22528
ds_read_b64_tr_b16 a[156:157], v43 offset:20480
v_mfma_f32_16x16x32_bf16 v[188:191], v[56:59], a[200:203], v[188:191]
ds_read_b64_tr_b16 a[158:159], v43 offset:22528
v_mfma_f32_16x16x32_bf16 v[212:215], v[56:59], a[204:207], v[212:215]
buffer_load_dwordx4 v[56:59], v33, s[20:23], s90 offen offset:1024 sc1
s_waitcnt vmcnt(26)
v_mfma_f32_16x16x32_bf16 v[144:147], v[60:63], a[192:195], v[144:147]
v_mfma_f32_16x16x32_bf16 v[168:171], v[60:63], a[196:199], v[168:171]
v_mfma_f32_16x16x32_bf16 v[192:195], v[60:63], a[200:203], v[192:195]
v_mfma_f32_16x16x32_bf16 v[216:219], v[60:63], a[204:207], v[216:219]
buffer_load_dwordx4 v[60:63], v33, s[20:23], s90 offen offset:3072 sc1
s_waitcnt vmcnt(24)
v_mfma_f32_16x16x32_bf16 v[148:151], v[64:67], a[192:195], v[148:151]
v_mfma_f32_16x16x32_bf16 v[172:175], v[64:67], a[196:199], v[172:175]
v_mfma_f32_16x16x32_bf16 v[196:199], v[64:67], a[200:203], v[196:199]
v_mfma_f32_16x16x32_bf16 v[220:223], v[64:67], a[204:207], v[220:223]
buffer_load_dwordx4 v[64:67], v47, s[20:23], s90 offen offset:1024 sc1
s_waitcnt vmcnt(24)
v_mfma_f32_16x16x32_bf16 v[128:131], v[68:71], a[208:211], v[128:131]
v_lshrrev_b32 v11, 3, v0
ds_read_b64_tr_b16 a[160:161], v40 offset:24576
v_lshlrev_b32 v11, 9, v11
v_mfma_f32_16x16x32_bf16 v[152:155], v[68:71], a[212:215], v[152:155]
ds_read_b64_tr_b16 a[162:163], v40 offset:26624
v_bfe_u32 v12, v0, 1, 2
v_lshl_add_u32 v11, v12, 7, v11
ds_read_b64_tr_b16 a[164:165], v41 offset:24576
v_mfma_f32_16x16x32_bf16 v[176:179], v[68:71], a[216:219], v[176:179]
s_lshl_b32 s86, s44, 12
s_add_u32 s86, s86, 40960
ds_read_b64_tr_b16 a[166:167], v41 offset:26624
v_mfma_f32_16x16x32_bf16 v[200:203], v[68:71], a[220:223], v[200:203]
buffer_load_dwordx4 v[68:71], v47, s[20:23], s90 offen offset:3072 sc1
s_waitcnt vmcnt(24)
v_mfma_f32_16x16x32_bf16 v[132:135], v[72:75], a[208:211], v[132:135]
buffer_load_dwordx2 v[34:35], v11, s[20:23], s86 offen sc1
v_mfma_f32_16x16x32_bf16 v[156:159], v[72:75], a[212:215], v[156:159]
ds_read_b64_tr_b16 a[168:169], v42 offset:24576
ds_read_b64_tr_b16 a[170:171], v42 offset:26624
v_mfma_f32_16x16x32_bf16 v[180:183], v[72:75], a[216:219], v[180:183]
v_mov_b32 v252, v25
ds_read_b64_tr_b16 a[172:173], v43 offset:24576
v_mov_b32 v253, v25
v_mov_b32 v254, v25
v_mfma_f32_16x16x32_bf16 v[204:207], v[72:75], a[220:223], v[204:207]
buffer_load_dwordx4 v[72:75], v55, s[20:23], s90 offen offset:1024 sc1
s_waitcnt vmcnt(25)
v_mfma_f32_16x16x32_bf16 v[136:139], v[76:79], a[208:211], v[136:139]
ds_read_b64_tr_b16 a[174:175], v43 offset:26624
v_mov_b32 v255, v25
v_mfma_f32_16x16x32_bf16 v[160:163], v[76:79], a[212:215], v[160:163]
buffer_load_dwordx2 v[244:245], v52, s[4:7], 0 offen offset:0
v_mfma_f32_16x16x32_bf16 v[184:187], v[76:79], a[216:219], v[184:187]
buffer_load_dwordx2 v[246:247], v52, s[4:7], 0 offen offset:32
v_mfma_f32_16x16x32_bf16 v[208:211], v[76:79], a[220:223], v[208:211]
buffer_load_dwordx4 v[76:79], v55, s[20:23], s90 offen offset:3072 sc1
s_waitcnt vmcnt(25)
v_mfma_f32_16x16x32_bf16 v[140:143], v[80:83], a[208:211], v[140:143]
ds_read_b64_tr_b16 a[176:177], v40 offset:28672
ds_read_b64_tr_b16 a[178:179], v40 offset:30720
v_mfma_f32_16x16x32_bf16 v[164:167], v[80:83], a[212:215], v[164:167]
ds_read_b64_tr_b16 a[180:181], v41 offset:28672
ds_read_b64_tr_b16 a[182:183], v41 offset:30720
ds_read_b64_tr_b16 a[184:185], v42 offset:28672
v_mfma_f32_16x16x32_bf16 v[188:191], v[80:83], a[216:219], v[188:191]
buffer_load_dwordx2 v[248:249], v52, s[4:7], 0 offen offset:64
v_mfma_f32_16x16x32_bf16 v[212:215], v[80:83], a[220:223], v[212:215]
buffer_load_dwordx2 v[250:251], v52, s[4:7], 0 offen offset:96
s_waitcnt vmcnt(25)
v_mfma_f32_16x16x32_bf16 v[144:147], v[84:87], a[208:211], v[144:147]
ds_read_b64_tr_b16 a[186:187], v42 offset:30720
ds_read_b64_tr_b16 a[188:189], v43 offset:28672
v_mfma_f32_16x16x32_bf16 v[168:171], v[84:87], a[212:215], v[168:171]
ds_read_b64_tr_b16 a[190:191], v43 offset:30720
v_mfma_f32_16x16x32_bf16 v[192:195], v[84:87], a[216:219], v[192:195]
v_mfma_f32_16x16x32_bf16 v[216:219], v[84:87], a[220:223], v[216:219]
s_waitcnt vmcnt(22)
v_mfma_f32_16x16x32_bf16 v[148:151], v[88:91], a[208:211], v[148:151]
v_mfma_f32_16x16x32_bf16 v[172:175], v[88:91], a[212:215], v[172:175]
v_mfma_f32_16x16x32_bf16 v[196:199], v[88:91], a[216:219], v[196:199]
v_mfma_f32_16x16x32_bf16 v[220:223], v[88:91], a[220:223], v[220:223]
s_waitcnt vmcnt(19)
v_mfma_f32_16x16x32_bf16 v[128:131], v[92:95], a[224:227], v[128:131]
ds_read_b64_tr_b16 a[192:193], v40 offset:32768
ds_read_b64_tr_b16 a[194:195], v40 offset:34816
ds_read_b64_tr_b16 a[196:197], v41 offset:32768
ds_read_b64_tr_b16 a[198:199], v41 offset:34816
v_mfma_f32_16x16x32_bf16 v[152:155], v[92:95], a[228:231], v[152:155]
ds_read_b64_tr_b16 a[200:201], v42 offset:32768
ds_read_b64_tr_b16 a[202:203], v42 offset:34816
ds_read_b64_tr_b16 a[204:205], v43 offset:32768
v_mfma_f32_16x16x32_bf16 v[176:179], v[92:95], a[232:235], v[176:179]
ds_read_b64_tr_b16 a[206:207], v43 offset:34816
ds_read_b64_tr_b16 a[208:209], v40 offset:36864
ds_read_b64_tr_b16 a[210:211], v40 offset:38912
ds_read_b64_tr_b16 a[212:213], v41 offset:36864
v_mfma_f32_16x16x32_bf16 v[200:203], v[92:95], a[236:239], v[200:203]
ds_read_b64_tr_b16 a[214:215], v41 offset:38912
ds_read_b64_tr_b16 a[216:217], v42 offset:36864
ds_read_b64_tr_b16 a[218:219], v42 offset:38912
s_waitcnt vmcnt(17)
v_mfma_f32_16x16x32_bf16 v[132:135], v[96:99], a[224:227], v[132:135]
ds_read_b64_tr_b16 a[220:221], v43 offset:36864
ds_read_b64_tr_b16 a[222:223], v43 offset:38912
v_mfma_f32_16x16x32_bf16 v[156:159], v[96:99], a[228:231], v[156:159]
v_mfma_f32_16x16x32_bf16 v[180:183], v[96:99], a[232:235], v[180:183]
v_mfma_f32_16x16x32_bf16 v[204:207], v[96:99], a[236:239], v[204:207]
s_waitcnt vmcnt(14)
v_mfma_f32_16x16x32_bf16 v[136:139], v[100:103], a[224:227], v[136:139]
v_mfma_f32_16x16x32_bf16 v[160:163], v[100:103], a[228:231], v[160:163]
v_mfma_f32_16x16x32_bf16 v[184:187], v[100:103], a[232:235], v[184:187]
v_mfma_f32_16x16x32_bf16 v[208:211], v[100:103], a[236:239], v[208:211]
s_waitcnt vmcnt(13)
v_mfma_f32_16x16x32_bf16 v[140:143], v[104:107], a[224:227], v[140:143]
s_mov_b32 s95, 0
s_waitcnt vmcnt(6)
v_cmp_ne_u64 vcc, v[34:35], v[26:27]
s_nop 3
s_cbranch_vccnz L_s3n_27
v_lshlrev_b32 v10, 3, v0
s_add_u32 s86, s57, 9306112
buffer_load_dwordx2 v[224:225], v10, s[20:23], s86 offen offset:0 sc1
buffer_load_dwordx2 v[226:227], v10, s[20:23], s86 offen offset:512 sc1
buffer_load_dwordx2 v[228:229], v10, s[20:23], s86 offen offset:1024 sc1
buffer_load_dwordx2 v[230:231], v10, s[20:23], s86 offen offset:1536 sc1
buffer_load_dwordx2 v[232:233], v10, s[20:23], s86 offen offset:2048 sc1
buffer_load_dwordx2 v[234:235], v10, s[20:23], s86 offen offset:2560 sc1
buffer_load_dwordx2 v[236:237], v10, s[20:23], s86 offen offset:3072 sc1
buffer_load_dwordx2 v[238:239], v10, s[20:23], s86 offen offset:3584 sc1
v_and_b32 v11, 56, v0
v_lshl_add_u32 v10, v11, 3, v10
s_lshl_b32 s0, s44, 10
s_add_u32 s86, s0, 9322496
buffer_load_dwordx2 v[240:241], v10, s[20:23], s86 offen sc1
s_mov_b32 s95, 1
L_s3n_27:
v_mfma_f32_16x16x32_bf16 v[164:167], v[104:107], a[228:231], v[164:167]
v_mfma_f32_16x16x32_bf16 v[188:191], v[104:107], a[232:235], v[188:191]
v_mfma_f32_16x16x32_bf16 v[212:215], v[104:107], a[236:239], v[212:215]
v_mfma_f32_16x16x32_bf16 v[144:147], v[108:111], a[224:227], v[144:147]
v_mfma_f32_16x16x32_bf16 v[168:171], v[108:111], a[228:231], v[168:171]
s_lshl_b32 s0, s47, 2
s_add_u32 s0, s0, s44
v_mfma_f32_16x16x32_bf16 v[192:195], v[108:111], a[232:235], v[192:195]
s_lshl_b32 s0, s0, 14
s_add_u32 s0, s0, 6029312
s_add_u32 s86, s0, 0
v_mfma_f32_16x16x32_bf16 v[216:219], v[108:111], a[236:239], v[216:219]
buffer_load_dwordx4 a[0:3], v32, s[20:23], s86 offen offset:0 sc1
v_mfma_f32_16x16x32_bf16 v[148:151], v[112:115], a[224:227], v[148:151]
buffer_load_dwordx4 a[4:7], v32, s[20:23], s86 offen offset:1024 sc1
v_mfma_f32_16x16x32_bf16 v[172:175], v[112:115], a[228:231], v[172:175]
v_mfma_f32_16x16x32_bf16 v[196:199], v[112:115], a[232:235], v[196:199]
buffer_load_dwordx4 a[8:11], v32, s[20:23], s86 offen offset:2048 sc1
v_mfma_f32_16x16x32_bf16 v[220:223], v[112:115], a[236:239], v[220:223]
buffer_load_dwordx4 a[12:15], v32, s[20:23], s86 offen offset:3072 sc1
s_waitcnt lgkmcnt(0)
s_barrier
v_mfma_f32_16x16x32_bf16 v[128:131], v[56:59], a[240:243], v[128:131]
s_add_u32 s86, s0, 4096
buffer_load_dwordx4 a[16:19], v32, s[20:23], s86 offen offset:0 sc1
v_mfma_f32_16x16x32_bf16 v[152:155], v[56:59], a[244:247], v[152:155]
v_mfma_f32_16x16x32_bf16 v[176:179], v[56:59], a[248:251], v[176:179]
buffer_load_dwordx4 a[20:23], v32, s[20:23], s86 offen offset:1024 sc1
v_mfma_f32_16x16x32_bf16 v[200:203], v[56:59], a[252:255], v[200:203]
buffer_load_dwordx4 a[24:27], v32, s[20:23], s86 offen offset:2048 sc1
v_mfma_f32_16x16x32_bf16 v[132:135], v[60:63], a[240:243], v[132:135]
v_mfma_f32_16x16x32_bf16 v[156:159], v[60:63], a[244:247], v[156:159]
buffer_load_dwordx4 a[28:31], v32, s[20:23], s86 offen offset:3072 sc1
v_mfma_f32_16x16x32_bf16 v[180:183], v[60:63], a[248:251], v[180:183]
v_mfma_f32_16x16x32_bf16 v[204:207], v[60:63], a[252:255], v[204:207]
v_mfma_f32_16x16x32_bf16 v[136:139], v[64:67], a[240:243], v[136:139]
v_mfma_f32_16x16x32_bf16 v[160:163], v[64:67], a[244:247], v[160:163]
v_mfma_f32_16x16x32_bf16 v[184:187], v[64:67], a[248:251], v[184:187]
v_mfma_f32_16x16x32_bf16 v[208:211], v[64:67], a[252:255], v[208:211]
v_mfma_f32_16x16x32_bf16 v[212:215], v[68:71], a[252:255], v[212:215]
s_waitcnt vmcnt(13)
v_mfma_f32_16x16x32_bf16 v[216:219], v[72:75], a[252:255], v[216:219]
s_waitcnt vmcnt(10)
v_mfma_f32_16x16x32_bf16 v[220:223], v[76:79], a[252:255], v[220:223]
v_mfma_f32_16x16x32_bf16 v[188:191], v[68:71], a[248:251], v[188:191]
v_mfma_f32_16x16x32_bf16 v[192:195], v[72:75], a[248:251], v[192:195]
v_mfma_f32_16x16x32_bf16 v[196:199], v[76:79], a[248:251], v[196:199]
v_mfma_f32_16x16x32_bf16 v[164:167], v[68:71], a[244:247], v[164:167]
v_mfma_f32_16x16x32_bf16 v[168:171], v[72:75], a[244:247], v[168:171]
v_mfma_f32_16x16x32_bf16 v[172:175], v[76:79], a[244:247], v[172:175]
v_mfma_f32_16x16x32_bf16 v[140:143], v[68:71], a[240:243], v[140:143]
v_mfma_f32_16x16x32_bf16 v[144:147], v[72:75], a[240:243], v[144:147]
v_mfma_f32_16x16x32_bf16 v[148:151], v[76:79], a[240:243], v[148:151]
s_branch L_join
L_notP:
s_cmp_lt_u32 s46, 11
s_cbranch_scc0 L_pathR
s_add_u32 m0, s57, 114688
s_mul_i32 s87, s94, s52
buffer_load_dwordx4 v40, s[12:15], s87 offen lds
buffer_load_dwordx4 v41, s[12:15], s87 offen offset:1024 lds
buffer_load_dwordx4 v42, s[12:15], s87 offen offset:2048 lds
buffer_load_dwordx4 v43, s[12:15], s87 offen offset:3072 lds
s_add_u32 s94, s94, 128
s_and_b32 s94, s94, 1023
s_lshl_b32 s53, s91, 7
v_lshrrev_b32 v5, 5, v0
v_lshlrev_b32 v5, 4, v5
v_add_u32 v5, s53, v5
v_add_u32 v5, 160768, v5
ds_read_b128 v[192:195], v5 offset:0
ds_read_b128 v[196:199], v5 offset:32
ds_read_b128 v[200:203], v5 offset:64
ds_read_b128 v[204:207], v5 offset:96
v_mov_b32 v112, 0
v_mov_b32 v113, 0
v_mov_b32 v114, 0
v_mov_b32 v115, 0
s_or_b32 s53, s91, s46
s_cmp_eq_u32 s53, 0
s_cselect_b32 s68, 0, -1
s_xor_b32 s54, s91, 1
s_or_b32 s53, s54, s46
s_cmp_eq_u32 s53, 0
s_cselect_b32 s69, 0, -1
s_lshl_b32 s54, s54, 7
s_mul_i32 s95, s96, 6144
s_add_u32 s95, s95, 12320768
s_lshl_b32 s53, s46, 9
s_add_u32 s63, s95, s53
s_waitcnt lgkmcnt(3)
v_pk_mul_f32 v[208:209], v[192:193], v[48:49] op_sel:[0,1] op_sel_hi:[1,1]
v_pk_mul_f32 v[210:211], v[194:195], v[48:49] op_sel:[0,1] op_sel_hi:[1,1]
s_waitcnt lgkmcnt(2)
v_pk_mul_f32 v[212:213], v[196:197], v[48:49] op_sel:[0,1] op_sel_hi:[1,1]
v_pk_mul_f32 v[214:215], v[198:199], v[48:49] op_sel:[0,1] op_sel_hi:[1,1]
v_pk_fma_f32 v[208:209], v[56:57], v[48:49], v[208:209] op_sel:[0,0,0] op_sel_hi:[1,0,1]
v_pk_fma_f32 v[210:211], v[58:59], v[48:49], v[210:211] op_sel:[0,0,0] op_sel_hi:[1,0,1]
v_pk_fma_f32 v[212:213], v[60:61], v[48:49], v[212:213] op_sel:[0,0,0] op_sel_hi:[1,0,1]
v_pk_fma_f32 v[214:215], v[62:63], v[48:49], v[214:215] op_sel:[0,0,0] op_sel_hi:[1,0,1]
v_pk_mul_f32 v[216:217], v[208:209], v[208:209]
v_pk_mul_f32 v[218:219], v[210:211], v[210:211]
v_pk_mul_f32 v[220:221], v[212:213], v[212:213]
v_pk_mul_f32 v[222:223], v[214:215], v[214:215]
v_pk_fma_f32 v[216:217], v[216:217], v[52:53], v[52:53] op_sel:[0,0,1] op_sel_hi:[1,0,1]
v_pk_fma_f32 v[218:219], v[218:219], v[52:53], v[52:53] op_sel:[0,0,1] op_sel_hi:[1,0,1]
v_pk_fma_f32 v[220:221], v[220:221], v[52:53], v[52:53] op_sel:[0,0,1] op_sel_hi:[1,0,1]
v_pk_fma_f32 v[222:223], v[222:223], v[52:53], v[52:53] op_sel:[0,0,1] op_sel_hi:[1,0,1]
v_pk_mul_f32 v[216:217], v[216:217], v[208:209]
v_pk_mul_f32 v[218:219], v[218:219], v[210:211]
v_pk_mul_f32 v[220:221], v[220:221], v[212:213]
v_pk_mul_f32 v[222:223], v[222:223], v[214:215]
v_exp_f32 v216, v216
v_exp_f32 v217, v217
v_exp_f32 v218, v218
v_exp_f32 v219, v219
v_exp_f32 v220, v220
v_exp_f32 v221, v221
v_exp_f32 v222, v222
v_exp_f32 v223, v223
v_pk_add_f32 v[216:217], v[216:217], 1.0 op_sel_hi:[1,0]
v_pk_add_f32 v[218:219], v[218:219], 1.0 op_sel_hi:[1,0]
v_pk_add_f32 v[220:221], v[220:221], 1.0 op_sel_hi:[1,0]
v_pk_add_f32 v[222:223], v[222:223], 1.0 op_sel_hi:[1,0]
v_rcp_f32 v216, v216
v_rcp_f32 v217, v217
v_rcp_f32 v218, v218
v_rcp_f32 v219, v219
v_rcp_f32 v220, v220
v_rcp_f32 v221, v221
v_rcp_f32 v222, v222
v_rcp_f32 v223, v223
v_pk_mul_f32 v[208:209], v[208:209], v[216:217]
v_pk_mul_f32 v[210:211], v[210:211], v[218:219]
v_pk_mul_f32 v[212:213], v[212:213], v[220:221]
v_pk_mul_f32 v[214:215], v[214:215], v[222:223]
v_cvt_pk_bf16_f32 v88, v208, v209
v_cvt_pk_bf16_f32 v89, v210, v211
v_cvt_pk_bf16_f32 v90, v212, v213
v_cvt_pk_bf16_f32 v91, v214, v215
s_waitcnt lgkmcnt(1)
v_pk_mul_f32 v[208:209], v[200:201], v[48:49] op_sel:[0,1] op_sel_hi:[1,1]
v_pk_mul_f32 v[210:211], v[202:203], v[48:49] op_sel:[0,1] op_sel_hi:[1,1]
s_waitcnt lgkmcnt(0)
v_pk_mul_f32 v[212:213], v[204:205], v[48:49] op_sel:[0,1] op_sel_hi:[1,1]
v_pk_mul_f32 v[214:215], v[206:207], v[48:49] op_sel:[0,1] op_sel_hi:[1,1]
v_pk_fma_f32 v[208:209], v[64:65], v[48:49], v[208:209] op_sel:[0,0,0] op_sel_hi:[1,0,1]
v_pk_fma_f32 v[210:211], v[66:67], v[48:49], v[210:211] op_sel:[0,0,0] op_sel_hi:[1,0,1]
v_pk_fma_f32 v[212:213], v[68:69], v[48:49], v[212:213] op_sel:[0,0,0] op_sel_hi:[1,0,1]
v_pk_fma_f32 v[214:215], v[70:71], v[48:49], v[214:215] op_sel:[0,0,0] op_sel_hi:[1,0,1]
v_pk_mul_f32 v[216:217], v[208:209], v[208:209]
v_pk_mul_f32 v[218:219], v[210:211], v[210:211]
v_pk_mul_f32 v[220:221], v[212:213], v[212:213]
v_pk_mul_f32 v[222:223], v[214:215], v[214:215]
v_pk_fma_f32 v[216:217], v[216:217], v[52:53], v[52:53] op_sel:[0,0,1] op_sel_hi:[1,0,1]
v_pk_fma_f32 v[218:219], v[218:219], v[52:53], v[52:53] op_sel:[0,0,1] op_sel_hi:[1,0,1]
v_pk_fma_f32 v[220:221], v[220:221], v[52:53], v[52:53] op_sel:[0,0,1] op_sel_hi:[1,0,1]
v_pk_fma_f32 v[222:223], v[222:223], v[52:53], v[52:53] op_sel:[0,0,1] op_sel_hi:[1,0,1]
v_pk_mul_f32 v[216:217], v[216:217], v[208:209]
v_pk_mul_f32 v[218:219], v[218:219], v[210:211]
v_pk_mul_f32 v[220:221], v[220:221], v[212:213]
v_pk_mul_f32 v[222:223], v[222:223], v[214:215]
v_exp_f32 v216, v216
v_exp_f32 v217, v217
v_exp_f32 v218, v218
v_exp_f32 v219, v219
v_exp_f32 v220, v220
v_exp_f32 v221, v221
v_exp_f32 v222, v222
v_exp_f32 v223, v223
v_pk_add_f32 v[216:217], v[216:217], 1.0 op_sel_hi:[1,0]
v_pk_add_f32 v[218:219], v[218:219], 1.0 op_sel_hi:[1,0]
v_pk_add_f32 v[220:221], v[220:221], 1.0 op_sel_hi:[1,0]
v_pk_add_f32 v[222:223], v[222:223], 1.0 op_sel_hi:[1,0]
v_rcp_f32 v216, v216
v_rcp_f32 v217, v217
v_rcp_f32 v218, v218
v_rcp_f32 v219, v219
v_rcp_f32 v220, v220
v_rcp_f32 v221, v221
v_rcp_f32 v222, v222
v_rcp_f32 v223, v223
v_pk_mul_f32 v[208:209], v[208:209], v[216:217]
v_pk_mul_f32 v[210:211], v[210:211], v[218:219]
v_pk_mul_f32 v[212:213], v[212:213], v[220:221]
v_pk_mul_f32 v[214:215], v[214:215], v[222:223]
v_cvt_pk_bf16_f32 v92, v208, v209
v_cvt_pk_bf16_f32 v93, v210, v211
v_cvt_pk_bf16_f32 v94, v212, v213
v_cvt_pk_bf16_f32 v95, v214, v215
v_lshrrev_b32 v5, 5, v0
v_lshlrev_b32 v5, 4, v5
v_add_u32 v5, s54, v5
v_add_u32 v5, 160768, v5
ds_read_b128 v[192:195], v5 offset:0
ds_read_b128 v[196:199], v5 offset:32
ds_read_b128 v[200:203], v5 offset:64
ds_read_b128 v[204:207], v5 offset:96
v_and_b32 v88, s68, v88
v_and_b32 v89, s68, v89
v_and_b32 v90, s68, v90
v_and_b32 v91, s68, v91
v_dot2_f32_bf16 v112, v88, s60, v112
v_dot2_f32_bf16 v113, v88, v88, v113
v_dot2_f32_bf16 v114, v89, s60, v114
v_dot2_f32_bf16 v115, v89, v89, v115
v_dot2_f32_bf16 v112, v90, s60, v112
v_dot2_f32_bf16 v113, v90, v90, v113
v_dot2_f32_bf16 v114, v91, s60, v114
v_dot2_f32_bf16 v115, v91, v91, v115
v_dot2_f32_bf16 v112, v92, s60, v112
v_dot2_f32_bf16 v113, v92, v92, v113
v_dot2_f32_bf16 v114, v93, s60, v114
v_dot2_f32_bf16 v115, v93, v93, v115
v_dot2_f32_bf16 v112, v94, s60, v112
v_dot2_f32_bf16 v113, v94, v94, v113
v_dot2_f32_bf16 v114, v95, s60, v114
v_dot2_f32_bf16 v115, v95, v95, v115
s_waitcnt lgkmcnt(3)
v_pk_mul_f32 v[208:209], v[192:193], v[48:49] op_sel:[0,1] op_sel_hi:[1,1]
v_pk_mul_f32 v[210:211], v[194:195], v[48:49] op_sel:[0,1] op_sel_hi:[1,1]
s_waitcnt lgkmcnt(2)
v_pk_mul_f32 v[212:213], v[196:197], v[48:49] op_sel:[0,1] op_sel_hi:[1,1]
v_pk_mul_f32 v[214:215], v[198:199], v[48:49] op_sel:[0,1] op_sel_hi:[1,1]
v_pk_fma_f32 v[208:209], v[72:73], v[48:49], v[208:209] op_sel:[0,0,0] op_sel_hi:[1,0,1]
v_pk_fma_f32 v[210:211], v[74:75], v[48:49], v[210:211] op_sel:[0,0,0] op_sel_hi:[1,0,1]
v_pk_fma_f32 v[212:213], v[76:77], v[48:49], v[212:213] op_sel:[0,0,0] op_sel_hi:[1,0,1]
v_pk_fma_f32 v[214:215], v[78:79], v[48:49], v[214:215] op_sel:[0,0,0] op_sel_hi:[1,0,1]
v_pk_mul_f32 v[216:217], v[208:209], v[208:209]
v_pk_mul_f32 v[218:219], v[210:211], v[210:211]
v_pk_mul_f32 v[220:221], v[212:213], v[212:213]
v_pk_mul_f32 v[222:223], v[214:215], v[214:215]
v_pk_fma_f32 v[216:217], v[216:217], v[52:53], v[52:53] op_sel:[0,0,1] op_sel_hi:[1,0,1]
v_pk_fma_f32 v[218:219], v[218:219], v[52:53], v[52:53] op_sel:[0,0,1] op_sel_hi:[1,0,1]
v_pk_fma_f32 v[220:221], v[220:221], v[52:53], v[52:53] op_sel:[0,0,1] op_sel_hi:[1,0,1]
v_pk_fma_f32 v[222:223], v[222:223], v[52:53], v[52:53] op_sel:[0,0,1] op_sel_hi:[1,0,1]
v_pk_mul_f32 v[216:217], v[216:217], v[208:209]
v_pk_mul_f32 v[218:219], v[218:219], v[210:211]
v_pk_mul_f32 v[220:221], v[220:221], v[212:213]
v_pk_mul_f32 v[222:223], v[222:223], v[214:215]
v_exp_f32 v216, v216
v_exp_f32 v217, v217
v_exp_f32 v218, v218
v_exp_f32 v219, v219
v_exp_f32 v220, v220
v_exp_f32 v221, v221
v_exp_f32 v222, v222
v_exp_f32 v223, v223
v_pk_add_f32 v[216:217], v[216:217], 1.0 op_sel_hi:[1,0]
v_pk_add_f32 v[218:219], v[218:219], 1.0 op_sel_hi:[1,0]
v_pk_add_f32 v[220:221], v[220:221], 1.0 op_sel_hi:[1,0]
v_pk_add_f32 v[222:223], v[222:223], 1.0 op_sel_hi:[1,0]
v_rcp_f32 v216, v216
v_rcp_f32 v217, v217
v_rcp_f32 v218, v218
v_rcp_f32 v219, v219
v_rcp_f32 v220, v220
v_rcp_f32 v221, v221
v_rcp_f32 v222, v222
v_rcp_f32 v223, v223
v_pk_mul_f32 v[208:209], v[208:209], v[216:217]
v_pk_mul_f32 v[210:211], v[210:211], v[218:219]
v_pk_mul_f32 v[212:213], v[212:213], v[220:221]
v_pk_mul_f32 v[214:215], v[214:215], v[222:223]
v_cvt_pk_bf16_f32 v96, v208, v209
v_cvt_pk_bf16_f32 v97, v210, v211
v_cvt_pk_bf16_f32 v98, v212, v213
v_cvt_pk_bf16_f32 v99, v214, v215
s_waitcnt lgkmcnt(1)
v_pk_mul_f32 v[208:209], v[200:201], v[48:49] op_sel:[0,1] op_sel_hi:[1,1]
v_pk_mul_f32 v[210:211], v[202:203], v[48:49] op_sel:[0,1] op_sel_hi:[1,1]
s_waitcnt lgkmcnt(0)
v_pk_mul_f32 v[212:213], v[204:205], v[48:49] op_sel:[0,1] op_sel_hi:[1,1]
v_pk_mul_f32 v[214:215], v[206:207], v[48:49] op_sel:[0,1] op_sel_hi:[1,1]
v_pk_fma_f32 v[208:209], v[80:81], v[48:49], v[208:209] op_sel:[0,0,0] op_sel_hi:[1,0,1]
v_pk_fma_f32 v[210:211], v[82:83], v[48:49], v[210:211] op_sel:[0,0,0] op_sel_hi:[1,0,1]
v_pk_fma_f32 v[212:213], v[84:85], v[48:49], v[212:213] op_sel:[0,0,0] op_sel_hi:[1,0,1]
v_pk_fma_f32 v[214:215], v[86:87], v[48:49], v[214:215] op_sel:[0,0,0] op_sel_hi:[1,0,1]
v_pk_mul_f32 v[216:217], v[208:209], v[208:209]
v_pk_mul_f32 v[218:219], v[210:211], v[210:211]
v_pk_mul_f32 v[220:221], v[212:213], v[212:213]
v_pk_mul_f32 v[222:223], v[214:215], v[214:215]
v_pk_fma_f32 v[216:217], v[216:217], v[52:53], v[52:53] op_sel:[0,0,1] op_sel_hi:[1,0,1]
v_pk_fma_f32 v[218:219], v[218:219], v[52:53], v[52:53] op_sel:[0,0,1] op_sel_hi:[1,0,1]
v_pk_fma_f32 v[220:221], v[220:221], v[52:53], v[52:53] op_sel:[0,0,1] op_sel_hi:[1,0,1]
v_pk_fma_f32 v[222:223], v[222:223], v[52:53], v[52:53] op_sel:[0,0,1] op_sel_hi:[1,0,1]
v_pk_mul_f32 v[216:217], v[216:217], v[208:209]
v_pk_mul_f32 v[218:219], v[218:219], v[210:211]
v_pk_mul_f32 v[220:221], v[220:221], v[212:213]
v_pk_mul_f32 v[222:223], v[222:223], v[214:215]
v_exp_f32 v216, v216
v_exp_f32 v217, v217
v_exp_f32 v218, v218
v_exp_f32 v219, v219
v_exp_f32 v220, v220
v_exp_f32 v221, v221
v_exp_f32 v222, v222
v_exp_f32 v223, v223
v_pk_add_f32 v[216:217], v[216:217], 1.0 op_sel_hi:[1,0]
v_pk_add_f32 v[218:219], v[218:219], 1.0 op_sel_hi:[1,0]
v_pk_add_f32 v[220:221], v[220:221], 1.0 op_sel_hi:[1,0]
v_pk_add_f32 v[222:223], v[222:223], 1.0 op_sel_hi:[1,0]
v_rcp_f32 v216, v216
v_rcp_f32 v217, v217
v_rcp_f32 v218, v218
v_rcp_f32 v219, v219
v_rcp_f32 v220, v220
v_rcp_f32 v221, v221
v_rcp_f32 v222, v222
v_rcp_f32 v223, v223
v_pk_mul_f32 v[208:209], v[208:209], v[216:217]
v_pk_mul_f32 v[210:211], v[210:211], v[218:219]
v_pk_mul_f32 v[212:213], v[212:213], v[220:221]
v_pk_mul_f32 v[214:215], v[214:215], v[222:223]
v_cvt_pk_bf16_f32 v100, v208, v209
v_cvt_pk_bf16_f32 v101, v210, v211
v_cvt_pk_bf16_f32 v102, v212, v213
v_cvt_pk_bf16_f32 v103, v214, v215
v_and_b32 v96, s69, v96
v_and_b32 v97, s69, v97
v_and_b32 v98, s69, v98
v_and_b32 v99, s69, v99
v_dot2_f32_bf16 v112, v96, s60, v112
v_dot2_f32_bf16 v113, v96, v96, v113
v_dot2_f32_bf16 v114, v97, s60, v114
v_dot2_f32_bf16 v115, v97, v97, v115
v_dot2_f32_bf16 v112, v98, s60, v112
v_dot2_f32_bf16 v113, v98, v98, v113
v_dot2_f32_bf16 v114, v99, s60, v114
v_dot2_f32_bf16 v115, v99, v99, v115
v_dot2_f32_bf16 v112, v100, s60, v112
v_dot2_f32_bf16 v113, v100, v100, v113
v_dot2_f32_bf16 v114, v101, s60, v114
v_dot2_f32_bf16 v115, v101, v101, v115
v_dot2_f32_bf16 v112, v102, s60, v112
v_dot2_f32_bf16 v113, v102, v102, v113
v_dot2_f32_bf16 v114, v103, s60, v114
v_dot2_f32_bf16 v115, v103, v103, v115
s_nop 1
v_add_f32 v112, v112, v114
v_add_f32 v113, v113, v115
v_mov_b32 v114, v112
v_mov_b32 v115, v113
s_nop 0
v_permlane32_swap_b32 v112, v114
v_permlane32_swap_b32 v113, v115
v_add_f32 v112, v112, v114
v_add_f32 v113, v113, v115
v_mov_b32 v114, v26
v_mov_b32 v115, v27
s_mov_b32 exec_hi, 0
buffer_store_dwordx4 v[112:115], v32, s[20:23], s63 offen sc1
s_mov_b64 exec, -1
s_barrier
ds_read_b64_tr_b16 v[224:225], v34 offset:0
ds_read_b64_tr_b16 v[226:227], v34 offset:1024
ds_read_b64_tr_b16 v[228:229], v35 offset:0
ds_read_b64_tr_b16 v[230:231], v35 offset:1024
ds_read_b64_tr_b16 v[232:233], v34 offset:4096
ds_read_b64_tr_b16 v[234:235], v34 offset:5120
ds_read_b64_tr_b16 v[236:237], v35 offset:4096
ds_read_b64_tr_b16 v[238:239], v35 offset:5120
s_waitcnt lgkmcnt(6)
v_mfma_f32_32x32x16_bf16 v[128:143], v[224:227], a[0:3], 0
ds_read_b64_tr_b16 v[240:241], v34 offset:8192
ds_read_b64_tr_b16 v[242:243], v34 offset:9216
v_and_b32 v11, 31, v0
s_add_u32 m0, s57, 131072
v_mul_u32_u24 v11, 72, v11
s_mul_i32 s87, s94, s52
v_lshrrev_b32 v10, 5, v0
v_lshl_add_u32 v11, v10, 3, v11
v_mfma_f32_32x32x16_bf16 v[160:175], v[224:227], a[4:7], 0
ds_read_b64_tr_b16 v[244:245], v35 offset:8192
ds_read_b64_tr_b16 v[246:247], v35 offset:9216
buffer_load_dwordx4 v40, s[12:15], s87 offen lds
s_mul_i32 s3, s44, 2304
s_add_u32 s3, s3, 147456
s_waitcnt lgkmcnt(8)
v_mfma_f32_32x32x16_bf16 v[144:159], v[228:231], a[0:3], 0
ds_read_b64_tr_b16 v[248:249], v34 offset:12288
ds_read_b64_tr_b16 v[250:251], v34 offset:13312
v_add_u32 v11, s3, v11
v_bfe_u32 v9, v0, 2, 2
v_lshl_add_u32 v9, v3, 3, v9
v_mul_u32_u24 v9, 72, v9
v_and_b32 v10, 3, v0
v_lshl_add_u32 v9, v10, 3, v9
v_mfma_f32_32x32x16_bf16 v[176:191], v[228:231], a[4:7], 0
ds_read_b64_tr_b16 v[252:253], v35 offset:12288
ds_read_b64_tr_b16 v[254:255], v35 offset:13312
buffer_load_dwordx4 v41, s[12:15], s87 offen offset:1024 lds
v_add_u32 v9, s3, v9
s_lshr_b32 s0, s96, 1
v_mfma_f32_16x16x32_bf16 v[44:47], v[36:39], v[224:227], 0
s_mul_i32 s0, s0, 22
s_lshl_b32 s1, s46, 1
s_waitcnt lgkmcnt(10)
v_mfma_f32_32x32x16_bf16 v[128:143], v[232:235], a[8:11], v[128:143]
s_add_u32 s0, s0, s1
s_lshl_b32 s0, s0, 12
s_lshl_b32 s1, s91, 10
s_add_u32 s0, s0, s1
buffer_load_dwordx4 v42, s[12:15], s87 offen offset:2048 lds
v_mfma_f32_32x32x16_bf16 v[160:175], v[232:235], a[12:15], v[160:175]
s_add_u32 s0, s0, 262144
s_lshl_b32 s1, s91, 12
s_add_u32 s0, s0, s1
s_xor_b32 s1, s0, 4096
s_lshl_b32 s86, s45, 4
s_add_u32 s86, s86, s46
s_lshl_b32 s86, s86, 2
s_add_u32 s86, s86, s44
s_waitcnt lgkmcnt(8)
v_mfma_f32_32x32x16_bf16 v[144:159], v[236:239], a[8:11], v[144:159]
buffer_load_dwordx4 v43, s[12:15], s87 offen offset:3072 lds
s_lshl_b32 s86, s86, 7
s_add_u32 s86, s86, 65536
s_add_u32 s94, s94, 128
v_mfma_f32_32x32x16_bf16 v[176:191], v[236:239], a[12:15], v[176:191]
s_and_b32 s94, s94, 1023
s_add_u32 m0, s57, 0
s_mul_i32 s87, s94, s52
buffer_load_dwordx4 v40, s[12:15], s87 offen lds
v_mfma_f32_16x16x32_bf16 v[44:47], v[36:39], v[232:235], v[44:47]
buffer_load_dwordx4 v41, s[12:15], s87 offen offset:1024 lds
s_waitcnt vmcnt(7)
s_waitcnt lgkmcnt(0)
s_barrier
v_mfma_f32_32x32x16_bf16 v[128:143], v[240:243], a[16:19], v[128:143]
ds_read_b64_tr_b16 v[224:225], v34 offset:16384
buffer_load_dwordx4 v42, s[12:15], s87 offen offset:2048 lds
v_mfma_f32_32x32x16_bf16 v[160:175], v[240:243], a[20:23], v[160:175]
ds_read_b64_tr_b16 v[226:227], v34 offset:17408
buffer_load_dwordx4 v43, s[12:15], s87 offen offset:3072 lds
s_add_u32 s94, s94, 128
s_and_b32 s94, s94, 1023
s_add_u32 m0, s57, 16384
v_mfma_f32_32x32x16_bf16 v[144:159], v[244:247], a[16:19], v[144:159]
ds_read_b64_tr_b16 v[228:229], v35 offset:16384
s_mul_i32 s87, s94, s52
buffer_load_dwordx4 v40, s[12:15], s87 offen lds
v_mfma_f32_32x32x16_bf16 v[176:191], v[244:247], a[20:23], v[176:191]
ds_read_b64_tr_b16 v[230:231], v35 offset:17408
buffer_load_dwordx4 v41, s[12:15], s87 offen offset:1024 lds
buffer_load_dwordx4 v42, s[12:15], s87 offen offset:2048 lds
v_mfma_f32_16x16x32_bf16 v[44:47], v[36:39], v[240:243], v[44:47]
v_mfma_f32_32x32x16_bf16 v[128:143], v[248:251], a[24:27], v[128:143]
ds_read_b64_tr_b16 v[232:233], v34 offset:20480
buffer_load_dwordx4 v43, s[12:15], s87 offen offset:3072 lds
s_add_u32 s94, s94, 128
s_and_b32 s94, s94, 1023
s_add_u32 m0, s57, 32768
v_mfma_f32_32x32x16_bf16 v[160:175], v[248:251], a[28:31], v[160:175]
ds_read_b64_tr_b16 v[234:235], v34 offset:21504
s_mul_i32 s87, s94, s52
buffer_load_dwordx4 v40, s[12:15], s87 offen lds
v_mfma_f32_32x32x16_bf16 v[144:159], v[252:255], a[24:27], v[144:159]
ds_read_b64_tr_b16 v[236:237], v35 offset:20480
buffer_load_dwordx4 v41, s[12:15], s87 offen offset:1024 lds
buffer_load_dwordx4 v42, s[12:15], s87 offen offset:2048 lds
v_mfma_f32_32x32x16_bf16 v[176:191], v[252:255], a[28:31], v[176:191]
ds_read_b64_tr_b16 v[238:239], v35 offset:21504
buffer_load_dwordx4 v43, s[12:15], s87 offen offset:3072 lds
s_add_u32 s94, s94, 128
s_and_b32 s94, s94, 1023
v_mfma_f32_16x16x32_bf16 v[44:47], v[36:39], v[248:251], v[44:47]
s_add_u32 m0, s57, 49152
s_mul_i32 s87, s94, s52
s_waitcnt lgkmcnt(6)
v_mfma_f32_32x32x16_bf16 v[128:143], v[224:227], a[32:35], v[128:143]
ds_read_b64_tr_b16 v[240:241], v34 offset:24576
ds_read_b64_tr_b16 v[242:243], v34 offset:25600
buffer_load_dwordx4 v40, s[12:15], s87 offen lds
v_mfma_f32_32x32x16_bf16 v[160:175], v[224:227], a[36:39], v[160:175]
ds_read_b64_tr_b16 v[244:245], v35 offset:24576
ds_read_b64_tr_b16 v[246:247], v35 offset:25600
buffer_load_dwordx4 v41, s[12:15], s87 offen offset:1024 lds
s_waitcnt lgkmcnt(8)
v_mfma_f32_32x32x16_bf16 v[144:159], v[228:231], a[32:35], v[144:159]
ds_read_b64_tr_b16 v[248:249], v34 offset:28672
ds_read_b64_tr_b16 v[250:251], v34 offset:29696
buffer_load_dwordx4 v42, s[12:15], s87 offen offset:2048 lds
v_mfma_f32_32x32x16_bf16 v[176:191], v[228:231], a[36:39], v[176:191]
ds_read_b64_tr_b16 v[252:253], v35 offset:28672
ds_read_b64_tr_b16 v[254:255], v35 offset:29696
buffer_load_dwordx4 v43, s[12:15], s87 offen offset:3072 lds
s_add_u32 s94, s94, 128
s_and_b32 s94, s94, 1023
v_mfma_f32_16x16x32_bf16 v[44:47], v[36:39], v[224:227], v[44:47]
s_waitcnt lgkmcnt(10)
v_mfma_f32_32x32x16_bf16 v[128:143], v[232:235], a[40:43], v[128:143]
v_mfma_f32_32x32x16_bf16 v[160:175], v[232:235], a[44:47], v[160:175]
s_waitcnt lgkmcnt(8)
v_mfma_f32_32x32x16_bf16 v[144:159], v[236:239], a[40:43], v[144:159]
v_mfma_f32_32x32x16_bf16 v[176:191], v[236:239], a[44:47], v[176:191]
v_mfma_f32_16x16x32_bf16 v[44:47], v[36:39], v[232:235], v[44:47]
s_waitcnt vmcnt(16)
s_waitcnt lgkmcnt(0)
s_barrier
v_mfma_f32_32x32x16_bf16 v[128:143], v[240:243], a[48:51], v[128:143]
ds_read_b64_tr_b16 v[224:225], v34 offset:32768
v_mfma_f32_32x32x16_bf16 v[160:175], v[240:243], a[52:55], v[160:175]
ds_read_b64_tr_b16 v[226:227], v34 offset:33792
v_mfma_f32_32x32x16_bf16 v[144:159], v[244:247], a[48:51], v[144:159]
ds_read_b64_tr_b16 v[228:229], v35 offset:32768
v_mfma_f32_32x32x16_bf16 v[176:191], v[244:247], a[52:55], v[176:191]
ds_read_b64_tr_b16 v[230:231], v35 offset:33792
v_mfma_f32_16x16x32_bf16 v[44:47], v[36:39], v[240:243], v[44:47]
v_mfma_f32_32x32x16_bf16 v[128:143], v[248:251], a[56:59], v[128:143]
ds_read_b64_tr_b16 v[232:233], v34 offset:36864
v_mov_b32 v76, 0
v_mov_b32 v77, 0
v_mov_b32 v78, v26
v_mov_b32 v79, v27
s_add_u32 s97, s95, 4096
v_mfma_f32_32x32x16_bf16 v[160:175], v[248:251], a[60:63], v[160:175]
ds_read_b64_tr_b16 v[234:235], v34 offset:37888
buffer_load_dwordx4 v[56:59], v32, s[20:23], s95 offen offset:0 sc1
buffer_load_dwordx4 v[60:63], v32, s[20:23], s95 offen offset:1024 sc1
v_mfma_f32_32x32x16_bf16 v[144:159], v[252:255], a[56:59], v[144:159]
ds_read_b64_tr_b16 v[236:237], v35 offset:36864
buffer_load_dwordx4 v[64:67], v32, s[20:23], s95 offen offset:2048 sc1
v_mfma_f32_32x32x16_bf16 v[176:191], v[252:255], a[60:63], v[176:191]
ds_read_b64_tr_b16 v[238:239], v35 offset:37888
buffer_load_dwordx4 v[68:71], v32, s[20:23], s95 offen offset:3072 sc1
buffer_load_dwordx4 v[72:75], v32, s[20:23], s97 offen offset:0 sc1
v_mfma_f32_16x16x32_bf16 v[44:47], v[36:39], v[248:251], v[44:47]
s_waitcnt lgkmcnt(6)
v_mfma_f32_32x32x16_bf16 v[128:143], v[224:227], a[64:67], v[128:143]
ds_read_b64_tr_b16 v[240:241], v34 offset:40960
ds_read_b64_tr_b16 v[242:243], v34 offset:41984
s_mov_b32 exec_hi, 0
buffer_load_dwordx4 v[76:79], v32, s[20:23], s97 offen offset:1024 sc1
s_mov_b64 exec, -1
v_mfma_f32_32x32x16_bf16 v[160:175], v[224:227], a[68:71], v[160:175]
ds_read_b64_tr_b16 v[244:245], v35 offset:40960
ds_read_b64_tr_b16 v[246:247], v35 offset:41984
s_waitcnt lgkmcnt(8)
v_mfma_f32_32x32x16_bf16 v[144:159], v[228:231], a[64:67], v[144:159]
ds_read_b64_tr_b16 v[248:249], v34 offset:45056
ds_read_b64_tr_b16 v[250:251], v34 offset:46080
v_mfma_f32_32x32x16_bf16 v[176:191], v[228:231], a[68:71], v[176:191]
ds_read_b64_tr_b16 v[252:253], v35 offset:45056
ds_read_b64_tr_b16 v[254:255], v35 offset:46080
v_mfma_f32_16x16x32_bf16 v[44:47], v[36:39], v[224:227], v[44:47]
s_waitcnt lgkmcnt(10)
v_mfma_f32_32x32x16_bf16 v[128:143], v[232:235], a[72:75], v[128:143]
v_mfma_f32_32x32x16_bf16 v[160:175], v[232:235], a[76:79], v[160:175]
s_waitcnt lgkmcnt(8)
v_mfma_f32_32x32x16_bf16 v[144:159], v[236:239], a[72:75], v[144:159]
v_mfma_f32_32x32x16_bf16 v[176:191], v[236:239], a[76:79], v[176:191]
v_mfma_f32_16x16x32_bf16 v[44:47], v[36:39], v[232:235], v[44:47]
s_waitcnt vmcnt(18)
s_waitcnt lgkmcnt(0)
s_barrier
v_mfma_f32_32x32x16_bf16 v[128:143], v[240:243], a[80:83], v[128:143]
ds_read_b64_tr_b16 v[224:225], v110 offset:0
s_add_u32 m0, s57, 131072
s_mul_i32 s87, s94, s52
buffer_load_dwordx4 v40, s[12:15], s87 offen lds
v_mfma_f32_32x32x16_bf16 v[160:175], v[240:243], a[84:87], v[160:175]
ds_read_b64_tr_b16 v[226:227], v110 offset:1024
buffer_load_dwordx4 v41, s[12:15], s87 offen offset:1024 lds
buffer_load_dwordx4 v42, s[12:15], s87 offen offset:2048 lds
v_mfma_f32_32x32x16_bf16 v[144:159], v[244:247], a[80:83], v[144:159]
ds_read_b64_tr_b16 v[228:229], v111 offset:0
buffer_load_dwordx4 v43, s[12:15], s87 offen offset:3072 lds
s_add_u32 s94, s94, 128
s_and_b32 s94, s94, 1023
v_mfma_f32_32x32x16_bf16 v[176:191], v[244:247], a[84:87], v[176:191]
ds_read_b64_tr_b16 v[230:231], v111 offset:1024
v_mfma_f32_16x16x32_bf16 v[44:47], v[36:39], v[240:243], v[44:47]
v_mfma_f32_32x32x16_bf16 v[128:143], v[248:251], a[88:91], v[128:143]
ds_read_b64_tr_b16 v[232:233], v110 offset:4096
s_waitcnt vmcnt(9)
v_xor_b32 v81, v58, v26
v_xor_b32 v82, v59, v27
v_or_b32 v80, v81, v82
s_waitcnt vmcnt(8)
v_xor_b32 v81, v62, v26
v_xor_b32 v82, v63, v27
v_or3_b32 v80, v80, v81, v82
s_waitcnt vmcnt(7)
v_xor_b32 v81, v66, v26
v_xor_b32 v82, v67, v27
v_or3_b32 v80, v80, v81, v82
s_waitcnt vmcnt(6)
v_xor_b32 v81, v70, v26
v_xor_b32 v82, v71, v27
v_or3_b32 v80, v80, v81, v82
s_waitcnt vmcnt(5)
v_xor_b32 v81, v74, v26
v_xor_b32 v82, v75, v27
v_or3_b32 v80, v80, v81, v82
s_waitcnt vmcnt(4)
v_xor_b32 v81, v78, v26
v_xor_b32 v82, v79, v27
v_or3_b32 v80, v80, v81, v82
v_cmp_ne_u32 vcc, 0, v80
s_nop 3
s_cbranch_vccz L_ok_30
s_mov_b32 s62, 4000
L_sp_29:
s_sleep 3
s_add_u32 s97, s95, 4096
buffer_load_dwordx4 v[56:59], v32, s[20:23], s95 offen offset:0 sc1
buffer_load_dwordx4 v[60:63], v32, s[20:23], s95 offen offset:1024 sc1
buffer_load_dwordx4 v[64:67], v32, s[20:23], s95 offen offset:2048 sc1
buffer_load_dwordx4 v[68:71], v32, s[20:23], s95 offen offset:3072 sc1
buffer_load_dwordx4 v[72:75], v32, s[20:23], s97 offen offset:0 sc1
s_mov_b32 exec_hi, 0
buffer_load_dwordx4 v[76:79], v32, s[20:23], s97 offen offset:1024 sc1
s_mov_b64 exec, -1
s_waitcnt vmcnt(0)
v_xor_b32 v81, v58, v26
v_xor_b32 v82, v59, v27
v_or_b32 v80, v81, v82
v_xor_b32 v81, v62, v26
v_xor_b32 v82, v63, v27
v_or3_b32 v80, v80, v81, v82
v_xor_b32 v81, v66, v26
v_xor_b32 v82, v67, v27
v_or3_b32 v80, v80, v81, v82
v_xor_b32 v81, v70, v26
v_xor_b32 v82, v71, v27
v_or3_b32 v80, v80, v81, v82
v_xor_b32 v81, v74, v26
v_xor_b32 v82, v75, v27
v_or3_b32 v80, v80, v81, v82
v_xor_b32 v81, v78, v26
v_xor_b32 v82, v79, v27
v_or3_b32 v80, v80, v81, v82
v_cmp_ne_u32 vcc, 0, v80
s_sub_u32 s62, s62, 1
s_cbranch_scc1 L_ok_30
s_nop 1
s_cbranch_vccnz L_sp_29
L_ok_30:
v_mfma_f32_32x32x16_bf16 v[160:175], v[248:251], a[92:95], v[160:175]
ds_read_b64_tr_b16 v[234:235], v110 offset:5120
v_mfma_f32_32x32x16_bf16 v[144:159], v[252:255], a[88:91], v[144:159]
ds_read_b64_tr_b16 v[236:237], v111 offset:4096
v_mfma_f32_32x32x16_bf16 v[176:191], v[252:255], a[92:95], v[176:191]
ds_read_b64_tr_b16 v[238:239], v111 offset:5120
s_add_u32 m0, s59, 65536
s_add_u32 s87, s61, s64
buffer_load_dwordx4 v20, s[16:19], s87 offen lds
v_mfma_f32_16x16x32_bf16 v[44:47], v[36:39], v[248:251], v[44:47]
s_waitcnt vmcnt(1)
v_add_f32 v56, v56, v60
s_waitcnt lgkmcnt(6)
v_mfma_f32_32x32x16_bf16 v[128:143], v[224:227], a[96:99], v[128:143]
ds_read_b64_tr_b16 v[240:241], v110 offset:8192
ds_read_b64_tr_b16 v[242:243], v110 offset:9216
buffer_load_dwordx4 v21, s[16:19], s87 offen offset:1024 lds
s_add_u32 m0, m0, 2048
s_nop 0
v_mfma_f32_32x32x16_bf16 v[160:175], v[224:227], a[100:103], v[160:175]
ds_read_b64_tr_b16 v[244:245], v111 offset:8192
ds_read_b64_tr_b16 v[246:247], v111 offset:9216
buffer_load_dwordx4 v22, s[16:19], s87 offen lds
v_add_f32 v57, v57, v61
s_waitcnt vmcnt(3)
v_add_f32 v56, v56, v64
s_waitcnt lgkmcnt(8)
v_mfma_f32_32x32x16_bf16 v[144:159], v[228:231], a[96:99], v[144:159]
ds_read_b64_tr_b16 v[248:249], v110 offset:12288
ds_read_b64_tr_b16 v[250:251], v110 offset:13312
buffer_load_dwordx4 v23, s[16:19], s87 offen offset:1024 lds
s_add_u32 m0, s59, 69632
v_mfma_f32_32x32x16_bf16 v[176:191], v[228:231], a[100:103], v[176:191]
ds_read_b64_tr_b16 v[252:253], v111 offset:12288
ds_read_b64_tr_b16 v[254:255], v111 offset:13312
s_add_u32 s87, s61, s65
buffer_load_dwordx4 v20, s[16:19], s87 offen lds
v_add_f32 v57, v57, v65
v_mfma_f32_16x16x32_bf16 v[44:47], v[36:39], v[224:227], v[44:47]
buffer_load_dwordx4 v21, s[16:19], s87 offen offset:1024 lds
s_waitcnt lgkmcnt(10)
v_mfma_f32_32x32x16_bf16 v[128:143], v[232:235], a[104:107], v[128:143]
s_add_u32 m0, m0, 2048
s_nop 0
buffer_load_dwordx4 v22, s[16:19], s87 offen lds
v_mfma_f32_32x32x16_bf16 v[160:175], v[232:235], a[108:111], v[160:175]
buffer_load_dwordx4 v23, s[16:19], s87 offen offset:1024 lds
s_waitcnt vmcnt(8)
v_add_f32 v56, v56, v68
s_add_u32 s61, s61, 128
v_add_f32 v57, v57, v69
s_waitcnt lgkmcnt(8)
v_mfma_f32_32x32x16_bf16 v[144:159], v[236:239], a[104:107], v[144:159]
s_waitcnt vmcnt(8)
v_add_f32 v56, v56, v72
s_and_b32 s61, s61, 1023
v_add_f32 v57, v57, v73
s_waitcnt vmcnt(8)
v_add_f32 v56, v56, v76
v_add_f32 v57, v57, v77
v_mov_b32 v58, v56
v_mov_b32 v59, v57
s_nop 0
v_permlane32_swap_b32 v56, v58
v_mfma_f32_32x32x16_bf16 v[176:191], v[236:239], a[108:111], v[176:191]
v_permlane32_swap_b32 v57, v59
v_add_f32 v56, v56, v58
v_add_f32 v57, v57, v59
v_mul_f32 v56, 0x3abe82fa, v56
v_mul_f32 v58, v56, v56
v_mov_b32 v59, 0x3abe82fa
v_fma_f32 v57, v57, v59, -v58
v_max_f32 v57, 0, v57
v_mfma_f32_16x16x32_bf16 v[44:47], v[36:39], v[232:235], v[44:47]
v_add_f32 v57, 0x3727c5ac, v57
v_rsq_f32 v60, v57
s_waitcnt lgkmcnt(0)
s_barrier
v_mfma_f32_32x32x16_bf16 v[128:143], v[240:243], a[112:115], v[128:143]
ds_read_b64_tr_b16 v[224:225], v110 offset:16384
s_add_u32 m0, s59, 98304
s_add_u32 s87, s61, s64
v_mul_f32_e64 v61, -v56, v60
v_lshlrev_b32 v80, 16, v88
v_and_b32 v81, 0xffff0000, v88
v_lshlrev_b32 v82, 16, v89
v_mfma_f32_32x32x16_bf16 v[160:175], v[240:243], a[116:119], v[160:175]
ds_read_b64_tr_b16 v[226:227], v110 offset:17408
buffer_load_dwordx4 v20, s[16:19], s87 offen lds
v_and_b32 v83, 0xffff0000, v89
v_lshlrev_b32 v84, 16, v90
v_and_b32 v85, 0xffff0000, v90
v_mfma_f32_32x32x16_bf16 v[144:159], v[244:247], a[112:115], v[144:159]
ds_read_b64_tr_b16 v[228:229], v111 offset:16384
v_lshlrev_b32 v86, 16, v91
v_and_b32 v87, 0xffff0000, v91
v_fma_f32 v80, v80, v60, v61
buffer_load_dwordx4 v21, s[16:19], s87 offen offset:1024 lds
v_mfma_f32_32x32x16_bf16 v[176:191], v[244:247], a[116:119], v[176:191]
ds_read_b64_tr_b16 v[230:231], v111 offset:17408
v_fma_f32 v81, v81, v60, v61
v_fma_f32 v82, v82, v60, v61
v_fma_f32 v83, v83, v60, v61
v_fma_f32 v84, v84, v60, v61
v_fma_f32 v85, v85, v60, v61
v_fma_f32 v86, v86, v60, v61
v_fma_f32 v87, v87, v60, v61
v_mfma_f32_16x16x32_bf16 v[44:47], v[36:39], v[240:243], v[44:47]
v_cvt_pk_bf16_f32 v104, v80, v81
s_add_u32 m0, m0, 2048
v_mfma_f32_32x32x16_bf16 v[128:143], v[248:251], a[120:123], v[128:143]
ds_read_b64_tr_b16 v[232:233], v110 offset:20480
v_cvt_pk_bf16_f32 v105, v82, v83
v_cvt_pk_bf16_f32 v106, v84, v85
s_nop 0
v_cvt_pk_bf16_f32 v107, v86, v87
v_and_b32 v104, s68, v104
v_and_b32 v105, s68, v105
v_and_b32 v106, s68, v106
v_mfma_f32_32x32x16_bf16 v[160:175], v[248:251], a[124:127], v[160:175]
ds_read_b64_tr_b16 v[234:235], v110 offset:21504
buffer_load_dwordx4 v22, s[16:19], s87 offen lds
v_and_b32 v107, s68, v107
ds_write_b64 v11, v[104:105] offset:0
v_mfma_f32_32x32x16_bf16 v[144:159], v[252:255], a[120:123], v[144:159]
ds_read_b64_tr_b16 v[236:237], v111 offset:20480
ds_write_b64 v11, v[106:107] offset:16
v_lshlrev_b32 v80, 16, v92
buffer_load_dwordx4 v23, s[16:19], s87 offen offset:1024 lds
v_mfma_f32_32x32x16_bf16 v[176:191], v[252:255], a[124:127], v[176:191]
ds_read_b64_tr_b16 v[238:239], v111 offset:21504
v_and_b32 v81, 0xffff0000, v92
v_lshlrev_b32 v82, 16, v93
v_and_b32 v83, 0xffff0000, v93
v_lshlrev_b32 v84, 16, v94
v_and_b32 v85, 0xffff0000, v94
v_lshlrev_b32 v86, 16, v95
v_mfma_f32_16x16x32_bf16 v[44:47], v[36:39], v[248:251], v[44:47]
v_and_b32 v87, 0xffff0000, v95
v_fma_f32 v80, v80, v60, v61
s_waitcnt lgkmcnt(8)
v_mfma_f32_32x32x16_bf16 v[128:143], v[224:227], a[128:131], v[128:143]
ds_read_b64_tr_b16 v[240:241], v110 offset:24576
ds_read_b64_tr_b16 v[242:243], v110 offset:25600
s_add_u32 m0, s59, 102400
v_fma_f32 v81, v81, v60, v61
s_add_u32 s87, s61, s65
v_fma_f32 v82, v82, v60, v61
v_fma_f32 v83, v83, v60, v61
v_fma_f32 v84, v84, v60, v61
v_mfma_f32_32x32x16_bf16 v[160:175], v[224:227], a[132:135], v[160:175]
ds_read_b64_tr_b16 v[244:245], v111 offset:24576
ds_read_b64_tr_b16 v[246:247], v111 offset:25600
buffer_load_dwordx4 v20, s[16:19], s87 offen lds
v_fma_f32 v85, v85, v60, v61
v_fma_f32 v86, v86, v60, v61
s_waitcnt lgkmcnt(10)
v_mfma_f32_32x32x16_bf16 v[144:159], v[228:231], a[128:131], v[144:159]
ds_read_b64_tr_b16 v[248:249], v110 offset:28672
ds_read_b64_tr_b16 v[250:251], v110 offset:29696
v_fma_f32 v87, v87, v60, v61
v_cvt_pk_bf16_f32 v104, v80, v81
v_cvt_pk_bf16_f32 v105, v82, v83
v_cvt_pk_bf16_f32 v106, v84, v85
v_cvt_pk_bf16_f32 v107, v86, v87
ds_write_b64 v11, v[104:105] offset:32
v_mfma_f32_32x32x16_bf16 v[176:191], v[228:231], a[132:135], v[176:191]
ds_read_b64_tr_b16 v[252:253], v111 offset:28672
ds_read_b64_tr_b16 v[254:255], v111 offset:29696
buffer_load_dwordx4 v21, s[16:19], s87 offen offset:1024 lds
ds_write_b64 v11, v[106:107] offset:48
v_mfma_f32_16x16x32_bf16 v[44:47], v[36:39], v[224:227], v[44:47]
ds_read_b64_tr_b16 v[88:89], v9 offset:0
s_waitcnt lgkmcnt(15)
v_mfma_f32_32x32x16_bf16 v[128:143], v[232:235], a[136:139], v[128:143]
ds_read_b64_tr_b16 v[90:91], v9 offset:288
ds_read_b64_tr_b16 v[92:93], v9 offset:32
ds_read_b64_tr_b16 v[94:95], v9 offset:320
s_add_u32 m0, m0, 2048
v_lshlrev_b32 v80, 16, v96
v_and_b32 v81, 0xffff0000, v96
s_nop 0
v_lshlrev_b32 v82, 16, v97
v_mfma_f32_32x32x16_bf16 v[160:175], v[232:235], a[140:143], v[160:175]
v_and_b32 v83, 0xffff0000, v97
buffer_load_dwordx4 v22, s[16:19], s87 offen lds
v_lshlrev_b32 v84, 16, v98
v_and_b32 v85, 0xffff0000, v98
v_lshlrev_b32 v86, 16, v99
s_waitcnt lgkmcnt(14)
v_mfma_f32_32x32x16_bf16 v[144:159], v[236:239], a[136:139], v[144:159]
v_and_b32 v87, 0xffff0000, v99
v_fma_f32 v80, v80, v60, v61
v_fma_f32 v81, v81, v60, v61
v_fma_f32 v82, v82, v60, v61
v_fma_f32 v83, v83, v60, v61
buffer_load_dwordx4 v23, s[16:19], s87 offen offset:1024 lds
v_mfma_f32_32x32x16_bf16 v[176:191], v[236:239], a[140:143], v[176:191]
v_fma_f32 v84, v84, v60, v61
v_fma_f32 v85, v85, v60, v61
v_fma_f32 v86, v86, v60, v61
v_fma_f32 v87, v87, v60, v61
v_cvt_pk_bf16_f32 v104, v80, v81
v_cvt_pk_bf16_f32 v105, v82, v83
v_mfma_f32_16x16x32_bf16 v[44:47], v[36:39], v[232:235], v[44:47]
v_cvt_pk_bf16_f32 v106, v84, v85
v_cvt_pk_bf16_f32 v107, v86, v87
s_waitcnt lgkmcnt(0)
s_barrier
v_mfma_f32_32x32x16_bf16 v[128:143], v[240:243], a[144:147], v[128:143]
ds_read_b64_tr_b16 v[224:225], v110 offset:32768
s_add_u32 s61, s61, 128
v_and_b32 v104, s69, v104
s_and_b32 s61, s61, 1023
v_and_b32 v105, s69, v105
v_and_b32 v106, s69, v106
v_and_b32 v107, s69, v107
ds_write_b64 v11, v[104:105] offset:0
v_mfma_f32_32x32x16_bf16 v[160:175], v[240:243], a[148:151], v[160:175]
ds_read_b64_tr_b16 v[226:227], v110 offset:33792
ds_write_b64 v11, v[106:107] offset:16
v_lshlrev_b32 v80, 16, v100
v_and_b32 v81, 0xffff0000, v100
v_lshlrev_b32 v82, 16, v101
v_and_b32 v83, 0xffff0000, v101
v_mfma_f32_32x32x16_bf16 v[144:159], v[244:247], a[144:147], v[144:159]
ds_read_b64_tr_b16 v[228:229], v111 offset:32768
v_lshlrev_b32 v84, 16, v102
v_and_b32 v85, 0xffff0000, v102
v_lshlrev_b32 v86, 16, v103
v_and_b32 v87, 0xffff0000, v103
v_fma_f32 v80, v80, v60, v61
v_fma_f32 v81, v81, v60, v61
v_fma_f32 v82, v82, v60, v61
v_mfma_f32_32x32x16_bf16 v[176:191], v[244:247], a[148:151], v[176:191]
ds_read_b64_tr_b16 v[230:231], v111 offset:33792
v_fma_f32 v83, v83, v60, v61
v_fma_f32 v84, v84, v60, v61
v_fma_f32 v85, v85, v60, v61
v_fma_f32 v86, v86, v60, v61
v_fma_f32 v87, v87, v60, v61
v_cvt_pk_bf16_f32 v104, v80, v81
v_cvt_pk_bf16_f32 v105, v82, v83
v_mfma_f32_16x16x32_bf16 v[44:47], v[36:39], v[240:243], v[44:47]
v_cvt_pk_bf16_f32 v106, v84, v85
v_cvt_pk_bf16_f32 v107, v86, v87
v_mfma_f32_32x32x16_bf16 v[128:143], v[248:251], a[152:155], v[128:143]
ds_read_b64_tr_b16 v[232:233], v110 offset:36864
ds_write_b64 v11, v[104:105] offset:32
ds_write_b64 v11, v[106:107] offset:48
ds_read_b64_tr_b16 v[96:97], v9 offset:0
ds_read_b64_tr_b16 v[98:99], v9 offset:288
ds_read_b64_tr_b16 v[100:101], v9 offset:32
v_mfma_f32_32x32x16_bf16 v[160:175], v[248:251], a[156:159], v[160:175]
ds_read_b64_tr_b16 v[234:235], v110 offset:37888
ds_read_b64_tr_b16 v[102:103], v9 offset:320
s_nop 7
buffer_store_dwordx4 v[88:91], v32, s[20:23], s0 offen offset:0 sc1
v_mfma_f32_32x32x16_bf16 v[144:159], v[252:255], a[152:155], v[144:159]
ds_read_b64_tr_b16 v[236:237], v111 offset:36864
buffer_store_dwordx4 v[92:95], v32, s[20:23], s0 offen offset:2048 sc1
s_waitcnt lgkmcnt(4)
buffer_store_dwordx4 v[96:99], v32, s[20:23], s1 offen offset:0 sc1
v_mfma_f32_32x32x16_bf16 v[176:191], v[252:255], a[156:159], v[176:191]
ds_read_b64_tr_b16 v[238:239], v111 offset:37888
s_waitcnt lgkmcnt(2)
buffer_store_dwordx4 v[100:103], v32, s[20:23], s1 offen offset:2048 sc1
v_mfma_f32_16x16x32_bf16 v[44:47], v[36:39], v[248:251], v[44:47]
v_mfma_f32_32x32x16_bf16 v[128:143], v[224:227], a[160:163], v[128:143]
ds_read_b64_tr_b16 v[240:241], v110 offset:40960
ds_read_b64_tr_b16 v[242:243], v110 offset:41984
v_mfma_f32_32x32x16_bf16 v[160:175], v[224:227], a[164:167], v[160:175]
ds_read_b64_tr_b16 v[244:245], v111 offset:40960
ds_read_b64_tr_b16 v[246:247], v111 offset:41984
v_mfma_f32_32x32x16_bf16 v[144:159], v[228:231], a[160:163], v[144:159]
ds_read_b64_tr_b16 v[248:249], v110 offset:45056
ds_read_b64_tr_b16 v[250:251], v110 offset:46080
v_mfma_f32_32x32x16_bf16 v[176:191], v[228:231], a[164:167], v[176:191]
ds_read_b64_tr_b16 v[252:253], v111 offset:45056
ds_read_b64_tr_b16 v[254:255], v111 offset:46080
v_mfma_f32_16x16x32_bf16 v[44:47], v[36:39], v[224:227], v[44:47]
v_mfma_f32_32x32x16_bf16 v[128:143], v[232:235], a[168:171], v[128:143]
s_waitcnt vmcnt(12)
ds_read_b128 a[0:3], v124 offset:0
ds_read_b128 a[4:7], v124 offset:2048
ds_read_b128 a[8:11], v124 offset:4096
ds_read_b128 a[12:15], v124 offset:6144
ds_read_b128 a[16:19], v125 offset:0
v_mfma_f32_32x32x16_bf16 v[160:175], v[232:235], a[172:175], v[160:175]
ds_read_b128 a[20:23], v125 offset:2048
ds_read_b128 a[24:27], v125 offset:4096
ds_read_b128 a[28:31], v125 offset:6144
s_waitcnt lgkmcnt(0)
s_add_u32 m0, s59, 65536
s_add_u32 s87, s61, s64
v_mfma_f32_32x32x16_bf16 v[144:159], v[236:239], a[168:171], v[144:159]
buffer_load_dwordx4 v20, s[16:19], s87 offen lds
buffer_load_dwordx4 v21, s[16:19], s87 offen offset:1024 lds
v_mfma_f32_32x32x16_bf16 v[176:191], v[236:239], a[172:175], v[176:191]
s_add_u32 m0, m0, 2048
s_nop 0
buffer_load_dwordx4 v22, s[16:19], s87 offen lds
v_mfma_f32_16x16x32_bf16 v[44:47], v[36:39], v[232:235], v[44:47]
buffer_load_dwordx4 v23, s[16:19], s87 offen offset:1024 lds
s_waitcnt lgkmcnt(0)
s_barrier
v_mfma_f32_32x32x16_bf16 v[128:143], v[240:243], a[176:179], v[128:143]
ds_read_b64_tr_b16 v[224:225], v110 offset:49152
s_add_u32 m0, s59, 69632
s_add_u32 s87, s61, s65
buffer_load_dwordx4 v20, s[16:19], s87 offen lds
v_mfma_f32_32x32x16_bf16 v[160:175], v[240:243], a[180:183], v[160:175]
ds_read_b64_tr_b16 v[226:227], v110 offset:50176
buffer_load_dwordx4 v21, s[16:19], s87 offen offset:1024 lds
s_add_u32 m0, m0, 2048
s_nop 0
v_mfma_f32_32x32x16_bf16 v[144:159], v[244:247], a[176:179], v[144:159]
ds_read_b64_tr_b16 v[228:229], v111 offset:49152
buffer_load_dwordx4 v22, s[16:19], s87 offen lds
v_mfma_f32_32x32x16_bf16 v[176:191], v[244:247], a[180:183], v[176:191]
ds_read_b64_tr_b16 v[230:231], v111 offset:50176
buffer_load_dwordx4 v23, s[16:19], s87 offen offset:1024 lds
s_add_u32 s61, s61, 128
s_and_b32 s61, s61, 1023
v_mfma_f32_16x16x32_bf16 v[44:47], v[36:39], v[240:243], v[44:47]
v_mfma_f32_32x32x16_bf16 v[128:143], v[248:251], a[184:187], v[128:143]
ds_read_b64_tr_b16 v[232:233], v110 offset:53248
v_mfma_f32_32x32x16_bf16 v[160:175], v[248:251], a[188:191], v[160:175]
ds_read_b64_tr_b16 v[234:235], v110 offset:54272
v_mfma_f32_32x32x16_bf16 v[144:159], v[252:255], a[184:187], v[144:159]
ds_read_b64_tr_b16 v[236:237], v111 offset:53248
v_mfma_f32_32x32x16_bf16 v[176:191], v[252:255], a[188:191], v[176:191]
ds_read_b64_tr_b16 v[238:239], v111 offset:54272
v_mfma_f32_16x16x32_bf16 v[44:47], v[36:39], v[248:251], v[44:47]
s_waitcnt lgkmcnt(6)
v_mfma_f32_32x32x16_bf16 v[128:143], v[224:227], a[192:195], v[128:143]
ds_read_b64_tr_b16 v[240:241], v110 offset:57344
ds_read_b64_tr_b16 v[242:243], v110 offset:58368
s_waitcnt vmcnt(8)
ds_read_b128 a[32:35], v124 offset:32768
ds_read_b128 a[36:39], v124 offset:34816
ds_read_b128 a[40:43], v124 offset:36864
v_mfma_f32_32x32x16_bf16 v[160:175], v[224:227], a[196:199], v[160:175]
ds_read_b64_tr_b16 v[244:245], v111 offset:57344
ds_read_b64_tr_b16 v[246:247], v111 offset:58368
s_mov_b64 exec, 1
buffer_store_dwordx2 v[26:27], v14, s[20:23], s86 offen sc1
s_mov_b64 exec, -1
s_waitcnt lgkmcnt(11)
v_mfma_f32_32x32x16_bf16 v[144:159], v[228:231], a[192:195], v[144:159]
ds_read_b64_tr_b16 v[248:249], v110 offset:61440
ds_read_b64_tr_b16 v[250:251], v110 offset:62464
ds_read_b128 a[44:47], v124 offset:38912
ds_read_b128 a[48:51], v125 offset:32768
ds_read_b128 a[52:55], v125 offset:34816
ds_read_b128 a[56:59], v125 offset:36864
v_mfma_f32_32x32x16_bf16 v[176:191], v[228:231], a[196:199], v[176:191]
ds_read_b64_tr_b16 v[252:253], v111 offset:61440
ds_read_b64_tr_b16 v[254:255], v111 offset:62464
ds_read_b128 a[60:63], v125 offset:38912
s_waitcnt lgkmcnt(0)
s_add_u32 m0, s59, 98304
s_add_u32 s87, s61, s64
v_mfma_f32_16x16x32_bf16 v[44:47], v[36:39], v[224:227], v[44:47]
buffer_load_dwordx4 v20, s[16:19], s87 offen lds
v_mfma_f32_32x32x16_bf16 v[128:143], v[232:235], a[200:203], v[128:143]
buffer_load_dwordx4 v21, s[16:19], s87 offen offset:1024 lds
s_add_u32 m0, m0, 2048
s_nop 0
v_mfma_f32_32x32x16_bf16 v[160:175], v[232:235], a[204:207], v[160:175]
buffer_load_dwordx4 v22, s[16:19], s87 offen lds
buffer_load_dwordx4 v23, s[16:19], s87 offen offset:1024 lds
v_mfma_f32_32x32x16_bf16 v[144:159], v[236:239], a[200:203], v[144:159]
s_add_u32 m0, s59, 102400
s_add_u32 s87, s61, s65
buffer_load_dwordx4 v20, s[16:19], s87 offen lds
v_mfma_f32_32x32x16_bf16 v[176:191], v[236:239], a[204:207], v[176:191]
buffer_load_dwordx4 v21, s[16:19], s87 offen offset:1024 lds
s_add_u32 m0, m0, 2048
s_nop 0
v_mfma_f32_16x16x32_bf16 v[44:47], v[36:39], v[232:235], v[44:47]
buffer_load_dwordx4 v22, s[16:19], s87 offen lds
s_waitcnt lgkmcnt(0)
s_barrier
v_mfma_f32_32x32x16_bf16 v[128:143], v[240:243], a[208:211], v[128:143]
ds_read_b64_tr_b16 v[224:225], v34 offset:32768
buffer_load_dwordx4 v23, s[16:19], s87 offen offset:1024 lds
s_add_u32 s61, s61, 128
v_mfma_f32_32x32x16_bf16 v[160:175], v[240:243], a[212:215], v[160:175]
ds_read_b64_tr_b16 v[226:227], v34 offset:33792
s_and_b32 s61, s61, 1023
v_mfma_f32_32x32x16_bf16 v[144:159], v[244:247], a[208:211], v[144:159]
ds_read_b64_tr_b16 v[228:229], v35 offset:32768
v_mfma_f32_32x32x16_bf16 v[176:191], v[244:247], a[212:215], v[176:191]
ds_read_b64_tr_b16 v[230:231], v35 offset:33792
v_mfma_f32_16x16x32_bf16 v[44:47], v[36:39], v[240:243], v[44:47]
v_mfma_f32_32x32x16_bf16 v[128:143], v[248:251], a[216:219], v[128:143]
ds_read_b64_tr_b16 v[232:233], v34 offset:36864
s_waitcnt vmcnt(9)
ds_read_b128 a[64:67], v124 offset:0
ds_read_b128 a[68:71], v124 offset:2048
ds_read_b128 a[72:75], v124 offset:4096
ds_read_b128 a[76:79], v124 offset:6144
v_mfma_f32_32x32x16_bf16 v[160:175], v[248:251], a[220:223], v[160:175]
ds_read_b64_tr_b16 v[234:235], v34 offset:37888
ds_read_b128 a[80:83], v125 offset:0
ds_read_b128 a[84:87], v125 offset:2048
ds_read_b128 a[88:91], v125 offset:4096
ds_read_b128 a[92:95], v125 offset:6144
s_add_u32 m0, s59, 0
v_mfma_f32_32x32x16_bf16 v[144:159], v[252:255], a[216:219], v[144:159]
ds_read_b64_tr_b16 v[236:237], v35 offset:36864
s_add_u32 s87, s61, s64
buffer_load_dwordx4 v20, s[16:19], s87 offen lds
v_mfma_f32_32x32x16_bf16 v[176:191], v[252:255], a[220:223], v[176:191]
ds_read_b64_tr_b16 v[238:239], v35 offset:37888
buffer_load_dwordx4 v21, s[16:19], s87 offen offset:1024 lds
s_add_u32 m0, m0, 2048
s_nop 0
v_mfma_f32_16x16x32_bf16 v[44:47], v[36:39], v[248:251], v[44:47]
buffer_load_dwordx4 v22, s[16:19], s87 offen lds
s_waitcnt lgkmcnt(14)
v_mfma_f32_32x32x16_bf16 v[128:143], v[224:227], a[224:227], v[128:143]
ds_read_b64_tr_b16 v[240:241], v34 offset:40960
ds_read_b64_tr_b16 v[242:243], v34 offset:41984
buffer_load_dwordx4 v23, s[16:19], s87 offen offset:1024 lds
v_mfma_f32_32x32x16_bf16 v[160:175], v[224:227], a[228:231], v[160:175]
ds_read_b64_tr_b16 v[244:245], v35 offset:40960
ds_read_b64_tr_b16 v[246:247], v35 offset:41984
s_add_u32 m0, s59, 4096
s_add_u32 s87, s61, s65
buffer_load_dwordx4 v20, s[16:19], s87 offen lds
s_waitcnt lgkmcnt(15)
v_mfma_f32_32x32x16_bf16 v[144:159], v[228:231], a[224:227], v[144:159]
ds_read_b64_tr_b16 v[248:249], v34 offset:45056
ds_read_b64_tr_b16 v[250:251], v34 offset:46080
buffer_load_dwordx4 v21, s[16:19], s87 offen offset:1024 lds
s_add_u32 m0, m0, 2048
v_mfma_f32_32x32x16_bf16 v[176:191], v[228:231], a[228:231], v[176:191]
ds_read_b64_tr_b16 v[252:253], v35 offset:45056
ds_read_b64_tr_b16 v[254:255], v35 offset:46080
s_nop 0
buffer_load_dwordx4 v22, s[16:19], s87 offen lds
v_mfma_f32_16x16x32_bf16 v[44:47], v[36:39], v[224:227], v[44:47]
buffer_load_dwordx4 v23, s[16:19], s87 offen offset:1024 lds
s_waitcnt lgkmcnt(14)
v_mfma_f32_32x32x16_bf16 v[128:143], v[232:235], a[232:235], v[128:143]
s_add_u32 s61, s61, 128
s_and_b32 s61, s61, 1023
v_mfma_f32_32x32x16_bf16 v[160:175], v[232:235], a[236:239], v[160:175]
s_waitcnt lgkmcnt(8)
v_mfma_f32_32x32x16_bf16 v[144:159], v[236:239], a[232:235], v[144:159]
v_mfma_f32_32x32x16_bf16 v[176:191], v[236:239], a[236:239], v[176:191]
v_mfma_f32_16x16x32_bf16 v[44:47], v[36:39], v[232:235], v[44:47]
s_waitcnt lgkmcnt(6)
v_mfma_f32_32x32x16_bf16 v[128:143], v[240:243], a[240:243], v[128:143]
s_waitcnt vmcnt(8)
ds_read_b128 a[96:99], v124 offset:32768
ds_read_b128 a[100:103], v124 offset:34816
ds_read_b128 a[104:107], v124 offset:36864
ds_read_b128 a[108:111], v124 offset:38912
ds_read_b128 a[112:115], v125 offset:32768
v_mfma_f32_32x32x16_bf16 v[160:175], v[240:243], a[244:247], v[160:175]
ds_read_b128 a[116:119], v125 offset:34816
ds_read_b128 a[120:123], v125 offset:36864
ds_read_b128 a[124:127], v125 offset:38912
s_add_u32 m0, s59, 32768
s_add_u32 s87, s61, s64
s_waitcnt lgkmcnt(12)
v_mfma_f32_32x32x16_bf16 v[144:159], v[244:247], a[240:243], v[144:159]
buffer_load_dwordx4 v20, s[16:19], s87 offen lds
buffer_load_dwordx4 v21, s[16:19], s87 offen offset:1024 lds
v_mfma_f32_32x32x16_bf16 v[176:191], v[244:247], a[244:247], v[176:191]
s_add_u32 m0, m0, 2048
s_nop 0
buffer_load_dwordx4 v22, s[16:19], s87 offen lds
v_mfma_f32_16x16x32_bf16 v[44:47], v[36:39], v[240:243], v[44:47]
buffer_load_dwordx4 v23, s[16:19], s87 offen offset:1024 lds
s_waitcnt lgkmcnt(10)
v_mfma_f32_32x32x16_bf16 v[128:143], v[248:251], a[248:251], v[128:143]
s_add_u32 m0, s59, 36864
s_add_u32 s87, s61, s65
buffer_load_dwordx4 v20, s[16:19], s87 offen lds
v_mfma_f32_32x32x16_bf16 v[160:175], v[248:251], a[252:255], v[160:175]
buffer_load_dwordx4 v21, s[16:19], s87 offen offset:1024 lds
s_add_u32 m0, m0, 2048
s_nop 0
s_waitcnt lgkmcnt(8)
v_mfma_f32_32x32x16_bf16 v[144:159], v[252:255], a[248:251], v[144:159]
buffer_load_dwordx4 v22, s[16:19], s87 offen lds
buffer_load_dwordx4 v23, s[16:19], s87 offen offset:1024 lds
v_mfma_f32_32x32x16_bf16 v[176:191], v[252:255], a[252:255], v[176:191]
s_add_u32 s61, s61, 128
s_and_b32 s61, s61, 1023
v_mfma_f32_16x16x32_bf16 v[44:47], v[36:39], v[248:251], v[44:47]
s_nop 7
v_cndmask_b32 v7, v44, v45, s[66:67]
s_lshl_b32 s53, s44, 7
v_add_u32 v6, s53, v54
ds_write_b32 v6, v7 offset:1280
s_add_u32 s54, s88, 0
s_lshl_b32 s54, s54, 12
v_add_u32 v33, s54, v32
s_add_u32 s54, s88, 1
s_lshl_b32 s54, s54, 12
v_add_u32 v47, s54, v32
s_add_u32 s54, s88, 2
s_lshl_b32 s54, s54, 12
s_cmp_eq_u32 s89, 3
s_cselect_b32 s54, s54, 0x40000000
v_add_u32 v55, s54, v32
s_mov_b32 s99, 0
s_waitcnt lgkmcnt(0)
s_barrier
s_lshl_b32 s53, s44, 7
v_lshrrev_b32 v5, 5, v0
v_lshlrev_b32 v5, 4, v5
v_add_u32 v5, s53, v5
v_add_u32 v5, 161024, v5
ds_read_b128 v[192:195], v5 offset:0
ds_read_b128 v[196:199], v5 offset:32
ds_read_b128 v[200:203], v5 offset:64
ds_read_b128 v[204:207], v5 offset:96
s_xor_b32 s54, s53, 128
v_add_u32 v6, s54, v54
ds_read_b32 v120, v6 offset:0
ds_read_b32 v121, v6 offset:512
s_xor_b32 s53, s53, 256
v_lshrrev_b32 v5, 5, v0
v_lshlrev_b32 v5, 4, v5
v_add_u32 v5, s53, v5
v_add_u32 v5, 161024, v5
ds_read_b128 v[104:107], v5 offset:0
ds_read_b128 v[108:111], v5 offset:32
ds_read_b128 v[112:115], v5 offset:64
ds_read_b128 v[116:119], v5 offset:96
v_bfe_u32 v5, v0, 4, 1
v_lshlrev_b32 v122, 14, v5
v_lshrrev_b32 v5, 5, v0
v_lshl_add_u32 v122, v5, 8, v122
v_lshl_add_u32 v122, v4, 4, v122
s_lshl_b32 s53, s46, 12
s_add_u32 s56, s53, 5996544
s_waitcnt lgkmcnt(9)
v_pk_mul_f32 v[208:209], v[192:193], v[48:49] op_sel:[0,1] op_sel_hi:[1,1]
v_pk_mul_f32 v[210:211], v[194:195], v[48:49] op_sel:[0,1] op_sel_hi:[1,1]
s_waitcnt lgkmcnt(8)
v_pk_mul_f32 v[212:213], v[196:197], v[48:49] op_sel:[0,1] op_sel_hi:[1,1]
v_pk_mul_f32 v[214:215], v[198:199], v[48:49] op_sel:[0,1] op_sel_hi:[1,1]
v_pk_fma_f32 v[208:209], v[128:129], v[48:49], v[208:209] op_sel:[0,0,0] op_sel_hi:[1,0,1]
v_pk_fma_f32 v[210:211], v[130:131], v[48:49], v[210:211] op_sel:[0,0,0] op_sel_hi:[1,0,1]
v_pk_fma_f32 v[212:213], v[132:133], v[48:49], v[212:213] op_sel:[0,0,0] op_sel_hi:[1,0,1]
v_pk_fma_f32 v[214:215], v[134:135], v[48:49], v[214:215] op_sel:[0,0,0] op_sel_hi:[1,0,1]
v_pk_mul_f32 v[216:217], v[208:209], v[24:25] op_sel:[0,0] op_sel_hi:[1,0]
v_pk_mul_f32 v[218:219], v[210:211], v[24:25] op_sel:[0,0] op_sel_hi:[1,0]
v_pk_mul_f32 v[220:221], v[212:213], v[24:25] op_sel:[0,0] op_sel_hi:[1,0]
v_pk_mul_f32 v[222:223], v[214:215], v[24:25] op_sel:[0,0] op_sel_hi:[1,0]
v_exp_f32_e64 v216, v216 clamp
v_exp_f32_e64 v217, v217 clamp
v_exp_f32_e64 v218, v218 clamp
v_exp_f32_e64 v219, v219 clamp
v_exp_f32_e64 v220, v220 clamp
v_exp_f32_e64 v221, v221 clamp
v_exp_f32_e64 v222, v222 clamp
v_exp_f32_e64 v223, v223 clamp
v_max_f32 v208, 0, v208
v_max_f32 v209, 0, v209
v_max_f32 v210, 0, v210
v_max_f32 v211, 0, v211
v_max_f32 v212, 0, v212
v_max_f32 v213, 0, v213
v_max_f32 v214, 0, v214
v_max_f32 v215, 0, v215
v_pk_add_f32 v[216:217], v[216:217], v[24:25] op_sel:[0,1] op_sel_hi:[1,1]
v_pk_add_f32 v[218:219], v[218:219], v[24:25] op_sel:[0,1] op_sel_hi:[1,1]
v_pk_add_f32 v[220:221], v[220:221], v[24:25] op_sel:[0,1] op_sel_hi:[1,1]
v_pk_add_f32 v[222:223], v[222:223], v[24:25] op_sel:[0,1] op_sel_hi:[1,1]
v_pk_add_f32 v[208:209], v[208:209], v[216:217]
v_pk_add_f32 v[210:211], v[210:211], v[218:219]
v_pk_add_f32 v[212:213], v[212:213], v[220:221]
v_pk_add_f32 v[214:215], v[214:215], v[222:223]
v_cvt_pk_bf16_f32 v224, v208, v209
v_cvt_pk_bf16_f32 v225, v210, v211
v_cvt_pk_bf16_f32 v228, v212, v213
v_cvt_pk_bf16_f32 v229, v214, v215
s_waitcnt vmcnt(8)
ds_read_b128 a[128:131], v16 offset:0
ds_read_b128 a[132:135], v16 offset:2048
ds_read_b128 a[136:139], v16 offset:4096
ds_read_b128 a[140:143], v16 offset:6144
ds_read_b128 a[144:147], v17 offset:0
ds_read_b128 a[148:151], v17 offset:2048
ds_read_b128 a[152:155], v17 offset:4096
ds_read_b128 a[156:159], v17 offset:6144
s_waitcnt lgkmcnt(0)
s_add_u32 m0, s59, 0
s_add_u32 s87, s61, s64
buffer_load_dwordx4 v20, s[16:19], s87 offen lds
buffer_load_dwordx4 v21, s[16:19], s87 offen offset:1024 lds
s_add_u32 m0, m0, 2048
s_nop 0
buffer_load_dwordx4 v22, s[16:19], s87 offen lds
buffer_load_dwordx4 v23, s[16:19], s87 offen offset:1024 lds
s_add_u32 m0, s59, 4096
s_add_u32 s87, s61, s65
buffer_load_dwordx4 v20, s[16:19], s87 offen lds
buffer_load_dwordx4 v21, s[16:19], s87 offen offset:1024 lds
s_add_u32 m0, m0, 2048
s_nop 0
buffer_load_dwordx4 v22, s[16:19], s87 offen lds
v_pk_mul_f32 v[208:209], v[200:201], v[48:49] op_sel:[0,1] op_sel_hi:[1,1]
v_pk_mul_f32 v[210:211], v[202:203], v[48:49] op_sel:[0,1] op_sel_hi:[1,1]
v_pk_mul_f32 v[212:213], v[204:205], v[48:49] op_sel:[0,1] op_sel_hi:[1,1]
v_pk_mul_f32 v[214:215], v[206:207], v[48:49] op_sel:[0,1] op_sel_hi:[1,1]
v_pk_fma_f32 v[208:209], v[136:137], v[48:49], v[208:209] op_sel:[0,0,0] op_sel_hi:[1,0,1]
v_pk_fma_f32 v[210:211], v[138:139], v[48:49], v[210:211] op_sel:[0,0,0] op_sel_hi:[1,0,1]
v_pk_fma_f32 v[212:213], v[140:141], v[48:49], v[212:213] op_sel:[0,0,0] op_sel_hi:[1,0,1]
v_pk_fma_f32 v[214:215], v[142:143], v[48:49], v[214:215] op_sel:[0,0,0] op_sel_hi:[1,0,1]
v_pk_mul_f32 v[216:217], v[208:209], v[24:25] op_sel:[0,0] op_sel_hi:[1,0]
v_pk_mul_f32 v[218:219], v[210:211], v[24:25] op_sel:[0,0] op_sel_hi:[1,0]
v_pk_mul_f32 v[220:221], v[212:213], v[24:25] op_sel:[0,0] op_sel_hi:[1,0]
v_pk_mul_f32 v[222:223], v[214:215], v[24:25] op_sel:[0,0] op_sel_hi:[1,0]
v_exp_f32_e64 v216, v216 clamp
v_exp_f32_e64 v217, v217 clamp
v_exp_f32_e64 v218, v218 clamp
v_exp_f32_e64 v219, v219 clamp
v_exp_f32_e64 v220, v220 clamp
v_exp_f32_e64 v221, v221 clamp
v_exp_f32_e64 v222, v222 clamp
v_exp_f32_e64 v223, v223 clamp
v_max_f32 v208, 0, v208
v_max_f32 v209, 0, v209
v_max_f32 v210, 0, v210
v_max_f32 v211, 0, v211
v_max_f32 v212, 0, v212
v_max_f32 v213, 0, v213
v_max_f32 v214, 0, v214
v_max_f32 v215, 0, v215
v_pk_add_f32 v[216:217], v[216:217], v[24:25] op_sel:[0,1] op_sel_hi:[1,1]
v_pk_add_f32 v[218:219], v[218:219], v[24:25] op_sel:[0,1] op_sel_hi:[1,1]
v_pk_add_f32 v[220:221], v[220:221], v[24:25] op_sel:[0,1] op_sel_hi:[1,1]
v_pk_add_f32 v[222:223], v[222:223], v[24:25] op_sel:[0,1] op_sel_hi:[1,1]
v_pk_add_f32 v[208:209], v[208:209], v[216:217]
v_pk_add_f32 v[210:211], v[210:211], v[218:219]
v_pk_add_f32 v[212:213], v[212:213], v[220:221]
v_pk_add_f32 v[214:215], v[214:215], v[222:223]
v_cvt_pk_bf16_f32 v226, v208, v209
v_cvt_pk_bf16_f32 v227, v210, v211
v_cvt_pk_bf16_f32 v230, v212, v213
v_cvt_pk_bf16_f32 v231, v214, v215
buffer_load_dwordx4 v23, s[16:19], s87 offen offset:1024 lds
s_add_u32 s61, s61, 128
s_and_b32 s61, s61, 1023
s_xor_b32 s53, s96, 0
s_mul_i32 s53, s53, 32768
s_xor_b32 s54, s44, 0
s_lshl_b32 s54, s54, 10
s_add_u32 s53, s53, s54
s_add_u32 s63, s53, s56
buffer_store_dwordx4 v[224:227], v122, s[20:23], s63 offen offset:0 sc1
buffer_store_dwordx4 v[228:231], v122, s[20:23], s63 offen offset:512 sc1
v_pk_mul_f32 v[208:209], v[192:193], v[120:121] op_sel:[0,1] op_sel_hi:[1,1]
v_pk_mul_f32 v[210:211], v[194:195], v[120:121] op_sel:[0,1] op_sel_hi:[1,1]
v_pk_mul_f32 v[212:213], v[196:197], v[120:121] op_sel:[0,1] op_sel_hi:[1,1]
v_pk_mul_f32 v[214:215], v[198:199], v[120:121] op_sel:[0,1] op_sel_hi:[1,1]
v_pk_fma_f32 v[208:209], v[160:161], v[120:121], v[208:209] op_sel:[0,0,0] op_sel_hi:[1,0,1]
v_pk_fma_f32 v[210:211], v[162:163], v[120:121], v[210:211] op_sel:[0,0,0] op_sel_hi:[1,0,1]
v_pk_fma_f32 v[212:213], v[164:165], v[120:121], v[212:213] op_sel:[0,0,0] op_sel_hi:[1,0,1]
v_pk_fma_f32 v[214:215], v[166:167], v[120:121], v[214:215] op_sel:[0,0,0] op_sel_hi:[1,0,1]
v_pk_mul_f32 v[216:217], v[208:209], v[24:25] op_sel:[0,0] op_sel_hi:[1,0]
v_pk_mul_f32 v[218:219], v[210:211], v[24:25] op_sel:[0,0] op_sel_hi:[1,0]
v_pk_mul_f32 v[220:221], v[212:213], v[24:25] op_sel:[0,0] op_sel_hi:[1,0]
v_pk_mul_f32 v[222:223], v[214:215], v[24:25] op_sel:[0,0] op_sel_hi:[1,0]
v_exp_f32_e64 v216, v216 clamp
v_exp_f32_e64 v217, v217 clamp
v_exp_f32_e64 v218, v218 clamp
v_exp_f32_e64 v219, v219 clamp
v_exp_f32_e64 v220, v220 clamp
v_exp_f32_e64 v221, v221 clamp
v_exp_f32_e64 v222, v222 clamp
v_exp_f32_e64 v223, v223 clamp
v_max_f32 v208, 0, v208
v_max_f32 v209, 0, v209
v_max_f32 v210, 0, v210
v_max_f32 v211, 0, v211
v_max_f32 v212, 0, v212
v_max_f32 v213, 0, v213
v_max_f32 v214, 0, v214
v_max_f32 v215, 0, v215
v_pk_add_f32 v[216:217], v[216:217], v[24:25] op_sel:[0,1] op_sel_hi:[1,1]
v_pk_add_f32 v[218:219], v[218:219], v[24:25] op_sel:[0,1] op_sel_hi:[1,1]
v_pk_add_f32 v[220:221], v[220:221], v[24:25] op_sel:[0,1] op_sel_hi:[1,1]
v_pk_add_f32 v[222:223], v[222:223], v[24:25] op_sel:[0,1] op_sel_hi:[1,1]
v_pk_add_f32 v[208:209], v[208:209], v[216:217]
v_pk_add_f32 v[210:211], v[210:211], v[218:219]
v_pk_add_f32 v[212:213], v[212:213], v[220:221]
v_pk_add_f32 v[214:215], v[214:215], v[222:223]
v_cvt_pk_bf16_f32 v232, v208, v209
v_cvt_pk_bf16_f32 v233, v210, v211
v_cvt_pk_bf16_f32 v236, v212, v213
v_cvt_pk_bf16_f32 v237, v214, v215
s_lshr_b32 s3, s88, 1
s_waitcnt vmcnt(10)
v_lshlrev_b32 v11, 13, v3
ds_read_b128 a[160:163], v16 offset:32768
s_and_b32 s97, s89, 1
s_lshl_b32 s97, s97, 3
v_and_b32 v12, s97, v0
ds_read_b128 a[164:167], v16 offset:34816
v_lshl_add_u32 v11, v12, 6, v11
v_and_b32 v12, 6, v0
v_lshl_add_u32 v11, v12, 6, v11
ds_read_b128 a[168:171], v16 offset:36864
s_lshl_b32 s97, s44, 6
s_add_u32 s97, s97, s3
s_lshl_b32 s97, s97, 9
ds_read_b128 a[172:175], v16 offset:38912
s_add_u32 s97, s97, 65536
buffer_load_dwordx2 v[34:35], v11, s[20:23], s97 offen sc1
ds_read_b128 a[176:179], v17 offset:32768
ds_read_b128 a[180:183], v17 offset:34816
ds_read_b128 a[184:187], v17 offset:36864
ds_read_b128 a[188:191], v17 offset:38912
s_waitcnt lgkmcnt(0)
s_add_u32 m0, s59, 32768
s_add_u32 s87, s61, s64
buffer_load_dwordx4 v20, s[16:19], s87 offen lds
buffer_load_dwordx4 v21, s[16:19], s87 offen offset:1024 lds
s_add_u32 m0, m0, 2048
s_nop 0
buffer_load_dwordx4 v22, s[16:19], s87 offen lds
buffer_load_dwordx4 v23, s[16:19], s87 offen offset:1024 lds
v_pk_mul_f32 v[208:209], v[200:201], v[120:121] op_sel:[0,1] op_sel_hi:[1,1]
v_pk_mul_f32 v[210:211], v[202:203], v[120:121] op_sel:[0,1] op_sel_hi:[1,1]
v_pk_mul_f32 v[212:213], v[204:205], v[120:121] op_sel:[0,1] op_sel_hi:[1,1]
v_pk_mul_f32 v[214:215], v[206:207], v[120:121] op_sel:[0,1] op_sel_hi:[1,1]
v_pk_fma_f32 v[208:209], v[168:169], v[120:121], v[208:209] op_sel:[0,0,0] op_sel_hi:[1,0,1]
v_pk_fma_f32 v[210:211], v[170:171], v[120:121], v[210:211] op_sel:[0,0,0] op_sel_hi:[1,0,1]
v_pk_fma_f32 v[212:213], v[172:173], v[120:121], v[212:213] op_sel:[0,0,0] op_sel_hi:[1,0,1]
v_pk_fma_f32 v[214:215], v[174:175], v[120:121], v[214:215] op_sel:[0,0,0] op_sel_hi:[1,0,1]
v_pk_mul_f32 v[216:217], v[208:209], v[24:25] op_sel:[0,0] op_sel_hi:[1,0]
v_pk_mul_f32 v[218:219], v[210:211], v[24:25] op_sel:[0,0] op_sel_hi:[1,0]
v_pk_mul_f32 v[220:221], v[212:213], v[24:25] op_sel:[0,0] op_sel_hi:[1,0]
v_pk_mul_f32 v[222:223], v[214:215], v[24:25] op_sel:[0,0] op_sel_hi:[1,0]
v_exp_f32_e64 v216, v216 clamp
v_exp_f32_e64 v217, v217 clamp
v_exp_f32_e64 v218, v218 clamp
v_exp_f32_e64 v219, v219 clamp
v_exp_f32_e64 v220, v220 clamp
v_exp_f32_e64 v221, v221 clamp
v_exp_f32_e64 v222, v222 clamp
v_exp_f32_e64 v223, v223 clamp
v_max_f32 v208, 0, v208
v_max_f32 v209, 0, v209
v_max_f32 v210, 0, v210
v_max_f32 v211, 0, v211
v_max_f32 v212, 0, v212
v_max_f32 v213, 0, v213
v_max_f32 v214, 0, v214
v_max_f32 v215, 0, v215
v_pk_add_f32 v[216:217], v[216:217], v[24:25] op_sel:[0,1] op_sel_hi:[1,1]
v_pk_add_f32 v[218:219], v[218:219], v[24:25] op_sel:[0,1] op_sel_hi:[1,1]
v_pk_add_f32 v[220:221], v[220:221], v[24:25] op_sel:[0,1] op_sel_hi:[1,1]
v_pk_add_f32 v[222:223], v[222:223], v[24:25] op_sel:[0,1] op_sel_hi:[1,1]
v_pk_add_f32 v[208:209], v[208:209], v[216:217]
v_pk_add_f32 v[210:211], v[210:211], v[218:219]
v_pk_add_f32 v[212:213], v[212:213], v[220:221]
v_pk_add_f32 v[214:215], v[214:215], v[222:223]
v_cvt_pk_bf16_f32 v234, v208, v209
v_cvt_pk_bf16_f32 v235, v210, v211
v_cvt_pk_bf16_f32 v238, v212, v213
v_cvt_pk_bf16_f32 v239, v214, v215
s_add_u32 m0, s59, 36864
s_add_u32 s87, s61, s65
buffer_load_dwordx4 v20, s[16:19], s87 offen lds
buffer_load_dwordx4 v21, s[16:19], s87 offen offset:1024 lds
s_add_u32 m0, m0, 2048
s_nop 0
buffer_load_dwordx4 v22, s[16:19], s87 offen lds
buffer_load_dwordx4 v23, s[16:19], s87 offen offset:1024 lds
s_add_u32 s61, s61, 128
s_and_b32 s61, s61, 1023
s_lshl_b32 s87, s44, 2
s_add_u32 s87, s87, s47
s_add_u32 s87, s87, 0
s_and_b32 s87, s87, 15
s_lshl_b32 m0, s87, 12
s_add_u32 m0, m0, 73728
s_lshl_b32 s87, s87, 15
buffer_load_dwordx4 v28, s[24:27], s87 offen lds
buffer_load_dwordx4 v29, s[24:27], s87 offen offset:1024 lds
buffer_load_dwordx4 v30, s[24:27], s87 offen offset:2048 lds
buffer_load_dwordx4 v31, s[24:27], s87 offen offset:3072 lds
s_lshl_b32 s87, s44, 2
s_add_u32 s87, s87, s47
s_add_u32 s87, s87, 1
s_xor_b32 s53, s96, 1
s_mul_i32 s53, s53, 32768
s_xor_b32 s54, s44, 0
s_lshl_b32 s54, s54, 10
s_add_u32 s53, s53, s54
s_add_u32 s63, s53, s56
buffer_store_dwordx4 v[232:235], v122, s[20:23], s63 offen offset:0 sc1
buffer_store_dwordx4 v[236:239], v122, s[20:23], s63 offen offset:512 sc1
v_pk_mul_f32 v[208:209], v[104:105], v[48:49] op_sel:[0,1] op_sel_hi:[1,1]
v_pk_mul_f32 v[210:211], v[106:107], v[48:49] op_sel:[0,1] op_sel_hi:[1,1]
v_pk_mul_f32 v[212:213], v[108:109], v[48:49] op_sel:[0,1] op_sel_hi:[1,1]
v_pk_mul_f32 v[214:215], v[110:111], v[48:49] op_sel:[0,1] op_sel_hi:[1,1]
v_pk_fma_f32 v[208:209], v[144:145], v[48:49], v[208:209] op_sel:[0,0,0] op_sel_hi:[1,0,1]
v_pk_fma_f32 v[210:211], v[146:147], v[48:49], v[210:211] op_sel:[0,0,0] op_sel_hi:[1,0,1]
v_pk_fma_f32 v[212:213], v[148:149], v[48:49], v[212:213] op_sel:[0,0,0] op_sel_hi:[1,0,1]
v_pk_fma_f32 v[214:215], v[150:151], v[48:49], v[214:215] op_sel:[0,0,0] op_sel_hi:[1,0,1]
v_pk_mul_f32 v[216:217], v[208:209], v[24:25] op_sel:[0,0] op_sel_hi:[1,0]
v_pk_mul_f32 v[218:219], v[210:211], v[24:25] op_sel:[0,0] op_sel_hi:[1,0]
v_pk_mul_f32 v[220:221], v[212:213], v[24:25] op_sel:[0,0] op_sel_hi:[1,0]
v_pk_mul_f32 v[222:223], v[214:215], v[24:25] op_sel:[0,0] op_sel_hi:[1,0]
v_exp_f32_e64 v216, v216 clamp
v_exp_f32_e64 v217, v217 clamp
v_exp_f32_e64 v218, v218 clamp
v_exp_f32_e64 v219, v219 clamp
v_exp_f32_e64 v220, v220 clamp
v_exp_f32_e64 v221, v221 clamp
v_exp_f32_e64 v222, v222 clamp
v_exp_f32_e64 v223, v223 clamp
v_max_f32 v208, 0, v208
v_max_f32 v209, 0, v209
v_max_f32 v210, 0, v210
v_max_f32 v211, 0, v211
v_max_f32 v212, 0, v212
v_max_f32 v213, 0, v213
v_max_f32 v214, 0, v214
v_max_f32 v215, 0, v215
v_pk_add_f32 v[216:217], v[216:217], v[24:25] op_sel:[0,1] op_sel_hi:[1,1]
v_pk_add_f32 v[218:219], v[218:219], v[24:25] op_sel:[0,1] op_sel_hi:[1,1]
v_pk_add_f32 v[220:221], v[220:221], v[24:25] op_sel:[0,1] op_sel_hi:[1,1]
v_pk_add_f32 v[222:223], v[222:223], v[24:25] op_sel:[0,1] op_sel_hi:[1,1]
v_pk_add_f32 v[208:209], v[208:209], v[216:217]
v_pk_add_f32 v[210:211], v[210:211], v[218:219]
v_pk_add_f32 v[212:213], v[212:213], v[220:221]
v_pk_add_f32 v[214:215], v[214:215], v[222:223]
v_cvt_pk_bf16_f32 v240, v208, v209
v_cvt_pk_bf16_f32 v241, v210, v211
v_cvt_pk_bf16_f32 v244, v212, v213
v_cvt_pk_bf16_f32 v245, v214, v215
s_and_b32 s87, s87, 15
s_lshl_b32 m0, s87, 12
s_add_u32 m0, m0, 73728
s_lshl_b32 s87, s87, 15
buffer_load_dwordx4 v28, s[24:27], s87 offen lds
buffer_load_dwordx4 v29, s[24:27], s87 offen offset:1024 lds
buffer_load_dwordx4 v30, s[24:27], s87 offen offset:2048 lds
buffer_load_dwordx4 v31, s[24:27], s87 offen offset:3072 lds
s_cmp_eq_u32 s99, 1
s_cbranch_scc1 L_tb_32
s_waitcnt vmcnt(18)
v_cmp_ne_u64 vcc, v[34:35], v[26:27]
s_nop 3
s_cbranch_vccnz L_tb_33
s_mul_i32 s90, s92, 90112
s_add_u32 s92, s92, 1
s_add_u32 s90, s90, s93
s_and_b32 s92, s92, 7
buffer_load_dwordx4 v[56:59], v33, s[20:23], s90 offen offset:0 sc1
buffer_load_dwordx4 v[60:63], v33, s[20:23], s90 offen offset:2048 sc1
buffer_load_dwordx4 v[64:67], v47, s[20:23], s90 offen offset:0 sc1
buffer_load_dwordx4 v[68:71], v47, s[20:23], s90 offen offset:2048 sc1
buffer_load_dwordx4 v[72:75], v55, s[20:23], s90 offen offset:0 sc1
buffer_load_dwordx4 v[76:79], v55, s[20:23], s90 offen offset:2048 sc1
buffer_load_dwordx4 v[80:83], v33, s[20:23], s90 offen offset:1024 sc1
buffer_load_dwordx4 v[84:87], v33, s[20:23], s90 offen offset:3072 sc1
buffer_load_dwordx4 v[88:91], v47, s[20:23], s90 offen offset:1024 sc1
buffer_load_dwordx4 v[92:95], v47, s[20:23], s90 offen offset:3072 sc1
buffer_load_dwordx4 v[96:99], v55, s[20:23], s90 offen offset:1024 sc1
buffer_load_dwordx4 v[100:103], v55, s[20:23], s90 offen offset:3072 sc1
s_mov_b32 s99, 1
s_branch L_tb_32
L_tb_33:
buffer_load_dwordx2 v[34:35], v11, s[20:23], s97 offen sc1
L_tb_32:
v_pk_mul_f32 v[208:209], v[112:113], v[48:49] op_sel:[0,1] op_sel_hi:[1,1]
v_pk_mul_f32 v[210:211], v[114:115], v[48:49] op_sel:[0,1] op_sel_hi:[1,1]
v_pk_mul_f32 v[212:213], v[116:117], v[48:49] op_sel:[0,1] op_sel_hi:[1,1]
v_pk_mul_f32 v[214:215], v[118:119], v[48:49] op_sel:[0,1] op_sel_hi:[1,1]
v_pk_fma_f32 v[208:209], v[152:153], v[48:49], v[208:209] op_sel:[0,0,0] op_sel_hi:[1,0,1]
v_pk_fma_f32 v[210:211], v[154:155], v[48:49], v[210:211] op_sel:[0,0,0] op_sel_hi:[1,0,1]
v_pk_fma_f32 v[212:213], v[156:157], v[48:49], v[212:213] op_sel:[0,0,0] op_sel_hi:[1,0,1]
v_pk_fma_f32 v[214:215], v[158:159], v[48:49], v[214:215] op_sel:[0,0,0] op_sel_hi:[1,0,1]
v_pk_mul_f32 v[216:217], v[208:209], v[24:25] op_sel:[0,0] op_sel_hi:[1,0]
v_pk_mul_f32 v[218:219], v[210:211], v[24:25] op_sel:[0,0] op_sel_hi:[1,0]
v_pk_mul_f32 v[220:221], v[212:213], v[24:25] op_sel:[0,0] op_sel_hi:[1,0]
v_pk_mul_f32 v[222:223], v[214:215], v[24:25] op_sel:[0,0] op_sel_hi:[1,0]
v_exp_f32_e64 v216, v216 clamp
v_exp_f32_e64 v217, v217 clamp
v_exp_f32_e64 v218, v218 clamp
v_exp_f32_e64 v219, v219 clamp
v_exp_f32_e64 v220, v220 clamp
v_exp_f32_e64 v221, v221 clamp
v_exp_f32_e64 v222, v222 clamp
v_exp_f32_e64 v223, v223 clamp
v_max_f32 v208, 0, v208
v_max_f32 v209, 0, v209
v_max_f32 v210, 0, v210
v_max_f32 v211, 0, v211
v_max_f32 v212, 0, v212
v_max_f32 v213, 0, v213
v_max_f32 v214, 0, v214
v_max_f32 v215, 0, v215
v_pk_add_f32 v[216:217], v[216:217], v[24:25] op_sel:[0,1] op_sel_hi:[1,1]
v_pk_add_f32 v[218:219], v[218:219], v[24:25] op_sel:[0,1] op_sel_hi:[1,1]
v_pk_add_f32 v[220:221], v[220:221], v[24:25] op_sel:[0,1] op_sel_hi:[1,1]
v_pk_add_f32 v[222:223], v[222:223], v[24:25] op_sel:[0,1] op_sel_hi:[1,1]
v_pk_add_f32 v[208:209], v[208:209], v[216:217]
v_pk_add_f32 v[210:211], v[210:211], v[218:219]
v_pk_add_f32 v[212:213], v[212:213], v[220:221]
v_pk_add_f32 v[214:215], v[214:215], v[222:223]
v_cvt_pk_bf16_f32 v242, v208, v209
v_cvt_pk_bf16_f32 v243, v210, v211
v_cvt_pk_bf16_f32 v246, v212, v213
v_cvt_pk_bf16_f32 v247, v214, v215
s_waitcnt vmcnt(21)
ds_read_b128 a[192:195], v16 offset:0
ds_read_b128 a[196:199], v16 offset:2048
ds_read_b128 a[200:203], v16 offset:4096
ds_read_b128 a[204:207], v16 offset:6144
ds_read_b128 a[208:211], v17 offset:0
ds_read_b128 a[212:215], v17 offset:2048
ds_read_b128 a[216:219], v17 offset:4096
ds_read_b128 a[220:223], v17 offset:6144
s_xor_b32 s53, s96, 0
s_mul_i32 s53, s53, 32768
s_xor_b32 s54, s44, 2
s_lshl_b32 s54, s54, 10
s_add_u32 s53, s53, s54
s_add_u32 s63, s53, s56
buffer_store_dwordx4 v[240:243], v122, s[20:23], s63 offen offset:0 sc1
buffer_store_dwordx4 v[244:247], v122, s[20:23], s63 offen offset:512 sc1
v_pk_mul_f32 v[208:209], v[104:105], v[120:121] op_sel:[0,1] op_sel_hi:[1,1]
v_pk_mul_f32 v[210:211], v[106:107], v[120:121] op_sel:[0,1] op_sel_hi:[1,1]
v_pk_mul_f32 v[212:213], v[108:109], v[120:121] op_sel:[0,1] op_sel_hi:[1,1]
v_pk_mul_f32 v[214:215], v[110:111], v[120:121] op_sel:[0,1] op_sel_hi:[1,1]
v_pk_fma_f32 v[208:209], v[176:177], v[120:121], v[208:209] op_sel:[0,0,0] op_sel_hi:[1,0,1]
v_pk_fma_f32 v[210:211], v[178:179], v[120:121], v[210:211] op_sel:[0,0,0] op_sel_hi:[1,0,1]
v_pk_fma_f32 v[212:213], v[180:181], v[120:121], v[212:213] op_sel:[0,0,0] op_sel_hi:[1,0,1]
v_pk_fma_f32 v[214:215], v[182:183], v[120:121], v[214:215] op_sel:[0,0,0] op_sel_hi:[1,0,1]
v_pk_mul_f32 v[216:217], v[208:209], v[24:25] op_sel:[0,0] op_sel_hi:[1,0]
v_pk_mul_f32 v[218:219], v[210:211], v[24:25] op_sel:[0,0] op_sel_hi:[1,0]
v_pk_mul_f32 v[220:221], v[212:213], v[24:25] op_sel:[0,0] op_sel_hi:[1,0]
v_pk_mul_f32 v[222:223], v[214:215], v[24:25] op_sel:[0,0] op_sel_hi:[1,0]
v_exp_f32_e64 v216, v216 clamp
v_exp_f32_e64 v217, v217 clamp
v_exp_f32_e64 v218, v218 clamp
v_exp_f32_e64 v219, v219 clamp
v_exp_f32_e64 v220, v220 clamp
v_exp_f32_e64 v221, v221 clamp
v_exp_f32_e64 v222, v222 clamp
v_exp_f32_e64 v223, v223 clamp
v_max_f32 v208, 0, v208
v_max_f32 v209, 0, v209
v_max_f32 v210, 0, v210
v_max_f32 v211, 0, v211
v_max_f32 v212, 0, v212
v_max_f32 v213, 0, v213
v_max_f32 v214, 0, v214
v_max_f32 v215, 0, v215
v_pk_add_f32 v[216:217], v[216:217], v[24:25] op_sel:[0,1] op_sel_hi:[1,1]
v_pk_add_f32 v[218:219], v[218:219], v[24:25] op_sel:[0,1] op_sel_hi:[1,1]
v_pk_add_f32 v[220:221], v[220:221], v[24:25] op_sel:[0,1] op_sel_hi:[1,1]
v_pk_add_f32 v[222:223], v[222:223], v[24:25] op_sel:[0,1] op_sel_hi:[1,1]
v_pk_add_f32 v[208:209], v[208:209], v[216:217]
v_pk_add_f32 v[210:211], v[210:211], v[218:219]
v_pk_add_f32 v[212:213], v[212:213], v[220:221]
v_pk_add_f32 v[214:215], v[214:215], v[222:223]
v_cvt_pk_bf16_f32 v248, v208, v209
v_cvt_pk_bf16_f32 v249, v210, v211
v_cvt_pk_bf16_f32 v252, v212, v213
v_cvt_pk_bf16_f32 v253, v214, v215
s_waitcnt vmcnt(12)
ds_read_b128 a[224:227], v16 offset:32768
ds_read_b128 a[228:231], v16 offset:34816
ds_read_b128 a[232:235], v16 offset:36864
ds_read_b128 a[236:239], v16 offset:38912
ds_read_b128 a[240:243], v17 offset:32768
ds_read_b128 a[244:247], v17 offset:34816
ds_read_b128 a[248:251], v17 offset:36864
ds_read_b128 a[252:255], v17 offset:38912
s_cmp_eq_u32 s99, 1
s_cbranch_scc1 L_tb_35
s_waitcnt vmcnt(2)
v_cmp_ne_u64 vcc, v[34:35], v[26:27]
s_nop 3
s_cbranch_vccnz L_tb_36
s_mul_i32 s90, s92, 90112
s_add_u32 s92, s92, 1
s_add_u32 s90, s90, s93
s_and_b32 s92, s92, 7
buffer_load_dwordx4 v[56:59], v33, s[20:23], s90 offen offset:0 sc1
buffer_load_dwordx4 v[60:63], v33, s[20:23], s90 offen offset:2048 sc1
buffer_load_dwordx4 v[64:67], v47, s[20:23], s90 offen offset:0 sc1
buffer_load_dwordx4 v[68:71], v47, s[20:23], s90 offen offset:2048 sc1
buffer_load_dwordx4 v[72:75], v55, s[20:23], s90 offen offset:0 sc1
buffer_load_dwordx4 v[76:79], v55, s[20:23], s90 offen offset:2048 sc1
buffer_load_dwordx4 v[80:83], v33, s[20:23], s90 offen offset:1024 sc1
buffer_load_dwordx4 v[84:87], v33, s[20:23], s90 offen offset:3072 sc1
buffer_load_dwordx4 v[88:91], v47, s[20:23], s90 offen offset:1024 sc1
buffer_load_dwordx4 v[92:95], v47, s[20:23], s90 offen offset:3072 sc1
buffer_load_dwordx4 v[96:99], v55, s[20:23], s90 offen offset:1024 sc1
buffer_load_dwordx4 v[100:103], v55, s[20:23], s90 offen offset:3072 sc1
s_mov_b32 s99, 1
s_branch L_tb_35
L_tb_36:
buffer_load_dwordx2 v[34:35], v11, s[20:23], s97 offen sc1
L_tb_35:
v_pk_mul_f32 v[208:209], v[112:113], v[120:121] op_sel:[0,1] op_sel_hi:[1,1]
v_pk_mul_f32 v[210:211], v[114:115], v[120:121] op_sel:[0,1] op_sel_hi:[1,1]
v_pk_mul_f32 v[212:213], v[116:117], v[120:121] op_sel:[0,1] op_sel_hi:[1,1]
v_pk_mul_f32 v[214:215], v[118:119], v[120:121] op_sel:[0,1] op_sel_hi:[1,1]
v_pk_fma_f32 v[208:209], v[184:185], v[120:121], v[208:209] op_sel:[0,0,0] op_sel_hi:[1,0,1]
v_pk_fma_f32 v[210:211], v[186:187], v[120:121], v[210:211] op_sel:[0,0,0] op_sel_hi:[1,0,1]
v_pk_fma_f32 v[212:213], v[188:189], v[120:121], v[212:213] op_sel:[0,0,0] op_sel_hi:[1,0,1]
v_pk_fma_f32 v[214:215], v[190:191], v[120:121], v[214:215] op_sel:[0,0,0] op_sel_hi:[1,0,1]
v_pk_mul_f32 v[216:217], v[208:209], v[24:25] op_sel:[0,0] op_sel_hi:[1,0]
v_pk_mul_f32 v[218:219], v[210:211], v[24:25] op_sel:[0,0] op_sel_hi:[1,0]
v_pk_mul_f32 v[220:221], v[212:213], v[24:25] op_sel:[0,0] op_sel_hi:[1,0]
v_pk_mul_f32 v[222:223], v[214:215], v[24:25] op_sel:[0,0] op_sel_hi:[1,0]
v_exp_f32_e64 v216, v216 clamp
v_exp_f32_e64 v217, v217 clamp
v_exp_f32_e64 v218, v218 clamp
v_exp_f32_e64 v219, v219 clamp
v_exp_f32_e64 v220, v220 clamp
v_exp_f32_e64 v221, v221 clamp
v_exp_f32_e64 v222, v222 clamp
v_exp_f32_e64 v223, v223 clamp
v_max_f32 v208, 0, v208
v_max_f32 v209, 0, v209
v_max_f32 v210, 0, v210
v_max_f32 v211, 0, v211
v_max_f32 v212, 0, v212
v_max_f32 v213, 0, v213
v_max_f32 v214, 0, v214
v_max_f32 v215, 0, v215
v_pk_add_f32 v[216:217], v[216:217], v[24:25] op_sel:[0,1] op_sel_hi:[1,1]
v_pk_add_f32 v[218:219], v[218:219], v[24:25] op_sel:[0,1] op_sel_hi:[1,1]
v_pk_add_f32 v[220:221], v[220:221], v[24:25] op_sel:[0,1] op_sel_hi:[1,1]
v_pk_add_f32 v[222:223], v[222:223], v[24:25] op_sel:[0,1] op_sel_hi:[1,1]
v_pk_add_f32 v[208:209], v[208:209], v[216:217]
v_pk_add_f32 v[210:211], v[210:211], v[218:219]
v_pk_add_f32 v[212:213], v[212:213], v[220:221]
v_pk_add_f32 v[214:215], v[214:215], v[222:223]
v_cvt_pk_bf16_f32 v250, v208, v209
v_cvt_pk_bf16_f32 v251, v210, v211
v_cvt_pk_bf16_f32 v254, v212, v213
v_cvt_pk_bf16_f32 v255, v214, v215
s_xor_b32 s53, s96, 1
s_mul_i32 s53, s53, 32768
s_xor_b32 s54, s44, 2
s_lshl_b32 s54, s54, 10
s_add_u32 s53, s53, s54
s_add_u32 s63, s53, s56
buffer_store_dwordx4 v[248:251], v122, s[20:23], s63 offen offset:0 sc1
buffer_store_dwordx4 v[252:255], v122, s[20:23], s63 offen offset:512 sc1
s_lshr_b32 s98, s96, 1
s_lshl_b32 s98, s98, 3
s_add_u32 s98, s98, s46
s_lshl_b32 s98, s98, 1
s_add_u32 s98, s98, s91
s_lshl_b32 s98, s98, 7
s_add_u32 s98, s98, 194560
v_lshrrev_b32 v6, 2, v0
v_bfe_u32 v7, v0, 3, 2
v_and_b32 v8, 3, v0
v_lshlrev_b32 v6, 7, v6
v_lshl_add_u32 v6, v8, 3, v6
v_lshl_add_u32 v40, v7, 5, v6
v_add_u32 v40, 73728, v40
v_xor_b32 v41, 32, v40
v_xor_b32 v42, 64, v40
v_xor_b32 v43, 96, v40
s_cmp_eq_u32 s99, 1
s_cbranch_scc1 L_bd_38
s_waitcnt vmcnt(2)
v_cmp_ne_u64 vcc, v[34:35], v[26:27]
s_nop 3
s_cbranch_vccz L_ok_41
s_mov_b32 s62, 4000
L_sp_40:
s_sleep 3
buffer_load_dwordx2 v[34:35], v11, s[20:23], s97 offen sc1
s_waitcnt vmcnt(0)
v_cmp_ne_u64 vcc, v[34:35], v[26:27]
s_sub_u32 s62, s62, 1
s_cbranch_scc1 L_ok_41
s_nop 1
s_cbranch_vccnz L_sp_40
L_ok_41:
s_mul_i32 s90, s92, 90112
s_add_u32 s92, s92, 1
s_add_u32 s90, s90, s93
s_and_b32 s92, s92, 7
buffer_load_dwordx4 v[56:59], v33, s[20:23], s90 offen offset:0 sc1
buffer_load_dwordx4 v[60:63], v33, s[20:23], s90 offen offset:2048 sc1
buffer_load_dwordx4 v[64:67], v47, s[20:23], s90 offen offset:0 sc1
buffer_load_dwordx4 v[68:71], v47, s[20:23], s90 offen offset:2048 sc1
buffer_load_dwordx4 v[72:75], v55, s[20:23], s90 offen offset:0 sc1
buffer_load_dwordx4 v[76:79], v55, s[20:23], s90 offen offset:2048 sc1
buffer_load_dwordx4 v[80:83], v33, s[20:23], s90 offen offset:1024 sc1
buffer_load_dwordx4 v[84:87], v33, s[20:23], s90 offen offset:3072 sc1
buffer_load_dwordx4 v[88:91], v47, s[20:23], s90 offen offset:1024 sc1
buffer_load_dwordx4 v[92:95], v47, s[20:23], s90 offen offset:3072 sc1
buffer_load_dwordx4 v[96:99], v55, s[20:23], s90 offen offset:1024 sc1
buffer_load_dwordx4 v[100:103], v55, s[20:23], s90 offen offset:3072 sc1
L_bd_38:
s_mul_i32 s90, s92, 90112
s_add_u32 s92, s92, 1
s_add_u32 s90, s90, s93
s_and_b32 s92, s92, 7
buffer_load_dwordx4 v[104:107], v33, s[20:23], s90 offen offset:0 sc1
buffer_load_dwordx4 v[108:111], v33, s[20:23], s90 offen offset:2048 sc1
buffer_load_dwordx4 v[112:115], v47, s[20:23], s90 offen offset:0 sc1
s_waitcnt vmcnt(14)
v_mfma_f32_16x16x32_bf16 v[128:131], v[56:59], a[0:3], 0
s_lshl_b32 s87, s44, 2
s_add_u32 s87, s87, s47
s_add_u32 s87, s87, 2
v_mfma_f32_16x16x32_bf16 v[152:155], v[56:59], a[4:7], 0
s_mov_b64 exec, 1
buffer_store_dwordx2 v[26:27], v14, s[20:23], s98 offen sc1
s_mov_b64 exec, -1
v_mfma_f32_16x16x32_bf16 v[176:179], v[56:59], a[8:11], 0
s_and_b32 s87, s87, 15
v_mfma_f32_16x16x32_bf16 v[200:203], v[56:59], a[12:15], 0
buffer_load_dwordx4 v[56:59], v47, s[20:23], s90 offen offset:2048 sc1
s_waitcnt vmcnt(15)
v_mfma_f32_16x16x32_bf16 v[132:135], v[60:63], a[0:3], 0
s_lshl_b32 m0, s87, 12
s_add_u32 m0, m0, 73728
v_mfma_f32_16x16x32_bf16 v[156:159], v[60:63], a[4:7], 0
s_lshl_b32 s87, s87, 15
buffer_load_dwordx4 v28, s[24:27], s87 offen lds
v_mfma_f32_16x16x32_bf16 v[180:183], v[60:63], a[8:11], 0
v_mfma_f32_16x16x32_bf16 v[204:207], v[60:63], a[12:15], 0
buffer_load_dwordx4 v[60:63], v55, s[20:23], s90 offen offset:0 sc1
s_waitcnt vmcnt(16)
v_mfma_f32_16x16x32_bf16 v[136:139], v[64:67], a[0:3], 0
buffer_load_dwordx4 v29, s[24:27], s87 offen offset:1024 lds
v_mfma_f32_16x16x32_bf16 v[160:163], v[64:67], a[4:7], 0
v_mfma_f32_16x16x32_bf16 v[184:187], v[64:67], a[8:11], 0
buffer_load_dwordx4 v30, s[24:27], s87 offen offset:2048 lds
v_mfma_f32_16x16x32_bf16 v[208:211], v[64:67], a[12:15], 0
buffer_load_dwordx4 v[64:67], v55, s[20:23], s90 offen offset:2048 sc1
s_waitcnt vmcnt(18)
v_mfma_f32_16x16x32_bf16 v[140:143], v[68:71], a[0:3], 0
v_mfma_f32_16x16x32_bf16 v[164:167], v[68:71], a[4:7], 0
buffer_load_dwordx4 v31, s[24:27], s87 offen offset:3072 lds
v_mfma_f32_16x16x32_bf16 v[188:191], v[68:71], a[8:11], 0
v_mfma_f32_16x16x32_bf16 v[212:215], v[68:71], a[12:15], 0
buffer_load_dwordx4 v[68:71], v33, s[20:23], s90 offen offset:1024 sc1
s_waitcnt vmcnt(19)
v_mfma_f32_16x16x32_bf16 v[144:147], v[72:75], a[0:3], 0
v_mfma_f32_16x16x32_bf16 v[168:171], v[72:75], a[4:7], 0
v_mfma_f32_16x16x32_bf16 v[192:195], v[72:75], a[8:11], 0
v_mfma_f32_16x16x32_bf16 v[216:219], v[72:75], a[12:15], 0
buffer_load_dwordx4 v[72:75], v33, s[20:23], s90 offen offset:3072 sc1
s_waitcnt vmcnt(19)
v_mfma_f32_16x16x32_bf16 v[148:151], v[76:79], a[0:3], 0
v_mfma_f32_16x16x32_bf16 v[172:175], v[76:79], a[4:7], 0
v_mfma_f32_16x16x32_bf16 v[196:199], v[76:79], a[8:11], 0
v_mfma_f32_16x16x32_bf16 v[220:223], v[76:79], a[12:15], 0
buffer_load_dwordx4 v[76:79], v47, s[20:23], s90 offen offset:1024 sc1
s_waitcnt vmcnt(19)
v_mfma_f32_16x16x32_bf16 v[128:131], v[80:83], a[16:19], v[128:131]
s_lshl_b32 s87, s44, 2
s_add_u32 s87, s87, s47
s_add_u32 s87, s87, 3
v_mfma_f32_16x16x32_bf16 v[152:155], v[80:83], a[20:23], v[152:155]
s_and_b32 s87, s87, 15
s_lshl_b32 m0, s87, 12
s_add_u32 m0, m0, 73728
s_lshl_b32 s87, s87, 15
v_mfma_f32_16x16x32_bf16 v[176:179], v[80:83], a[24:27], v[176:179]
buffer_load_dwordx4 v28, s[24:27], s87 offen lds
v_mfma_f32_16x16x32_bf16 v[200:203], v[80:83], a[28:31], v[200:203]
buffer_load_dwordx4 v[80:83], v47, s[20:23], s90 offen offset:3072 sc1
s_waitcnt vmcnt(20)
v_mfma_f32_16x16x32_bf16 v[132:135], v[84:87], a[16:19], v[132:135]
v_mfma_f32_16x16x32_bf16 v[156:159], v[84:87], a[20:23], v[156:159]
buffer_load_dwordx4 v29, s[24:27], s87 offen offset:1024 lds
v_mfma_f32_16x16x32_bf16 v[180:183], v[84:87], a[24:27], v[180:183]
buffer_load_dwordx4 v30, s[24:27], s87 offen offset:2048 lds
v_mfma_f32_16x16x32_bf16 v[204:207], v[84:87], a[28:31], v[204:207]
buffer_load_dwordx4 v[84:87], v55, s[20:23], s90 offen offset:1024 sc1
s_waitcnt vmcnt(22)
v_mfma_f32_16x16x32_bf16 v[136:139], v[88:91], a[16:19], v[136:139]
v_mfma_f32_16x16x32_bf16 v[160:163], v[88:91], a[20:23], v[160:163]
buffer_load_dwordx4 v31, s[24:27], s87 offen offset:3072 lds
v_mfma_f32_16x16x32_bf16 v[184:187], v[88:91], a[24:27], v[184:187]
v_mfma_f32_16x16x32_bf16 v[208:211], v[88:91], a[28:31], v[208:211]
buffer_load_dwordx4 v[88:91], v55, s[20:23], s90 offen offset:3072 sc1
s_waitcnt vmcnt(23)
v_mfma_f32_16x16x32_bf16 v[140:143], v[92:95], a[16:19], v[140:143]
v_mfma_f32_16x16x32_bf16 v[164:167], v[92:95], a[20:23], v[164:167]
v_mfma_f32_16x16x32_bf16 v[188:191], v[92:95], a[24:27], v[188:191]
v_mfma_f32_16x16x32_bf16 v[212:215], v[92:95], a[28:31], v[212:215]
s_mul_i32 s90, s92, 90112
s_add_u32 s92, s92, 1
s_add_u32 s90, s90, s93
s_and_b32 s92, s92, 7
buffer_load_dwordx4 v[92:95], v33, s[20:23], s90 offen offset:0 sc1
s_waitcnt vmcnt(23)
v_mfma_f32_16x16x32_bf16 v[144:147], v[96:99], a[16:19], v[144:147]
v_mfma_f32_16x16x32_bf16 v[168:171], v[96:99], a[20:23], v[168:171]
v_mfma_f32_16x16x32_bf16 v[192:195], v[96:99], a[24:27], v[192:195]
v_mfma_f32_16x16x32_bf16 v[216:219], v[96:99], a[28:31], v[216:219]
buffer_load_dwordx4 v[96:99], v33, s[20:23], s90 offen offset:2048 sc1
s_waitcnt vmcnt(23)
v_mfma_f32_16x16x32_bf16 v[148:151], v[100:103], a[16:19], v[148:151]
v_mfma_f32_16x16x32_bf16 v[172:175], v[100:103], a[20:23], v[172:175]
v_mfma_f32_16x16x32_bf16 v[196:199], v[100:103], a[24:27], v[196:199]
v_mfma_f32_16x16x32_bf16 v[220:223], v[100:103], a[28:31], v[220:223]
buffer_load_dwordx4 v[100:103], v47, s[20:23], s90 offen offset:0 sc1
s_waitcnt vmcnt(23)
v_mfma_f32_16x16x32_bf16 v[128:131], v[104:107], a[32:35], v[128:131]
v_mfma_f32_16x16x32_bf16 v[152:155], v[104:107], a[36:39], v[152:155]
v_mfma_f32_16x16x32_bf16 v[176:179], v[104:107], a[40:43], v[176:179]
v_mfma_f32_16x16x32_bf16 v[200:203], v[104:107], a[44:47], v[200:203]
buffer_load_dwordx4 v[104:107], v47, s[20:23], s90 offen offset:2048 sc1
s_waitcnt vmcnt(23)
v_mfma_f32_16x16x32_bf16 v[132:135], v[108:111], a[32:35], v[132:135]
v_mfma_f32_16x16x32_bf16 v[156:159], v[108:111], a[36:39], v[156:159]
v_mfma_f32_16x16x32_bf16 v[180:183], v[108:111], a[40:43], v[180:183]
v_mfma_f32_16x16x32_bf16 v[204:207], v[108:111], a[44:47], v[204:207]
buffer_load_dwordx4 v[108:111], v55, s[20:23], s90 offen offset:0 sc1
s_waitcnt vmcnt(23)
v_mfma_f32_16x16x32_bf16 v[136:139], v[112:115], a[32:35], v[136:139]
v_mfma_f32_16x16x32_bf16 v[160:163], v[112:115], a[36:39], v[160:163]
v_mfma_f32_16x16x32_bf16 v[184:187], v[112:115], a[40:43], v[184:187]
v_mfma_f32_16x16x32_bf16 v[208:211], v[112:115], a[44:47], v[208:211]
buffer_load_dwordx4 v[112:115], v55, s[20:23], s90 offen offset:2048 sc1
s_waitcnt vmcnt(22)
v_mfma_f32_16x16x32_bf16 v[140:143], v[56:59], a[32:35], v[140:143]
v_mfma_f32_16x16x32_bf16 v[164:167], v[56:59], a[36:39], v[164:167]
v_mfma_f32_16x16x32_bf16 v[188:191], v[56:59], a[40:43], v[188:191]
v_mfma_f32_16x16x32_bf16 v[212:215], v[56:59], a[44:47], v[212:215]
buffer_load_dwordx4 v[56:59], v33, s[20:23], s90 offen offset:1024 sc1
s_waitcnt vmcnt(21)
v_mfma_f32_16x16x32_bf16 v[144:147], v[60:63], a[32:35], v[144:147]
v_mfma_f32_16x16x32_bf16 v[168:171], v[60:63], a[36:39], v[168:171]
v_mfma_f32_16x16x32_bf16 v[192:195], v[60:63], a[40:43], v[192:195]
v_mfma_f32_16x16x32_bf16 v[216:219], v[60:63], a[44:47], v[216:219]
buffer_load_dwordx4 v[60:63], v33, s[20:23], s90 offen offset:3072 sc1
s_waitcnt vmcnt(19)
v_mfma_f32_16x16x32_bf16 v[148:151], v[64:67], a[32:35], v[148:151]
v_mfma_f32_16x16x32_bf16 v[172:175], v[64:67], a[36:39], v[172:175]
v_mfma_f32_16x16x32_bf16 v[196:199], v[64:67], a[40:43], v[196:199]
v_mfma_f32_16x16x32_bf16 v[220:223], v[64:67], a[44:47], v[220:223]
buffer_load_dwordx4 v[64:67], v47, s[20:23], s90 offen offset:1024 sc1
s_waitcnt vmcnt(18)
v_mfma_f32_16x16x32_bf16 v[128:131], v[68:71], a[48:51], v[128:131]
v_mfma_f32_16x16x32_bf16 v[152:155], v[68:71], a[52:55], v[152:155]
v_mfma_f32_16x16x32_bf16 v[176:179], v[68:71], a[56:59], v[176:179]
v_mfma_f32_16x16x32_bf16 v[200:203], v[68:71], a[60:63], v[200:203]
buffer_load_dwordx4 v[68:71], v47, s[20:23], s90 offen offset:3072 sc1
s_waitcnt vmcnt(18)
v_mfma_f32_16x16x32_bf16 v[132:135], v[72:75], a[48:51], v[132:135]
v_mfma_f32_16x16x32_bf16 v[156:159], v[72:75], a[52:55], v[156:159]
v_mfma_f32_16x16x32_bf16 v[180:183], v[72:75], a[56:59], v[180:183]
v_mfma_f32_16x16x32_bf16 v[204:207], v[72:75], a[60:63], v[204:207]
buffer_load_dwordx4 v[72:75], v55, s[20:23], s90 offen offset:1024 sc1
s_waitcnt vmcnt(18)
v_mfma_f32_16x16x32_bf16 v[136:139], v[76:79], a[48:51], v[136:139]
v_mfma_f32_16x16x32_bf16 v[160:163], v[76:79], a[52:55], v[160:163]
v_mfma_f32_16x16x32_bf16 v[184:187], v[76:79], a[56:59], v[184:187]
v_mfma_f32_16x16x32_bf16 v[208:211], v[76:79], a[60:63], v[208:211]
buffer_load_dwordx4 v[76:79], v55, s[20:23], s90 offen offset:3072 sc1
s_waitcnt vmcnt(17)
v_mfma_f32_16x16x32_bf16 v[140:143], v[80:83], a[48:51], v[140:143]
v_mfma_f32_16x16x32_bf16 v[164:167], v[80:83], a[52:55], v[164:167]
v_mfma_f32_16x16x32_bf16 v[188:191], v[80:83], a[56:59], v[188:191]
v_mfma_f32_16x16x32_bf16 v[212:215], v[80:83], a[60:63], v[212:215]
s_mul_i32 s90, s92, 90112
s_add_u32 s92, s92, 1
s_add_u32 s90, s90, s93
s_and_b32 s92, s92, 7
buffer_load_dwordx4 v[80:83], v33, s[20:23], s90 offen offset:0 sc1
s_waitcnt vmcnt(15)
v_mfma_f32_16x16x32_bf16 v[144:147], v[84:87], a[48:51], v[144:147]
v_mfma_f32_16x16x32_bf16 v[168:171], v[84:87], a[52:55], v[168:171]
v_mfma_f32_16x16x32_bf16 v[192:195], v[84:87], a[56:59], v[192:195]
v_mfma_f32_16x16x32_bf16 v[216:219], v[84:87], a[60:63], v[216:219]
buffer_load_dwordx4 v[84:87], v33, s[20:23], s90 offen offset:2048 sc1
s_waitcnt vmcnt(14)
v_mfma_f32_16x16x32_bf16 v[148:151], v[88:91], a[48:51], v[148:151]
v_mfma_f32_16x16x32_bf16 v[172:175], v[88:91], a[52:55], v[172:175]
v_mfma_f32_16x16x32_bf16 v[196:199], v[88:91], a[56:59], v[196:199]
v_mfma_f32_16x16x32_bf16 v[220:223], v[88:91], a[60:63], v[220:223]
buffer_load_dwordx4 v[88:91], v47, s[20:23], s90 offen offset:0 sc1
s_waitcnt vmcnt(14)
v_mfma_f32_16x16x32_bf16 v[128:131], v[92:95], a[64:67], v[128:131]
v_mfma_f32_16x16x32_bf16 v[152:155], v[92:95], a[68:71], v[152:155]
v_mfma_f32_16x16x32_bf16 v[176:179], v[92:95], a[72:75], v[176:179]
v_mfma_f32_16x16x32_bf16 v[200:203], v[92:95], a[76:79], v[200:203]
buffer_load_dwordx4 v[92:95], v47, s[20:23], s90 offen offset:2048 sc1
s_waitcnt vmcnt(14)
v_mfma_f32_16x16x32_bf16 v[132:135], v[96:99], a[64:67], v[132:135]
v_mfma_f32_16x16x32_bf16 v[156:159], v[96:99], a[68:71], v[156:159]
v_mfma_f32_16x16x32_bf16 v[180:183], v[96:99], a[72:75], v[180:183]
v_mfma_f32_16x16x32_bf16 v[204:207], v[96:99], a[76:79], v[204:207]
buffer_load_dwordx4 v[96:99], v55, s[20:23], s90 offen offset:0 sc1
s_waitcnt vmcnt(14)
v_mfma_f32_16x16x32_bf16 v[136:139], v[100:103], a[64:67], v[136:139]
v_mfma_f32_16x16x32_bf16 v[160:163], v[100:103], a[68:71], v[160:163]
v_mfma_f32_16x16x32_bf16 v[184:187], v[100:103], a[72:75], v[184:187]
v_mfma_f32_16x16x32_bf16 v[208:211], v[100:103], a[76:79], v[208:211]
buffer_load_dwordx4 v[100:103], v55, s[20:23], s90 offen offset:2048 sc1
s_waitcnt vmcnt(14)
v_mfma_f32_16x16x32_bf16 v[140:143], v[104:107], a[64:67], v[140:143]
v_mfma_f32_16x16x32_bf16 v[164:167], v[104:107], a[68:71], v[164:167]
v_mfma_f32_16x16x32_bf16 v[188:191], v[104:107], a[72:75], v[188:191]
v_mfma_f32_16x16x32_bf16 v[212:215], v[104:107], a[76:79], v[212:215]
buffer_load_dwordx4 v[104:107], v33, s[20:23], s90 offen offset:1024 sc1
s_waitcnt vmcnt(14)
v_mfma_f32_16x16x32_bf16 v[144:147], v[108:111], a[64:67], v[144:147]
v_mfma_f32_16x16x32_bf16 v[168:171], v[108:111], a[68:71], v[168:171]
v_mfma_f32_16x16x32_bf16 v[192:195], v[108:111], a[72:75], v[192:195]
v_mfma_f32_16x16x32_bf16 v[216:219], v[108:111], a[76:79], v[216:219]
buffer_load_dwordx4 v[108:111], v33, s[20:23], s90 offen offset:3072 sc1
s_waitcnt vmcnt(14)
v_mfma_f32_16x16x32_bf16 v[148:151], v[112:115], a[64:67], v[148:151]
v_mfma_f32_16x16x32_bf16 v[172:175], v[112:115], a[68:71], v[172:175]
v_mfma_f32_16x16x32_bf16 v[196:199], v[112:115], a[72:75], v[196:199]
v_mfma_f32_16x16x32_bf16 v[220:223], v[112:115], a[76:79], v[220:223]
buffer_load_dwordx4 v[112:115], v47, s[20:23], s90 offen offset:1024 sc1
s_waitcnt vmcnt(14)
v_mfma_f32_16x16x32_bf16 v[128:131], v[56:59], a[80:83], v[128:131]
v_mfma_f32_16x16x32_bf16 v[152:155], v[56:59], a[84:87], v[152:155]
v_mfma_f32_16x16x32_bf16 v[176:179], v[56:59], a[88:91], v[176:179]
v_mfma_f32_16x16x32_bf16 v[200:203], v[56:59], a[92:95], v[200:203]
buffer_load_dwordx4 v[56:59], v47, s[20:23], s90 offen offset:3072 sc1
s_waitcnt vmcnt(14)
v_mfma_f32_16x16x32_bf16 v[132:135], v[60:63], a[80:83], v[132:135]
v_mfma_f32_16x16x32_bf16 v[156:159], v[60:63], a[84:87], v[156:159]
v_mfma_f32_16x16x32_bf16 v[180:183], v[60:63], a[88:91], v[180:183]
v_mfma_f32_16x16x32_bf16 v[204:207], v[60:63], a[92:95], v[204:207]
buffer_load_dwordx4 v[60:63], v55, s[20:23], s90 offen offset:1024 sc1
s_waitcnt vmcnt(14)
v_mfma_f32_16x16x32_bf16 v[136:139], v[64:67], a[80:83], v[136:139]
v_mfma_f32_16x16x32_bf16 v[160:163], v[64:67], a[84:87], v[160:163]
v_mfma_f32_16x16x32_bf16 v[184:187], v[64:67], a[88:91], v[184:187]
v_mfma_f32_16x16x32_bf16 v[208:211], v[64:67], a[92:95], v[208:211]
buffer_load_dwordx4 v[64:67], v55, s[20:23], s90 offen offset:3072 sc1
s_waitcnt vmcnt(14)
v_mfma_f32_16x16x32_bf16 v[140:143], v[68:71], a[80:83], v[140:143]
v_mfma_f32_16x16x32_bf16 v[164:167], v[68:71], a[84:87], v[164:167]
v_mfma_f32_16x16x32_bf16 v[188:191], v[68:71], a[88:91], v[188:191]
v_mfma_f32_16x16x32_bf16 v[212:215], v[68:71], a[92:95], v[212:215]
s_mul_i32 s90, s92, 90112
s_add_u32 s92, s92, 1
s_add_u32 s90, s90, s93
s_and_b32 s92, s92, 7
buffer_load_dwordx4 v[68:71], v33, s[20:23], s90 offen offset:0 sc1
s_waitcnt vmcnt(14)
v_mfma_f32_16x16x32_bf16 v[144:147], v[72:75], a[80:83], v[144:147]
v_mfma_f32_16x16x32_bf16 v[168:171], v[72:75], a[84:87], v[168:171]
v_mfma_f32_16x16x32_bf16 v[192:195], v[72:75], a[88:91], v[192:195]
v_mfma_f32_16x16x32_bf16 v[216:219], v[72:75], a[92:95], v[216:219]
buffer_load_dwordx4 v[72:75], v33, s[20:23], s90 offen offset:2048 sc1
s_waitcnt vmcnt(14)
v_mfma_f32_16x16x32_bf16 v[148:151], v[76:79], a[80:83], v[148:151]
v_mfma_f32_16x16x32_bf16 v[172:175], v[76:79], a[84:87], v[172:175]
v_mfma_f32_16x16x32_bf16 v[196:199], v[76:79], a[88:91], v[196:199]
v_mfma_f32_16x16x32_bf16 v[220:223], v[76:79], a[92:95], v[220:223]
buffer_load_dwordx4 v[76:79], v47, s[20:23], s90 offen offset:0 sc1
s_waitcnt lgkmcnt(0)
s_barrier
s_waitcnt vmcnt(14)
v_mfma_f32_16x16x32_bf16 v[128:131], v[80:83], a[96:99], v[128:131]
v_mfma_f32_16x16x32_bf16 v[152:155], v[80:83], a[100:103], v[152:155]
v_mfma_f32_16x16x32_bf16 v[176:179], v[80:83], a[104:107], v[176:179]
v_mfma_f32_16x16x32_bf16 v[200:203], v[80:83], a[108:111], v[200:203]
buffer_load_dwordx4 v[80:83], v47, s[20:23], s90 offen offset:2048 sc1
s_waitcnt vmcnt(14)
v_mfma_f32_16x16x32_bf16 v[132:135], v[84:87], a[96:99], v[132:135]
v_mfma_f32_16x16x32_bf16 v[156:159], v[84:87], a[100:103], v[156:159]
v_mfma_f32_16x16x32_bf16 v[180:183], v[84:87], a[104:107], v[180:183]
v_mfma_f32_16x16x32_bf16 v[204:207], v[84:87], a[108:111], v[204:207]
buffer_load_dwordx4 v[84:87], v55, s[20:23], s90 offen offset:0 sc1
s_waitcnt vmcnt(14)
v_mfma_f32_16x16x32_bf16 v[136:139], v[88:91], a[96:99], v[136:139]
v_mfma_f32_16x16x32_bf16 v[160:163], v[88:91], a[100:103], v[160:163]
v_mfma_f32_16x16x32_bf16 v[184:187], v[88:91], a[104:107], v[184:187]
v_mfma_f32_16x16x32_bf16 v[208:211], v[88:91], a[108:111], v[208:211]
buffer_load_dwordx4 v[88:91], v55, s[20:23], s90 offen offset:2048 sc1
s_waitcnt vmcnt(14)
v_mfma_f32_16x16x32_bf16 v[140:143], v[92:95], a[96:99], v[140:143]
s_lshl_b32 s97, s47, 2
ds_read_b64_tr_b16 a[64:65], v40 offset:0
s_add_u32 s97, s97, s44
v_mfma_f32_16x16x32_bf16 v[164:167], v[92:95], a[100:103], v[164:167]
ds_read_b64_tr_b16 a[66:67], v40 offset:2048
s_mul_i32 s0, s97, 43
s_lshl_b32 s1, s88, 1
ds_read_b64_tr_b16 a[68:69], v41 offset:0
v_mfma_f32_16x16x32_bf16 v[188:191], v[92:95], a[104:107], v[188:191]
s_add_u32 s0, s0, s1
s_lshl_b32 s0, s0, 9
ds_read_b64_tr_b16 a[70:71], v41 offset:2048
v_mfma_f32_16x16x32_bf16 v[212:215], v[92:95], a[108:111], v[212:215]
buffer_load_dwordx4 v[92:95], v33, s[20:23], s90 offen offset:1024 sc1
s_waitcnt vmcnt(14)
v_mfma_f32_16x16x32_bf16 v[144:147], v[96:99], a[96:99], v[144:147]
s_add_u32 s70, s0, 3145216
s_mul_i32 s0, s97, 22
ds_read_b64_tr_b16 a[72:73], v42 offset:0
v_mfma_f32_16x16x32_bf16 v[168:171], v[96:99], a[100:103], v[168:171]
s_add_u32 s0, s0, s88
s_lshl_b32 s0, s0, 10
ds_read_b64_tr_b16 a[74:75], v42 offset:2048
v_mfma_f32_16x16x32_bf16 v[192:195], v[96:99], a[104:107], v[192:195]
s_add_u32 s71, s0, 9437184
s_cmp_eq_u32 s89, 3
s_cselect_b32 s72, s71, 0x40000000
ds_read_b64_tr_b16 a[76:77], v43 offset:0
v_mfma_f32_16x16x32_bf16 v[216:219], v[96:99], a[108:111], v[216:219]
buffer_load_dwordx4 v[96:99], v33, s[20:23], s90 offen offset:3072 sc1
s_waitcnt vmcnt(14)
v_mfma_f32_16x16x32_bf16 v[148:151], v[100:103], a[96:99], v[148:151]
s_cmp_eq_u32 s48, 0
s_cselect_b32 s68, 0, -1
ds_read_b64_tr_b16 a[78:79], v43 offset:2048
v_mfma_f32_16x16x32_bf16 v[172:175], v[100:103], a[100:103], v[172:175]
v_lshlrev_b32 v10, 1, v4
s_lshl_b32 s86, s97, 5
v_mfma_f32_16x16x32_bf16 v[196:199], v[100:103], a[104:107], v[196:199]
buffer_load_ushort v39, v10, s[36:39], s86 offen
v_mfma_f32_16x16x32_bf16 v[220:223], v[100:103], a[108:111], v[220:223]
buffer_load_dwordx4 v[100:103], v47, s[20:23], s90 offen offset:1024 sc1
s_waitcnt vmcnt(15)
v_mfma_f32_16x16x32_bf16 v[128:131], v[104:107], a[112:115], v[128:131]
ds_read_b64_tr_b16 a[80:81], v40 offset:4096
ds_read_b64_tr_b16 a[82:83], v40 offset:6144
v_mfma_f32_16x16x32_bf16 v[152:155], v[104:107], a[116:119], v[152:155]
ds_read_b64_tr_b16 a[84:85], v41 offset:4096
s_xor_b32 s0, s44, 2
s_mul_i32 s0, s0, 12288
ds_read_b64_tr_b16 a[86:87], v41 offset:6144
v_mfma_f32_16x16x32_bf16 v[176:179], v[104:107], a[120:123], v[176:179]
s_add_u32 s0, s0, 65536
v_add_u32 v20, s0, v32
ds_read_b64_tr_b16 a[88:89], v42 offset:4096
v_mfma_f32_16x16x32_bf16 v[200:203], v[104:107], a[124:127], v[200:203]
buffer_load_dwordx4 v[104:107], v47, s[20:23], s90 offen offset:3072 sc1
s_waitcnt vmcnt(15)
v_mfma_f32_16x16x32_bf16 v[132:135], v[108:111], a[112:115], v[132:135]
s_xor_b32 s0, s44, 0
s_mul_i32 s0, s0, 12288
ds_read_b64_tr_b16 a[90:91], v42 offset:6144
v_mfma_f32_16x16x32_bf16 v[156:159], v[108:111], a[116:119], v[156:159]
s_add_u32 s0, s0, 65536
ds_read_b64_tr_b16 a[92:93], v43 offset:4096
v_add_u32 v21, s0, v32
s_xor_b32 s0, s44, 1
v_mfma_f32_16x16x32_bf16 v[180:183], v[108:111], a[120:123], v[180:183]
ds_read_b64_tr_b16 a[94:95], v43 offset:6144
s_mul_i32 s0, s0, 12288
s_add_u32 s0, s0, 65536
v_mfma_f32_16x16x32_bf16 v[204:207], v[108:111], a[124:127], v[204:207]
buffer_load_dwordx4 v[108:111], v55, s[20:23], s90 offen offset:1024 sc1
s_waitcnt vmcnt(15)
v_mfma_f32_16x16x32_bf16 v[136:139], v[112:115], a[112:115], v[136:139]
v_add_u32 v22, s0, v32
s_lshl_b32 s97, s97, 10
s_add_u32 s73, s97, 12779520
v_mfma_f32_16x16x32_bf16 v[160:163], v[112:115], a[116:119], v[160:163]
s_lshl_b32 s1, s48, 7
s_add_u32 s98, s1, s73
s_lshl_b32 s0, s47, 2
v_mfma_f32_16x16x32_bf16 v[184:187], v[112:115], a[120:123], v[184:187]
s_add_u32 s74, s0, s44
v_lshlrev_b32 v52, 10, v4
v_lshl_add_u32 v52, v3, 3, v52
s_lshl_b32 s0, s74, 14
v_mfma_f32_16x16x32_bf16 v[208:211], v[112:115], a[124:127], v[208:211]
buffer_load_dwordx4 v[112:115], v55, s[20:23], s90 offen offset:3072 sc1
s_waitcnt vmcnt(15)
v_mfma_f32_16x16x32_bf16 v[140:143], v[56:59], a[112:115], v[140:143]
ds_read_b64_tr_b16 a[96:97], v40 offset:8192
s_lshl_b32 s1, s48, 7
ds_read_b64_tr_b16 a[98:99], v40 offset:10240
v_mfma_f32_16x16x32_bf16 v[164:167], v[56:59], a[116:119], v[164:167]
s_add_u32 s0, s0, s1
v_add_u32 v52, s0, v52
ds_read_b64_tr_b16 a[100:101], v41 offset:8192
v_mfma_f32_16x16x32_bf16 v[188:191], v[56:59], a[120:123], v[188:191]
s_mul_i32 s74, s74, 22528
s_add_u32 s74, s74, 9437184
ds_read_b64_tr_b16 a[102:103], v41 offset:10240
v_subrev_u32 v48, 73728, v40
v_mfma_f32_16x16x32_bf16 v[212:215], v[56:59], a[124:127], v[212:215]
s_mul_i32 s90, s92, 90112
s_add_u32 s92, s92, 1
s_add_u32 s90, s90, s93
s_and_b32 s92, s92, 7
buffer_load_dwordx4 v[56:59], v33, s[20:23], s90 offen offset:0 sc1
s_waitcnt vmcnt(15)
v_mfma_f32_16x16x32_bf16 v[144:147], v[60:63], a[112:115], v[144:147]
v_mfma_f32_16x16x32_bf16 v[168:171], v[60:63], a[116:119], v[168:171]
v_subrev_u32 v49, 73728, v41
ds_read_b64_tr_b16 a[104:105], v42 offset:8192
v_mfma_f32_16x16x32_bf16 v[192:195], v[60:63], a[120:123], v[192:195]
v_subrev_u32 v50, 73728, v42
v_subrev_u32 v51, 73728, v43
ds_read_b64_tr_b16 a[106:107], v42 offset:10240
v_mfma_f32_16x16x32_bf16 v[216:219], v[60:63], a[124:127], v[216:219]
buffer_load_dwordx4 v[60:63], v33, s[20:23], s90 offen offset:2048 sc1
s_waitcnt vmcnt(15)
v_mfma_f32_16x16x32_bf16 v[148:151], v[64:67], a[112:115], v[148:151]
v_add_u32 v16, 65536, v48
v_add_u32 v17, 65536, v49
ds_read_b64_tr_b16 a[108:109], v43 offset:8192
v_mfma_f32_16x16x32_bf16 v[172:175], v[64:67], a[116:119], v[172:175]
v_add_u32 v18, 65536, v50
v_add_u32 v19, 65536, v51
ds_read_b64_tr_b16 a[110:111], v43 offset:10240
v_and_b32 v9, 1, v0
v_mfma_f32_16x16x32_bf16 v[196:199], v[64:67], a[120:123], v[196:199]
v_lshlrev_b32 v9, 6, v9
v_lshl_add_u32 v9, v3, 4, v9
v_add_u32 v53, 155648, v9
v_mfma_f32_16x16x32_bf16 v[220:223], v[64:67], a[124:127], v[220:223]
buffer_load_dwordx4 v[64:67], v47, s[20:23], s90 offen offset:0 sc1
s_waitcnt vmcnt(15)
v_mfma_f32_16x16x32_bf16 v[128:131], v[68:71], a[128:131], v[128:131]
s_lshl_b32 s87, s44, 2
v_add_u32 v242, 139264, v32
s_add_u32 s87, s87, s47
v_mfma_f32_16x16x32_bf16 v[152:155], v[68:71], a[132:135], v[152:155]
v_lshlrev_b32 v243, 7, v1
v_add_u32 v23, s57, v242
s_add_u32 s87, s87, 0
v_mfma_f32_16x16x32_bf16 v[176:179], v[68:71], a[136:139], v[176:179]
v_lshlrev_b32 v10, 3, v0
s_lshl_b32 s0, s44, 9
s_and_b32 s87, s87, 15
s_add_u32 s0, s0, 155648
v_mfma_f32_16x16x32_bf16 v[200:203], v[68:71], a[140:143], v[200:203]
buffer_load_dwordx4 v[68:71], v47, s[20:23], s90 offen offset:2048 sc1
s_waitcnt vmcnt(15)
v_mfma_f32_16x16x32_bf16 v[132:135], v[72:75], a[128:131], v[132:135]
v_add_u32 v38, s0, v10
s_lshl_b32 m0, s87, 12
s_lshl_b32 s87, s87, 15
v_mfma_f32_16x16x32_bf16 v[156:159], v[72:75], a[132:135], v[156:159]
s_sub_u32 s56, s87, 16384
s_cselect_b32 s56, 0x40000000, s56
v_mfma_f32_16x16x32_bf16 v[180:183], v[72:75], a[136:139], v[180:183]
buffer_load_dwordx4 v28, s[28:31], s56 offen lds
v_mfma_f32_16x16x32_bf16 v[204:207], v[72:75], a[140:143], v[204:207]
buffer_load_dwordx4 v[72:75], v55, s[20:23], s90 offen offset:0 sc1
s_waitcnt vmcnt(16)
v_mfma_f32_16x16x32_bf16 v[136:139], v[76:79], a[128:131], v[136:139]
v_mfma_f32_16x16x32_bf16 v[160:163], v[76:79], a[132:135], v[160:163]
buffer_load_dwordx4 v29, s[28:31], s56 offen offset:1024 lds
v_mfma_f32_16x16x32_bf16 v[184:187], v[76:79], a[136:139], v[184:187]
s_add_u32 m0, m0, 2048
s_nop 0
v_mfma_f32_16x16x32_bf16 v[208:211], v[76:79], a[140:143], v[208:211]
buffer_load_dwordx4 v[76:79], v55, s[20:23], s90 offen offset:2048 sc1
s_waitcnt vmcnt(17)
v_mfma_f32_16x16x32_bf16 v[140:143], v[80:83], a[128:131], v[140:143]
buffer_load_dwordx4 v28, s[28:31], s87 offen lds
v_mfma_f32_16x16x32_bf16 v[164:167], v[80:83], a[132:135], v[164:167]
v_mfma_f32_16x16x32_bf16 v[188:191], v[80:83], a[136:139], v[188:191]
buffer_load_dwordx4 v29, s[28:31], s87 offen offset:1024 lds
v_mfma_f32_16x16x32_bf16 v[212:215], v[80:83], a[140:143], v[212:215]
buffer_load_dwordx4 v[80:83], v33, s[20:23], s90 offen offset:1024 sc1
s_waitcnt vmcnt(19)
v_mfma_f32_16x16x32_bf16 v[144:147], v[84:87], a[128:131], v[144:147]
v_mfma_f32_16x16x32_bf16 v[168:171], v[84:87], a[132:135], v[168:171]
v_mfma_f32_16x16x32_bf16 v[192:195], v[84:87], a[136:139], v[192:195]
v_mfma_f32_16x16x32_bf16 v[216:219], v[84:87], a[140:143], v[216:219]
buffer_load_dwordx4 v[84:87], v33, s[20:23], s90 offen offset:3072 sc1
s_waitcnt vmcnt(19)
v_mfma_f32_16x16x32_bf16 v[148:151], v[88:91], a[128:131], v[148:151]
v_mfma_f32_16x16x32_bf16 v[172:175], v[88:91], a[132:135], v[172:175]
v_mfma_f32_16x16x32_bf16 v[196:199], v[88:91], a[136:139], v[196:199]
v_mfma_f32_16x16x32_bf16 v[220:223], v[88:91], a[140:143], v[220:223]
buffer_load_dwordx4 v[88:91], v47, s[20:23], s90 offen offset:1024 sc1
s_waitcnt vmcnt(19)
v_mfma_f32_16x16x32_bf16 v[128:131], v[92:95], a[144:147], v[128:131]
v_lshrrev_b32 v11, 3, v0
s_lshl_b32 s87, s44, 2
v_lshlrev_b32 v11, 8, v11
v_mfma_f32_16x16x32_bf16 v[152:155], v[92:95], a[148:151], v[152:155]
s_add_u32 s87, s87, s47
v_bfe_u32 v12, v0, 2, 1
v_lshl_add_u32 v11, v12, 7, v11
s_add_u32 s87, s87, 1
v_mfma_f32_16x16x32_bf16 v[176:179], v[92:95], a[152:155], v[176:179]
s_lshl_b32 s86, s47, 11
s_add_u32 s86, s86, 196608
s_and_b32 s87, s87, 15
v_mfma_f32_16x16x32_bf16 v[200:203], v[92:95], a[156:159], v[200:203]
buffer_load_dwordx4 v[92:95], v47, s[20:23], s90 offen offset:3072 sc1
s_waitcnt vmcnt(19)
v_mfma_f32_16x16x32_bf16 v[132:135], v[96:99], a[144:147], v[132:135]
buffer_load_dwordx2 v[34:35], v11, s[20:23], s86 offen sc1
v_mfma_f32_16x16x32_bf16 v[156:159], v[96:99], a[148:151], v[156:159]
s_lshl_b32 m0, s87, 12
s_lshl_b32 s87, s87, 15
v_mfma_f32_16x16x32_bf16 v[180:183], v[96:99], a[152:155], v[180:183]
s_sub_u32 s56, s87, 16384
s_cselect_b32 s56, 0x40000000, s56
v_mfma_f32_16x16x32_bf16 v[204:207], v[96:99], a[156:159], v[204:207]
buffer_load_dwordx4 v[96:99], v55, s[20:23], s90 offen offset:1024 sc1
s_waitcnt vmcnt(19)
v_mfma_f32_16x16x32_bf16 v[136:139], v[100:103], a[144:147], v[136:139]
buffer_load_dwordx4 v28, s[28:31], s56 offen lds
v_mfma_f32_16x16x32_bf16 v[160:163], v[100:103], a[148:151], v[160:163]
v_mfma_f32_16x16x32_bf16 v[184:187], v[100:103], a[152:155], v[184:187]
buffer_load_dwordx4 v29, s[28:31], s56 offen offset:1024 lds
v_mfma_f32_16x16x32_bf16 v[208:211], v[100:103], a[156:159], v[208:211]
buffer_load_dwordx4 v[100:103], v55, s[20:23], s90 offen offset:3072 sc1
s_waitcnt vmcnt(21)
v_mfma_f32_16x16x32_bf16 v[140:143], v[104:107], a[144:147], v[140:143]
s_add_u32 m0, m0, 2048
s_nop 0
v_mfma_f32_16x16x32_bf16 v[164:167], v[104:107], a[148:151], v[164:167]
buffer_load_dwordx4 v28, s[28:31], s87 offen lds
v_mfma_f32_16x16x32_bf16 v[188:191], v[104:107], a[152:155], v[188:191]
buffer_load_dwordx4 v29, s[28:31], s87 offen offset:1024 lds
v_mfma_f32_16x16x32_bf16 v[212:215], v[104:107], a[156:159], v[212:215]
s_mul_i32 s90, s92, 90112
s_add_u32 s92, s92, 1
s_add_u32 s90, s90, s93
s_and_b32 s92, s92, 7
buffer_load_dwordx4 v[104:107], v33, s[20:23], s90 offen offset:0 sc1
s_waitcnt vmcnt(23)
v_mfma_f32_16x16x32_bf16 v[144:147], v[108:111], a[144:147], v[144:147]
v_mfma_f32_16x16x32_bf16 v[168:171], v[108:111], a[148:151], v[168:171]
v_mfma_f32_16x16x32_bf16 v[192:195], v[108:111], a[152:155], v[192:195]
v_mfma_f32_16x16x32_bf16 v[216:219], v[108:111], a[156:159], v[216:219]
buffer_load_dwordx4 v[108:111], v33, s[20:23], s90 offen offset:2048 sc1
s_waitcnt vmcnt(23)
v_mfma_f32_16x16x32_bf16 v[148:151], v[112:115], a[144:147], v[148:151]
v_mfma_f32_16x16x32_bf16 v[172:175], v[112:115], a[148:151], v[172:175]
v_mfma_f32_16x16x32_bf16 v[196:199], v[112:115], a[152:155], v[196:199]
v_mfma_f32_16x16x32_bf16 v[220:223], v[112:115], a[156:159], v[220:223]
buffer_load_dwordx4 v[112:115], v47, s[20:23], s90 offen offset:0 sc1
s_waitcnt vmcnt(23)
v_mfma_f32_16x16x32_bf16 v[128:131], v[56:59], a[160:163], v[128:131]
s_lshl_b32 s87, s44, 2
s_add_u32 s87, s87, s47
s_add_u32 s87, s87, 2
v_mfma_f32_16x16x32_bf16 v[152:155], v[56:59], a[164:167], v[152:155]
s_and_b32 s87, s87, 15
s_lshl_b32 m0, s87, 12
s_lshl_b32 s87, s87, 15
s_sub_u32 s56, s87, 16384
s_cselect_b32 s56, 0x40000000, s56
v_mfma_f32_16x16x32_bf16 v[176:179], v[56:59], a[168:171], v[176:179]
v_mfma_f32_16x16x32_bf16 v[200:203], v[56:59], a[172:175], v[200:203]
buffer_load_dwordx4 v[56:59], v47, s[20:23], s90 offen offset:2048 sc1
s_waitcnt vmcnt(23)
v_mfma_f32_16x16x32_bf16 v[132:135], v[60:63], a[160:163], v[132:135]
buffer_load_dwordx4 v28, s[28:31], s56 offen lds
v_mfma_f32_16x16x32_bf16 v[156:159], v[60:63], a[164:167], v[156:159]
v_mfma_f32_16x16x32_bf16 v[180:183], v[60:63], a[168:171], v[180:183]
buffer_load_dwordx4 v29, s[28:31], s56 offen offset:1024 lds
v_mfma_f32_16x16x32_bf16 v[204:207], v[60:63], a[172:175], v[204:207]
buffer_load_dwordx4 v[60:63], v55, s[20:23], s90 offen offset:0 sc1
s_waitcnt vmcnt(25)
v_mfma_f32_16x16x32_bf16 v[136:139], v[64:67], a[160:163], v[136:139]
s_add_u32 m0, m0, 2048
s_nop 0
v_mfma_f32_16x16x32_bf16 v[160:163], v[64:67], a[164:167], v[160:163]
buffer_load_dwordx4 v28, s[28:31], s87 offen lds
v_mfma_f32_16x16x32_bf16 v[184:187], v[64:67], a[168:171], v[184:187]
buffer_load_dwordx4 v29, s[28:31], s87 offen offset:1024 lds
v_mfma_f32_16x16x32_bf16 v[208:211], v[64:67], a[172:175], v[208:211]
buffer_load_dwordx4 v[64:67], v55, s[20:23], s90 offen offset:2048 sc1
s_waitcnt vmcnt(27)
v_mfma_f32_16x16x32_bf16 v[140:143], v[68:71], a[160:163], v[140:143]
ds_read_b64_tr_b16 a[112:113], v40 offset:12288
ds_read_b64_tr_b16 a[114:115], v40 offset:14336
v_mfma_f32_16x16x32_bf16 v[164:167], v[68:71], a[164:167], v[164:167]
s_waitcnt vmcnt(16)
v_cmp_ne_u64 vcc, v[34:35], v[26:27]
s_nop 3
s_cbranch_vccz L_ok_44
s_mov_b32 s62, 4000
L_sp_43:
s_sleep 3
v_lshrrev_b32 v11, 3, v0
v_lshlrev_b32 v11, 8, v11
v_bfe_u32 v12, v0, 2, 1
v_lshl_add_u32 v11, v12, 7, v11
s_lshl_b32 s86, s47, 11
s_add_u32 s86, s86, 196608
buffer_load_dwordx2 v[34:35], v11, s[20:23], s86 offen sc1
s_waitcnt vmcnt(0)
v_cmp_ne_u64 vcc, v[34:35], v[26:27]
s_sub_u32 s62, s62, 1
s_cbranch_scc1 L_ok_44
s_nop 1
s_cbranch_vccnz L_sp_43
L_ok_44:
v_mfma_f32_16x16x32_bf16 v[188:191], v[68:71], a[168:171], v[188:191]
v_mfma_f32_16x16x32_bf16 v[212:215], v[68:71], a[172:175], v[212:215]
buffer_load_dwordx4 v[68:71], v33, s[20:23], s90 offen offset:1024 sc1
v_mfma_f32_16x16x32_bf16 v[144:147], v[72:75], a[160:163], v[144:147]
v_mfma_f32_16x16x32_bf16 v[168:171], v[72:75], a[164:167], v[168:171]
v_mfma_f32_16x16x32_bf16 v[192:195], v[72:75], a[168:171], v[192:195]
v_mfma_f32_16x16x32_bf16 v[216:219], v[72:75], a[172:175], v[216:219]
buffer_load_dwordx4 v[72:75], v33, s[20:23], s90 offen offset:3072 sc1
v_mfma_f32_16x16x32_bf16 v[148:151], v[76:79], a[160:163], v[148:151]
v_mfma_f32_16x16x32_bf16 v[172:175], v[76:79], a[164:167], v[172:175]
ds_read_b64_tr_b16 a[116:117], v41 offset:12288
ds_read_b64_tr_b16 a[118:119], v41 offset:14336
ds_read_b64_tr_b16 a[120:121], v42 offset:12288
ds_read_b64_tr_b16 a[122:123], v42 offset:14336
v_mfma_f32_16x16x32_bf16 v[196:199], v[76:79], a[168:171], v[196:199]
ds_read_b64_tr_b16 a[124:125], v43 offset:12288
v_lshlrev_b32 v10, 3, v0
ds_read_b64_tr_b16 a[126:127], v43 offset:14336
v_mfma_f32_16x16x32_bf16 v[220:223], v[76:79], a[172:175], v[220:223]
buffer_load_dwordx4 v[76:79], v47, s[20:23], s90 offen offset:1024 sc1
v_mfma_f32_16x16x32_bf16 v[128:131], v[80:83], a[176:179], v[128:131]
buffer_load_dwordx2 v[116:117], v10, s[20:23], s70 offen offset:0 sc1
v_mfma_f32_16x16x32_bf16 v[152:155], v[80:83], a[180:183], v[152:155]
s_lshl_b32 s87, s44, 2
s_add_u32 s87, s87, s47
v_mfma_f32_16x16x32_bf16 v[176:179], v[80:83], a[184:187], v[176:179]
buffer_load_dwordx2 v[118:119], v10, s[20:23], s70 offen offset:512 sc1
v_mfma_f32_16x16x32_bf16 v[200:203], v[80:83], a[188:191], v[200:203]
buffer_load_dwordx4 v[80:83], v47, s[20:23], s90 offen offset:3072 sc1
v_mfma_f32_16x16x32_bf16 v[132:135], v[84:87], a[176:179], v[132:135]
s_add_u32 s87, s87, 3
s_and_b32 s87, s87, 15
v_mfma_f32_16x16x32_bf16 v[156:159], v[84:87], a[180:183], v[156:159]
buffer_load_dwordx2 v[120:121], v10, s[20:23], s70 offen offset:1024 sc1
v_mfma_f32_16x16x32_bf16 v[180:183], v[84:87], a[184:187], v[180:183]
s_lshl_b32 m0, s87, 12
s_lshl_b32 s87, s87, 15
s_sub_u32 s56, s87, 16384
s_cselect_b32 s56, 0x40000000, s56
v_mfma_f32_16x16x32_bf16 v[204:207], v[84:87], a[188:191], v[204:207]
buffer_load_dwordx4 v[84:87], v55, s[20:23], s90 offen offset:1024 sc1
v_mfma_f32_16x16x32_bf16 v[136:139], v[88:91], a[176:179], v[136:139]
v_mfma_f32_16x16x32_bf16 v[160:163], v[88:91], a[180:183], v[160:163]
buffer_load_dwordx2 v[122:123], v10, s[20:23], s70 offen offset:1536 sc1
v_mfma_f32_16x16x32_bf16 v[184:187], v[88:91], a[184:187], v[184:187]
buffer_load_dwordx2 v[124:125], v10, s[20:23], s70 offen offset:2048 sc1
v_mfma_f32_16x16x32_bf16 v[208:211], v[88:91], a[188:191], v[208:211]
buffer_load_dwordx4 v[88:91], v55, s[20:23], s90 offen offset:3072 sc1
v_mfma_f32_16x16x32_bf16 v[140:143], v[92:95], a[176:179], v[140:143]
v_mfma_f32_16x16x32_bf16 v[164:167], v[92:95], a[180:183], v[164:167]
buffer_load_dwordx4 v28, s[28:31], s56 offen lds
v_mfma_f32_16x16x32_bf16 v[188:191], v[92:95], a[184:187], v[188:191]
buffer_load_dwordx2 v[126:127], v10, s[20:23], s70 offen offset:2560 sc1
v_mfma_f32_16x16x32_bf16 v[212:215], v[92:95], a[188:191], v[212:215]
s_mul_i32 s90, s92, 90112
s_add_u32 s92, s92, 1
s_add_u32 s90, s90, s93
s_and_b32 s92, s92, 7
buffer_load_dwordx4 v[92:95], v33, s[20:23], s90 offen offset:0 sc1
s_waitcnt vmcnt(29)
v_mfma_f32_16x16x32_bf16 v[144:147], v[96:99], a[176:179], v[144:147]
v_mfma_f32_16x16x32_bf16 v[168:171], v[96:99], a[180:183], v[168:171]
v_mfma_f32_16x16x32_bf16 v[192:195], v[96:99], a[184:187], v[192:195]
buffer_load_dwordx4 v29, s[28:31], s56 offen offset:1024 lds
v_mfma_f32_16x16x32_bf16 v[216:219], v[96:99], a[188:191], v[216:219]
buffer_load_dwordx4 v[96:99], v33, s[20:23], s90 offen offset:2048 sc1
s_waitcnt vmcnt(28)
v_mfma_f32_16x16x32_bf16 v[148:151], v[100:103], a[176:179], v[148:151]
s_add_u32 m0, m0, 2048
s_nop 0
v_mfma_f32_16x16x32_bf16 v[172:175], v[100:103], a[180:183], v[172:175]
buffer_load_dwordx4 v28, s[28:31], s87 offen lds
v_mfma_f32_16x16x32_bf16 v[196:199], v[100:103], a[184:187], v[196:199]
buffer_load_dwordx4 v29, s[28:31], s87 offen offset:1024 lds
v_mfma_f32_16x16x32_bf16 v[220:223], v[100:103], a[188:191], v[220:223]
buffer_load_dwordx4 v[100:103], v47, s[20:23], s90 offen offset:0 sc1
s_waitcnt vmcnt(28)
v_mfma_f32_16x16x32_bf16 v[128:131], v[104:107], a[192:195], v[128:131]
ds_read_b64_tr_b16 a[128:129], v40 offset:16384
ds_read_b64_tr_b16 a[130:131], v40 offset:18432
v_mfma_f32_16x16x32_bf16 v[152:155], v[104:107], a[196:199], v[152:155]
ds_read_b64_tr_b16 a[132:133], v41 offset:16384
ds_read_b64_tr_b16 a[134:135], v41 offset:18432
ds_read_b64_tr_b16 a[136:137], v42 offset:16384
v_mfma_f32_16x16x32_bf16 v[176:179], v[104:107], a[200:203], v[176:179]
ds_read_b64_tr_b16 a[138:139], v42 offset:18432
ds_read_b64_tr_b16 a[140:141], v43 offset:16384
ds_read_b64_tr_b16 a[142:143], v43 offset:18432
v_mfma_f32_16x16x32_bf16 v[200:203], v[104:107], a[204:207], v[200:203]
buffer_load_dwordx4 v[104:107], v47, s[20:23], s90 offen offset:2048 sc1
s_waitcnt vmcnt(28)
v_mfma_f32_16x16x32_bf16 v[132:135], v[108:111], a[192:195], v[132:135]
v_mfma_f32_16x16x32_bf16 v[156:159], v[108:111], a[196:199], v[156:159]
v_mfma_f32_16x16x32_bf16 v[180:183], v[108:111], a[200:203], v[180:183]
v_mfma_f32_16x16x32_bf16 v[204:207], v[108:111], a[204:207], v[204:207]
buffer_load_dwordx4 v[108:111], v55, s[20:23], s90 offen offset:0 sc1
s_waitcnt vmcnt(28)
v_mfma_f32_16x16x32_bf16 v[136:139], v[112:115], a[192:195], v[136:139]
v_mfma_f32_16x16x32_bf16 v[160:163], v[112:115], a[196:199], v[160:163]
v_mfma_f32_16x16x32_bf16 v[184:187], v[112:115], a[200:203], v[184:187]
v_mfma_f32_16x16x32_bf16 v[208:211], v[112:115], a[204:207], v[208:211]
buffer_load_dwordx4 v[112:115], v55, s[20:23], s90 offen offset:2048 sc1
s_waitcnt vmcnt(28)
v_mfma_f32_16x16x32_bf16 v[140:143], v[56:59], a[192:195], v[140:143]
ds_read_b64_tr_b16 a[144:145], v40 offset:20480
ds_read_b64_tr_b16 a[146:147], v40 offset:22528
ds_read_b64_tr_b16 a[148:149], v41 offset:20480
v_mfma_f32_16x16x32_bf16 v[164:167], v[56:59], a[196:199], v[164:167]
ds_read_b64_tr_b16 a[150:151], v41 offset:22528
ds_read_b64_tr_b16 a[152:153], v42 offset:20480
ds_read_b64_tr_b16 a[154:155], v42 offset:22528
ds_read_b64_tr_b16 a[156:157], v43 offset:20480
v_mfma_f32_16x16x32_bf16 v[188:191], v[56:59], a[200:203], v[188:191]
ds_read_b64_tr_b16 a[158:159], v43 offset:22528
v_mfma_f32_16x16x32_bf16 v[212:215], v[56:59], a[204:207], v[212:215]
buffer_load_dwordx4 v[56:59], v33, s[20:23], s90 offen offset:1024 sc1
s_waitcnt vmcnt(26)
v_mfma_f32_16x16x32_bf16 v[144:147], v[60:63], a[192:195], v[144:147]
v_mfma_f32_16x16x32_bf16 v[168:171], v[60:63], a[196:199], v[168:171]
v_mfma_f32_16x16x32_bf16 v[192:195], v[60:63], a[200:203], v[192:195]
v_mfma_f32_16x16x32_bf16 v[216:219], v[60:63], a[204:207], v[216:219]
buffer_load_dwordx4 v[60:63], v33, s[20:23], s90 offen offset:3072 sc1
s_waitcnt vmcnt(24)
v_mfma_f32_16x16x32_bf16 v[148:151], v[64:67], a[192:195], v[148:151]
v_mfma_f32_16x16x32_bf16 v[172:175], v[64:67], a[196:199], v[172:175]
v_mfma_f32_16x16x32_bf16 v[196:199], v[64:67], a[200:203], v[196:199]
v_mfma_f32_16x16x32_bf16 v[220:223], v[64:67], a[204:207], v[220:223]
buffer_load_dwordx4 v[64:67], v47, s[20:23], s90 offen offset:1024 sc1
s_waitcnt vmcnt(24)
v_mfma_f32_16x16x32_bf16 v[128:131], v[68:71], a[208:211], v[128:131]
v_lshrrev_b32 v11, 3, v0
ds_read_b64_tr_b16 a[160:161], v40 offset:24576
v_lshlrev_b32 v11, 9, v11
v_mfma_f32_16x16x32_bf16 v[152:155], v[68:71], a[212:215], v[152:155]
ds_read_b64_tr_b16 a[162:163], v40 offset:26624
v_bfe_u32 v12, v0, 1, 2
v_lshl_add_u32 v11, v12, 7, v11
ds_read_b64_tr_b16 a[164:165], v41 offset:24576
v_mfma_f32_16x16x32_bf16 v[176:179], v[68:71], a[216:219], v[176:179]
s_lshl_b32 s86, s44, 12
s_add_u32 s86, s86, 40960
ds_read_b64_tr_b16 a[166:167], v41 offset:26624
v_mfma_f32_16x16x32_bf16 v[200:203], v[68:71], a[220:223], v[200:203]
buffer_load_dwordx4 v[68:71], v47, s[20:23], s90 offen offset:3072 sc1
s_waitcnt vmcnt(24)
v_mfma_f32_16x16x32_bf16 v[132:135], v[72:75], a[208:211], v[132:135]
buffer_load_dwordx2 v[34:35], v11, s[20:23], s86 offen sc1
v_mfma_f32_16x16x32_bf16 v[156:159], v[72:75], a[212:215], v[156:159]
ds_read_b64_tr_b16 a[168:169], v42 offset:24576
ds_read_b64_tr_b16 a[170:171], v42 offset:26624
v_mfma_f32_16x16x32_bf16 v[180:183], v[72:75], a[216:219], v[180:183]
v_mov_b32 v252, v25
ds_read_b64_tr_b16 a[172:173], v43 offset:24576
v_mov_b32 v253, v25
v_mov_b32 v254, v25
v_mfma_f32_16x16x32_bf16 v[204:207], v[72:75], a[220:223], v[204:207]
buffer_load_dwordx4 v[72:75], v55, s[20:23], s90 offen offset:1024 sc1
s_waitcnt vmcnt(25)
v_mfma_f32_16x16x32_bf16 v[136:139], v[76:79], a[208:211], v[136:139]
ds_read_b64_tr_b16 a[174:175], v43 offset:26624
v_mov_b32 v255, v25
v_mfma_f32_16x16x32_bf16 v[160:163], v[76:79], a[212:215], v[160:163]
buffer_load_dwordx2 v[244:245], v52, s[4:7], 0 offen offset:0
v_mfma_f32_16x16x32_bf16 v[184:187], v[76:79], a[216:219], v[184:187]
buffer_load_dwordx2 v[246:247], v52, s[4:7], 0 offen offset:32
v_mfma_f32_16x16x32_bf16 v[208:211], v[76:79], a[220:223], v[208:211]
buffer_load_dwordx4 v[76:79], v55, s[20:23], s90 offen offset:3072 sc1
s_waitcnt vmcnt(25)
v_mfma_f32_16x16x32_bf16 v[140:143], v[80:83], a[208:211], v[140:143]
ds_read_b64_tr_b16 a[176:177], v40 offset:28672
ds_read_b64_tr_b16 a[178:179], v40 offset:30720
v_mfma_f32_16x16x32_bf16 v[164:167], v[80:83], a[212:215], v[164:167]
ds_read_b64_tr_b16 a[180:181], v41 offset:28672
ds_read_b64_tr_b16 a[182:183], v41 offset:30720
ds_read_b64_tr_b16 a[184:185], v42 offset:28672
v_mfma_f32_16x16x32_bf16 v[188:191], v[80:83], a[216:219], v[188:191]
buffer_load_dwordx2 v[248:249], v52, s[4:7], 0 offen offset:64
v_mfma_f32_16x16x32_bf16 v[212:215], v[80:83], a[220:223], v[212:215]
buffer_load_dwordx2 v[250:251], v52, s[4:7], 0 offen offset:96
s_waitcnt vmcnt(25)
v_mfma_f32_16x16x32_bf16 v[144:147], v[84:87], a[208:211], v[144:147]
ds_read_b64_tr_b16 a[186:187], v42 offset:30720
ds_read_b64_tr_b16 a[188:189], v43 offset:28672
v_mfma_f32_16x16x32_bf16 v[168:171], v[84:87], a[212:215], v[168:171]
ds_read_b64_tr_b16 a[190:191], v43 offset:30720
v_mfma_f32_16x16x32_bf16 v[192:195], v[84:87], a[216:219], v[192:195]
v_mfma_f32_16x16x32_bf16 v[216:219], v[84:87], a[220:223], v[216:219]
s_waitcnt vmcnt(22)
v_mfma_f32_16x16x32_bf16 v[148:151], v[88:91], a[208:211], v[148:151]
v_mfma_f32_16x16x32_bf16 v[172:175], v[88:91], a[212:215], v[172:175]
v_mfma_f32_16x16x32_bf16 v[196:199], v[88:91], a[216:219], v[196:199]
v_mfma_f32_16x16x32_bf16 v[220:223], v[88:91], a[220:223], v[220:223]
s_waitcnt vmcnt(19)
v_mfma_f32_16x16x32_bf16 v[128:131], v[92:95], a[224:227], v[128:131]
ds_read_b64_tr_b16 a[192:193], v40 offset:32768
ds_read_b64_tr_b16 a[194:195], v40 offset:34816
ds_read_b64_tr_b16 a[196:197], v41 offset:32768
ds_read_b64_tr_b16 a[198:199], v41 offset:34816
v_mfma_f32_16x16x32_bf16 v[152:155], v[92:95], a[228:231], v[152:155]
ds_read_b64_tr_b16 a[200:201], v42 offset:32768
ds_read_b64_tr_b16 a[202:203], v42 offset:34816
ds_read_b64_tr_b16 a[204:205], v43 offset:32768
v_mfma_f32_16x16x32_bf16 v[176:179], v[92:95], a[232:235], v[176:179]
ds_read_b64_tr_b16 a[206:207], v43 offset:34816
ds_read_b64_tr_b16 a[208:209], v40 offset:36864
ds_read_b64_tr_b16 a[210:211], v40 offset:38912
ds_read_b64_tr_b16 a[212:213], v41 offset:36864
v_mfma_f32_16x16x32_bf16 v[200:203], v[92:95], a[236:239], v[200:203]
ds_read_b64_tr_b16 a[214:215], v41 offset:38912
ds_read_b64_tr_b16 a[216:217], v42 offset:36864
ds_read_b64_tr_b16 a[218:219], v42 offset:38912
s_waitcnt vmcnt(17)
v_mfma_f32_16x16x32_bf16 v[132:135], v[96:99], a[224:227], v[132:135]
ds_read_b64_tr_b16 a[220:221], v43 offset:36864
ds_read_b64_tr_b16 a[222:223], v43 offset:38912
v_mfma_f32_16x16x32_bf16 v[156:159], v[96:99], a[228:231], v[156:159]
v_mfma_f32_16x16x32_bf16 v[180:183], v[96:99], a[232:235], v[180:183]
v_mfma_f32_16x16x32_bf16 v[204:207], v[96:99], a[236:239], v[204:207]
s_waitcnt vmcnt(14)
v_mfma_f32_16x16x32_bf16 v[136:139], v[100:103], a[224:227], v[136:139]
v_mfma_f32_16x16x32_bf16 v[160:163], v[100:103], a[228:231], v[160:163]
v_mfma_f32_16x16x32_bf16 v[184:187], v[100:103], a[232:235], v[184:187]
v_mfma_f32_16x16x32_bf16 v[208:211], v[100:103], a[236:239], v[208:211]
s_waitcnt vmcnt(13)
v_mfma_f32_16x16x32_bf16 v[140:143], v[104:107], a[224:227], v[140:143]
s_mov_b32 s95, 0
s_waitcnt vmcnt(6)
v_cmp_ne_u64 vcc, v[34:35], v[26:27]
s_nop 3
s_cbranch_vccnz L_s3n_46
v_lshlrev_b32 v10, 3, v0
s_add_u32 s86, s57, 9306112
buffer_load_dwordx2 v[224:225], v10, s[20:23], s86 offen offset:0 sc1
buffer_load_dwordx2 v[226:227], v10, s[20:23], s86 offen offset:512 sc1
buffer_load_dwordx2 v[228:229], v10, s[20:23], s86 offen offset:1024 sc1
buffer_load_dwordx2 v[230:231], v10, s[20:23], s86 offen offset:1536 sc1
buffer_load_dwordx2 v[232:233], v10, s[20:23], s86 offen offset:2048 sc1
buffer_load_dwordx2 v[234:235], v10, s[20:23], s86 offen offset:2560 sc1
buffer_load_dwordx2 v[236:237], v10, s[20:23], s86 offen offset:3072 sc1
buffer_load_dwordx2 v[238:239], v10, s[20:23], s86 offen offset:3584 sc1
v_and_b32 v11, 56, v0
v_lshl_add_u32 v10, v11, 3, v10
s_lshl_b32 s0, s44, 10
s_add_u32 s86, s0, 9322496
buffer_load_dwordx2 v[240:241], v10, s[20:23], s86 offen sc1
s_mov_b32 s95, 1
L_s3n_46:
v_mfma_f32_16x16x32_bf16 v[164:167], v[104:107], a[228:231], v[164:167]
v_mfma_f32_16x16x32_bf16 v[188:191], v[104:107], a[232:235], v[188:191]
v_mfma_f32_16x16x32_bf16 v[212:215], v[104:107], a[236:239], v[212:215]
v_mfma_f32_16x16x32_bf16 v[144:147], v[108:111], a[224:227], v[144:147]
v_mfma_f32_16x16x32_bf16 v[168:171], v[108:111], a[228:231], v[168:171]
s_lshl_b32 s0, s47, 2
s_add_u32 s0, s0, s44
v_mfma_f32_16x16x32_bf16 v[192:195], v[108:111], a[232:235], v[192:195]
s_lshl_b32 s0, s0, 14
s_add_u32 s0, s0, 6029312
s_add_u32 s86, s0, 0
v_mfma_f32_16x16x32_bf16 v[216:219], v[108:111], a[236:239], v[216:219]
buffer_load_dwordx4 a[0:3], v32, s[20:23], s86 offen offset:0 sc1
v_mfma_f32_16x16x32_bf16 v[148:151], v[112:115], a[224:227], v[148:151]
buffer_load_dwordx4 a[4:7], v32, s[20:23], s86 offen offset:1024 sc1
v_mfma_f32_16x16x32_bf16 v[172:175], v[112:115], a[228:231], v[172:175]
v_mfma_f32_16x16x32_bf16 v[196:199], v[112:115], a[232:235], v[196:199]
buffer_load_dwordx4 a[8:11], v32, s[20:23], s86 offen offset:2048 sc1
v_mfma_f32_16x16x32_bf16 v[220:223], v[112:115], a[236:239], v[220:223]
buffer_load_dwordx4 a[12:15], v32, s[20:23], s86 offen offset:3072 sc1
s_waitcnt lgkmcnt(0)
s_barrier
v_mfma_f32_16x16x32_bf16 v[128:131], v[56:59], a[240:243], v[128:131]
s_add_u32 s86, s0, 4096
buffer_load_dwordx4 a[16:19], v32, s[20:23], s86 offen offset:0 sc1
v_mfma_f32_16x16x32_bf16 v[152:155], v[56:59], a[244:247], v[152:155]
v_mfma_f32_16x16x32_bf16 v[176:179], v[56:59], a[248:251], v[176:179]
buffer_load_dwordx4 a[20:23], v32, s[20:23], s86 offen offset:1024 sc1
v_mfma_f32_16x16x32_bf16 v[200:203], v[56:59], a[252:255], v[200:203]
buffer_load_dwordx4 a[24:27], v32, s[20:23], s86 offen offset:2048 sc1
v_mfma_f32_16x16x32_bf16 v[132:135], v[60:63], a[240:243], v[132:135]
v_mfma_f32_16x16x32_bf16 v[156:159], v[60:63], a[244:247], v[156:159]
buffer_load_dwordx4 a[28:31], v32, s[20:23], s86 offen offset:3072 sc1
v_mfma_f32_16x16x32_bf16 v[180:183], v[60:63], a[248:251], v[180:183]
v_mfma_f32_16x16x32_bf16 v[204:207], v[60:63], a[252:255], v[204:207]
v_mfma_f32_16x16x32_bf16 v[136:139], v[64:67], a[240:243], v[136:139]
v_mfma_f32_16x16x32_bf16 v[160:163], v[64:67], a[244:247], v[160:163]
v_mfma_f32_16x16x32_bf16 v[184:187], v[64:67], a[248:251], v[184:187]
v_mfma_f32_16x16x32_bf16 v[208:211], v[64:67], a[252:255], v[208:211]
v_mfma_f32_16x16x32_bf16 v[212:215], v[68:71], a[252:255], v[212:215]
s_waitcnt vmcnt(13)
v_mfma_f32_16x16x32_bf16 v[216:219], v[72:75], a[252:255], v[216:219]
s_waitcnt vmcnt(10)
v_mfma_f32_16x16x32_bf16 v[220:223], v[76:79], a[252:255], v[220:223]
v_mfma_f32_16x16x32_bf16 v[188:191], v[68:71], a[248:251], v[188:191]
v_mfma_f32_16x16x32_bf16 v[192:195], v[72:75], a[248:251], v[192:195]
v_mfma_f32_16x16x32_bf16 v[196:199], v[76:79], a[248:251], v[196:199]
v_mfma_f32_16x16x32_bf16 v[164:167], v[68:71], a[244:247], v[164:167]
v_mfma_f32_16x16x32_bf16 v[168:171], v[72:75], a[244:247], v[168:171]
v_mfma_f32_16x16x32_bf16 v[172:175], v[76:79], a[244:247], v[172:175]
v_mfma_f32_16x16x32_bf16 v[140:143], v[68:71], a[240:243], v[140:143]
v_mfma_f32_16x16x32_bf16 v[144:147], v[72:75], a[240:243], v[144:147]
v_mfma_f32_16x16x32_bf16 v[148:151], v[76:79], a[240:243], v[148:151]
s_branch L_join
L_pathR:
s_add_u32 m0, s57, 114688
s_mul_i32 s87, s94, s52
buffer_load_dwordx4 v40, s[12:15], s87 offen lds
buffer_load_dwordx4 v41, s[12:15], s87 offen offset:1024 lds
buffer_load_dwordx4 v42, s[12:15], s87 offen offset:2048 lds
buffer_load_dwordx4 v43, s[12:15], s87 offen offset:3072 lds
s_add_u32 s94, s94, 128
s_and_b32 s94, s94, 1023
s_add_u32 m0, s59, 65536
s_add_u32 s87, s61, s64
buffer_load_dwordx4 v20, s[16:19], s87 offen lds
buffer_load_dwordx4 v21, s[16:19], s87 offen offset:1024 lds
s_add_u32 m0, m0, 2048
s_nop 0
buffer_load_dwordx4 v22, s[16:19], s87 offen lds
buffer_load_dwordx4 v23, s[16:19], s87 offen offset:1024 lds
s_add_u32 m0, s59, 69632
s_add_u32 s87, s61, s65
buffer_load_dwordx4 v20, s[16:19], s87 offen lds
buffer_load_dwordx4 v21, s[16:19], s87 offen offset:1024 lds
s_add_u32 m0, m0, 2048
s_nop 0
buffer_load_dwordx4 v22, s[16:19], s87 offen lds
buffer_load_dwordx4 v23, s[16:19], s87 offen offset:1024 lds
s_add_u32 s61, s61, 128
s_and_b32 s61, s61, 1023
s_cmp_ge_u32 s46, 14
s_cbranch_scc1 L_rd_49
s_cmp_eq_u32 s46, 13
s_cbranch_scc1 L_rz_48
v_bfe_u32 v5, v0, 4, 1
v_lshlrev_b32 v109, 14, v5
v_lshrrev_b32 v5, 5, v0
v_lshl_add_u32 v109, v5, 8, v109
v_lshl_add_u32 v109, v4, 4, v109
s_lshl_b32 s53, s96, 15
s_sub_u32 s54, s46, 5
s_lshl_b32 s54, s54, 11
s_add_u32 s53, s53, s54
s_add_u32 s56, s53, 6029312
s_xor_b32 s54, s91, 0
s_lshl_b32 s53, s54, 7
v_lshrrev_b32 v5, 5, v0
v_lshlrev_b32 v5, 4, v5
v_add_u32 v5, s53, v5
v_add_u32 v5, 160768, v5
ds_read_b128 v[192:195], v5 offset:0
ds_read_b128 v[196:199], v5 offset:32
ds_read_b128 v[200:203], v5 offset:64
ds_read_b128 v[204:207], v5 offset:96
s_waitcnt lgkmcnt(3)
v_pk_mul_f32 v[208:209], v[192:193], v[48:49] op_sel:[0,1] op_sel_hi:[1,1]
v_pk_mul_f32 v[210:211], v[194:195], v[48:49] op_sel:[0,1] op_sel_hi:[1,1]
s_waitcnt lgkmcnt(2)
v_pk_mul_f32 v[212:213], v[196:197], v[48:49] op_sel:[0,1] op_sel_hi:[1,1]
v_pk_mul_f32 v[214:215], v[198:199], v[48:49] op_sel:[0,1] op_sel_hi:[1,1]
v_pk_fma_f32 v[208:209], v[56:57], v[48:49], v[208:209] op_sel:[0,0,0] op_sel_hi:[1,0,1]
v_pk_fma_f32 v[210:211], v[58:59], v[48:49], v[210:211] op_sel:[0,0,0] op_sel_hi:[1,0,1]
v_pk_fma_f32 v[212:213], v[60:61], v[48:49], v[212:213] op_sel:[0,0,0] op_sel_hi:[1,0,1]
v_pk_fma_f32 v[214:215], v[62:63], v[48:49], v[214:215] op_sel:[0,0,0] op_sel_hi:[1,0,1]
v_pk_mul_f32 v[216:217], v[208:209], v[24:25] op_sel:[0,0] op_sel_hi:[1,0]
v_pk_mul_f32 v[218:219], v[210:211], v[24:25] op_sel:[0,0] op_sel_hi:[1,0]
v_pk_mul_f32 v[220:221], v[212:213], v[24:25] op_sel:[0,0] op_sel_hi:[1,0]
v_pk_mul_f32 v[222:223], v[214:215], v[24:25] op_sel:[0,0] op_sel_hi:[1,0]
v_exp_f32_e64 v216, v216 clamp
v_exp_f32_e64 v217, v217 clamp
v_exp_f32_e64 v218, v218 clamp
v_exp_f32_e64 v219, v219 clamp
v_exp_f32_e64 v220, v220 clamp
v_exp_f32_e64 v221, v221 clamp
v_exp_f32_e64 v222, v222 clamp
v_exp_f32_e64 v223, v223 clamp
v_max_f32 v208, 0, v208
v_max_f32 v209, 0, v209
v_max_f32 v210, 0, v210
v_max_f32 v211, 0, v211
v_max_f32 v212, 0, v212
v_max_f32 v213, 0, v213
v_max_f32 v214, 0, v214
v_max_f32 v215, 0, v215
v_pk_add_f32 v[216:217], v[216:217], v[24:25] op_sel:[0,1] op_sel_hi:[1,1]
v_pk_add_f32 v[218:219], v[218:219], v[24:25] op_sel:[0,1] op_sel_hi:[1,1]
v_pk_add_f32 v[220:221], v[220:221], v[24:25] op_sel:[0,1] op_sel_hi:[1,1]
v_pk_add_f32 v[222:223], v[222:223], v[24:25] op_sel:[0,1] op_sel_hi:[1,1]
v_pk_add_f32 v[208:209], v[208:209], v[216:217]
v_pk_add_f32 v[210:211], v[210:211], v[218:219]
v_pk_add_f32 v[212:213], v[212:213], v[220:221]
v_pk_add_f32 v[214:215], v[214:215], v[222:223]
v_cvt_pk_bf16_f32 v88, v208, v209
v_cvt_pk_bf16_f32 v89, v210, v211
v_cvt_pk_bf16_f32 v92, v212, v213
v_cvt_pk_bf16_f32 v93, v214, v215
s_waitcnt lgkmcnt(1)
v_pk_mul_f32 v[208:209], v[200:201], v[48:49] op_sel:[0,1] op_sel_hi:[1,1]
v_pk_mul_f32 v[210:211], v[202:203], v[48:49] op_sel:[0,1] op_sel_hi:[1,1]
s_waitcnt lgkmcnt(0)
v_pk_mul_f32 v[212:213], v[204:205], v[48:49] op_sel:[0,1] op_sel_hi:[1,1]
v_pk_mul_f32 v[214:215], v[206:207], v[48:49] op_sel:[0,1] op_sel_hi:[1,1]
v_pk_fma_f32 v[208:209], v[64:65], v[48:49], v[208:209] op_sel:[0,0,0] op_sel_hi:[1,0,1]
v_pk_fma_f32 v[210:211], v[66:67], v[48:49], v[210:211] op_sel:[0,0,0] op_sel_hi:[1,0,1]
v_pk_fma_f32 v[212:213], v[68:69], v[48:49], v[212:213] op_sel:[0,0,0] op_sel_hi:[1,0,1]
v_pk_fma_f32 v[214:215], v[70:71], v[48:49], v[214:215] op_sel:[0,0,0] op_sel_hi:[1,0,1]
v_pk_mul_f32 v[216:217], v[208:209], v[24:25] op_sel:[0,0] op_sel_hi:[1,0]
v_pk_mul_f32 v[218:219], v[210:211], v[24:25] op_sel:[0,0] op_sel_hi:[1,0]
v_pk_mul_f32 v[220:221], v[212:213], v[24:25] op_sel:[0,0] op_sel_hi:[1,0]
v_pk_mul_f32 v[222:223], v[214:215], v[24:25] op_sel:[0,0] op_sel_hi:[1,0]
v_exp_f32_e64 v216, v216 clamp
v_exp_f32_e64 v217, v217 clamp
v_exp_f32_e64 v218, v218 clamp
v_exp_f32_e64 v219, v219 clamp
v_exp_f32_e64 v220, v220 clamp
v_exp_f32_e64 v221, v221 clamp
v_exp_f32_e64 v222, v222 clamp
v_exp_f32_e64 v223, v223 clamp
v_max_f32 v208, 0, v208
v_max_f32 v209, 0, v209
v_max_f32 v210, 0, v210
v_max_f32 v211, 0, v211
v_max_f32 v212, 0, v212
v_max_f32 v213, 0, v213
v_max_f32 v214, 0, v214
v_max_f32 v215, 0, v215
v_pk_add_f32 v[216:217], v[216:217], v[24:25] op_sel:[0,1] op_sel_hi:[1,1]
v_pk_add_f32 v[218:219], v[218:219], v[24:25] op_sel:[0,1] op_sel_hi:[1,1]
v_pk_add_f32 v[220:221], v[220:221], v[24:25] op_sel:[0,1] op_sel_hi:[1,1]
v_pk_add_f32 v[222:223], v[222:223], v[24:25] op_sel:[0,1] op_sel_hi:[1,1]
v_pk_add_f32 v[208:209], v[208:209], v[216:217]
v_pk_add_f32 v[210:211], v[210:211], v[218:219]
v_pk_add_f32 v[212:213], v[212:213], v[220:221]
v_pk_add_f32 v[214:215], v[214:215], v[222:223]
v_cvt_pk_bf16_f32 v90, v208, v209
v_cvt_pk_bf16_f32 v91, v210, v211
v_cvt_pk_bf16_f32 v94, v212, v213
v_cvt_pk_bf16_f32 v95, v214, v215
s_lshl_b32 s53, s54, 10
s_add_u32 s63, s56, s53
buffer_store_dwordx4 v[88:91], v109, s[20:23], s63 offen offset:0 sc1
buffer_store_dwordx4 v[92:95], v109, s[20:23], s63 offen offset:512 sc1
s_xor_b32 s54, s91, 1
s_lshl_b32 s53, s54, 7
v_lshrrev_b32 v5, 5, v0
v_lshlrev_b32 v5, 4, v5
v_add_u32 v5, s53, v5
v_add_u32 v5, 160768, v5
ds_read_b128 v[192:195], v5 offset:0
ds_read_b128 v[196:199], v5 offset:32
ds_read_b128 v[200:203], v5 offset:64
ds_read_b128 v[204:207], v5 offset:96
s_waitcnt lgkmcnt(3)
v_pk_mul_f32 v[208:209], v[192:193], v[48:49] op_sel:[0,1] op_sel_hi:[1,1]
v_pk_mul_f32 v[210:211], v[194:195], v[48:49] op_sel:[0,1] op_sel_hi:[1,1]
s_waitcnt lgkmcnt(2)
v_pk_mul_f32 v[212:213], v[196:197], v[48:49] op_sel:[0,1] op_sel_hi:[1,1]
v_pk_mul_f32 v[214:215], v[198:199], v[48:49] op_sel:[0,1] op_sel_hi:[1,1]
v_pk_fma_f32 v[208:209], v[72:73], v[48:49], v[208:209] op_sel:[0,0,0] op_sel_hi:[1,0,1]
v_pk_fma_f32 v[210:211], v[74:75], v[48:49], v[210:211] op_sel:[0,0,0] op_sel_hi:[1,0,1]
v_pk_fma_f32 v[212:213], v[76:77], v[48:49], v[212:213] op_sel:[0,0,0] op_sel_hi:[1,0,1]
v_pk_fma_f32 v[214:215], v[78:79], v[48:49], v[214:215] op_sel:[0,0,0] op_sel_hi:[1,0,1]
v_pk_mul_f32 v[216:217], v[208:209], v[24:25] op_sel:[0,0] op_sel_hi:[1,0]
v_pk_mul_f32 v[218:219], v[210:211], v[24:25] op_sel:[0,0] op_sel_hi:[1,0]
v_pk_mul_f32 v[220:221], v[212:213], v[24:25] op_sel:[0,0] op_sel_hi:[1,0]
v_pk_mul_f32 v[222:223], v[214:215], v[24:25] op_sel:[0,0] op_sel_hi:[1,0]
v_exp_f32_e64 v216, v216 clamp
v_exp_f32_e64 v217, v217 clamp
v_exp_f32_e64 v218, v218 clamp
v_exp_f32_e64 v219, v219 clamp
v_exp_f32_e64 v220, v220 clamp
v_exp_f32_e64 v221, v221 clamp
v_exp_f32_e64 v222, v222 clamp
v_exp_f32_e64 v223, v223 clamp
v_max_f32 v208, 0, v208
v_max_f32 v209, 0, v209
v_max_f32 v210, 0, v210
v_max_f32 v211, 0, v211
v_max_f32 v212, 0, v212
v_max_f32 v213, 0, v213
v_max_f32 v214, 0, v214
v_max_f32 v215, 0, v215
v_pk_add_f32 v[216:217], v[216:217], v[24:25] op_sel:[0,1] op_sel_hi:[1,1]
v_pk_add_f32 v[218:219], v[218:219], v[24:25] op_sel:[0,1] op_sel_hi:[1,1]
v_pk_add_f32 v[220:221], v[220:221], v[24:25] op_sel:[0,1] op_sel_hi:[1,1]
v_pk_add_f32 v[222:223], v[222:223], v[24:25] op_sel:[0,1] op_sel_hi:[1,1]
v_pk_add_f32 v[208:209], v[208:209], v[216:217]
v_pk_add_f32 v[210:211], v[210:211], v[218:219]
v_pk_add_f32 v[212:213], v[212:213], v[220:221]
v_pk_add_f32 v[214:215], v[214:215], v[222:223]
v_cvt_pk_bf16_f32 v96, v208, v209
v_cvt_pk_bf16_f32 v97, v210, v211
v_cvt_pk_bf16_f32 v100, v212, v213
v_cvt_pk_bf16_f32 v101, v214, v215
s_waitcnt lgkmcnt(1)
v_pk_mul_f32 v[208:209], v[200:201], v[48:49] op_sel:[0,1] op_sel_hi:[1,1]
v_pk_mul_f32 v[210:211], v[202:203], v[48:49] op_sel:[0,1] op_sel_hi:[1,1]
s_waitcnt lgkmcnt(0)
v_pk_mul_f32 v[212:213], v[204:205], v[48:49] op_sel:[0,1] op_sel_hi:[1,1]
v_pk_mul_f32 v[214:215], v[206:207], v[48:49] op_sel:[0,1] op_sel_hi:[1,1]
v_pk_fma_f32 v[208:209], v[80:81], v[48:49], v[208:209] op_sel:[0,0,0] op_sel_hi:[1,0,1]
v_pk_fma_f32 v[210:211], v[82:83], v[48:49], v[210:211] op_sel:[0,0,0] op_sel_hi:[1,0,1]
v_pk_fma_f32 v[212:213], v[84:85], v[48:49], v[212:213] op_sel:[0,0,0] op_sel_hi:[1,0,1]
v_pk_fma_f32 v[214:215], v[86:87], v[48:49], v[214:215] op_sel:[0,0,0] op_sel_hi:[1,0,1]
v_pk_mul_f32 v[216:217], v[208:209], v[24:25] op_sel:[0,0] op_sel_hi:[1,0]
v_pk_mul_f32 v[218:219], v[210:211], v[24:25] op_sel:[0,0] op_sel_hi:[1,0]
v_pk_mul_f32 v[220:221], v[212:213], v[24:25] op_sel:[0,0] op_sel_hi:[1,0]
v_pk_mul_f32 v[222:223], v[214:215], v[24:25] op_sel:[0,0] op_sel_hi:[1,0]
v_exp_f32_e64 v216, v216 clamp
v_exp_f32_e64 v217, v217 clamp
v_exp_f32_e64 v218, v218 clamp
v_exp_f32_e64 v219, v219 clamp
v_exp_f32_e64 v220, v220 clamp
v_exp_f32_e64 v221, v221 clamp
v_exp_f32_e64 v222, v222 clamp
v_exp_f32_e64 v223, v223 clamp
v_max_f32 v208, 0, v208
v_max_f32 v209, 0, v209
v_max_f32 v210, 0, v210
v_max_f32 v211, 0, v211
v_max_f32 v212, 0, v212
v_max_f32 v213, 0, v213
v_max_f32 v214, 0, v214
v_max_f32 v215, 0, v215
v_pk_add_f32 v[216:217], v[216:217], v[24:25] op_sel:[0,1] op_sel_hi:[1,1]
v_pk_add_f32 v[218:219], v[218:219], v[24:25] op_sel:[0,1] op_sel_hi:[1,1]
v_pk_add_f32 v[220:221], v[220:221], v[24:25] op_sel:[0,1] op_sel_hi:[1,1]
v_pk_add_f32 v[222:223], v[222:223], v[24:25] op_sel:[0,1] op_sel_hi:[1,1]
v_pk_add_f32 v[208:209], v[208:209], v[216:217]
v_pk_add_f32 v[210:211], v[210:211], v[218:219]
v_pk_add_f32 v[212:213], v[212:213], v[220:221]
v_pk_add_f32 v[214:215], v[214:215], v[222:223]
v_cvt_pk_bf16_f32 v98, v208, v209
v_cvt_pk_bf16_f32 v99, v210, v211
v_cvt_pk_bf16_f32 v102, v212, v213
v_cvt_pk_bf16_f32 v103, v214, v215
s_lshl_b32 s53, s54, 10
s_add_u32 s63, s56, s53
buffer_store_dwordx4 v[96:99], v109, s[20:23], s63 offen offset:0 sc1
buffer_store_dwordx4 v[100:103], v109, s[20:23], s63 offen offset:512 sc1
s_waitcnt lgkmcnt(0)
s_branch L_rd_49
L_rz_48:
v_bfe_u32 v5, v0, 4, 1
v_mul_u32_u24 v109, 22016, v5
v_lshrrev_b32 v5, 5, v0
v_lshl_add_u32 v109, v5, 7, v109
v_lshl_add_u32 v109, v4, 3, v109
s_mul_i32 s53, s96, 44032
s_add_u32 s56, s53, 3166208
s_xor_b32 s54, s91, 0
s_lshl_b32 s53, s54, 7
v_lshrrev_b32 v5, 5, v0
v_lshlrev_b32 v5, 4, v5
v_add_u32 v5, s53, v5
v_add_u32 v5, 160768, v5
s_waitcnt lgkmcnt(0)
ds_read_b128 v[192:195], v5 offset:0
s_waitcnt lgkmcnt(1)
ds_read_b128 v[196:199], v5 offset:32
s_waitcnt lgkmcnt(2)
ds_read_b128 v[200:203], v5 offset:64
s_waitcnt lgkmcnt(3)
ds_read_b128 v[204:207], v5 offset:96
s_waitcnt lgkmcnt(3)
v_pk_mul_f32 v[208:209], v[192:193], v[48:49] op_sel:[0,1] op_sel_hi:[1,1]
v_pk_mul_f32 v[210:211], v[194:195], v[48:49] op_sel:[0,1] op_sel_hi:[1,1]
s_waitcnt lgkmcnt(2)
v_pk_mul_f32 v[212:213], v[196:197], v[48:49] op_sel:[0,1] op_sel_hi:[1,1]
v_pk_mul_f32 v[214:215], v[198:199], v[48:49] op_sel:[0,1] op_sel_hi:[1,1]
v_pk_fma_f32 v[208:209], v[56:57], v[48:49], v[208:209] op_sel:[0,0,0] op_sel_hi:[1,0,1]
v_pk_fma_f32 v[210:211], v[58:59], v[48:49], v[210:211] op_sel:[0,0,0] op_sel_hi:[1,0,1]
v_pk_fma_f32 v[212:213], v[60:61], v[48:49], v[212:213] op_sel:[0,0,0] op_sel_hi:[1,0,1]
v_pk_fma_f32 v[214:215], v[62:63], v[48:49], v[214:215] op_sel:[0,0,0] op_sel_hi:[1,0,1]
v_pk_mul_f32 v[216:217], v[208:209], v[208:209]
v_pk_mul_f32 v[218:219], v[210:211], v[210:211]
v_pk_mul_f32 v[220:221], v[212:213], v[212:213]
v_pk_mul_f32 v[222:223], v[214:215], v[214:215]
v_pk_fma_f32 v[216:217], v[216:217], v[52:53], v[52:53] op_sel:[0,0,1] op_sel_hi:[1,0,1]
v_pk_fma_f32 v[218:219], v[218:219], v[52:53], v[52:53] op_sel:[0,0,1] op_sel_hi:[1,0,1]
v_pk_fma_f32 v[220:221], v[220:221], v[52:53], v[52:53] op_sel:[0,0,1] op_sel_hi:[1,0,1]
v_pk_fma_f32 v[222:223], v[222:223], v[52:53], v[52:53] op_sel:[0,0,1] op_sel_hi:[1,0,1]
v_pk_mul_f32 v[216:217], v[216:217], v[208:209]
v_pk_mul_f32 v[218:219], v[218:219], v[210:211]
v_pk_mul_f32 v[220:221], v[220:221], v[212:213]
v_pk_mul_f32 v[222:223], v[222:223], v[214:215]
v_exp_f32 v216, v216
v_exp_f32 v217, v217
v_exp_f32 v218, v218
v_exp_f32 v219, v219
v_exp_f32 v220, v220
v_exp_f32 v221, v221
v_exp_f32 v222, v222
v_exp_f32 v223, v223
v_pk_add_f32 v[216:217], v[216:217], 1.0 op_sel_hi:[1,0]
v_pk_add_f32 v[218:219], v[218:219], 1.0 op_sel_hi:[1,0]
v_pk_add_f32 v[220:221], v[220:221], 1.0 op_sel_hi:[1,0]
v_pk_add_f32 v[222:223], v[222:223], 1.0 op_sel_hi:[1,0]
v_rcp_f32 v216, v216
v_rcp_f32 v217, v217
v_rcp_f32 v218, v218
v_rcp_f32 v219, v219
v_rcp_f32 v220, v220
v_rcp_f32 v221, v221
v_rcp_f32 v222, v222
v_rcp_f32 v223, v223
v_pk_mul_f32 v[208:209], v[208:209], v[216:217]
v_pk_mul_f32 v[210:211], v[210:211], v[218:219]
v_pk_mul_f32 v[212:213], v[212:213], v[220:221]
v_pk_mul_f32 v[214:215], v[214:215], v[222:223]
v_cvt_pk_bf16_f32 v88, v208, v209
v_cvt_pk_bf16_f32 v89, v210, v211
v_cvt_pk_bf16_f32 v90, v212, v213
v_cvt_pk_bf16_f32 v91, v214, v215
s_waitcnt lgkmcnt(1)
v_pk_mul_f32 v[208:209], v[200:201], v[48:49] op_sel:[0,1] op_sel_hi:[1,1]
v_pk_mul_f32 v[210:211], v[202:203], v[48:49] op_sel:[0,1] op_sel_hi:[1,1]
s_waitcnt lgkmcnt(0)
v_pk_mul_f32 v[212:213], v[204:205], v[48:49] op_sel:[0,1] op_sel_hi:[1,1]
v_pk_mul_f32 v[214:215], v[206:207], v[48:49] op_sel:[0,1] op_sel_hi:[1,1]
v_pk_fma_f32 v[208:209], v[64:65], v[48:49], v[208:209] op_sel:[0,0,0] op_sel_hi:[1,0,1]
v_pk_fma_f32 v[210:211], v[66:67], v[48:49], v[210:211] op_sel:[0,0,0] op_sel_hi:[1,0,1]
v_pk_fma_f32 v[212:213], v[68:69], v[48:49], v[212:213] op_sel:[0,0,0] op_sel_hi:[1,0,1]
v_pk_fma_f32 v[214:215], v[70:71], v[48:49], v[214:215] op_sel:[0,0,0] op_sel_hi:[1,0,1]
v_pk_mul_f32 v[216:217], v[208:209], v[208:209]
v_pk_mul_f32 v[218:219], v[210:211], v[210:211]
v_pk_mul_f32 v[220:221], v[212:213], v[212:213]
v_pk_mul_f32 v[222:223], v[214:215], v[214:215]
v_pk_fma_f32 v[216:217], v[216:217], v[52:53], v[52:53] op_sel:[0,0,1] op_sel_hi:[1,0,1]
v_pk_fma_f32 v[218:219], v[218:219], v[52:53], v[52:53] op_sel:[0,0,1] op_sel_hi:[1,0,1]
v_pk_fma_f32 v[220:221], v[220:221], v[52:53], v[52:53] op_sel:[0,0,1] op_sel_hi:[1,0,1]
v_pk_fma_f32 v[222:223], v[222:223], v[52:53], v[52:53] op_sel:[0,0,1] op_sel_hi:[1,0,1]
v_pk_mul_f32 v[216:217], v[216:217], v[208:209]
v_pk_mul_f32 v[218:219], v[218:219], v[210:211]
v_pk_mul_f32 v[220:221], v[220:221], v[212:213]
v_pk_mul_f32 v[222:223], v[222:223], v[214:215]
v_exp_f32 v216, v216
v_exp_f32 v217, v217
v_exp_f32 v218, v218
v_exp_f32 v219, v219
v_exp_f32 v220, v220
v_exp_f32 v221, v221
v_exp_f32 v222, v222
v_exp_f32 v223, v223
v_pk_add_f32 v[216:217], v[216:217], 1.0 op_sel_hi:[1,0]
v_pk_add_f32 v[218:219], v[218:219], 1.0 op_sel_hi:[1,0]
v_pk_add_f32 v[220:221], v[220:221], 1.0 op_sel_hi:[1,0]
v_pk_add_f32 v[222:223], v[222:223], 1.0 op_sel_hi:[1,0]
v_rcp_f32 v216, v216
v_rcp_f32 v217, v217
v_rcp_f32 v218, v218
v_rcp_f32 v219, v219
v_rcp_f32 v220, v220
v_rcp_f32 v221, v221
v_rcp_f32 v222, v222
v_rcp_f32 v223, v223
v_pk_mul_f32 v[208:209], v[208:209], v[216:217]
v_pk_mul_f32 v[210:211], v[210:211], v[218:219]
v_pk_mul_f32 v[212:213], v[212:213], v[220:221]
v_pk_mul_f32 v[214:215], v[214:215], v[222:223]
v_cvt_pk_bf16_f32 v92, v208, v209
v_cvt_pk_bf16_f32 v93, v210, v211
v_cvt_pk_bf16_f32 v94, v212, v213
v_cvt_pk_bf16_f32 v95, v214, v215
s_lshl_b32 s53, s54, 10
s_add_u32 s63, s56, s53
buffer_store_dwordx2 v[88:89], v109, s[20:23], s63 offen offset:0 sc1
buffer_store_dwordx2 v[90:91], v109, s[20:23], s63 offen offset:256 sc1
s_cmp_eq_u32 s54, 1
s_cselect_b32 s63, 0x40000000, s63
buffer_store_dwordx2 v[92:93], v109, s[20:23], s63 offen offset:512 sc1
buffer_store_dwordx2 v[94:95], v109, s[20:23], s63 offen offset:768 sc1
s_xor_b32 s54, s91, 1
s_lshl_b32 s53, s54, 7
v_lshrrev_b32 v5, 5, v0
v_lshlrev_b32 v5, 4, v5
v_add_u32 v5, s53, v5
v_add_u32 v5, 160768, v5
ds_read_b128 v[192:195], v5 offset:0
ds_read_b128 v[196:199], v5 offset:32
ds_read_b128 v[200:203], v5 offset:64
ds_read_b128 v[204:207], v5 offset:96
s_waitcnt lgkmcnt(3)
v_pk_mul_f32 v[208:209], v[192:193], v[48:49] op_sel:[0,1] op_sel_hi:[1,1]
v_pk_mul_f32 v[210:211], v[194:195], v[48:49] op_sel:[0,1] op_sel_hi:[1,1]
s_waitcnt lgkmcnt(2)
v_pk_mul_f32 v[212:213], v[196:197], v[48:49] op_sel:[0,1] op_sel_hi:[1,1]
v_pk_mul_f32 v[214:215], v[198:199], v[48:49] op_sel:[0,1] op_sel_hi:[1,1]
v_pk_fma_f32 v[208:209], v[72:73], v[48:49], v[208:209] op_sel:[0,0,0] op_sel_hi:[1,0,1]
v_pk_fma_f32 v[210:211], v[74:75], v[48:49], v[210:211] op_sel:[0,0,0] op_sel_hi:[1,0,1]
v_pk_fma_f32 v[212:213], v[76:77], v[48:49], v[212:213] op_sel:[0,0,0] op_sel_hi:[1,0,1]
v_pk_fma_f32 v[214:215], v[78:79], v[48:49], v[214:215] op_sel:[0,0,0] op_sel_hi:[1,0,1]
v_pk_mul_f32 v[216:217], v[208:209], v[208:209]
v_pk_mul_f32 v[218:219], v[210:211], v[210:211]
v_pk_mul_f32 v[220:221], v[212:213], v[212:213]
v_pk_mul_f32 v[222:223], v[214:215], v[214:215]
v_pk_fma_f32 v[216:217], v[216:217], v[52:53], v[52:53] op_sel:[0,0,1] op_sel_hi:[1,0,1]
v_pk_fma_f32 v[218:219], v[218:219], v[52:53], v[52:53] op_sel:[0,0,1] op_sel_hi:[1,0,1]
v_pk_fma_f32 v[220:221], v[220:221], v[52:53], v[52:53] op_sel:[0,0,1] op_sel_hi:[1,0,1]
v_pk_fma_f32 v[222:223], v[222:223], v[52:53], v[52:53] op_sel:[0,0,1] op_sel_hi:[1,0,1]
v_pk_mul_f32 v[216:217], v[216:217], v[208:209]
v_pk_mul_f32 v[218:219], v[218:219], v[210:211]
v_pk_mul_f32 v[220:221], v[220:221], v[212:213]
v_pk_mul_f32 v[222:223], v[222:223], v[214:215]
v_exp_f32 v216, v216
v_exp_f32 v217, v217
v_exp_f32 v218, v218
v_exp_f32 v219, v219
v_exp_f32 v220, v220
v_exp_f32 v221, v221
v_exp_f32 v222, v222
v_exp_f32 v223, v223
v_pk_add_f32 v[216:217], v[216:217], 1.0 op_sel_hi:[1,0]
v_pk_add_f32 v[218:219], v[218:219], 1.0 op_sel_hi:[1,0]
v_pk_add_f32 v[220:221], v[220:221], 1.0 op_sel_hi:[1,0]
v_pk_add_f32 v[222:223], v[222:223], 1.0 op_sel_hi:[1,0]
v_rcp_f32 v216, v216
v_rcp_f32 v217, v217
v_rcp_f32 v218, v218
v_rcp_f32 v219, v219
v_rcp_f32 v220, v220
v_rcp_f32 v221, v221
v_rcp_f32 v222, v222
v_rcp_f32 v223, v223
v_pk_mul_f32 v[208:209], v[208:209], v[216:217]
v_pk_mul_f32 v[210:211], v[210:211], v[218:219]
v_pk_mul_f32 v[212:213], v[212:213], v[220:221]
v_pk_mul_f32 v[214:215], v[214:215], v[222:223]
v_cvt_pk_bf16_f32 v96, v208, v209
v_cvt_pk_bf16_f32 v97, v210, v211
v_cvt_pk_bf16_f32 v98, v212, v213
v_cvt_pk_bf16_f32 v99, v214, v215
s_waitcnt lgkmcnt(1)
v_pk_mul_f32 v[208:209], v[200:201], v[48:49] op_sel:[0,1] op_sel_hi:[1,1]
v_pk_mul_f32 v[210:211], v[202:203], v[48:49] op_sel:[0,1] op_sel_hi:[1,1]
s_waitcnt lgkmcnt(0)
v_pk_mul_f32 v[212:213], v[204:205], v[48:49] op_sel:[0,1] op_sel_hi:[1,1]
v_pk_mul_f32 v[214:215], v[206:207], v[48:49] op_sel:[0,1] op_sel_hi:[1,1]
v_pk_fma_f32 v[208:209], v[80:81], v[48:49], v[208:209] op_sel:[0,0,0] op_sel_hi:[1,0,1]
v_pk_fma_f32 v[210:211], v[82:83], v[48:49], v[210:211] op_sel:[0,0,0] op_sel_hi:[1,0,1]
v_pk_fma_f32 v[212:213], v[84:85], v[48:49], v[212:213] op_sel:[0,0,0] op_sel_hi:[1,0,1]
v_pk_fma_f32 v[214:215], v[86:87], v[48:49], v[214:215] op_sel:[0,0,0] op_sel_hi:[1,0,1]
v_pk_mul_f32 v[216:217], v[208:209], v[208:209]
v_pk_mul_f32 v[218:219], v[210:211], v[210:211]
v_pk_mul_f32 v[220:221], v[212:213], v[212:213]
v_pk_mul_f32 v[222:223], v[214:215], v[214:215]
v_pk_fma_f32 v[216:217], v[216:217], v[52:53], v[52:53] op_sel:[0,0,1] op_sel_hi:[1,0,1]
v_pk_fma_f32 v[218:219], v[218:219], v[52:53], v[52:53] op_sel:[0,0,1] op_sel_hi:[1,0,1]
v_pk_fma_f32 v[220:221], v[220:221], v[52:53], v[52:53] op_sel:[0,0,1] op_sel_hi:[1,0,1]
v_pk_fma_f32 v[222:223], v[222:223], v[52:53], v[52:53] op_sel:[0,0,1] op_sel_hi:[1,0,1]
v_pk_mul_f32 v[216:217], v[216:217], v[208:209]
v_pk_mul_f32 v[218:219], v[218:219], v[210:211]
v_pk_mul_f32 v[220:221], v[220:221], v[212:213]
v_pk_mul_f32 v[222:223], v[222:223], v[214:215]
v_exp_f32 v216, v216
v_exp_f32 v217, v217
v_exp_f32 v218, v218
v_exp_f32 v219, v219
v_exp_f32 v220, v220
v_exp_f32 v221, v221
v_exp_f32 v222, v222
v_exp_f32 v223, v223
v_pk_add_f32 v[216:217], v[216:217], 1.0 op_sel_hi:[1,0]
v_pk_add_f32 v[218:219], v[218:219], 1.0 op_sel_hi:[1,0]
v_pk_add_f32 v[220:221], v[220:221], 1.0 op_sel_hi:[1,0]
v_pk_add_f32 v[222:223], v[222:223], 1.0 op_sel_hi:[1,0]
v_rcp_f32 v216, v216
v_rcp_f32 v217, v217
v_rcp_f32 v218, v218
v_rcp_f32 v219, v219
v_rcp_f32 v220, v220
v_rcp_f32 v221, v221
v_rcp_f32 v222, v222
v_rcp_f32 v223, v223
v_pk_mul_f32 v[208:209], v[208:209], v[216:217]
v_pk_mul_f32 v[210:211], v[210:211], v[218:219]
v_pk_mul_f32 v[212:213], v[212:213], v[220:221]
v_pk_mul_f32 v[214:215], v[214:215], v[222:223]
v_cvt_pk_bf16_f32 v100, v208, v209
v_cvt_pk_bf16_f32 v101, v210, v211
v_cvt_pk_bf16_f32 v102, v212, v213
v_cvt_pk_bf16_f32 v103, v214, v215
s_lshl_b32 s53, s54, 10
s_add_u32 s63, s56, s53
buffer_store_dwordx2 v[96:97], v109, s[20:23], s63 offen offset:0 sc1
buffer_store_dwordx2 v[98:99], v109, s[20:23], s63 offen offset:256 sc1
s_cmp_eq_u32 s54, 1
s_cselect_b32 s63, 0x40000000, s63
buffer_store_dwordx2 v[100:101], v109, s[20:23], s63 offen offset:512 sc1
buffer_store_dwordx2 v[102:103], v109, s[20:23], s63 offen offset:768 sc1
s_waitcnt lgkmcnt(0)
L_rd_49:
s_barrier
ds_read_b64_tr_b16 v[224:225], v34 offset:0
ds_read_b64_tr_b16 v[226:227], v34 offset:1024
ds_read_b64_tr_b16 v[228:229], v35 offset:0
ds_read_b64_tr_b16 v[230:231], v35 offset:1024
ds_read_b64_tr_b16 v[232:233], v34 offset:4096
ds_read_b64_tr_b16 v[234:235], v34 offset:5120
ds_read_b64_tr_b16 v[236:237], v35 offset:4096
ds_read_b64_tr_b16 v[238:239], v35 offset:5120
s_waitcnt lgkmcnt(6)
v_mfma_f32_32x32x16_bf16 v[128:143], v[224:227], a[0:3], 0
ds_read_b64_tr_b16 v[240:241], v34 offset:8192
ds_read_b64_tr_b16 v[242:243], v34 offset:9216
s_add_u32 m0, s57, 131072
s_mul_i32 s87, s94, s52
buffer_load_dwordx4 v40, s[12:15], s87 offen lds
v_mfma_f32_32x32x16_bf16 v[160:175], v[224:227], a[4:7], 0
ds_read_b64_tr_b16 v[244:245], v35 offset:8192
ds_read_b64_tr_b16 v[246:247], v35 offset:9216
buffer_load_dwordx4 v41, s[12:15], s87 offen offset:1024 lds
s_waitcnt lgkmcnt(8)
v_mfma_f32_32x32x16_bf16 v[144:159], v[228:231], a[0:3], 0
ds_read_b64_tr_b16 v[248:249], v34 offset:12288
ds_read_b64_tr_b16 v[250:251], v34 offset:13312
buffer_load_dwordx4 v42, s[12:15], s87 offen offset:2048 lds
v_mfma_f32_32x32x16_bf16 v[176:191], v[228:231], a[4:7], 0
ds_read_b64_tr_b16 v[252:253], v35 offset:12288
ds_read_b64_tr_b16 v[254:255], v35 offset:13312
buffer_load_dwordx4 v43, s[12:15], s87 offen offset:3072 lds
v_mfma_f32_16x16x32_bf16 v[44:47], v[36:39], v[224:227], 0
s_add_u32 s94, s94, 128
s_waitcnt lgkmcnt(10)
v_mfma_f32_32x32x16_bf16 v[128:143], v[232:235], a[8:11], v[128:143]
s_and_b32 s94, s94, 1023
s_add_u32 m0, s57, 0
s_mul_i32 s87, s94, s52
buffer_load_dwordx4 v40, s[12:15], s87 offen lds
v_mfma_f32_32x32x16_bf16 v[160:175], v[232:235], a[12:15], v[160:175]
buffer_load_dwordx4 v41, s[12:15], s87 offen offset:1024 lds
s_waitcnt lgkmcnt(8)
v_mfma_f32_32x32x16_bf16 v[144:159], v[236:239], a[8:11], v[144:159]
buffer_load_dwordx4 v42, s[12:15], s87 offen offset:2048 lds
buffer_load_dwordx4 v43, s[12:15], s87 offen offset:3072 lds
v_mfma_f32_32x32x16_bf16 v[176:191], v[236:239], a[12:15], v[176:191]
s_add_u32 s94, s94, 128
s_and_b32 s94, s94, 1023
s_add_u32 m0, s57, 16384
s_mul_i32 s87, s94, s52
v_mfma_f32_16x16x32_bf16 v[44:47], v[36:39], v[232:235], v[44:47]
buffer_load_dwordx4 v40, s[12:15], s87 offen lds
s_waitcnt vmcnt(17)
s_waitcnt lgkmcnt(0)
s_barrier
v_mfma_f32_32x32x16_bf16 v[128:143], v[240:243], a[16:19], v[128:143]
ds_read_b64_tr_b16 v[224:225], v34 offset:16384
buffer_load_dwordx4 v41, s[12:15], s87 offen offset:1024 lds
v_mfma_f32_32x32x16_bf16 v[160:175], v[240:243], a[20:23], v[160:175]
ds_read_b64_tr_b16 v[226:227], v34 offset:17408
buffer_load_dwordx4 v42, s[12:15], s87 offen offset:2048 lds
v_mfma_f32_32x32x16_bf16 v[144:159], v[244:247], a[16:19], v[144:159]
ds_read_b64_tr_b16 v[228:229], v35 offset:16384
buffer_load_dwordx4 v43, s[12:15], s87 offen offset:3072 lds
s_add_u32 s94, s94, 128
s_and_b32 s94, s94, 1023
v_mfma_f32_32x32x16_bf16 v[176:191], v[244:247], a[20:23], v[176:191]
ds_read_b64_tr_b16 v[230:231], v35 offset:17408
s_add_u32 m0, s57, 32768
s_mul_i32 s87, s94, s52
buffer_load_dwordx4 v40, s[12:15], s87 offen lds
v_mfma_f32_16x16x32_bf16 v[44:47], v[36:39], v[240:243], v[44:47]
v_mfma_f32_32x32x16_bf16 v[128:143], v[248:251], a[24:27], v[128:143]
ds_read_b64_tr_b16 v[232:233], v34 offset:20480
buffer_load_dwordx4 v41, s[12:15], s87 offen offset:1024 lds
v_mfma_f32_32x32x16_bf16 v[160:175], v[248:251], a[28:31], v[160:175]
ds_read_b64_tr_b16 v[234:235], v34 offset:21504
buffer_load_dwordx4 v42, s[12:15], s87 offen offset:2048 lds
v_mfma_f32_32x32x16_bf16 v[144:159], v[252:255], a[24:27], v[144:159]
ds_read_b64_tr_b16 v[236:237], v35 offset:20480
buffer_load_dwordx4 v43, s[12:15], s87 offen offset:3072 lds
s_add_u32 s94, s94, 128
s_and_b32 s94, s94, 1023
v_mfma_f32_32x32x16_bf16 v[176:191], v[252:255], a[28:31], v[176:191]
ds_read_b64_tr_b16 v[238:239], v35 offset:21504
s_add_u32 m0, s57, 49152
s_mul_i32 s87, s94, s52
buffer_load_dwordx4 v40, s[12:15], s87 offen lds
v_mfma_f32_16x16x32_bf16 v[44:47], v[36:39], v[248:251], v[44:47]
s_waitcnt lgkmcnt(6)
v_mfma_f32_32x32x16_bf16 v[128:143], v[224:227], a[32:35], v[128:143]
ds_read_b64_tr_b16 v[240:241], v34 offset:24576
ds_read_b64_tr_b16 v[242:243], v34 offset:25600
buffer_load_dwordx4 v41, s[12:15], s87 offen offset:1024 lds
v_mfma_f32_32x32x16_bf16 v[160:175], v[224:227], a[36:39], v[160:175]
ds_read_b64_tr_b16 v[244:245], v35 offset:24576
ds_read_b64_tr_b16 v[246:247], v35 offset:25600
buffer_load_dwordx4 v42, s[12:15], s87 offen offset:2048 lds
s_waitcnt lgkmcnt(8)
v_mfma_f32_32x32x16_bf16 v[144:159], v[228:231], a[32:35], v[144:159]
ds_read_b64_tr_b16 v[248:249], v34 offset:28672
ds_read_b64_tr_b16 v[250:251], v34 offset:29696
buffer_load_dwordx4 v43, s[12:15], s87 offen offset:3072 lds
s_add_u32 s94, s94, 128
v_mfma_f32_32x32x16_bf16 v[176:191], v[228:231], a[36:39], v[176:191]
ds_read_b64_tr_b16 v[252:253], v35 offset:28672
ds_read_b64_tr_b16 v[254:255], v35 offset:29696
s_and_b32 s94, s94, 1023
v_mfma_f32_16x16x32_bf16 v[44:47], v[36:39], v[224:227], v[44:47]
s_waitcnt lgkmcnt(10)
v_mfma_f32_32x32x16_bf16 v[128:143], v[232:235], a[40:43], v[128:143]
v_mfma_f32_32x32x16_bf16 v[160:175], v[232:235], a[44:47], v[160:175]
s_waitcnt lgkmcnt(8)
v_mfma_f32_32x32x16_bf16 v[144:159], v[236:239], a[40:43], v[144:159]
v_mfma_f32_32x32x16_bf16 v[176:191], v[236:239], a[44:47], v[176:191]
v_mfma_f32_16x16x32_bf16 v[44:47], v[36:39], v[232:235], v[44:47]
s_waitcnt vmcnt(16)
s_waitcnt lgkmcnt(0)
s_barrier
v_mfma_f32_32x32x16_bf16 v[128:143], v[240:243], a[48:51], v[128:143]
ds_read_b64_tr_b16 v[224:225], v34 offset:32768
s_add_u32 m0, s59, 98304
s_add_u32 s87, s61, s64
buffer_load_dwordx4 v20, s[16:19], s87 offen lds
v_mfma_f32_32x32x16_bf16 v[160:175], v[240:243], a[52:55], v[160:175]
ds_read_b64_tr_b16 v[226:227], v34 offset:33792
buffer_load_dwordx4 v21, s[16:19], s87 offen offset:1024 lds
s_add_u32 m0, m0, 2048
v_mfma_f32_32x32x16_bf16 v[144:159], v[244:247], a[48:51], v[144:159]
ds_read_b64_tr_b16 v[228:229], v35 offset:32768
s_nop 0
buffer_load_dwordx4 v22, s[16:19], s87 offen lds
v_mfma_f32_32x32x16_bf16 v[176:191], v[244:247], a[52:55], v[176:191]
ds_read_b64_tr_b16 v[230:231], v35 offset:33792
buffer_load_dwordx4 v23, s[16:19], s87 offen offset:1024 lds
s_add_u32 m0, s59, 102400
v_mfma_f32_16x16x32_bf16 v[44:47], v[36:39], v[240:243], v[44:47]
s_add_u32 s87, s61, s65
v_mfma_f32_32x32x16_bf16 v[128:143], v[248:251], a[56:59], v[128:143]
ds_read_b64_tr_b16 v[232:233], v34 offset:36864
buffer_load_dwordx4 v20, s[16:19], s87 offen lds
v_mfma_f32_32x32x16_bf16 v[160:175], v[248:251], a[60:63], v[160:175]
ds_read_b64_tr_b16 v[234:235], v34 offset:37888
buffer_load_dwordx4 v21, s[16:19], s87 offen offset:1024 lds
s_add_u32 m0, m0, 2048
s_nop 0
v_mfma_f32_32x32x16_bf16 v[144:159], v[252:255], a[56:59], v[144:159]
ds_read_b64_tr_b16 v[236:237], v35 offset:36864
buffer_load_dwordx4 v22, s[16:19], s87 offen lds
v_mfma_f32_32x32x16_bf16 v[176:191], v[252:255], a[60:63], v[176:191]
ds_read_b64_tr_b16 v[238:239], v35 offset:37888
buffer_load_dwordx4 v23, s[16:19], s87 offen offset:1024 lds
s_add_u32 s61, s61, 128
s_and_b32 s61, s61, 1023
v_mfma_f32_16x16x32_bf16 v[44:47], v[36:39], v[248:251], v[44:47]
s_waitcnt lgkmcnt(6)
v_mfma_f32_32x32x16_bf16 v[128:143], v[224:227], a[64:67], v[128:143]
ds_read_b64_tr_b16 v[240:241], v34 offset:40960
ds_read_b64_tr_b16 v[242:243], v34 offset:41984
ds_read_b128 a[0:3], v124 offset:0
ds_read_b128 a[4:7], v124 offset:2048
ds_read_b128 a[8:11], v124 offset:4096
v_mfma_f32_32x32x16_bf16 v[160:175], v[224:227], a[68:71], v[160:175]
ds_read_b64_tr_b16 v[244:245], v35 offset:40960
ds_read_b64_tr_b16 v[246:247], v35 offset:41984
ds_read_b128 a[12:15], v124 offset:6144
ds_read_b128 a[16:19], v125 offset:0
ds_read_b128 a[20:23], v125 offset:2048
s_waitcnt lgkmcnt(14)
v_mfma_f32_32x32x16_bf16 v[144:159], v[228:231], a[64:67], v[144:159]
ds_read_b64_tr_b16 v[248:249], v34 offset:45056
ds_read_b64_tr_b16 v[250:251], v34 offset:46080
ds_read_b128 a[24:27], v125 offset:4096
ds_read_b128 a[28:31], v125 offset:6144
s_waitcnt lgkmcnt(0)
v_mfma_f32_32x32x16_bf16 v[176:191], v[228:231], a[68:71], v[176:191]
ds_read_b64_tr_b16 v[252:253], v35 offset:45056
ds_read_b64_tr_b16 v[254:255], v35 offset:46080
s_add_u32 m0, s59, 65536
s_add_u32 s87, s61, s64
v_mfma_f32_16x16x32_bf16 v[44:47], v[36:39], v[224:227], v[44:47]
buffer_load_dwordx4 v20, s[16:19], s87 offen lds
v_mfma_f32_32x32x16_bf16 v[128:143], v[232:235], a[72:75], v[128:143]
buffer_load_dwordx4 v21, s[16:19], s87 offen offset:1024 lds
v_mfma_f32_32x32x16_bf16 v[160:175], v[232:235], a[76:79], v[160:175]
s_add_u32 m0, m0, 2048
s_nop 0
buffer_load_dwordx4 v22, s[16:19], s87 offen lds
v_mfma_f32_32x32x16_bf16 v[144:159], v[236:239], a[72:75], v[144:159]
buffer_load_dwordx4 v23, s[16:19], s87 offen offset:1024 lds
s_add_u32 m0, s59, 69632
s_add_u32 s87, s61, s65
v_mfma_f32_32x32x16_bf16 v[176:191], v[236:239], a[76:79], v[176:191]
buffer_load_dwordx4 v20, s[16:19], s87 offen lds
buffer_load_dwordx4 v21, s[16:19], s87 offen offset:1024 lds
v_mfma_f32_16x16x32_bf16 v[44:47], v[36:39], v[232:235], v[44:47]
s_waitcnt vmcnt(26)
s_waitcnt lgkmcnt(0)
s_barrier
v_mfma_f32_32x32x16_bf16 v[128:143], v[240:243], a[80:83], v[128:143]
ds_read_b64_tr_b16 v[224:225], v110 offset:0
s_add_u32 m0, m0, 2048
s_nop 0
buffer_load_dwordx4 v22, s[16:19], s87 offen lds
v_mfma_f32_32x32x16_bf16 v[160:175], v[240:243], a[84:87], v[160:175]
ds_read_b64_tr_b16 v[226:227], v110 offset:1024
buffer_load_dwordx4 v23, s[16:19], s87 offen offset:1024 lds
s_add_u32 s61, s61, 128
v_mfma_f32_32x32x16_bf16 v[144:159], v[244:247], a[80:83], v[144:159]
ds_read_b64_tr_b16 v[228:229], v111 offset:0
s_and_b32 s61, s61, 1023
s_add_u32 m0, s57, 131072
s_mul_i32 s87, s94, s52
v_mfma_f32_32x32x16_bf16 v[176:191], v[244:247], a[84:87], v[176:191]
ds_read_b64_tr_b16 v[230:231], v111 offset:1024
buffer_load_dwordx4 v40, s[12:15], s87 offen lds
v_mfma_f32_16x16x32_bf16 v[44:47], v[36:39], v[240:243], v[44:47]
buffer_load_dwordx4 v41, s[12:15], s87 offen offset:1024 lds
v_mfma_f32_32x32x16_bf16 v[128:143], v[248:251], a[88:91], v[128:143]
ds_read_b64_tr_b16 v[232:233], v110 offset:4096
buffer_load_dwordx4 v42, s[12:15], s87 offen offset:2048 lds
v_mfma_f32_32x32x16_bf16 v[160:175], v[248:251], a[92:95], v[160:175]
ds_read_b64_tr_b16 v[234:235], v110 offset:5120
buffer_load_dwordx4 v43, s[12:15], s87 offen offset:3072 lds
s_add_u32 s94, s94, 128
v_mfma_f32_32x32x16_bf16 v[144:159], v[252:255], a[88:91], v[144:159]
ds_read_b64_tr_b16 v[236:237], v111 offset:4096
s_and_b32 s94, s94, 1023
v_mfma_f32_32x32x16_bf16 v[176:191], v[252:255], a[92:95], v[176:191]
ds_read_b64_tr_b16 v[238:239], v111 offset:5120
v_mfma_f32_16x16x32_bf16 v[44:47], v[36:39], v[248:251], v[44:47]
s_waitcnt lgkmcnt(6)
v_mfma_f32_32x32x16_bf16 v[128:143], v[224:227], a[96:99], v[128:143]
ds_read_b64_tr_b16 v[240:241], v110 offset:8192
ds_read_b64_tr_b16 v[242:243], v110 offset:9216
v_mfma_f32_32x32x16_bf16 v[160:175], v[224:227], a[100:103], v[160:175]
ds_read_b64_tr_b16 v[244:245], v111 offset:8192
ds_read_b64_tr_b16 v[246:247], v111 offset:9216
s_waitcnt lgkmcnt(8)
v_mfma_f32_32x32x16_bf16 v[144:159], v[228:231], a[96:99], v[144:159]
ds_read_b64_tr_b16 v[248:249], v110 offset:12288
ds_read_b64_tr_b16 v[250:251], v110 offset:13312
v_mfma_f32_32x32x16_bf16 v[176:191], v[228:231], a[100:103], v[176:191]
ds_read_b64_tr_b16 v[252:253], v111 offset:12288
ds_read_b64_tr_b16 v[254:255], v111 offset:13312
v_mfma_f32_16x16x32_bf16 v[44:47], v[36:39], v[224:227], v[44:47]
s_waitcnt lgkmcnt(10)
v_mfma_f32_32x32x16_bf16 v[128:143], v[232:235], a[104:107], v[128:143]
v_mfma_f32_32x32x16_bf16 v[160:175], v[232:235], a[108:111], v[160:175]
s_waitcnt lgkmcnt(8)
v_mfma_f32_32x32x16_bf16 v[144:159], v[236:239], a[104:107], v[144:159]
v_mfma_f32_32x32x16_bf16 v[176:191], v[236:239], a[108:111], v[176:191]
v_mfma_f32_16x16x32_bf16 v[44:47], v[36:39], v[232:235], v[44:47]
s_waitcnt vmcnt(28)
s_waitcnt lgkmcnt(0)
s_barrier
v_mfma_f32_32x32x16_bf16 v[128:143], v[240:243], a[112:115], v[128:143]
ds_read_b64_tr_b16 v[224:225], v110 offset:16384
v_mfma_f32_32x32x16_bf16 v[160:175], v[240:243], a[116:119], v[160:175]
ds_read_b64_tr_b16 v[226:227], v110 offset:17408
v_mfma_f32_32x32x16_bf16 v[144:159], v[244:247], a[112:115], v[144:159]
ds_read_b64_tr_b16 v[228:229], v111 offset:16384
v_mfma_f32_32x32x16_bf16 v[176:191], v[244:247], a[116:119], v[176:191]
ds_read_b64_tr_b16 v[230:231], v111 offset:17408
v_mfma_f32_16x16x32_bf16 v[44:47], v[36:39], v[240:243], v[44:47]
v_mfma_f32_32x32x16_bf16 v[128:143], v[248:251], a[120:123], v[128:143]
ds_read_b64_tr_b16 v[232:233], v110 offset:20480
v_mfma_f32_32x32x16_bf16 v[160:175], v[248:251], a[124:127], v[160:175]
ds_read_b64_tr_b16 v[234:235], v110 offset:21504
v_mfma_f32_32x32x16_bf16 v[144:159], v[252:255], a[120:123], v[144:159]
ds_read_b64_tr_b16 v[236:237], v111 offset:20480
v_mfma_f32_32x32x16_bf16 v[176:191], v[252:255], a[124:127], v[176:191]
ds_read_b64_tr_b16 v[238:239], v111 offset:21504
v_mfma_f32_16x16x32_bf16 v[44:47], v[36:39], v[248:251], v[44:47]
s_waitcnt lgkmcnt(6)
v_mfma_f32_32x32x16_bf16 v[128:143], v[224:227], a[128:131], v[128:143]
ds_read_b64_tr_b16 v[240:241], v110 offset:24576
ds_read_b64_tr_b16 v[242:243], v110 offset:25600
v_mfma_f32_32x32x16_bf16 v[160:175], v[224:227], a[132:135], v[160:175]
ds_read_b64_tr_b16 v[244:245], v111 offset:24576
ds_read_b64_tr_b16 v[246:247], v111 offset:25600
s_waitcnt lgkmcnt(8)
v_mfma_f32_32x32x16_bf16 v[144:159], v[228:231], a[128:131], v[144:159]
ds_read_b64_tr_b16 v[248:249], v110 offset:28672
ds_read_b64_tr_b16 v[250:251], v110 offset:29696
v_mfma_f32_32x32x16_bf16 v[176:191], v[228:231], a[132:135], v[176:191]
ds_read_b64_tr_b16 v[252:253], v111 offset:28672
ds_read_b64_tr_b16 v[254:255], v111 offset:29696
v_mfma_f32_16x16x32_bf16 v[44:47], v[36:39], v[224:227], v[44:47]
s_waitcnt lgkmcnt(10)
v_mfma_f32_32x32x16_bf16 v[128:143], v[232:235], a[136:139], v[128:143]
v_mfma_f32_32x32x16_bf16 v[160:175], v[232:235], a[140:143], v[160:175]
s_waitcnt lgkmcnt(8)
v_mfma_f32_32x32x16_bf16 v[144:159], v[236:239], a[136:139], v[144:159]
v_mfma_f32_32x32x16_bf16 v[176:191], v[236:239], a[140:143], v[176:191]
v_mfma_f32_16x16x32_bf16 v[44:47], v[36:39], v[232:235], v[44:47]
s_waitcnt vmcnt(24)
s_waitcnt lgkmcnt(0)
s_barrier
v_mfma_f32_32x32x16_bf16 v[128:143], v[240:243], a[144:147], v[128:143]
ds_read_b64_tr_b16 v[224:225], v110 offset:32768
v_mfma_f32_32x32x16_bf16 v[160:175], v[240:243], a[148:151], v[160:175]
ds_read_b64_tr_b16 v[226:227], v110 offset:33792
v_mfma_f32_32x32x16_bf16 v[144:159], v[244:247], a[144:147], v[144:159]
ds_read_b64_tr_b16 v[228:229], v111 offset:32768
v_mfma_f32_32x32x16_bf16 v[176:191], v[244:247], a[148:151], v[176:191]
ds_read_b64_tr_b16 v[230:231], v111 offset:33792
v_mfma_f32_16x16x32_bf16 v[44:47], v[36:39], v[240:243], v[44:47]
v_mfma_f32_32x32x16_bf16 v[128:143], v[248:251], a[152:155], v[128:143]
ds_read_b64_tr_b16 v[232:233], v110 offset:36864
v_mfma_f32_32x32x16_bf16 v[160:175], v[248:251], a[156:159], v[160:175]
ds_read_b64_tr_b16 v[234:235], v110 offset:37888
v_mfma_f32_32x32x16_bf16 v[144:159], v[252:255], a[152:155], v[144:159]
ds_read_b64_tr_b16 v[236:237], v111 offset:36864
v_mfma_f32_32x32x16_bf16 v[176:191], v[252:255], a[156:159], v[176:191]
ds_read_b64_tr_b16 v[238:239], v111 offset:37888
v_mfma_f32_16x16x32_bf16 v[44:47], v[36:39], v[248:251], v[44:47]
s_waitcnt lgkmcnt(6)
v_mfma_f32_32x32x16_bf16 v[128:143], v[224:227], a[160:163], v[128:143]
ds_read_b64_tr_b16 v[240:241], v110 offset:40960
ds_read_b64_tr_b16 v[242:243], v110 offset:41984
v_mfma_f32_32x32x16_bf16 v[160:175], v[224:227], a[164:167], v[160:175]
ds_read_b64_tr_b16 v[244:245], v111 offset:40960
ds_read_b64_tr_b16 v[246:247], v111 offset:41984
s_waitcnt lgkmcnt(8)
v_mfma_f32_32x32x16_bf16 v[144:159], v[228:231], a[160:163], v[144:159]
ds_read_b64_tr_b16 v[248:249], v110 offset:45056
ds_read_b64_tr_b16 v[250:251], v110 offset:46080
v_mfma_f32_32x32x16_bf16 v[176:191], v[228:231], a[164:167], v[176:191]
ds_read_b64_tr_b16 v[252:253], v111 offset:45056
ds_read_b64_tr_b16 v[254:255], v111 offset:46080
v_mfma_f32_16x16x32_bf16 v[44:47], v[36:39], v[224:227], v[44:47]
s_waitcnt lgkmcnt(10)
v_mfma_f32_32x32x16_bf16 v[128:143], v[232:235], a[168:171], v[128:143]
v_mfma_f32_32x32x16_bf16 v[160:175], v[232:235], a[172:175], v[160:175]
s_waitcnt lgkmcnt(8)
v_mfma_f32_32x32x16_bf16 v[144:159], v[236:239], a[168:171], v[144:159]
v_mfma_f32_32x32x16_bf16 v[176:191], v[236:239], a[172:175], v[176:191]
v_mfma_f32_16x16x32_bf16 v[44:47], v[36:39], v[232:235], v[44:47]
s_waitcnt vmcnt(20)
s_waitcnt lgkmcnt(0)
s_barrier
v_mfma_f32_32x32x16_bf16 v[128:143], v[240:243], a[176:179], v[128:143]
ds_read_b64_tr_b16 v[224:225], v110 offset:49152
s_waitcnt vmcnt(12)
ds_read_b128 a[32:35], v124 offset:32768
ds_read_b128 a[36:39], v124 offset:34816
ds_read_b128 a[40:43], v124 offset:36864
v_mfma_f32_32x32x16_bf16 v[160:175], v[240:243], a[180:183], v[160:175]
ds_read_b64_tr_b16 v[226:227], v110 offset:50176
ds_read_b128 a[44:47], v124 offset:38912
ds_read_b128 a[48:51], v125 offset:32768
ds_read_b128 a[52:55], v125 offset:34816
ds_read_b128 a[56:59], v125 offset:36864
v_mfma_f32_32x32x16_bf16 v[144:159], v[244:247], a[176:179], v[144:159]
ds_read_b64_tr_b16 v[228:229], v111 offset:49152
ds_read_b128 a[60:63], v125 offset:38912
s_waitcnt lgkmcnt(0)
s_add_u32 m0, s59, 98304
s_add_u32 s87, s61, s64
v_mfma_f32_32x32x16_bf16 v[176:191], v[244:247], a[180:183], v[176:191]
ds_read_b64_tr_b16 v[230:231], v111 offset:50176
buffer_load_dwordx4 v20, s[16:19], s87 offen lds
v_mfma_f32_16x16x32_bf16 v[44:47], v[36:39], v[240:243], v[44:47]
buffer_load_dwordx4 v21, s[16:19], s87 offen offset:1024 lds
v_mfma_f32_32x32x16_bf16 v[128:143], v[248:251], a[184:187], v[128:143]
ds_read_b64_tr_b16 v[232:233], v110 offset:53248
s_add_u32 m0, m0, 2048
s_nop 0
v_mfma_f32_32x32x16_bf16 v[160:175], v[248:251], a[188:191], v[160:175]
ds_read_b64_tr_b16 v[234:235], v110 offset:54272
buffer_load_dwordx4 v22, s[16:19], s87 offen lds
v_mfma_f32_32x32x16_bf16 v[144:159], v[252:255], a[184:187], v[144:159]
ds_read_b64_tr_b16 v[236:237], v111 offset:53248
buffer_load_dwordx4 v23, s[16:19], s87 offen offset:1024 lds
s_add_u32 m0, s59, 102400
s_add_u32 s87, s61, s65
v_mfma_f32_32x32x16_bf16 v[176:191], v[252:255], a[188:191], v[176:191]
ds_read_b64_tr_b16 v[238:239], v111 offset:54272
buffer_load_dwordx4 v20, s[16:19], s87 offen lds
v_mfma_f32_16x16x32_bf16 v[44:47], v[36:39], v[248:251], v[44:47]
buffer_load_dwordx4 v21, s[16:19], s87 offen offset:1024 lds
v_mfma_f32_32x32x16_bf16 v[128:143], v[224:227], a[192:195], v[128:143]
ds_read_b64_tr_b16 v[240:241], v110 offset:57344
ds_read_b64_tr_b16 v[242:243], v110 offset:58368
s_add_u32 m0, m0, 2048
s_nop 0
v_mfma_f32_32x32x16_bf16 v[160:175], v[224:227], a[196:199], v[160:175]
ds_read_b64_tr_b16 v[244:245], v111 offset:57344
ds_read_b64_tr_b16 v[246:247], v111 offset:58368
buffer_load_dwordx4 v22, s[16:19], s87 offen lds
s_waitcnt lgkmcnt(8)
v_mfma_f32_32x32x16_bf16 v[144:159], v[228:231], a[192:195], v[144:159]
ds_read_b64_tr_b16 v[248:249], v110 offset:61440
ds_read_b64_tr_b16 v[250:251], v110 offset:62464
buffer_load_dwordx4 v23, s[16:19], s87 offen offset:1024 lds
s_add_u32 s61, s61, 128
v_mfma_f32_32x32x16_bf16 v[176:191], v[228:231], a[196:199], v[176:191]
ds_read_b64_tr_b16 v[252:253], v111 offset:61440
ds_read_b64_tr_b16 v[254:255], v111 offset:62464
s_and_b32 s61, s61, 1023
v_mfma_f32_16x16x32_bf16 v[44:47], v[36:39], v[224:227], v[44:47]
s_waitcnt lgkmcnt(10)
v_mfma_f32_32x32x16_bf16 v[128:143], v[232:235], a[200:203], v[128:143]
s_waitcnt vmcnt(12)
ds_read_b128 a[64:67], v124 offset:0
ds_read_b128 a[68:71], v124 offset:2048
ds_read_b128 a[72:75], v124 offset:4096
ds_read_b128 a[76:79], v124 offset:6144
v_mfma_f32_32x32x16_bf16 v[160:175], v[232:235], a[204:207], v[160:175]
ds_read_b128 a[80:83], v125 offset:0
ds_read_b128 a[84:87], v125 offset:2048
ds_read_b128 a[88:91], v125 offset:4096
ds_read_b128 a[92:95], v125 offset:6144
s_waitcnt lgkmcnt(15)
v_mfma_f32_32x32x16_bf16 v[144:159], v[236:239], a[200:203], v[144:159]
s_waitcnt lgkmcnt(0)
s_add_u32 m0, s59, 65536
s_add_u32 s87, s61, s64
buffer_load_dwordx4 v20, s[16:19], s87 offen lds
v_mfma_f32_32x32x16_bf16 v[176:191], v[236:239], a[204:207], v[176:191]
buffer_load_dwordx4 v21, s[16:19], s87 offen offset:1024 lds
s_add_u32 m0, m0, 2048
s_nop 0
v_mfma_f32_16x16x32_bf16 v[44:47], v[36:39], v[232:235], v[44:47]
buffer_load_dwordx4 v22, s[16:19], s87 offen lds
s_waitcnt vmcnt(11)
s_waitcnt lgkmcnt(0)
s_barrier
v_mfma_f32_32x32x16_bf16 v[128:143], v[240:243], a[208:211], v[128:143]
ds_read_b64_tr_b16 v[224:225], v34 offset:32768
buffer_load_dwordx4 v23, s[16:19], s87 offen offset:1024 lds
v_mfma_f32_32x32x16_bf16 v[160:175], v[240:243], a[212:215], v[160:175]
ds_read_b64_tr_b16 v[226:227], v34 offset:33792
s_add_u32 m0, s59, 69632
s_add_u32 s87, s61, s65
v_mfma_f32_32x32x16_bf16 v[144:159], v[244:247], a[208:211], v[144:159]
ds_read_b64_tr_b16 v[228:229], v35 offset:32768
buffer_load_dwordx4 v20, s[16:19], s87 offen lds
v_mfma_f32_32x32x16_bf16 v[176:191], v[244:247], a[212:215], v[176:191]
ds_read_b64_tr_b16 v[230:231], v35 offset:33792
buffer_load_dwordx4 v21, s[16:19], s87 offen offset:1024 lds
s_add_u32 m0, m0, 2048
s_nop 0
v_mfma_f32_16x16x32_bf16 v[44:47], v[36:39], v[240:243], v[44:47]
buffer_load_dwordx4 v22, s[16:19], s87 offen lds
v_mfma_f32_32x32x16_bf16 v[128:143], v[248:251], a[216:219], v[128:143]
ds_read_b64_tr_b16 v[232:233], v34 offset:36864
buffer_load_dwordx4 v23, s[16:19], s87 offen offset:1024 lds
v_mfma_f32_32x32x16_bf16 v[160:175], v[248:251], a[220:223], v[160:175]
ds_read_b64_tr_b16 v[234:235], v34 offset:37888
s_add_u32 s61, s61, 128
s_and_b32 s61, s61, 1023
v_mfma_f32_32x32x16_bf16 v[144:159], v[252:255], a[216:219], v[144:159]
ds_read_b64_tr_b16 v[236:237], v35 offset:36864
v_mfma_f32_32x32x16_bf16 v[176:191], v[252:255], a[220:223], v[176:191]
ds_read_b64_tr_b16 v[238:239], v35 offset:37888
v_mfma_f32_16x16x32_bf16 v[44:47], v[36:39], v[248:251], v[44:47]
s_waitcnt lgkmcnt(6)
v_mfma_f32_32x32x16_bf16 v[128:143], v[224:227], a[224:227], v[128:143]
ds_read_b64_tr_b16 v[240:241], v34 offset:40960
ds_read_b64_tr_b16 v[242:243], v34 offset:41984
s_waitcnt vmcnt(8)
ds_read_b128 a[96:99], v124 offset:32768
ds_read_b128 a[100:103], v124 offset:34816
ds_read_b128 a[104:107], v124 offset:36864
v_mfma_f32_32x32x16_bf16 v[160:175], v[224:227], a[228:231], v[160:175]
ds_read_b64_tr_b16 v[244:245], v35 offset:40960
ds_read_b64_tr_b16 v[246:247], v35 offset:41984
ds_read_b128 a[108:111], v124 offset:38912
ds_read_b128 a[112:115], v125 offset:32768
ds_read_b128 a[116:119], v125 offset:34816
s_waitcnt lgkmcnt(14)
v_mfma_f32_32x32x16_bf16 v[144:159], v[228:231], a[224:227], v[144:159]
ds_read_b64_tr_b16 v[248:249], v34 offset:45056
ds_read_b64_tr_b16 v[250:251], v34 offset:46080
ds_read_b128 a[120:123], v125 offset:36864
ds_read_b128 a[124:127], v125 offset:38912
s_add_u32 m0, s59, 0
v_mfma_f32_32x32x16_bf16 v[176:191], v[228:231], a[228:231], v[176:191]
ds_read_b64_tr_b16 v[252:253], v35 offset:45056
ds_read_b64_tr_b16 v[254:255], v35 offset:46080
s_add_u32 s87, s61, s64
buffer_load_dwordx4 v20, s[16:19], s87 offen lds
v_mfma_f32_16x16x32_bf16 v[44:47], v[36:39], v[224:227], v[44:47]
s_waitcnt lgkmcnt(15)
v_mfma_f32_32x32x16_bf16 v[128:143], v[232:235], a[232:235], v[128:143]
buffer_load_dwordx4 v21, s[16:19], s87 offen offset:1024 lds
s_add_u32 m0, m0, 2048
s_nop 0
v_mfma_f32_32x32x16_bf16 v[160:175], v[232:235], a[236:239], v[160:175]
buffer_load_dwordx4 v22, s[16:19], s87 offen lds
buffer_load_dwordx4 v23, s[16:19], s87 offen offset:1024 lds
s_waitcnt lgkmcnt(15)
v_mfma_f32_32x32x16_bf16 v[144:159], v[236:239], a[232:235], v[144:159]
s_add_u32 m0, s59, 4096
s_add_u32 s87, s61, s65
buffer_load_dwordx4 v20, s[16:19], s87 offen lds
v_mfma_f32_32x32x16_bf16 v[176:191], v[236:239], a[236:239], v[176:191]
buffer_load_dwordx4 v21, s[16:19], s87 offen offset:1024 lds
s_add_u32 m0, m0, 2048
v_mfma_f32_16x16x32_bf16 v[44:47], v[36:39], v[232:235], v[44:47]
s_nop 0
s_waitcnt lgkmcnt(14)
v_mfma_f32_32x32x16_bf16 v[128:143], v[240:243], a[240:243], v[128:143]
buffer_load_dwordx4 v22, s[16:19], s87 offen lds
buffer_load_dwordx4 v23, s[16:19], s87 offen offset:1024 lds
v_mfma_f32_32x32x16_bf16 v[160:175], v[240:243], a[244:247], v[160:175]
s_add_u32 s61, s61, 128
s_and_b32 s61, s61, 1023
s_waitcnt lgkmcnt(9)
v_mfma_f32_32x32x16_bf16 v[144:159], v[244:247], a[240:243], v[144:159]
v_mfma_f32_32x32x16_bf16 v[176:191], v[244:247], a[244:247], v[176:191]
v_mfma_f32_16x16x32_bf16 v[44:47], v[36:39], v[240:243], v[44:47]
s_waitcnt lgkmcnt(4)
v_mfma_f32_32x32x16_bf16 v[128:143], v[248:251], a[248:251], v[128:143]
s_waitcnt vmcnt(8)
ds_read_b128 a[128:131], v124 offset:0
ds_read_b128 a[132:135], v124 offset:2048
ds_read_b128 a[136:139], v124 offset:4096
ds_read_b128 a[140:143], v124 offset:6144
v_mfma_f32_32x32x16_bf16 v[160:175], v[248:251], a[252:255], v[160:175]
ds_read_b128 a[144:147], v125 offset:0
ds_read_b128 a[148:151], v125 offset:2048
ds_read_b128 a[152:155], v125 offset:4096
ds_read_b128 a[156:159], v125 offset:6144
s_waitcnt lgkmcnt(8)
v_mfma_f32_32x32x16_bf16 v[144:159], v[252:255], a[248:251], v[144:159]
s_add_u32 m0, s59, 32768
s_add_u32 s87, s61, s64
buffer_load_dwordx4 v20, s[16:19], s87 offen lds
v_mfma_f32_32x32x16_bf16 v[176:191], v[252:255], a[252:255], v[176:191]
buffer_load_dwordx4 v21, s[16:19], s87 offen offset:1024 lds
s_add_u32 m0, m0, 2048
s_nop 0
v_mfma_f32_16x16x32_bf16 v[44:47], v[36:39], v[248:251], v[44:47]
buffer_load_dwordx4 v22, s[16:19], s87 offen lds
s_nop 6
v_cndmask_b32 v7, v44, v45, s[66:67]
s_lshl_b32 s53, s44, 7
v_add_u32 v6, s53, v54
ds_write_b32 v6, v7 offset:1280
s_add_u32 s54, s88, 0
s_lshl_b32 s54, s54, 12
v_add_u32 v33, s54, v32
s_add_u32 s54, s88, 1
s_lshl_b32 s54, s54, 12
v_add_u32 v47, s54, v32
s_add_u32 s54, s88, 2
s_lshl_b32 s54, s54, 12
s_cmp_eq_u32 s89, 3
s_cselect_b32 s54, s54, 0x40000000
v_add_u32 v55, s54, v32
s_mov_b32 s99, 0
s_waitcnt lgkmcnt(0)
s_barrier
s_lshl_b32 s53, s44, 7
v_lshrrev_b32 v5, 5, v0
v_lshlrev_b32 v5, 4, v5
v_add_u32 v5, s53, v5
v_add_u32 v5, 161024, v5
ds_read_b128 v[192:195], v5 offset:0
ds_read_b128 v[196:199], v5 offset:32
ds_read_b128 v[200:203], v5 offset:64
ds_read_b128 v[204:207], v5 offset:96
s_xor_b32 s54, s53, 128
v_add_u32 v6, s54, v54
ds_read_b32 v120, v6 offset:0
ds_read_b32 v121, v6 offset:512
s_xor_b32 s53, s53, 256
v_lshrrev_b32 v5, 5, v0
v_lshlrev_b32 v5, 4, v5
v_add_u32 v5, s53, v5
v_add_u32 v5, 161024, v5
ds_read_b128 v[104:107], v5 offset:0
ds_read_b128 v[108:111], v5 offset:32
ds_read_b128 v[112:115], v5 offset:64
ds_read_b128 v[116:119], v5 offset:96
v_bfe_u32 v5, v0, 4, 1
v_mul_u32_u24 v122, 22016, v5
v_lshrrev_b32 v5, 5, v0
v_lshl_add_u32 v122, v5, 7, v122
v_lshl_add_u32 v122, v4, 3, v122
s_lshl_b32 s53, s46, 12
s_add_u32 s56, s53, 3100672
s_waitcnt lgkmcnt(9)
v_pk_mul_f32 v[208:209], v[192:193], v[48:49] op_sel:[0,1] op_sel_hi:[1,1]
v_pk_mul_f32 v[210:211], v[194:195], v[48:49] op_sel:[0,1] op_sel_hi:[1,1]
s_waitcnt lgkmcnt(8)
v_pk_mul_f32 v[212:213], v[196:197], v[48:49] op_sel:[0,1] op_sel_hi:[1,1]
v_pk_mul_f32 v[214:215], v[198:199], v[48:49] op_sel:[0,1] op_sel_hi:[1,1]
v_pk_fma_f32 v[208:209], v[128:129], v[48:49], v[208:209] op_sel:[0,0,0] op_sel_hi:[1,0,1]
v_pk_fma_f32 v[210:211], v[130:131], v[48:49], v[210:211] op_sel:[0,0,0] op_sel_hi:[1,0,1]
v_pk_fma_f32 v[212:213], v[132:133], v[48:49], v[212:213] op_sel:[0,0,0] op_sel_hi:[1,0,1]
v_pk_fma_f32 v[214:215], v[134:135], v[48:49], v[214:215] op_sel:[0,0,0] op_sel_hi:[1,0,1]
v_pk_mul_f32 v[216:217], v[208:209], v[208:209]
v_pk_mul_f32 v[218:219], v[210:211], v[210:211]
v_pk_mul_f32 v[220:221], v[212:213], v[212:213]
v_pk_mul_f32 v[222:223], v[214:215], v[214:215]
v_pk_fma_f32 v[216:217], v[216:217], v[52:53], v[52:53] op_sel:[0,0,1] op_sel_hi:[1,0,1]
v_pk_fma_f32 v[218:219], v[218:219], v[52:53], v[52:53] op_sel:[0,0,1] op_sel_hi:[1,0,1]
v_pk_fma_f32 v[220:221], v[220:221], v[52:53], v[52:53] op_sel:[0,0,1] op_sel_hi:[1,0,1]
v_pk_fma_f32 v[222:223], v[222:223], v[52:53], v[52:53] op_sel:[0,0,1] op_sel_hi:[1,0,1]
v_pk_mul_f32 v[216:217], v[216:217], v[208:209]
v_pk_mul_f32 v[218:219], v[218:219], v[210:211]
v_pk_mul_f32 v[220:221], v[220:221], v[212:213]
v_pk_mul_f32 v[222:223], v[222:223], v[214:215]
v_exp_f32 v216, v216
v_exp_f32 v217, v217
v_exp_f32 v218, v218
v_exp_f32 v219, v219
v_exp_f32 v220, v220
v_exp_f32 v221, v221
v_exp_f32 v222, v222
v_exp_f32 v223, v223
v_pk_add_f32 v[216:217], v[216:217], 1.0 op_sel_hi:[1,0]
v_pk_add_f32 v[218:219], v[218:219], 1.0 op_sel_hi:[1,0]
v_pk_add_f32 v[220:221], v[220:221], 1.0 op_sel_hi:[1,0]
v_pk_add_f32 v[222:223], v[222:223], 1.0 op_sel_hi:[1,0]
v_rcp_f32 v216, v216
v_rcp_f32 v217, v217
v_rcp_f32 v218, v218
v_rcp_f32 v219, v219
v_rcp_f32 v220, v220
v_rcp_f32 v221, v221
v_rcp_f32 v222, v222
v_rcp_f32 v223, v223
v_pk_mul_f32 v[208:209], v[208:209], v[216:217]
v_pk_mul_f32 v[210:211], v[210:211], v[218:219]
v_pk_mul_f32 v[212:213], v[212:213], v[220:221]
v_pk_mul_f32 v[214:215], v[214:215], v[222:223]
v_cvt_pk_bf16_f32 v224, v208, v209
v_cvt_pk_bf16_f32 v225, v210, v211
v_cvt_pk_bf16_f32 v226, v212, v213
v_cvt_pk_bf16_f32 v227, v214, v215
buffer_load_dwordx4 v23, s[16:19], s87 offen offset:1024 lds
s_add_u32 m0, s59, 36864
s_add_u32 s87, s61, s65
buffer_load_dwordx4 v20, s[16:19], s87 offen lds
buffer_load_dwordx4 v21, s[16:19], s87 offen offset:1024 lds
s_add_u32 m0, m0, 2048
s_nop 0
buffer_load_dwordx4 v22, s[16:19], s87 offen lds
buffer_load_dwordx4 v23, s[16:19], s87 offen offset:1024 lds
s_add_u32 s61, s61, 128
s_and_b32 s61, s61, 1023
s_waitcnt lgkmcnt(7)
v_pk_mul_f32 v[208:209], v[200:201], v[48:49] op_sel:[0,1] op_sel_hi:[1,1]
v_pk_mul_f32 v[210:211], v[202:203], v[48:49] op_sel:[0,1] op_sel_hi:[1,1]
s_waitcnt lgkmcnt(6)
v_pk_mul_f32 v[212:213], v[204:205], v[48:49] op_sel:[0,1] op_sel_hi:[1,1]
v_pk_mul_f32 v[214:215], v[206:207], v[48:49] op_sel:[0,1] op_sel_hi:[1,1]
v_pk_fma_f32 v[208:209], v[136:137], v[48:49], v[208:209] op_sel:[0,0,0] op_sel_hi:[1,0,1]
v_pk_fma_f32 v[210:211], v[138:139], v[48:49], v[210:211] op_sel:[0,0,0] op_sel_hi:[1,0,1]
v_pk_fma_f32 v[212:213], v[140:141], v[48:49], v[212:213] op_sel:[0,0,0] op_sel_hi:[1,0,1]
v_pk_fma_f32 v[214:215], v[142:143], v[48:49], v[214:215] op_sel:[0,0,0] op_sel_hi:[1,0,1]
v_pk_mul_f32 v[216:217], v[208:209], v[208:209]
v_pk_mul_f32 v[218:219], v[210:211], v[210:211]
v_pk_mul_f32 v[220:221], v[212:213], v[212:213]
v_pk_mul_f32 v[222:223], v[214:215], v[214:215]
v_pk_fma_f32 v[216:217], v[216:217], v[52:53], v[52:53] op_sel:[0,0,1] op_sel_hi:[1,0,1]
v_pk_fma_f32 v[218:219], v[218:219], v[52:53], v[52:53] op_sel:[0,0,1] op_sel_hi:[1,0,1]
v_pk_fma_f32 v[220:221], v[220:221], v[52:53], v[52:53] op_sel:[0,0,1] op_sel_hi:[1,0,1]
v_pk_fma_f32 v[222:223], v[222:223], v[52:53], v[52:53] op_sel:[0,0,1] op_sel_hi:[1,0,1]
v_pk_mul_f32 v[216:217], v[216:217], v[208:209]
v_pk_mul_f32 v[218:219], v[218:219], v[210:211]
v_pk_mul_f32 v[220:221], v[220:221], v[212:213]
v_pk_mul_f32 v[222:223], v[222:223], v[214:215]
v_exp_f32 v216, v216
v_exp_f32 v217, v217
v_exp_f32 v218, v218
v_exp_f32 v219, v219
v_exp_f32 v220, v220
v_exp_f32 v221, v221
v_exp_f32 v222, v222
v_exp_f32 v223, v223
v_pk_add_f32 v[216:217], v[216:217], 1.0 op_sel_hi:[1,0]
v_pk_add_f32 v[218:219], v[218:219], 1.0 op_sel_hi:[1,0]
v_pk_add_f32 v[220:221], v[220:221], 1.0 op_sel_hi:[1,0]
v_pk_add_f32 v[222:223], v[222:223], 1.0 op_sel_hi:[1,0]
v_rcp_f32 v216, v216
v_rcp_f32 v217, v217
v_rcp_f32 v218, v218
v_rcp_f32 v219, v219
v_rcp_f32 v220, v220
v_rcp_f32 v221, v221
v_rcp_f32 v222, v222
v_rcp_f32 v223, v223
v_pk_mul_f32 v[208:209], v[208:209], v[216:217]
v_pk_mul_f32 v[210:211], v[210:211], v[218:219]
v_pk_mul_f32 v[212:213], v[212:213], v[220:221]
v_pk_mul_f32 v[214:215], v[214:215], v[222:223]
v_cvt_pk_bf16_f32 v228, v208, v209
v_cvt_pk_bf16_f32 v229, v210, v211
v_cvt_pk_bf16_f32 v230, v212, v213
v_cvt_pk_bf16_f32 v231, v214, v215
s_waitcnt vmcnt(8)
ds_read_b128 a[160:163], v16 offset:0
ds_read_b128 a[164:167], v16 offset:2048
ds_read_b128 a[168:171], v16 offset:4096
ds_read_b128 a[172:175], v16 offset:6144
ds_read_b128 a[176:179], v17 offset:0
ds_read_b128 a[180:183], v17 offset:2048
ds_read_b128 a[184:187], v17 offset:4096
ds_read_b128 a[188:191], v17 offset:6144
s_waitcnt lgkmcnt(0)
s_add_u32 m0, s59, 0
s_add_u32 s87, s61, s64
buffer_load_dwordx4 v20, s[16:19], s87 offen lds
buffer_load_dwordx4 v21, s[16:19], s87 offen offset:1024 lds
s_add_u32 m0, m0, 2048
s_nop 0
buffer_load_dwordx4 v22, s[16:19], s87 offen lds
buffer_load_dwordx4 v23, s[16:19], s87 offen offset:1024 lds
s_add_u32 m0, s59, 4096
s_add_u32 s87, s61, s65
buffer_load_dwordx4 v20, s[16:19], s87 offen lds
buffer_load_dwordx4 v21, s[16:19], s87 offen offset:1024 lds
s_add_u32 m0, m0, 2048
s_nop 0
buffer_load_dwordx4 v22, s[16:19], s87 offen lds
s_xor_b32 s53, s96, 0
s_mul_i32 s53, s53, 44032
s_xor_b32 s54, s44, 0
s_lshl_b32 s54, s54, 10
s_add_u32 s53, s53, s54
s_add_u32 s63, s53, s56
buffer_store_dwordx2 v[224:225], v122, s[20:23], s63 offen offset:0 sc1
buffer_store_dwordx2 v[226:227], v122, s[20:23], s63 offen offset:256 sc1
buffer_store_dwordx2 v[228:229], v122, s[20:23], s63 offen offset:512 sc1
buffer_store_dwordx2 v[230:231], v122, s[20:23], s63 offen offset:768 sc1
v_pk_mul_f32 v[208:209], v[192:193], v[120:121] op_sel:[0,1] op_sel_hi:[1,1]
v_pk_mul_f32 v[210:211], v[194:195], v[120:121] op_sel:[0,1] op_sel_hi:[1,1]
v_pk_mul_f32 v[212:213], v[196:197], v[120:121] op_sel:[0,1] op_sel_hi:[1,1]
v_pk_mul_f32 v[214:215], v[198:199], v[120:121] op_sel:[0,1] op_sel_hi:[1,1]
v_pk_fma_f32 v[208:209], v[160:161], v[120:121], v[208:209] op_sel:[0,0,0] op_sel_hi:[1,0,1]
v_pk_fma_f32 v[210:211], v[162:163], v[120:121], v[210:211] op_sel:[0,0,0] op_sel_hi:[1,0,1]
v_pk_fma_f32 v[212:213], v[164:165], v[120:121], v[212:213] op_sel:[0,0,0] op_sel_hi:[1,0,1]
v_pk_fma_f32 v[214:215], v[166:167], v[120:121], v[214:215] op_sel:[0,0,0] op_sel_hi:[1,0,1]
v_pk_mul_f32 v[216:217], v[208:209], v[208:209]
v_pk_mul_f32 v[218:219], v[210:211], v[210:211]
v_pk_mul_f32 v[220:221], v[212:213], v[212:213]
v_pk_mul_f32 v[222:223], v[214:215], v[214:215]
v_pk_fma_f32 v[216:217], v[216:217], v[52:53], v[52:53] op_sel:[0,0,1] op_sel_hi:[1,0,1]
v_pk_fma_f32 v[218:219], v[218:219], v[52:53], v[52:53] op_sel:[0,0,1] op_sel_hi:[1,0,1]
v_pk_fma_f32 v[220:221], v[220:221], v[52:53], v[52:53] op_sel:[0,0,1] op_sel_hi:[1,0,1]
v_pk_fma_f32 v[222:223], v[222:223], v[52:53], v[52:53] op_sel:[0,0,1] op_sel_hi:[1,0,1]
v_pk_mul_f32 v[216:217], v[216:217], v[208:209]
v_pk_mul_f32 v[218:219], v[218:219], v[210:211]
v_pk_mul_f32 v[220:221], v[220:221], v[212:213]
v_pk_mul_f32 v[222:223], v[222:223], v[214:215]
v_exp_f32 v216, v216
v_exp_f32 v217, v217
v_exp_f32 v218, v218
v_exp_f32 v219, v219
v_exp_f32 v220, v220
v_exp_f32 v221, v221
v_exp_f32 v222, v222
v_exp_f32 v223, v223
v_pk_add_f32 v[216:217], v[216:217], 1.0 op_sel_hi:[1,0]
v_pk_add_f32 v[218:219], v[218:219], 1.0 op_sel_hi:[1,0]
v_pk_add_f32 v[220:221], v[220:221], 1.0 op_sel_hi:[1,0]
v_pk_add_f32 v[222:223], v[222:223], 1.0 op_sel_hi:[1,0]
v_rcp_f32 v216, v216
v_rcp_f32 v217, v217
v_rcp_f32 v218, v218
v_rcp_f32 v219, v219
v_rcp_f32 v220, v220
v_rcp_f32 v221, v221
v_rcp_f32 v222, v222
v_rcp_f32 v223, v223
v_pk_mul_f32 v[208:209], v[208:209], v[216:217]
v_pk_mul_f32 v[210:211], v[210:211], v[218:219]
v_pk_mul_f32 v[212:213], v[212:213], v[220:221]
v_pk_mul_f32 v[214:215], v[214:215], v[222:223]
v_cvt_pk_bf16_f32 v232, v208, v209
v_cvt_pk_bf16_f32 v233, v210, v211
v_cvt_pk_bf16_f32 v234, v212, v213
v_cvt_pk_bf16_f32 v235, v214, v215
s_lshr_b32 s3, s88, 1
v_lshlrev_b32 v11, 13, v3
s_and_b32 s97, s89, 1
s_lshl_b32 s97, s97, 3
v_and_b32 v12, s97, v0
v_lshl_add_u32 v11, v12, 6, v11
v_and_b32 v12, 6, v0
v_lshl_add_u32 v11, v12, 6, v11
buffer_load_dwordx4 v23, s[16:19], s87 offen offset:1024 lds
s_lshl_b32 s97, s44, 6
s_add_u32 s97, s97, s3
s_lshl_b32 s97, s97, 9
s_add_u32 s97, s97, 65536
buffer_load_dwordx2 v[34:35], v11, s[20:23], s97 offen sc1
s_add_u32 s61, s61, 128
s_and_b32 s61, s61, 1023
s_lshl_b32 s87, s44, 2
s_add_u32 s87, s87, s47
s_add_u32 s87, s87, 0
s_and_b32 s87, s87, 15
s_lshl_b32 m0, s87, 12
s_add_u32 m0, m0, 73728
s_lshl_b32 s87, s87, 15
buffer_load_dwordx4 v28, s[24:27], s87 offen lds
buffer_load_dwordx4 v29, s[24:27], s87 offen offset:1024 lds
buffer_load_dwordx4 v30, s[24:27], s87 offen offset:2048 lds
buffer_load_dwordx4 v31, s[24:27], s87 offen offset:3072 lds
s_lshl_b32 s87, s44, 2
s_add_u32 s87, s87, s47
s_add_u32 s87, s87, 1
s_and_b32 s87, s87, 15
v_pk_mul_f32 v[208:209], v[200:201], v[120:121] op_sel:[0,1] op_sel_hi:[1,1]
v_pk_mul_f32 v[210:211], v[202:203], v[120:121] op_sel:[0,1] op_sel_hi:[1,1]
v_pk_mul_f32 v[212:213], v[204:205], v[120:121] op_sel:[0,1] op_sel_hi:[1,1]
v_pk_mul_f32 v[214:215], v[206:207], v[120:121] op_sel:[0,1] op_sel_hi:[1,1]
v_pk_fma_f32 v[208:209], v[168:169], v[120:121], v[208:209] op_sel:[0,0,0] op_sel_hi:[1,0,1]
v_pk_fma_f32 v[210:211], v[170:171], v[120:121], v[210:211] op_sel:[0,0,0] op_sel_hi:[1,0,1]
v_pk_fma_f32 v[212:213], v[172:173], v[120:121], v[212:213] op_sel:[0,0,0] op_sel_hi:[1,0,1]
v_pk_fma_f32 v[214:215], v[174:175], v[120:121], v[214:215] op_sel:[0,0,0] op_sel_hi:[1,0,1]
v_pk_mul_f32 v[216:217], v[208:209], v[208:209]
v_pk_mul_f32 v[218:219], v[210:211], v[210:211]
v_pk_mul_f32 v[220:221], v[212:213], v[212:213]
v_pk_mul_f32 v[222:223], v[214:215], v[214:215]
v_pk_fma_f32 v[216:217], v[216:217], v[52:53], v[52:53] op_sel:[0,0,1] op_sel_hi:[1,0,1]
v_pk_fma_f32 v[218:219], v[218:219], v[52:53], v[52:53] op_sel:[0,0,1] op_sel_hi:[1,0,1]
v_pk_fma_f32 v[220:221], v[220:221], v[52:53], v[52:53] op_sel:[0,0,1] op_sel_hi:[1,0,1]
v_pk_fma_f32 v[222:223], v[222:223], v[52:53], v[52:53] op_sel:[0,0,1] op_sel_hi:[1,0,1]
v_pk_mul_f32 v[216:217], v[216:217], v[208:209]
v_pk_mul_f32 v[218:219], v[218:219], v[210:211]
v_pk_mul_f32 v[220:221], v[220:221], v[212:213]
v_pk_mul_f32 v[222:223], v[222:223], v[214:215]
v_exp_f32 v216, v216
v_exp_f32 v217, v217
v_exp_f32 v218, v218
v_exp_f32 v219, v219
v_exp_f32 v220, v220
v_exp_f32 v221, v221
v_exp_f32 v222, v222
v_exp_f32 v223, v223
v_pk_add_f32 v[216:217], v[216:217], 1.0 op_sel_hi:[1,0]
v_pk_add_f32 v[218:219], v[218:219], 1.0 op_sel_hi:[1,0]
v_pk_add_f32 v[220:221], v[220:221], 1.0 op_sel_hi:[1,0]
v_pk_add_f32 v[222:223], v[222:223], 1.0 op_sel_hi:[1,0]
v_rcp_f32 v216, v216
v_rcp_f32 v217, v217
v_rcp_f32 v218, v218
v_rcp_f32 v219, v219
v_rcp_f32 v220, v220
v_rcp_f32 v221, v221
v_rcp_f32 v222, v222
v_rcp_f32 v223, v223
v_pk_mul_f32 v[208:209], v[208:209], v[216:217]
v_pk_mul_f32 v[210:211], v[210:211], v[218:219]
v_pk_mul_f32 v[212:213], v[212:213], v[220:221]
v_pk_mul_f32 v[214:215], v[214:215], v[222:223]
v_cvt_pk_bf16_f32 v236, v208, v209
v_cvt_pk_bf16_f32 v237, v210, v211
v_cvt_pk_bf16_f32 v238, v212, v213
v_cvt_pk_bf16_f32 v239, v214, v215
s_lshl_b32 m0, s87, 12
s_add_u32 m0, m0, 73728
s_lshl_b32 s87, s87, 15
buffer_load_dwordx4 v28, s[24:27], s87 offen lds
buffer_load_dwordx4 v29, s[24:27], s87 offen offset:1024 lds
buffer_load_dwordx4 v30, s[24:27], s87 offen offset:2048 lds
buffer_load_dwordx4 v31, s[24:27], s87 offen offset:3072 lds
s_lshl_b32 s87, s44, 2
s_add_u32 s87, s87, s47
s_add_u32 s87, s87, 2
s_and_b32 s87, s87, 15
s_lshl_b32 m0, s87, 12
s_add_u32 m0, m0, 73728
s_lshl_b32 s87, s87, 15
buffer_load_dwordx4 v28, s[24:27], s87 offen lds
buffer_load_dwordx4 v29, s[24:27], s87 offen offset:1024 lds
buffer_load_dwordx4 v30, s[24:27], s87 offen offset:2048 lds
buffer_load_dwordx4 v31, s[24:27], s87 offen offset:3072 lds
s_xor_b32 s53, s96, 1
s_mul_i32 s53, s53, 44032
s_xor_b32 s54, s44, 0
s_lshl_b32 s54, s54, 10
s_add_u32 s53, s53, s54
s_add_u32 s63, s53, s56
buffer_store_dwordx2 v[232:233], v122, s[20:23], s63 offen offset:0 sc1
buffer_store_dwordx2 v[234:235], v122, s[20:23], s63 offen offset:256 sc1
buffer_store_dwordx2 v[236:237], v122, s[20:23], s63 offen offset:512 sc1
buffer_store_dwordx2 v[238:239], v122, s[20:23], s63 offen offset:768 sc1
v_pk_mul_f32 v[208:209], v[104:105], v[48:49] op_sel:[0,1] op_sel_hi:[1,1]
v_pk_mul_f32 v[210:211], v[106:107], v[48:49] op_sel:[0,1] op_sel_hi:[1,1]
v_pk_mul_f32 v[212:213], v[108:109], v[48:49] op_sel:[0,1] op_sel_hi:[1,1]
v_pk_mul_f32 v[214:215], v[110:111], v[48:49] op_sel:[0,1] op_sel_hi:[1,1]
v_pk_fma_f32 v[208:209], v[144:145], v[48:49], v[208:209] op_sel:[0,0,0] op_sel_hi:[1,0,1]
v_pk_fma_f32 v[210:211], v[146:147], v[48:49], v[210:211] op_sel:[0,0,0] op_sel_hi:[1,0,1]
v_pk_fma_f32 v[212:213], v[148:149], v[48:49], v[212:213] op_sel:[0,0,0] op_sel_hi:[1,0,1]
v_pk_fma_f32 v[214:215], v[150:151], v[48:49], v[214:215] op_sel:[0,0,0] op_sel_hi:[1,0,1]
v_pk_mul_f32 v[216:217], v[208:209], v[208:209]
v_pk_mul_f32 v[218:219], v[210:211], v[210:211]
v_pk_mul_f32 v[220:221], v[212:213], v[212:213]
v_pk_mul_f32 v[222:223], v[214:215], v[214:215]
v_pk_fma_f32 v[216:217], v[216:217], v[52:53], v[52:53] op_sel:[0,0,1] op_sel_hi:[1,0,1]
v_pk_fma_f32 v[218:219], v[218:219], v[52:53], v[52:53] op_sel:[0,0,1] op_sel_hi:[1,0,1]
v_pk_fma_f32 v[220:221], v[220:221], v[52:53], v[52:53] op_sel:[0,0,1] op_sel_hi:[1,0,1]
v_pk_fma_f32 v[222:223], v[222:223], v[52:53], v[52:53] op_sel:[0,0,1] op_sel_hi:[1,0,1]
v_pk_mul_f32 v[216:217], v[216:217], v[208:209]
v_pk_mul_f32 v[218:219], v[218:219], v[210:211]
v_pk_mul_f32 v[220:221], v[220:221], v[212:213]
v_pk_mul_f32 v[222:223], v[222:223], v[214:215]
v_exp_f32 v216, v216
v_exp_f32 v217, v217
v_exp_f32 v218, v218
v_exp_f32 v219, v219
v_exp_f32 v220, v220
v_exp_f32 v221, v221
v_exp_f32 v222, v222
v_exp_f32 v223, v223
v_pk_add_f32 v[216:217], v[216:217], 1.0 op_sel_hi:[1,0]
v_pk_add_f32 v[218:219], v[218:219], 1.0 op_sel_hi:[1,0]
v_pk_add_f32 v[220:221], v[220:221], 1.0 op_sel_hi:[1,0]
v_pk_add_f32 v[222:223], v[222:223], 1.0 op_sel_hi:[1,0]
v_rcp_f32 v216, v216
v_rcp_f32 v217, v217
v_rcp_f32 v218, v218
v_rcp_f32 v219, v219
v_rcp_f32 v220, v220
v_rcp_f32 v221, v221
v_rcp_f32 v222, v222
v_rcp_f32 v223, v223
v_pk_mul_f32 v[208:209], v[208:209], v[216:217]
v_pk_mul_f32 v[210:211], v[210:211], v[218:219]
v_pk_mul_f32 v[212:213], v[212:213], v[220:221]
v_pk_mul_f32 v[214:215], v[214:215], v[222:223]
v_cvt_pk_bf16_f32 v240, v208, v209
v_cvt_pk_bf16_f32 v241, v210, v211
v_cvt_pk_bf16_f32 v242, v212, v213
v_cvt_pk_bf16_f32 v243, v214, v215
s_waitcnt vmcnt(29)
ds_read_b128 a[192:195], v16 offset:32768
ds_read_b128 a[196:199], v16 offset:34816
ds_read_b128 a[200:203], v16 offset:36864
ds_read_b128 a[204:207], v16 offset:38912
ds_read_b128 a[208:211], v17 offset:32768
ds_read_b128 a[212:215], v17 offset:34816
ds_read_b128 a[216:219], v17 offset:36864
ds_read_b128 a[220:223], v17 offset:38912
s_cmp_eq_u32 s99, 1
s_cbranch_scc1 L_tb_52
s_waitcnt vmcnt(16)
v_cmp_ne_u64 vcc, v[34:35], v[26:27]
s_nop 3
s_cbranch_vccnz L_tb_53
s_mul_i32 s90, s92, 90112
s_add_u32 s92, s92, 1
s_add_u32 s90, s90, s93
s_and_b32 s92, s92, 7
buffer_load_dwordx4 v[56:59], v33, s[20:23], s90 offen offset:0 sc1
buffer_load_dwordx4 v[60:63], v33, s[20:23], s90 offen offset:2048 sc1
buffer_load_dwordx4 v[64:67], v47, s[20:23], s90 offen offset:0 sc1
buffer_load_dwordx4 v[68:71], v47, s[20:23], s90 offen offset:2048 sc1
buffer_load_dwordx4 v[72:75], v55, s[20:23], s90 offen offset:0 sc1
buffer_load_dwordx4 v[76:79], v55, s[20:23], s90 offen offset:2048 sc1
buffer_load_dwordx4 v[80:83], v33, s[20:23], s90 offen offset:1024 sc1
buffer_load_dwordx4 v[84:87], v33, s[20:23], s90 offen offset:3072 sc1
buffer_load_dwordx4 v[88:91], v47, s[20:23], s90 offen offset:1024 sc1
buffer_load_dwordx4 v[92:95], v47, s[20:23], s90 offen offset:3072 sc1
buffer_load_dwordx4 v[96:99], v55, s[20:23], s90 offen offset:1024 sc1
buffer_load_dwordx4 v[100:103], v55, s[20:23], s90 offen offset:3072 sc1
s_mov_b32 s99, 1
s_branch L_tb_52
L_tb_53:
buffer_load_dwordx2 v[34:35], v11, s[20:23], s97 offen sc1
L_tb_52:
v_pk_mul_f32 v[208:209], v[112:113], v[48:49] op_sel:[0,1] op_sel_hi:[1,1]
v_pk_mul_f32 v[210:211], v[114:115], v[48:49] op_sel:[0,1] op_sel_hi:[1,1]
v_pk_mul_f32 v[212:213], v[116:117], v[48:49] op_sel:[0,1] op_sel_hi:[1,1]
v_pk_mul_f32 v[214:215], v[118:119], v[48:49] op_sel:[0,1] op_sel_hi:[1,1]
v_pk_fma_f32 v[208:209], v[152:153], v[48:49], v[208:209] op_sel:[0,0,0] op_sel_hi:[1,0,1]
v_pk_fma_f32 v[210:211], v[154:155], v[48:49], v[210:211] op_sel:[0,0,0] op_sel_hi:[1,0,1]
v_pk_fma_f32 v[212:213], v[156:157], v[48:49], v[212:213] op_sel:[0,0,0] op_sel_hi:[1,0,1]
v_pk_fma_f32 v[214:215], v[158:159], v[48:49], v[214:215] op_sel:[0,0,0] op_sel_hi:[1,0,1]
v_pk_mul_f32 v[216:217], v[208:209], v[208:209]
v_pk_mul_f32 v[218:219], v[210:211], v[210:211]
v_pk_mul_f32 v[220:221], v[212:213], v[212:213]
v_pk_mul_f32 v[222:223], v[214:215], v[214:215]
v_pk_fma_f32 v[216:217], v[216:217], v[52:53], v[52:53] op_sel:[0,0,1] op_sel_hi:[1,0,1]
v_pk_fma_f32 v[218:219], v[218:219], v[52:53], v[52:53] op_sel:[0,0,1] op_sel_hi:[1,0,1]
v_pk_fma_f32 v[220:221], v[220:221], v[52:53], v[52:53] op_sel:[0,0,1] op_sel_hi:[1,0,1]
v_pk_fma_f32 v[222:223], v[222:223], v[52:53], v[52:53] op_sel:[0,0,1] op_sel_hi:[1,0,1]
v_pk_mul_f32 v[216:217], v[216:217], v[208:209]
v_pk_mul_f32 v[218:219], v[218:219], v[210:211]
v_pk_mul_f32 v[220:221], v[220:221], v[212:213]
v_pk_mul_f32 v[222:223], v[222:223], v[214:215]
v_exp_f32 v216, v216
v_exp_f32 v217, v217
v_exp_f32 v218, v218
v_exp_f32 v219, v219
v_exp_f32 v220, v220
v_exp_f32 v221, v221
v_exp_f32 v222, v222
v_exp_f32 v223, v223
v_pk_add_f32 v[216:217], v[216:217], 1.0 op_sel_hi:[1,0]
v_pk_add_f32 v[218:219], v[218:219], 1.0 op_sel_hi:[1,0]
v_pk_add_f32 v[220:221], v[220:221], 1.0 op_sel_hi:[1,0]
v_pk_add_f32 v[222:223], v[222:223], 1.0 op_sel_hi:[1,0]
v_rcp_f32 v216, v216
v_rcp_f32 v217, v217
v_rcp_f32 v218, v218
v_rcp_f32 v219, v219
v_rcp_f32 v220, v220
v_rcp_f32 v221, v221
v_rcp_f32 v222, v222
v_rcp_f32 v223, v223
v_pk_mul_f32 v[208:209], v[208:209], v[216:217]
v_pk_mul_f32 v[210:211], v[210:211], v[218:219]
v_pk_mul_f32 v[212:213], v[212:213], v[220:221]
v_pk_mul_f32 v[214:215], v[214:215], v[222:223]
v_cvt_pk_bf16_f32 v244, v208, v209
v_cvt_pk_bf16_f32 v245, v210, v211
v_cvt_pk_bf16_f32 v246, v212, v213
v_cvt_pk_bf16_f32 v247, v214, v215
s_waitcnt vmcnt(17)
ds_read_b128 a[224:227], v16 offset:0
ds_read_b128 a[228:231], v16 offset:2048
ds_read_b128 a[232:235], v16 offset:4096
ds_read_b128 a[236:239], v16 offset:6144
ds_read_b128 a[240:243], v17 offset:0
ds_read_b128 a[244:247], v17 offset:2048
ds_read_b128 a[248:251], v17 offset:4096
ds_read_b128 a[252:255], v17 offset:6144
s_xor_b32 s53, s96, 0
s_mul_i32 s53, s53, 44032
s_xor_b32 s54, s44, 2
s_lshl_b32 s54, s54, 10
s_add_u32 s53, s53, s54
s_add_u32 s63, s53, s56
buffer_store_dwordx2 v[240:241], v122, s[20:23], s63 offen offset:0 sc1
buffer_store_dwordx2 v[242:243], v122, s[20:23], s63 offen offset:256 sc1
buffer_store_dwordx2 v[244:245], v122, s[20:23], s63 offen offset:512 sc1
buffer_store_dwordx2 v[246:247], v122, s[20:23], s63 offen offset:768 sc1
v_pk_mul_f32 v[208:209], v[104:105], v[120:121] op_sel:[0,1] op_sel_hi:[1,1]
v_pk_mul_f32 v[210:211], v[106:107], v[120:121] op_sel:[0,1] op_sel_hi:[1,1]
v_pk_mul_f32 v[212:213], v[108:109], v[120:121] op_sel:[0,1] op_sel_hi:[1,1]
v_pk_mul_f32 v[214:215], v[110:111], v[120:121] op_sel:[0,1] op_sel_hi:[1,1]
v_pk_fma_f32 v[208:209], v[176:177], v[120:121], v[208:209] op_sel:[0,0,0] op_sel_hi:[1,0,1]
v_pk_fma_f32 v[210:211], v[178:179], v[120:121], v[210:211] op_sel:[0,0,0] op_sel_hi:[1,0,1]
v_pk_fma_f32 v[212:213], v[180:181], v[120:121], v[212:213] op_sel:[0,0,0] op_sel_hi:[1,0,1]
v_pk_fma_f32 v[214:215], v[182:183], v[120:121], v[214:215] op_sel:[0,0,0] op_sel_hi:[1,0,1]
v_pk_mul_f32 v[216:217], v[208:209], v[208:209]
v_pk_mul_f32 v[218:219], v[210:211], v[210:211]
v_pk_mul_f32 v[220:221], v[212:213], v[212:213]
v_pk_mul_f32 v[222:223], v[214:215], v[214:215]
v_pk_fma_f32 v[216:217], v[216:217], v[52:53], v[52:53] op_sel:[0,0,1] op_sel_hi:[1,0,1]
v_pk_fma_f32 v[218:219], v[218:219], v[52:53], v[52:53] op_sel:[0,0,1] op_sel_hi:[1,0,1]
v_pk_fma_f32 v[220:221], v[220:221], v[52:53], v[52:53] op_sel:[0,0,1] op_sel_hi:[1,0,1]
v_pk_fma_f32 v[222:223], v[222:223], v[52:53], v[52:53] op_sel:[0,0,1] op_sel_hi:[1,0,1]
v_pk_mul_f32 v[216:217], v[216:217], v[208:209]
v_pk_mul_f32 v[218:219], v[218:219], v[210:211]
v_pk_mul_f32 v[220:221], v[220:221], v[212:213]
v_pk_mul_f32 v[222:223], v[222:223], v[214:215]
v_exp_f32 v216, v216
v_exp_f32 v217, v217
v_exp_f32 v218, v218
v_exp_f32 v219, v219
v_exp_f32 v220, v220
v_exp_f32 v221, v221
v_exp_f32 v222, v222
v_exp_f32 v223, v223
v_pk_add_f32 v[216:217], v[216:217], 1.0 op_sel_hi:[1,0]
v_pk_add_f32 v[218:219], v[218:219], 1.0 op_sel_hi:[1,0]
v_pk_add_f32 v[220:221], v[220:221], 1.0 op_sel_hi:[1,0]
v_pk_add_f32 v[222:223], v[222:223], 1.0 op_sel_hi:[1,0]
v_rcp_f32 v216, v216
v_rcp_f32 v217, v217
v_rcp_f32 v218, v218
v_rcp_f32 v219, v219
v_rcp_f32 v220, v220
v_rcp_f32 v221, v221
v_rcp_f32 v222, v222
v_rcp_f32 v223, v223
v_pk_mul_f32 v[208:209], v[208:209], v[216:217]
v_pk_mul_f32 v[210:211], v[210:211], v[218:219]
v_pk_mul_f32 v[212:213], v[212:213], v[220:221]
v_pk_mul_f32 v[214:215], v[214:215], v[222:223]
v_cvt_pk_bf16_f32 v248, v208, v209
v_cvt_pk_bf16_f32 v249, v210, v211
v_cvt_pk_bf16_f32 v250, v212, v213
v_cvt_pk_bf16_f32 v251, v214, v215
s_cmp_eq_u32 s99, 1
s_cbranch_scc1 L_tb_55
s_waitcnt vmcnt(4)
v_cmp_ne_u64 vcc, v[34:35], v[26:27]
s_nop 3
s_cbranch_vccnz L_tb_56
s_mul_i32 s90, s92, 90112
s_add_u32 s92, s92, 1
s_add_u32 s90, s90, s93
s_and_b32 s92, s92, 7
buffer_load_dwordx4 v[56:59], v33, s[20:23], s90 offen offset:0 sc1
buffer_load_dwordx4 v[60:63], v33, s[20:23], s90 offen offset:2048 sc1
buffer_load_dwordx4 v[64:67], v47, s[20:23], s90 offen offset:0 sc1
buffer_load_dwordx4 v[68:71], v47, s[20:23], s90 offen offset:2048 sc1
buffer_load_dwordx4 v[72:75], v55, s[20:23], s90 offen offset:0 sc1
buffer_load_dwordx4 v[76:79], v55, s[20:23], s90 offen offset:2048 sc1
buffer_load_dwordx4 v[80:83], v33, s[20:23], s90 offen offset:1024 sc1
buffer_load_dwordx4 v[84:87], v33, s[20:23], s90 offen offset:3072 sc1
buffer_load_dwordx4 v[88:91], v47, s[20:23], s90 offen offset:1024 sc1
buffer_load_dwordx4 v[92:95], v47, s[20:23], s90 offen offset:3072 sc1
buffer_load_dwordx4 v[96:99], v55, s[20:23], s90 offen offset:1024 sc1
buffer_load_dwordx4 v[100:103], v55, s[20:23], s90 offen offset:3072 sc1
s_mov_b32 s99, 1
s_branch L_tb_55
L_tb_56:
buffer_load_dwordx2 v[34:35], v11, s[20:23], s97 offen sc1
L_tb_55:
v_pk_mul_f32 v[208:209], v[112:113], v[120:121] op_sel:[0,1] op_sel_hi:[1,1]
v_pk_mul_f32 v[210:211], v[114:115], v[120:121] op_sel:[0,1] op_sel_hi:[1,1]
v_pk_mul_f32 v[212:213], v[116:117], v[120:121] op_sel:[0,1] op_sel_hi:[1,1]
v_pk_mul_f32 v[214:215], v[118:119], v[120:121] op_sel:[0,1] op_sel_hi:[1,1]
v_pk_fma_f32 v[208:209], v[184:185], v[120:121], v[208:209] op_sel:[0,0,0] op_sel_hi:[1,0,1]
v_pk_fma_f32 v[210:211], v[186:187], v[120:121], v[210:211] op_sel:[0,0,0] op_sel_hi:[1,0,1]
v_pk_fma_f32 v[212:213], v[188:189], v[120:121], v[212:213] op_sel:[0,0,0] op_sel_hi:[1,0,1]
v_pk_fma_f32 v[214:215], v[190:191], v[120:121], v[214:215] op_sel:[0,0,0] op_sel_hi:[1,0,1]
v_pk_mul_f32 v[216:217], v[208:209], v[208:209]
v_pk_mul_f32 v[218:219], v[210:211], v[210:211]
v_pk_mul_f32 v[220:221], v[212:213], v[212:213]
v_pk_mul_f32 v[222:223], v[214:215], v[214:215]
v_pk_fma_f32 v[216:217], v[216:217], v[52:53], v[52:53] op_sel:[0,0,1] op_sel_hi:[1,0,1]
v_pk_fma_f32 v[218:219], v[218:219], v[52:53], v[52:53] op_sel:[0,0,1] op_sel_hi:[1,0,1]
v_pk_fma_f32 v[220:221], v[220:221], v[52:53], v[52:53] op_sel:[0,0,1] op_sel_hi:[1,0,1]
v_pk_fma_f32 v[222:223], v[222:223], v[52:53], v[52:53] op_sel:[0,0,1] op_sel_hi:[1,0,1]
v_pk_mul_f32 v[216:217], v[216:217], v[208:209]
v_pk_mul_f32 v[218:219], v[218:219], v[210:211]
v_pk_mul_f32 v[220:221], v[220:221], v[212:213]
v_pk_mul_f32 v[222:223], v[222:223], v[214:215]
v_exp_f32 v216, v216
v_exp_f32 v217, v217
v_exp_f32 v218, v218
v_exp_f32 v219, v219
v_exp_f32 v220, v220
v_exp_f32 v221, v221
v_exp_f32 v222, v222
v_exp_f32 v223, v223
v_pk_add_f32 v[216:217], v[216:217], 1.0 op_sel_hi:[1,0]
v_pk_add_f32 v[218:219], v[218:219], 1.0 op_sel_hi:[1,0]
v_pk_add_f32 v[220:221], v[220:221], 1.0 op_sel_hi:[1,0]
v_pk_add_f32 v[222:223], v[222:223], 1.0 op_sel_hi:[1,0]
v_rcp_f32 v216, v216
v_rcp_f32 v217, v217
v_rcp_f32 v218, v218
v_rcp_f32 v219, v219
v_rcp_f32 v220, v220
v_rcp_f32 v221, v221
v_rcp_f32 v222, v222
v_rcp_f32 v223, v223
v_pk_mul_f32 v[208:209], v[208:209], v[216:217]
v_pk_mul_f32 v[210:211], v[210:211], v[218:219]
v_pk_mul_f32 v[212:213], v[212:213], v[220:221]
v_pk_mul_f32 v[214:215], v[214:215], v[222:223]
v_cvt_pk_bf16_f32 v252, v208, v209
v_cvt_pk_bf16_f32 v253, v210, v211
v_cvt_pk_bf16_f32 v254, v212, v213
v_cvt_pk_bf16_f32 v255, v214, v215
s_xor_b32 s53, s96, 1
s_mul_i32 s53, s53, 44032
s_xor_b32 s54, s44, 2
s_lshl_b32 s54, s54, 10
s_add_u32 s53, s53, s54
s_add_u32 s63, s53, s56
buffer_store_dwordx2 v[248:249], v122, s[20:23], s63 offen offset:0 sc1
buffer_store_dwordx2 v[250:251], v122, s[20:23], s63 offen offset:256 sc1
buffer_store_dwordx2 v[252:253], v122, s[20:23], s63 offen offset:512 sc1
buffer_store_dwordx2 v[254:255], v122, s[20:23], s63 offen offset:768 sc1
s_lshr_b32 s98, s96, 1
s_lshl_b32 s98, s98, 3
s_add_u32 s98, s98, s46
s_lshl_b32 s98, s98, 1
s_add_u32 s98, s98, s91
s_lshl_b32 s98, s98, 7
s_add_u32 s98, s98, 194560
v_lshrrev_b32 v6, 2, v0
v_bfe_u32 v7, v0, 3, 2
v_and_b32 v8, 3, v0
v_lshlrev_b32 v6, 7, v6
v_lshl_add_u32 v6, v8, 3, v6
v_lshl_add_u32 v40, v7, 5, v6
v_add_u32 v40, 73728, v40
v_xor_b32 v41, 32, v40
v_xor_b32 v42, 64, v40
v_xor_b32 v43, 96, v40
s_cmp_eq_u32 s99, 1
s_cbranch_scc1 L_bd_58
s_waitcnt vmcnt(4)
v_cmp_ne_u64 vcc, v[34:35], v[26:27]
s_nop 3
s_cbranch_vccz L_ok_61
s_mov_b32 s62, 4000
L_sp_60:
s_sleep 3
buffer_load_dwordx2 v[34:35], v11, s[20:23], s97 offen sc1
s_waitcnt vmcnt(0)
v_cmp_ne_u64 vcc, v[34:35], v[26:27]
s_sub_u32 s62, s62, 1
s_cbranch_scc1 L_ok_61
s_nop 1
s_cbranch_vccnz L_sp_60
L_ok_61:
s_mul_i32 s90, s92, 90112
s_add_u32 s92, s92, 1
s_add_u32 s90, s90, s93
s_and_b32 s92, s92, 7
buffer_load_dwordx4 v[56:59], v33, s[20:23], s90 offen offset:0 sc1
buffer_load_dwordx4 v[60:63], v33, s[20:23], s90 offen offset:2048 sc1
buffer_load_dwordx4 v[64:67], v47, s[20:23], s90 offen offset:0 sc1
buffer_load_dwordx4 v[68:71], v47, s[20:23], s90 offen offset:2048 sc1
buffer_load_dwordx4 v[72:75], v55, s[20:23], s90 offen offset:0 sc1
buffer_load_dwordx4 v[76:79], v55, s[20:23], s90 offen offset:2048 sc1
buffer_load_dwordx4 v[80:83], v33, s[20:23], s90 offen offset:1024 sc1
buffer_load_dwordx4 v[84:87], v33, s[20:23], s90 offen offset:3072 sc1
buffer_load_dwordx4 v[88:91], v47, s[20:23], s90 offen offset:1024 sc1
buffer_load_dwordx4 v[92:95], v47, s[20:23], s90 offen offset:3072 sc1
buffer_load_dwordx4 v[96:99], v55, s[20:23], s90 offen offset:1024 sc1
buffer_load_dwordx4 v[100:103], v55, s[20:23], s90 offen offset:3072 sc1
L_bd_58:
s_cmp_eq_u32 s48, 7
s_cbranch_scc1 L_light
s_mul_i32 s90, s92, 90112
s_add_u32 s92, s92, 1
s_add_u32 s90, s90, s93
s_and_b32 s92, s92, 7
buffer_load_dwordx4 v[104:107], v33, s[20:23], s90 offen offset:0 sc1
buffer_load_dwordx4 v[108:111], v33, s[20:23], s90 offen offset:2048 sc1
buffer_load_dwordx4 v[112:115], v47, s[20:23], s90 offen offset:0 sc1
s_waitcnt vmcnt(14)
v_mfma_f32_16x16x32_bf16 v[128:131], v[56:59], a[0:3], 0
s_lshl_b32 s87, s44, 2
s_add_u32 s87, s87, s47
s_add_u32 s87, s87, 3
v_mfma_f32_16x16x32_bf16 v[152:155], v[56:59], a[4:7], 0
s_mov_b64 exec, 1
buffer_store_dwordx2 v[26:27], v14, s[20:23], s98 offen sc1
s_mov_b64 exec, -1
v_mfma_f32_16x16x32_bf16 v[176:179], v[56:59], a[8:11], 0
s_and_b32 s87, s87, 15
v_mfma_f32_16x16x32_bf16 v[200:203], v[56:59], a[12:15], 0
buffer_load_dwordx4 v[56:59], v47, s[20:23], s90 offen offset:2048 sc1
s_waitcnt vmcnt(15)
v_mfma_f32_16x16x32_bf16 v[132:135], v[60:63], a[0:3], 0
s_lshl_b32 m0, s87, 12
s_add_u32 m0, m0, 73728
v_mfma_f32_16x16x32_bf16 v[156:159], v[60:63], a[4:7], 0
s_lshl_b32 s87, s87, 15
buffer_load_dwordx4 v28, s[24:27], s87 offen lds
v_mfma_f32_16x16x32_bf16 v[180:183], v[60:63], a[8:11], 0
v_mfma_f32_16x16x32_bf16 v[204:207], v[60:63], a[12:15], 0
buffer_load_dwordx4 v[60:63], v55, s[20:23], s90 offen offset:0 sc1
s_waitcnt vmcnt(16)
v_mfma_f32_16x16x32_bf16 v[136:139], v[64:67], a[0:3], 0
buffer_load_dwordx4 v29, s[24:27], s87 offen offset:1024 lds
v_mfma_f32_16x16x32_bf16 v[160:163], v[64:67], a[4:7], 0
v_mfma_f32_16x16x32_bf16 v[184:187], v[64:67], a[8:11], 0
buffer_load_dwordx4 v30, s[24:27], s87 offen offset:2048 lds
v_mfma_f32_16x16x32_bf16 v[208:211], v[64:67], a[12:15], 0
buffer_load_dwordx4 v[64:67], v55, s[20:23], s90 offen offset:2048 sc1
s_waitcnt vmcnt(18)
v_mfma_f32_16x16x32_bf16 v[140:143], v[68:71], a[0:3], 0
v_mfma_f32_16x16x32_bf16 v[164:167], v[68:71], a[4:7], 0
buffer_load_dwordx4 v31, s[24:27], s87 offen offset:3072 lds
v_mfma_f32_16x16x32_bf16 v[188:191], v[68:71], a[8:11], 0
v_mfma_f32_16x16x32_bf16 v[212:215], v[68:71], a[12:15], 0
buffer_load_dwordx4 v[68:71], v33, s[20:23], s90 offen offset:1024 sc1
s_waitcnt vmcnt(19)
v_mfma_f32_16x16x32_bf16 v[144:147], v[72:75], a[0:3], 0
v_mfma_f32_16x16x32_bf16 v[168:171], v[72:75], a[4:7], 0
v_mfma_f32_16x16x32_bf16 v[192:195], v[72:75], a[8:11], 0
v_mfma_f32_16x16x32_bf16 v[216:219], v[72:75], a[12:15], 0
buffer_load_dwordx4 v[72:75], v33, s[20:23], s90 offen offset:3072 sc1
s_waitcnt vmcnt(19)
v_mfma_f32_16x16x32_bf16 v[148:151], v[76:79], a[0:3], 0
v_mfma_f32_16x16x32_bf16 v[172:175], v[76:79], a[4:7], 0
v_mfma_f32_16x16x32_bf16 v[196:199], v[76:79], a[8:11], 0
v_mfma_f32_16x16x32_bf16 v[220:223], v[76:79], a[12:15], 0
buffer_load_dwordx4 v[76:79], v47, s[20:23], s90 offen offset:1024 sc1
s_waitcnt vmcnt(19)
v_mfma_f32_16x16x32_bf16 v[128:131], v[80:83], a[16:19], v[128:131]
v_mfma_f32_16x16x32_bf16 v[152:155], v[80:83], a[20:23], v[152:155]
v_mfma_f32_16x16x32_bf16 v[176:179], v[80:83], a[24:27], v[176:179]
v_mfma_f32_16x16x32_bf16 v[200:203], v[80:83], a[28:31], v[200:203]
buffer_load_dwordx4 v[80:83], v47, s[20:23], s90 offen offset:3072 sc1
s_waitcnt vmcnt(19)
v_mfma_f32_16x16x32_bf16 v[132:135], v[84:87], a[16:19], v[132:135]
v_mfma_f32_16x16x32_bf16 v[156:159], v[84:87], a[20:23], v[156:159]
v_mfma_f32_16x16x32_bf16 v[180:183], v[84:87], a[24:27], v[180:183]
v_mfma_f32_16x16x32_bf16 v[204:207], v[84:87], a[28:31], v[204:207]
buffer_load_dwordx4 v[84:87], v55, s[20:23], s90 offen offset:1024 sc1
s_waitcnt vmcnt(19)
v_mfma_f32_16x16x32_bf16 v[136:139], v[88:91], a[16:19], v[136:139]
v_mfma_f32_16x16x32_bf16 v[160:163], v[88:91], a[20:23], v[160:163]
v_mfma_f32_16x16x32_bf16 v[184:187], v[88:91], a[24:27], v[184:187]
v_mfma_f32_16x16x32_bf16 v[208:211], v[88:91], a[28:31], v[208:211]
buffer_load_dwordx4 v[88:91], v55, s[20:23], s90 offen offset:3072 sc1
s_waitcnt vmcnt(19)
v_mfma_f32_16x16x32_bf16 v[140:143], v[92:95], a[16:19], v[140:143]
v_mfma_f32_16x16x32_bf16 v[164:167], v[92:95], a[20:23], v[164:167]
v_mfma_f32_16x16x32_bf16 v[188:191], v[92:95], a[24:27], v[188:191]
v_mfma_f32_16x16x32_bf16 v[212:215], v[92:95], a[28:31], v[212:215]
s_mul_i32 s90, s92, 90112
s_add_u32 s92, s92, 1
s_add_u32 s90, s90, s93
s_and_b32 s92, s92, 7
buffer_load_dwordx4 v[92:95], v33, s[20:23], s90 offen offset:0 sc1
s_waitcnt vmcnt(19)
v_mfma_f32_16x16x32_bf16 v[144:147], v[96:99], a[16:19], v[144:147]
v_mfma_f32_16x16x32_bf16 v[168:171], v[96:99], a[20:23], v[168:171]
v_mfma_f32_16x16x32_bf16 v[192:195], v[96:99], a[24:27], v[192:195]
v_mfma_f32_16x16x32_bf16 v[216:219], v[96:99], a[28:31], v[216:219]
buffer_load_dwordx4 v[96:99], v33, s[20:23], s90 offen offset:2048 sc1
s_waitcnt vmcnt(19)
v_mfma_f32_16x16x32_bf16 v[148:151], v[100:103], a[16:19], v[148:151]
v_mfma_f32_16x16x32_bf16 v[172:175], v[100:103], a[20:23], v[172:175]
v_mfma_f32_16x16x32_bf16 v[196:199], v[100:103], a[24:27], v[196:199]
v_mfma_f32_16x16x32_bf16 v[220:223], v[100:103], a[28:31], v[220:223]
buffer_load_dwordx4 v[100:103], v47, s[20:23], s90 offen offset:0 sc1
s_waitcnt vmcnt(19)
v_mfma_f32_16x16x32_bf16 v[128:131], v[104:107], a[32:35], v[128:131]
v_mfma_f32_16x16x32_bf16 v[152:155], v[104:107], a[36:39], v[152:155]
v_mfma_f32_16x16x32_bf16 v[176:179], v[104:107], a[40:43], v[176:179]
v_mfma_f32_16x16x32_bf16 v[200:203], v[104:107], a[44:47], v[200:203]
buffer_load_dwordx4 v[104:107], v47, s[20:23], s90 offen offset:2048 sc1
s_waitcnt vmcnt(19)
v_mfma_f32_16x16x32_bf16 v[132:135], v[108:111], a[32:35], v[132:135]
v_mfma_f32_16x16x32_bf16 v[156:159], v[108:111], a[36:39], v[156:159]
v_mfma_f32_16x16x32_bf16 v[180:183], v[108:111], a[40:43], v[180:183]
v_mfma_f32_16x16x32_bf16 v[204:207], v[108:111], a[44:47], v[204:207]
buffer_load_dwordx4 v[108:111], v55, s[20:23], s90 offen offset:0 sc1
s_waitcnt vmcnt(19)
v_mfma_f32_16x16x32_bf16 v[136:139], v[112:115], a[32:35], v[136:139]
v_mfma_f32_16x16x32_bf16 v[160:163], v[112:115], a[36:39], v[160:163]
v_mfma_f32_16x16x32_bf16 v[184:187], v[112:115], a[40:43], v[184:187]
v_mfma_f32_16x16x32_bf16 v[208:211], v[112:115], a[44:47], v[208:211]
buffer_load_dwordx4 v[112:115], v55, s[20:23], s90 offen offset:2048 sc1
s_waitcnt vmcnt(18)
v_mfma_f32_16x16x32_bf16 v[140:143], v[56:59], a[32:35], v[140:143]
v_mfma_f32_16x16x32_bf16 v[164:167], v[56:59], a[36:39], v[164:167]
v_mfma_f32_16x16x32_bf16 v[188:191], v[56:59], a[40:43], v[188:191]
v_mfma_f32_16x16x32_bf16 v[212:215], v[56:59], a[44:47], v[212:215]
buffer_load_dwordx4 v[56:59], v33, s[20:23], s90 offen offset:1024 sc1
s_waitcnt vmcnt(17)
v_mfma_f32_16x16x32_bf16 v[144:147], v[60:63], a[32:35], v[144:147]
v_mfma_f32_16x16x32_bf16 v[168:171], v[60:63], a[36:39], v[168:171]
v_mfma_f32_16x16x32_bf16 v[192:195], v[60:63], a[40:43], v[192:195]
v_mfma_f32_16x16x32_bf16 v[216:219], v[60:63], a[44:47], v[216:219]
buffer_load_dwordx4 v[60:63], v33, s[20:23], s90 offen offset:3072 sc1
s_waitcnt vmcnt(15)
v_mfma_f32_16x16x32_bf16 v[148:151], v[64:67], a[32:35], v[148:151]
v_mfma_f32_16x16x32_bf16 v[172:175], v[64:67], a[36:39], v[172:175]
v_mfma_f32_16x16x32_bf16 v[196:199], v[64:67], a[40:43], v[196:199]
v_mfma_f32_16x16x32_bf16 v[220:223], v[64:67], a[44:47], v[220:223]
buffer_load_dwordx4 v[64:67], v47, s[20:23], s90 offen offset:1024 sc1
s_waitcnt vmcnt(14)
v_mfma_f32_16x16x32_bf16 v[128:131], v[68:71], a[48:51], v[128:131]
v_mfma_f32_16x16x32_bf16 v[152:155], v[68:71], a[52:55], v[152:155]
v_mfma_f32_16x16x32_bf16 v[176:179], v[68:71], a[56:59], v[176:179]
v_mfma_f32_16x16x32_bf16 v[200:203], v[68:71], a[60:63], v[200:203]
buffer_load_dwordx4 v[68:71], v47, s[20:23], s90 offen offset:3072 sc1
s_waitcnt vmcnt(14)
v_mfma_f32_16x16x32_bf16 v[132:135], v[72:75], a[48:51], v[132:135]
v_mfma_f32_16x16x32_bf16 v[156:159], v[72:75], a[52:55], v[156:159]
v_mfma_f32_16x16x32_bf16 v[180:183], v[72:75], a[56:59], v[180:183]
v_mfma_f32_16x16x32_bf16 v[204:207], v[72:75], a[60:63], v[204:207]
buffer_load_dwordx4 v[72:75], v55, s[20:23], s90 offen offset:1024 sc1
s_waitcnt vmcnt(14)
v_mfma_f32_16x16x32_bf16 v[136:139], v[76:79], a[48:51], v[136:139]
v_mfma_f32_16x16x32_bf16 v[160:163], v[76:79], a[52:55], v[160:163]
v_mfma_f32_16x16x32_bf16 v[184:187], v[76:79], a[56:59], v[184:187]
v_mfma_f32_16x16x32_bf16 v[208:211], v[76:79], a[60:63], v[208:211]
buffer_load_dwordx4 v[76:79], v55, s[20:23], s90 offen offset:3072 sc1
s_waitcnt vmcnt(14)
v_mfma_f32_16x16x32_bf16 v[140:143], v[80:83], a[48:51], v[140:143]
v_mfma_f32_16x16x32_bf16 v[164:167], v[80:83], a[52:55], v[164:167]
v_mfma_f32_16x16x32_bf16 v[188:191], v[80:83], a[56:59], v[188:191]
v_mfma_f32_16x16x32_bf16 v[212:215], v[80:83], a[60:63], v[212:215]
s_mul_i32 s90, s92, 90112
s_add_u32 s92, s92, 1
s_add_u32 s90, s90, s93
s_and_b32 s92, s92, 7
buffer_load_dwordx4 v[80:83], v33, s[20:23], s90 offen offset:0 sc1
s_waitcnt vmcnt(14)
v_mfma_f32_16x16x32_bf16 v[144:147], v[84:87], a[48:51], v[144:147]
v_mfma_f32_16x16x32_bf16 v[168:171], v[84:87], a[52:55], v[168:171]
v_mfma_f32_16x16x32_bf16 v[192:195], v[84:87], a[56:59], v[192:195]
v_mfma_f32_16x16x32_bf16 v[216:219], v[84:87], a[60:63], v[216:219]
buffer_load_dwordx4 v[84:87], v33, s[20:23], s90 offen offset:2048 sc1
s_waitcnt vmcnt(14)
v_mfma_f32_16x16x32_bf16 v[148:151], v[88:91], a[48:51], v[148:151]
v_mfma_f32_16x16x32_bf16 v[172:175], v[88:91], a[52:55], v[172:175]
v_mfma_f32_16x16x32_bf16 v[196:199], v[88:91], a[56:59], v[196:199]
v_mfma_f32_16x16x32_bf16 v[220:223], v[88:91], a[60:63], v[220:223]
buffer_load_dwordx4 v[88:91], v47, s[20:23], s90 offen offset:0 sc1
s_waitcnt vmcnt(14)
v_mfma_f32_16x16x32_bf16 v[128:131], v[92:95], a[64:67], v[128:131]
v_mfma_f32_16x16x32_bf16 v[152:155], v[92:95], a[68:71], v[152:155]
v_mfma_f32_16x16x32_bf16 v[176:179], v[92:95], a[72:75], v[176:179]
v_mfma_f32_16x16x32_bf16 v[200:203], v[92:95], a[76:79], v[200:203]
buffer_load_dwordx4 v[92:95], v47, s[20:23], s90 offen offset:2048 sc1
s_waitcnt vmcnt(14)
v_mfma_f32_16x16x32_bf16 v[132:135], v[96:99], a[64:67], v[132:135]
v_mfma_f32_16x16x32_bf16 v[156:159], v[96:99], a[68:71], v[156:159]
v_mfma_f32_16x16x32_bf16 v[180:183], v[96:99], a[72:75], v[180:183]
v_mfma_f32_16x16x32_bf16 v[204:207], v[96:99], a[76:79], v[204:207]
buffer_load_dwordx4 v[96:99], v55, s[20:23], s90 offen offset:0 sc1
s_waitcnt vmcnt(14)
v_mfma_f32_16x16x32_bf16 v[136:139], v[100:103], a[64:67], v[136:139]
v_mfma_f32_16x16x32_bf16 v[160:163], v[100:103], a[68:71], v[160:163]
v_mfma_f32_16x16x32_bf16 v[184:187], v[100:103], a[72:75], v[184:187]
v_mfma_f32_16x16x32_bf16 v[208:211], v[100:103], a[76:79], v[208:211]
buffer_load_dwordx4 v[100:103], v55, s[20:23], s90 offen offset:2048 sc1
s_waitcnt vmcnt(14)
v_mfma_f32_16x16x32_bf16 v[140:143], v[104:107], a[64:67], v[140:143]
v_mfma_f32_16x16x32_bf16 v[164:167], v[104:107], a[68:71], v[164:167]
v_mfma_f32_16x16x32_bf16 v[188:191], v[104:107], a[72:75], v[188:191]
v_mfma_f32_16x16x32_bf16 v[212:215], v[104:107], a[76:79], v[212:215]
buffer_load_dwordx4 v[104:107], v33, s[20:23], s90 offen offset:1024 sc1
s_waitcnt vmcnt(14)
v_mfma_f32_16x16x32_bf16 v[144:147], v[108:111], a[64:67], v[144:147]
v_mfma_f32_16x16x32_bf16 v[168:171], v[108:111], a[68:71], v[168:171]
v_mfma_f32_16x16x32_bf16 v[192:195], v[108:111], a[72:75], v[192:195]
v_mfma_f32_16x16x32_bf16 v[216:219], v[108:111], a[76:79], v[216:219]
buffer_load_dwordx4 v[108:111], v33, s[20:23], s90 offen offset:3072 sc1
s_waitcnt vmcnt(14)
v_mfma_f32_16x16x32_bf16 v[148:151], v[112:115], a[64:67], v[148:151]
v_mfma_f32_16x16x32_bf16 v[172:175], v[112:115], a[68:71], v[172:175]
v_mfma_f32_16x16x32_bf16 v[196:199], v[112:115], a[72:75], v[196:199]
v_mfma_f32_16x16x32_bf16 v[220:223], v[112:115], a[76:79], v[220:223]
buffer_load_dwordx4 v[112:115], v47, s[20:23], s90 offen offset:1024 sc1
s_waitcnt vmcnt(14)
v_mfma_f32_16x16x32_bf16 v[128:131], v[56:59], a[80:83], v[128:131]
v_mfma_f32_16x16x32_bf16 v[152:155], v[56:59], a[84:87], v[152:155]
v_mfma_f32_16x16x32_bf16 v[176:179], v[56:59], a[88:91], v[176:179]
v_mfma_f32_16x16x32_bf16 v[200:203], v[56:59], a[92:95], v[200:203]
buffer_load_dwordx4 v[56:59], v47, s[20:23], s90 offen offset:3072 sc1
s_waitcnt vmcnt(14)
v_mfma_f32_16x16x32_bf16 v[132:135], v[60:63], a[80:83], v[132:135]
v_mfma_f32_16x16x32_bf16 v[156:159], v[60:63], a[84:87], v[156:159]
v_mfma_f32_16x16x32_bf16 v[180:183], v[60:63], a[88:91], v[180:183]
v_mfma_f32_16x16x32_bf16 v[204:207], v[60:63], a[92:95], v[204:207]
buffer_load_dwordx4 v[60:63], v55, s[20:23], s90 offen offset:1024 sc1
s_waitcnt vmcnt(14)
v_mfma_f32_16x16x32_bf16 v[136:139], v[64:67], a[80:83], v[136:139]
v_mfma_f32_16x16x32_bf16 v[160:163], v[64:67], a[84:87], v[160:163]
v_mfma_f32_16x16x32_bf16 v[184:187], v[64:67], a[88:91], v[184:187]
v_mfma_f32_16x16x32_bf16 v[208:211], v[64:67], a[92:95], v[208:211]
buffer_load_dwordx4 v[64:67], v55, s[20:23], s90 offen offset:3072 sc1
s_waitcnt vmcnt(14)
v_mfma_f32_16x16x32_bf16 v[140:143], v[68:71], a[80:83], v[140:143]
v_mfma_f32_16x16x32_bf16 v[164:167], v[68:71], a[84:87], v[164:167]
v_mfma_f32_16x16x32_bf16 v[188:191], v[68:71], a[88:91], v[188:191]
v_mfma_f32_16x16x32_bf16 v[212:215], v[68:71], a[92:95], v[212:215]
s_mul_i32 s90, s92, 90112
s_add_u32 s92, s92, 1
s_add_u32 s90, s90, s93
s_and_b32 s92, s92, 7
buffer_load_dwordx4 v[68:71], v33, s[20:23], s90 offen offset:0 sc1
s_waitcnt vmcnt(14)
v_mfma_f32_16x16x32_bf16 v[144:147], v[72:75], a[80:83], v[144:147]
v_mfma_f32_16x16x32_bf16 v[168:171], v[72:75], a[84:87], v[168:171]
v_mfma_f32_16x16x32_bf16 v[192:195], v[72:75], a[88:91], v[192:195]
v_mfma_f32_16x16x32_bf16 v[216:219], v[72:75], a[92:95], v[216:219]
buffer_load_dwordx4 v[72:75], v33, s[20:23], s90 offen offset:2048 sc1
s_waitcnt vmcnt(14)
v_mfma_f32_16x16x32_bf16 v[148:151], v[76:79], a[80:83], v[148:151]
v_mfma_f32_16x16x32_bf16 v[172:175], v[76:79], a[84:87], v[172:175]
v_mfma_f32_16x16x32_bf16 v[196:199], v[76:79], a[88:91], v[196:199]
v_mfma_f32_16x16x32_bf16 v[220:223], v[76:79], a[92:95], v[220:223]
buffer_load_dwordx4 v[76:79], v47, s[20:23], s90 offen offset:0 sc1
s_waitcnt lgkmcnt(0)
s_barrier
s_waitcnt vmcnt(14)
v_mfma_f32_16x16x32_bf16 v[128:131], v[80:83], a[96:99], v[128:131]
v_mfma_f32_16x16x32_bf16 v[152:155], v[80:83], a[100:103], v[152:155]
v_mfma_f32_16x16x32_bf16 v[176:179], v[80:83], a[104:107], v[176:179]
v_mfma_f32_16x16x32_bf16 v[200:203], v[80:83], a[108:111], v[200:203]
buffer_load_dwordx4 v[80:83], v47, s[20:23], s90 offen offset:2048 sc1
s_waitcnt vmcnt(14)
v_mfma_f32_16x16x32_bf16 v[132:135], v[84:87], a[96:99], v[132:135]
v_mfma_f32_16x16x32_bf16 v[156:159], v[84:87], a[100:103], v[156:159]
v_mfma_f32_16x16x32_bf16 v[180:183], v[84:87], a[104:107], v[180:183]
v_mfma_f32_16x16x32_bf16 v[204:207], v[84:87], a[108:111], v[204:207]
buffer_load_dwordx4 v[84:87], v55, s[20:23], s90 offen offset:0 sc1
s_waitcnt vmcnt(14)
v_mfma_f32_16x16x32_bf16 v[136:139], v[88:91], a[96:99], v[136:139]
v_mfma_f32_16x16x32_bf16 v[160:163], v[88:91], a[100:103], v[160:163]
v_mfma_f32_16x16x32_bf16 v[184:187], v[88:91], a[104:107], v[184:187]
v_mfma_f32_16x16x32_bf16 v[208:211], v[88:91], a[108:111], v[208:211]
buffer_load_dwordx4 v[88:91], v55, s[20:23], s90 offen offset:2048 sc1
s_waitcnt vmcnt(14)
v_mfma_f32_16x16x32_bf16 v[140:143], v[92:95], a[96:99], v[140:143]
s_lshl_b32 s97, s47, 2
ds_read_b64_tr_b16 a[64:65], v40 offset:0
s_add_u32 s97, s97, s44
v_mfma_f32_16x16x32_bf16 v[164:167], v[92:95], a[100:103], v[164:167]
ds_read_b64_tr_b16 a[66:67], v40 offset:2048
s_mul_i32 s0, s97, 43
s_lshl_b32 s1, s88, 1
ds_read_b64_tr_b16 a[68:69], v41 offset:0
v_mfma_f32_16x16x32_bf16 v[188:191], v[92:95], a[104:107], v[188:191]
s_add_u32 s0, s0, s1
s_lshl_b32 s0, s0, 9
ds_read_b64_tr_b16 a[70:71], v41 offset:2048
v_mfma_f32_16x16x32_bf16 v[212:215], v[92:95], a[108:111], v[212:215]
buffer_load_dwordx4 v[92:95], v33, s[20:23], s90 offen offset:1024 sc1
s_waitcnt vmcnt(14)
v_mfma_f32_16x16x32_bf16 v[144:147], v[96:99], a[96:99], v[144:147]
s_add_u32 s70, s0, 3145216
s_mul_i32 s0, s97, 22
ds_read_b64_tr_b16 a[72:73], v42 offset:0
v_mfma_f32_16x16x32_bf16 v[168:171], v[96:99], a[100:103], v[168:171]
s_add_u32 s0, s0, s88
s_lshl_b32 s0, s0, 10
ds_read_b64_tr_b16 a[74:75], v42 offset:2048
v_mfma_f32_16x16x32_bf16 v[192:195], v[96:99], a[104:107], v[192:195]
s_add_u32 s71, s0, 9437184
s_cmp_eq_u32 s89, 3
s_cselect_b32 s72, s71, 0x40000000
ds_read_b64_tr_b16 a[76:77], v43 offset:0
v_mfma_f32_16x16x32_bf16 v[216:219], v[96:99], a[108:111], v[216:219]
buffer_load_dwordx4 v[96:99], v33, s[20:23], s90 offen offset:3072 sc1
s_waitcnt vmcnt(14)
v_mfma_f32_16x16x32_bf16 v[148:151], v[100:103], a[96:99], v[148:151]
s_cmp_eq_u32 s48, 0
s_cselect_b32 s68, 0, -1
ds_read_b64_tr_b16 a[78:79], v43 offset:2048
v_mfma_f32_16x16x32_bf16 v[172:175], v[100:103], a[100:103], v[172:175]
v_lshlrev_b32 v10, 1, v4
s_lshl_b32 s86, s97, 5
v_mfma_f32_16x16x32_bf16 v[196:199], v[100:103], a[104:107], v[196:199]
buffer_load_ushort v39, v10, s[36:39], s86 offen
v_mfma_f32_16x16x32_bf16 v[220:223], v[100:103], a[108:111], v[220:223]
buffer_load_dwordx4 v[100:103], v47, s[20:23], s90 offen offset:1024 sc1
s_waitcnt vmcnt(15)
v_mfma_f32_16x16x32_bf16 v[128:131], v[104:107], a[112:115], v[128:131]
ds_read_b64_tr_b16 a[80:81], v40 offset:4096
ds_read_b64_tr_b16 a[82:83], v40 offset:6144
v_mfma_f32_16x16x32_bf16 v[152:155], v[104:107], a[116:119], v[152:155]
ds_read_b64_tr_b16 a[84:85], v41 offset:4096
s_xor_b32 s0, s44, 2
s_mul_i32 s0, s0, 12288
ds_read_b64_tr_b16 a[86:87], v41 offset:6144
v_mfma_f32_16x16x32_bf16 v[176:179], v[104:107], a[120:123], v[176:179]
s_add_u32 s0, s0, 65536
v_add_u32 v20, s0, v32
ds_read_b64_tr_b16 a[88:89], v42 offset:4096
v_mfma_f32_16x16x32_bf16 v[200:203], v[104:107], a[124:127], v[200:203]
buffer_load_dwordx4 v[104:107], v47, s[20:23], s90 offen offset:3072 sc1
s_waitcnt vmcnt(15)
v_mfma_f32_16x16x32_bf16 v[132:135], v[108:111], a[112:115], v[132:135]
s_xor_b32 s0, s44, 0
s_mul_i32 s0, s0, 12288
ds_read_b64_tr_b16 a[90:91], v42 offset:6144
v_mfma_f32_16x16x32_bf16 v[156:159], v[108:111], a[116:119], v[156:159]
s_add_u32 s0, s0, 65536
ds_read_b64_tr_b16 a[92:93], v43 offset:4096
v_add_u32 v21, s0, v32
s_xor_b32 s0, s44, 1
v_mfma_f32_16x16x32_bf16 v[180:183], v[108:111], a[120:123], v[180:183]
ds_read_b64_tr_b16 a[94:95], v43 offset:6144
s_mul_i32 s0, s0, 12288
s_add_u32 s0, s0, 65536
v_mfma_f32_16x16x32_bf16 v[204:207], v[108:111], a[124:127], v[204:207]
buffer_load_dwordx4 v[108:111], v55, s[20:23], s90 offen offset:1024 sc1
s_waitcnt vmcnt(15)
v_mfma_f32_16x16x32_bf16 v[136:139], v[112:115], a[112:115], v[136:139]
v_add_u32 v22, s0, v32
s_lshl_b32 s97, s97, 10
s_add_u32 s73, s97, 12779520
v_mfma_f32_16x16x32_bf16 v[160:163], v[112:115], a[116:119], v[160:163]
s_lshl_b32 s1, s48, 7
s_add_u32 s98, s1, s73
s_lshl_b32 s0, s47, 2
v_mfma_f32_16x16x32_bf16 v[184:187], v[112:115], a[120:123], v[184:187]
s_add_u32 s74, s0, s44
v_lshlrev_b32 v52, 10, v4
v_lshl_add_u32 v52, v3, 3, v52
s_lshl_b32 s0, s74, 14
v_mfma_f32_16x16x32_bf16 v[208:211], v[112:115], a[124:127], v[208:211]
buffer_load_dwordx4 v[112:115], v55, s[20:23], s90 offen offset:3072 sc1
s_waitcnt vmcnt(15)
v_mfma_f32_16x16x32_bf16 v[140:143], v[56:59], a[112:115], v[140:143]
ds_read_b64_tr_b16 a[96:97], v40 offset:8192
s_lshl_b32 s1, s48, 7
ds_read_b64_tr_b16 a[98:99], v40 offset:10240
v_mfma_f32_16x16x32_bf16 v[164:167], v[56:59], a[116:119], v[164:167]
s_add_u32 s0, s0, s1
v_add_u32 v52, s0, v52
ds_read_b64_tr_b16 a[100:101], v41 offset:8192
v_mfma_f32_16x16x32_bf16 v[188:191], v[56:59], a[120:123], v[188:191]
s_mul_i32 s74, s74, 22528
s_add_u32 s74, s74, 9437184
ds_read_b64_tr_b16 a[102:103], v41 offset:10240
v_subrev_u32 v48, 73728, v40
v_mfma_f32_16x16x32_bf16 v[212:215], v[56:59], a[124:127], v[212:215]
s_mul_i32 s90, s92, 90112
s_add_u32 s92, s92, 1
s_add_u32 s90, s90, s93
s_and_b32 s92, s92, 7
buffer_load_dwordx4 v[56:59], v33, s[20:23], s90 offen offset:0 sc1
s_waitcnt vmcnt(15)
v_mfma_f32_16x16x32_bf16 v[144:147], v[60:63], a[112:115], v[144:147]
v_mfma_f32_16x16x32_bf16 v[168:171], v[60:63], a[116:119], v[168:171]
v_subrev_u32 v49, 73728, v41
ds_read_b64_tr_b16 a[104:105], v42 offset:8192
v_mfma_f32_16x16x32_bf16 v[192:195], v[60:63], a[120:123], v[192:195]
v_subrev_u32 v50, 73728, v42
v_subrev_u32 v51, 73728, v43
ds_read_b64_tr_b16 a[106:107], v42 offset:10240
v_mfma_f32_16x16x32_bf16 v[216:219], v[60:63], a[124:127], v[216:219]
buffer_load_dwordx4 v[60:63], v33, s[20:23], s90 offen offset:2048 sc1
s_waitcnt vmcnt(15)
v_mfma_f32_16x16x32_bf16 v[148:151], v[64:67], a[112:115], v[148:151]
v_add_u32 v16, 65536, v48
v_add_u32 v17, 65536, v49
ds_read_b64_tr_b16 a[108:109], v43 offset:8192
v_mfma_f32_16x16x32_bf16 v[172:175], v[64:67], a[116:119], v[172:175]
v_add_u32 v18, 65536, v50
v_add_u32 v19, 65536, v51
ds_read_b64_tr_b16 a[110:111], v43 offset:10240
v_and_b32 v9, 1, v0
v_mfma_f32_16x16x32_bf16 v[196:199], v[64:67], a[120:123], v[196:199]
v_lshlrev_b32 v9, 6, v9
v_lshl_add_u32 v9, v3, 4, v9
v_add_u32 v53, 155648, v9
v_mfma_f32_16x16x32_bf16 v[220:223], v[64:67], a[124:127], v[220:223]
buffer_load_dwordx4 v[64:67], v47, s[20:23], s90 offen offset:0 sc1
s_waitcnt vmcnt(15)
v_mfma_f32_16x16x32_bf16 v[128:131], v[68:71], a[128:131], v[128:131]
s_lshl_b32 s87, s44, 2
v_add_u32 v242, 139264, v32
s_add_u32 s87, s87, s47
v_mfma_f32_16x16x32_bf16 v[152:155], v[68:71], a[132:135], v[152:155]
v_lshlrev_b32 v243, 7, v1
v_add_u32 v23, s57, v242
s_add_u32 s87, s87, 0
v_mfma_f32_16x16x32_bf16 v[176:179], v[68:71], a[136:139], v[176:179]
v_lshlrev_b32 v10, 3, v0
s_lshl_b32 s0, s44, 9
s_and_b32 s87, s87, 15
s_add_u32 s0, s0, 155648
v_mfma_f32_16x16x32_bf16 v[200:203], v[68:71], a[140:143], v[200:203]
buffer_load_dwordx4 v[68:71], v47, s[20:23], s90 offen offset:2048 sc1
s_waitcnt vmcnt(15)
v_mfma_f32_16x16x32_bf16 v[132:135], v[72:75], a[128:131], v[132:135]
v_add_u32 v38, s0, v10
s_lshl_b32 m0, s87, 12
s_lshl_b32 s87, s87, 15
v_mfma_f32_16x16x32_bf16 v[156:159], v[72:75], a[132:135], v[156:159]
s_sub_u32 s56, s87, 16384
s_cselect_b32 s56, 0x40000000, s56
v_mfma_f32_16x16x32_bf16 v[180:183], v[72:75], a[136:139], v[180:183]
buffer_load_dwordx4 v28, s[28:31], s56 offen lds
v_mfma_f32_16x16x32_bf16 v[204:207], v[72:75], a[140:143], v[204:207]
buffer_load_dwordx4 v[72:75], v55, s[20:23], s90 offen offset:0 sc1
s_waitcnt vmcnt(16)
v_mfma_f32_16x16x32_bf16 v[136:139], v[76:79], a[128:131], v[136:139]
v_mfma_f32_16x16x32_bf16 v[160:163], v[76:79], a[132:135], v[160:163]
buffer_load_dwordx4 v29, s[28:31], s56 offen offset:1024 lds
v_mfma_f32_16x16x32_bf16 v[184:187], v[76:79], a[136:139], v[184:187]
s_add_u32 m0, m0, 2048
s_nop 0
v_mfma_f32_16x16x32_bf16 v[208:211], v[76:79], a[140:143], v[208:211]
buffer_load_dwordx4 v[76:79], v55, s[20:23], s90 offen offset:2048 sc1
s_waitcnt vmcnt(17)
v_mfma_f32_16x16x32_bf16 v[140:143], v[80:83], a[128:131], v[140:143]
buffer_load_dwordx4 v28, s[28:31], s87 offen lds
v_mfma_f32_16x16x32_bf16 v[164:167], v[80:83], a[132:135], v[164:167]
v_mfma_f32_16x16x32_bf16 v[188:191], v[80:83], a[136:139], v[188:191]
buffer_load_dwordx4 v29, s[28:31], s87 offen offset:1024 lds
v_mfma_f32_16x16x32_bf16 v[212:215], v[80:83], a[140:143], v[212:215]
buffer_load_dwordx4 v[80:83], v33, s[20:23], s90 offen offset:1024 sc1
s_waitcnt vmcnt(19)
v_mfma_f32_16x16x32_bf16 v[144:147], v[84:87], a[128:131], v[144:147]
v_mfma_f32_16x16x32_bf16 v[168:171], v[84:87], a[132:135], v[168:171]
v_mfma_f32_16x16x32_bf16 v[192:195], v[84:87], a[136:139], v[192:195]
v_mfma_f32_16x16x32_bf16 v[216:219], v[84:87], a[140:143], v[216:219]
buffer_load_dwordx4 v[84:87], v33, s[20:23], s90 offen offset:3072 sc1
s_waitcnt vmcnt(19)
v_mfma_f32_16x16x32_bf16 v[148:151], v[88:91], a[128:131], v[148:151]
v_mfma_f32_16x16x32_bf16 v[172:175], v[88:91], a[132:135], v[172:175]
v_mfma_f32_16x16x32_bf16 v[196:199], v[88:91], a[136:139], v[196:199]
v_mfma_f32_16x16x32_bf16 v[220:223], v[88:91], a[140:143], v[220:223]
buffer_load_dwordx4 v[88:91], v47, s[20:23], s90 offen offset:1024 sc1
s_waitcnt vmcnt(19)
v_mfma_f32_16x16x32_bf16 v[128:131], v[92:95], a[144:147], v[128:131]
v_lshrrev_b32 v11, 3, v0
s_lshl_b32 s87, s44, 2
v_lshlrev_b32 v11, 8, v11
v_mfma_f32_16x16x32_bf16 v[152:155], v[92:95], a[148:151], v[152:155]
s_add_u32 s87, s87, s47
v_bfe_u32 v12, v0, 2, 1
v_lshl_add_u32 v11, v12, 7, v11
s_add_u32 s87, s87, 1
v_mfma_f32_16x16x32_bf16 v[176:179], v[92:95], a[152:155], v[176:179]
s_lshl_b32 s86, s47, 11
s_add_u32 s86, s86, 196608
s_and_b32 s87, s87, 15
v_mfma_f32_16x16x32_bf16 v[200:203], v[92:95], a[156:159], v[200:203]
buffer_load_dwordx4 v[92:95], v47, s[20:23], s90 offen offset:3072 sc1
s_waitcnt vmcnt(19)
v_mfma_f32_16x16x32_bf16 v[132:135], v[96:99], a[144:147], v[132:135]
buffer_load_dwordx2 v[34:35], v11, s[20:23], s86 offen sc1
v_mfma_f32_16x16x32_bf16 v[156:159], v[96:99], a[148:151], v[156:159]
s_lshl_b32 m0, s87, 12
s_lshl_b32 s87, s87, 15
v_mfma_f32_16x16x32_bf16 v[180:183], v[96:99], a[152:155], v[180:183]
s_sub_u32 s56, s87, 16384
s_cselect_b32 s56, 0x40000000, s56
v_mfma_f32_16x16x32_bf16 v[204:207], v[96:99], a[156:159], v[204:207]
buffer_load_dwordx4 v[96:99], v55, s[20:23], s90 offen offset:1024 sc1
s_waitcnt vmcnt(19)
v_mfma_f32_16x16x32_bf16 v[136:139], v[100:103], a[144:147], v[136:139]
buffer_load_dwordx4 v28, s[28:31], s56 offen lds
v_mfma_f32_16x16x32_bf16 v[160:163], v[100:103], a[148:151], v[160:163]
v_mfma_f32_16x16x32_bf16 v[184:187], v[100:103], a[152:155], v[184:187]
buffer_load_dwordx4 v29, s[28:31], s56 offen offset:1024 lds
v_mfma_f32_16x16x32_bf16 v[208:211], v[100:103], a[156:159], v[208:211]
buffer_load_dwordx4 v[100:103], v55, s[20:23], s90 offen offset:3072 sc1
s_waitcnt vmcnt(21)
v_mfma_f32_16x16x32_bf16 v[140:143], v[104:107], a[144:147], v[140:143]
s_add_u32 m0, m0, 2048
s_nop 0
v_mfma_f32_16x16x32_bf16 v[164:167], v[104:107], a[148:151], v[164:167]
buffer_load_dwordx4 v28, s[28:31], s87 offen lds
v_mfma_f32_16x16x32_bf16 v[188:191], v[104:107], a[152:155], v[188:191]
buffer_load_dwordx4 v29, s[28:31], s87 offen offset:1024 lds
v_mfma_f32_16x16x32_bf16 v[212:215], v[104:107], a[156:159], v[212:215]
s_mul_i32 s90, s92, 90112
s_add_u32 s92, s92, 1
s_add_u32 s90, s90, s93
s_and_b32 s92, s92, 7
buffer_load_dwordx4 v[104:107], v33, s[20:23], s90 offen offset:0 sc1
s_waitcnt vmcnt(23)
v_mfma_f32_16x16x32_bf16 v[144:147], v[108:111], a[144:147], v[144:147]
v_mfma_f32_16x16x32_bf16 v[168:171], v[108:111], a[148:151], v[168:171]
v_mfma_f32_16x16x32_bf16 v[192:195], v[108:111], a[152:155], v[192:195]
v_mfma_f32_16x16x32_bf16 v[216:219], v[108:111], a[156:159], v[216:219]
buffer_load_dwordx4 v[108:111], v33, s[20:23], s90 offen offset:2048 sc1
s_waitcnt vmcnt(23)
v_mfma_f32_16x16x32_bf16 v[148:151], v[112:115], a[144:147], v[148:151]
v_mfma_f32_16x16x32_bf16 v[172:175], v[112:115], a[148:151], v[172:175]
v_mfma_f32_16x16x32_bf16 v[196:199], v[112:115], a[152:155], v[196:199]
v_mfma_f32_16x16x32_bf16 v[220:223], v[112:115], a[156:159], v[220:223]
buffer_load_dwordx4 v[112:115], v47, s[20:23], s90 offen offset:0 sc1
s_waitcnt vmcnt(23)
v_mfma_f32_16x16x32_bf16 v[128:131], v[56:59], a[160:163], v[128:131]
s_lshl_b32 s87, s44, 2
s_add_u32 s87, s87, s47
s_add_u32 s87, s87, 2
v_mfma_f32_16x16x32_bf16 v[152:155], v[56:59], a[164:167], v[152:155]
s_and_b32 s87, s87, 15
s_lshl_b32 m0, s87, 12
s_lshl_b32 s87, s87, 15
s_sub_u32 s56, s87, 16384
s_cselect_b32 s56, 0x40000000, s56
v_mfma_f32_16x16x32_bf16 v[176:179], v[56:59], a[168:171], v[176:179]
v_mfma_f32_16x16x32_bf16 v[200:203], v[56:59], a[172:175], v[200:203]
buffer_load_dwordx4 v[56:59], v47, s[20:23], s90 offen offset:2048 sc1
s_waitcnt vmcnt(23)
v_mfma_f32_16x16x32_bf16 v[132:135], v[60:63], a[160:163], v[132:135]
buffer_load_dwordx4 v28, s[28:31], s56 offen lds
v_mfma_f32_16x16x32_bf16 v[156:159], v[60:63], a[164:167], v[156:159]
v_mfma_f32_16x16x32_bf16 v[180:183], v[60:63], a[168:171], v[180:183]
buffer_load_dwordx4 v29, s[28:31], s56 offen offset:1024 lds
v_mfma_f32_16x16x32_bf16 v[204:207], v[60:63], a[172:175], v[204:207]
buffer_load_dwordx4 v[60:63], v55, s[20:23], s90 offen offset:0 sc1
s_waitcnt vmcnt(25)
v_mfma_f32_16x16x32_bf16 v[136:139], v[64:67], a[160:163], v[136:139]
s_add_u32 m0, m0, 2048
s_nop 0
v_mfma_f32_16x16x32_bf16 v[160:163], v[64:67], a[164:167], v[160:163]
buffer_load_dwordx4 v28, s[28:31], s87 offen lds
v_mfma_f32_16x16x32_bf16 v[184:187], v[64:67], a[168:171], v[184:187]
buffer_load_dwordx4 v29, s[28:31], s87 offen offset:1024 lds
v_mfma_f32_16x16x32_bf16 v[208:211], v[64:67], a[172:175], v[208:211]
buffer_load_dwordx4 v[64:67], v55, s[20:23], s90 offen offset:2048 sc1
s_waitcnt vmcnt(27)
v_mfma_f32_16x16x32_bf16 v[140:143], v[68:71], a[160:163], v[140:143]
ds_read_b64_tr_b16 a[112:113], v40 offset:12288
ds_read_b64_tr_b16 a[114:115], v40 offset:14336
v_mfma_f32_16x16x32_bf16 v[164:167], v[68:71], a[164:167], v[164:167]
s_waitcnt vmcnt(16)
v_cmp_ne_u64 vcc, v[34:35], v[26:27]
s_nop 3
s_cbranch_vccz L_ok_64
s_mov_b32 s62, 4000
L_sp_63:
s_sleep 3
v_lshrrev_b32 v11, 3, v0
v_lshlrev_b32 v11, 8, v11
v_bfe_u32 v12, v0, 2, 1
v_lshl_add_u32 v11, v12, 7, v11
s_lshl_b32 s86, s47, 11
s_add_u32 s86, s86, 196608
buffer_load_dwordx2 v[34:35], v11, s[20:23], s86 offen sc1
s_waitcnt vmcnt(0)
v_cmp_ne_u64 vcc, v[34:35], v[26:27]
s_sub_u32 s62, s62, 1
s_cbranch_scc1 L_ok_64
s_nop 1
s_cbranch_vccnz L_sp_63
L_ok_64:
v_mfma_f32_16x16x32_bf16 v[188:191], v[68:71], a[168:171], v[188:191]
v_mfma_f32_16x16x32_bf16 v[212:215], v[68:71], a[172:175], v[212:215]
buffer_load_dwordx4 v[68:71], v33, s[20:23], s90 offen offset:1024 sc1
v_mfma_f32_16x16x32_bf16 v[144:147], v[72:75], a[160:163], v[144:147]
v_mfma_f32_16x16x32_bf16 v[168:171], v[72:75], a[164:167], v[168:171]
v_mfma_f32_16x16x32_bf16 v[192:195], v[72:75], a[168:171], v[192:195]
v_mfma_f32_16x16x32_bf16 v[216:219], v[72:75], a[172:175], v[216:219]
buffer_load_dwordx4 v[72:75], v33, s[20:23], s90 offen offset:3072 sc1
v_mfma_f32_16x16x32_bf16 v[148:151], v[76:79], a[160:163], v[148:151]
v_mfma_f32_16x16x32_bf16 v[172:175], v[76:79], a[164:167], v[172:175]
ds_read_b64_tr_b16 a[116:117], v41 offset:12288
ds_read_b64_tr_b16 a[118:119], v41 offset:14336
ds_read_b64_tr_b16 a[120:121], v42 offset:12288
ds_read_b64_tr_b16 a[122:123], v42 offset:14336
v_mfma_f32_16x16x32_bf16 v[196:199], v[76:79], a[168:171], v[196:199]
ds_read_b64_tr_b16 a[124:125], v43 offset:12288
v_lshlrev_b32 v10, 3, v0
ds_read_b64_tr_b16 a[126:127], v43 offset:14336
v_mfma_f32_16x16x32_bf16 v[220:223], v[76:79], a[172:175], v[220:223]
buffer_load_dwordx4 v[76:79], v47, s[20:23], s90 offen offset:1024 sc1
v_mfma_f32_16x16x32_bf16 v[128:131], v[80:83], a[176:179], v[128:131]
buffer_load_dwordx2 v[116:117], v10, s[20:23], s70 offen offset:0 sc1
v_mfma_f32_16x16x32_bf16 v[152:155], v[80:83], a[180:183], v[152:155]
s_lshl_b32 s87, s44, 2
s_add_u32 s87, s87, s47
v_mfma_f32_16x16x32_bf16 v[176:179], v[80:83], a[184:187], v[176:179]
buffer_load_dwordx2 v[118:119], v10, s[20:23], s70 offen offset:512 sc1
v_mfma_f32_16x16x32_bf16 v[200:203], v[80:83], a[188:191], v[200:203]
buffer_load_dwordx4 v[80:83], v47, s[20:23], s90 offen offset:3072 sc1
v_mfma_f32_16x16x32_bf16 v[132:135], v[84:87], a[176:179], v[132:135]
s_add_u32 s87, s87, 3
s_and_b32 s87, s87, 15
v_mfma_f32_16x16x32_bf16 v[156:159], v[84:87], a[180:183], v[156:159]
buffer_load_dwordx2 v[120:121], v10, s[20:23], s70 offen offset:1024 sc1
v_mfma_f32_16x16x32_bf16 v[180:183], v[84:87], a[184:187], v[180:183]
s_lshl_b32 m0, s87, 12
s_lshl_b32 s87, s87, 15
s_sub_u32 s56, s87, 16384
s_cselect_b32 s56, 0x40000000, s56
v_mfma_f32_16x16x32_bf16 v[204:207], v[84:87], a[188:191], v[204:207]
buffer_load_dwordx4 v[84:87], v55, s[20:23], s90 offen offset:1024 sc1
v_mfma_f32_16x16x32_bf16 v[136:139], v[88:91], a[176:179], v[136:139]
v_mfma_f32_16x16x32_bf16 v[160:163], v[88:91], a[180:183], v[160:163]
buffer_load_dwordx2 v[122:123], v10, s[20:23], s70 offen offset:1536 sc1
v_mfma_f32_16x16x32_bf16 v[184:187], v[88:91], a[184:187], v[184:187]
buffer_load_dwordx2 v[124:125], v10, s[20:23], s70 offen offset:2048 sc1
v_mfma_f32_16x16x32_bf16 v[208:211], v[88:91], a[188:191], v[208:211]
buffer_load_dwordx4 v[88:91], v55, s[20:23], s90 offen offset:3072 sc1
v_mfma_f32_16x16x32_bf16 v[140:143], v[92:95], a[176:179], v[140:143]
v_mfma_f32_16x16x32_bf16 v[164:167], v[92:95], a[180:183], v[164:167]
buffer_load_dwordx4 v28, s[28:31], s56 offen lds
v_mfma_f32_16x16x32_bf16 v[188:191], v[92:95], a[184:187], v[188:191]
buffer_load_dwordx2 v[126:127], v10, s[20:23], s70 offen offset:2560 sc1
v_mfma_f32_16x16x32_bf16 v[212:215], v[92:95], a[188:191], v[212:215]
s_mul_i32 s90, s92, 90112
s_add_u32 s92, s92, 1
s_add_u32 s90, s90, s93
s_and_b32 s92, s92, 7
buffer_load_dwordx4 v[92:95], v33, s[20:23], s90 offen offset:0 sc1
s_waitcnt vmcnt(29)
v_mfma_f32_16x16x32_bf16 v[144:147], v[96:99], a[176:179], v[144:147]
v_mfma_f32_16x16x32_bf16 v[168:171], v[96:99], a[180:183], v[168:171]
v_mfma_f32_16x16x32_bf16 v[192:195], v[96:99], a[184:187], v[192:195]
buffer_load_dwordx4 v29, s[28:31], s56 offen offset:1024 lds
v_mfma_f32_16x16x32_bf16 v[216:219], v[96:99], a[188:191], v[216:219]
buffer_load_dwordx4 v[96:99], v33, s[20:23], s90 offen offset:2048 sc1
s_waitcnt vmcnt(28)
v_mfma_f32_16x16x32_bf16 v[148:151], v[100:103], a[176:179], v[148:151]
s_add_u32 m0, m0, 2048
s_nop 0
v_mfma_f32_16x16x32_bf16 v[172:175], v[100:103], a[180:183], v[172:175]
buffer_load_dwordx4 v28, s[28:31], s87 offen lds
v_mfma_f32_16x16x32_bf16 v[196:199], v[100:103], a[184:187], v[196:199]
buffer_load_dwordx4 v29, s[28:31], s87 offen offset:1024 lds
v_mfma_f32_16x16x32_bf16 v[220:223], v[100:103], a[188:191], v[220:223]
buffer_load_dwordx4 v[100:103], v47, s[20:23], s90 offen offset:0 sc1
s_waitcnt vmcnt(28)
v_mfma_f32_16x16x32_bf16 v[128:131], v[104:107], a[192:195], v[128:131]
ds_read_b64_tr_b16 a[128:129], v40 offset:16384
ds_read_b64_tr_b16 a[130:131], v40 offset:18432
v_mfma_f32_16x16x32_bf16 v[152:155], v[104:107], a[196:199], v[152:155]
ds_read_b64_tr_b16 a[132:133], v41 offset:16384
ds_read_b64_tr_b16 a[134:135], v41 offset:18432
ds_read_b64_tr_b16 a[136:137], v42 offset:16384
v_mfma_f32_16x16x32_bf16 v[176:179], v[104:107], a[200:203], v[176:179]
ds_read_b64_tr_b16 a[138:139], v42 offset:18432
ds_read_b64_tr_b16 a[140:141], v43 offset:16384
ds_read_b64_tr_b16 a[142:143], v43 offset:18432
v_mfma_f32_16x16x32_bf16 v[200:203], v[104:107], a[204:207], v[200:203]
buffer_load_dwordx4 v[104:107], v47, s[20:23], s90 offen offset:2048 sc1
s_waitcnt vmcnt(28)
v_mfma_f32_16x16x32_bf16 v[132:135], v[108:111], a[192:195], v[132:135]
v_mfma_f32_16x16x32_bf16 v[156:159], v[108:111], a[196:199], v[156:159]
v_mfma_f32_16x16x32_bf16 v[180:183], v[108:111], a[200:203], v[180:183]
v_mfma_f32_16x16x32_bf16 v[204:207], v[108:111], a[204:207], v[204:207]
buffer_load_dwordx4 v[108:111], v55, s[20:23], s90 offen offset:0 sc1
s_waitcnt vmcnt(28)
v_mfma_f32_16x16x32_bf16 v[136:139], v[112:115], a[192:195], v[136:139]
v_mfma_f32_16x16x32_bf16 v[160:163], v[112:115], a[196:199], v[160:163]
v_mfma_f32_16x16x32_bf16 v[184:187], v[112:115], a[200:203], v[184:187]
v_mfma_f32_16x16x32_bf16 v[208:211], v[112:115], a[204:207], v[208:211]
buffer_load_dwordx4 v[112:115], v55, s[20:23], s90 offen offset:2048 sc1
s_waitcnt vmcnt(28)
v_mfma_f32_16x16x32_bf16 v[140:143], v[56:59], a[192:195], v[140:143]
ds_read_b64_tr_b16 a[144:145], v40 offset:20480
ds_read_b64_tr_b16 a[146:147], v40 offset:22528
ds_read_b64_tr_b16 a[148:149], v41 offset:20480
v_mfma_f32_16x16x32_bf16 v[164:167], v[56:59], a[196:199], v[164:167]
ds_read_b64_tr_b16 a[150:151], v41 offset:22528
ds_read_b64_tr_b16 a[152:153], v42 offset:20480
ds_read_b64_tr_b16 a[154:155], v42 offset:22528
ds_read_b64_tr_b16 a[156:157], v43 offset:20480
v_mfma_f32_16x16x32_bf16 v[188:191], v[56:59], a[200:203], v[188:191]
ds_read_b64_tr_b16 a[158:159], v43 offset:22528
v_mfma_f32_16x16x32_bf16 v[212:215], v[56:59], a[204:207], v[212:215]
buffer_load_dwordx4 v[56:59], v33, s[20:23], s90 offen offset:1024 sc1
s_waitcnt vmcnt(26)
v_mfma_f32_16x16x32_bf16 v[144:147], v[60:63], a[192:195], v[144:147]
v_mfma_f32_16x16x32_bf16 v[168:171], v[60:63], a[196:199], v[168:171]
v_mfma_f32_16x16x32_bf16 v[192:195], v[60:63], a[200:203], v[192:195]
v_mfma_f32_16x16x32_bf16 v[216:219], v[60:63], a[204:207], v[216:219]
buffer_load_dwordx4 v[60:63], v33, s[20:23], s90 offen offset:3072 sc1
s_waitcnt vmcnt(24)
v_mfma_f32_16x16x32_bf16 v[148:151], v[64:67], a[192:195], v[148:151]
v_mfma_f32_16x16x32_bf16 v[172:175], v[64:67], a[196:199], v[172:175]
v_mfma_f32_16x16x32_bf16 v[196:199], v[64:67], a[200:203], v[196:199]
v_mfma_f32_16x16x32_bf16 v[220:223], v[64:67], a[204:207], v[220:223]
buffer_load_dwordx4 v[64:67], v47, s[20:23], s90 offen offset:1024 sc1
s_waitcnt vmcnt(24)
v_mfma_f32_16x16x32_bf16 v[128:131], v[68:71], a[208:211], v[128:131]
v_lshrrev_b32 v11, 3, v0
ds_read_b64_tr_b16 a[160:161], v40 offset:24576
v_lshlrev_b32 v11, 9, v11
v_mfma_f32_16x16x32_bf16 v[152:155], v[68:71], a[212:215], v[152:155]
ds_read_b64_tr_b16 a[162:163], v40 offset:26624
v_bfe_u32 v12, v0, 1, 2
v_lshl_add_u32 v11, v12, 7, v11
ds_read_b64_tr_b16 a[164:165], v41 offset:24576
v_mfma_f32_16x16x32_bf16 v[176:179], v[68:71], a[216:219], v[176:179]
s_lshl_b32 s86, s44, 12
s_add_u32 s86, s86, 40960
ds_read_b64_tr_b16 a[166:167], v41 offset:26624
v_mfma_f32_16x16x32_bf16 v[200:203], v[68:71], a[220:223], v[200:203]
buffer_load_dwordx4 v[68:71], v47, s[20:23], s90 offen offset:3072 sc1
s_waitcnt vmcnt(24)
v_mfma_f32_16x16x32_bf16 v[132:135], v[72:75], a[208:211], v[132:135]
buffer_load_dwordx2 v[34:35], v11, s[20:23], s86 offen sc1
v_mfma_f32_16x16x32_bf16 v[156:159], v[72:75], a[212:215], v[156:159]
ds_read_b64_tr_b16 a[168:169], v42 offset:24576
ds_read_b64_tr_b16 a[170:171], v42 offset:26624
v_mfma_f32_16x16x32_bf16 v[180:183], v[72:75], a[216:219], v[180:183]
v_mov_b32 v252, v25
ds_read_b64_tr_b16 a[172:173], v43 offset:24576
v_mov_b32 v253, v25
v_mov_b32 v254, v25
v_mfma_f32_16x16x32_bf16 v[204:207], v[72:75], a[220:223], v[204:207]
buffer_load_dwordx4 v[72:75], v55, s[20:23], s90 offen offset:1024 sc1
s_waitcnt vmcnt(25)
v_mfma_f32_16x16x32_bf16 v[136:139], v[76:79], a[208:211], v[136:139]
ds_read_b64_tr_b16 a[174:175], v43 offset:26624
v_mov_b32 v255, v25
v_mfma_f32_16x16x32_bf16 v[160:163], v[76:79], a[212:215], v[160:163]
buffer_load_dwordx2 v[244:245], v52, s[4:7], 0 offen offset:0
v_mfma_f32_16x16x32_bf16 v[184:187], v[76:79], a[216:219], v[184:187]
buffer_load_dwordx2 v[246:247], v52, s[4:7], 0 offen offset:32
v_mfma_f32_16x16x32_bf16 v[208:211], v[76:79], a[220:223], v[208:211]
buffer_load_dwordx4 v[76:79], v55, s[20:23], s90 offen offset:3072 sc1
s_waitcnt vmcnt(25)
v_mfma_f32_16x16x32_bf16 v[140:143], v[80:83], a[208:211], v[140:143]
ds_read_b64_tr_b16 a[176:177], v40 offset:28672
ds_read_b64_tr_b16 a[178:179], v40 offset:30720
v_mfma_f32_16x16x32_bf16 v[164:167], v[80:83], a[212:215], v[164:167]
ds_read_b64_tr_b16 a[180:181], v41 offset:28672
ds_read_b64_tr_b16 a[182:183], v41 offset:30720
ds_read_b64_tr_b16 a[184:185], v42 offset:28672
v_mfma_f32_16x16x32_bf16 v[188:191], v[80:83], a[216:219], v[188:191]
buffer_load_dwordx2 v[248:249], v52, s[4:7], 0 offen offset:64
v_mfma_f32_16x16x32_bf16 v[212:215], v[80:83], a[220:223], v[212:215]
buffer_load_dwordx2 v[250:251], v52, s[4:7], 0 offen offset:96
s_waitcnt vmcnt(25)
v_mfma_f32_16x16x32_bf16 v[144:147], v[84:87], a[208:211], v[144:147]
ds_read_b64_tr_b16 a[186:187], v42 offset:30720
ds_read_b64_tr_b16 a[188:189], v43 offset:28672
v_mfma_f32_16x16x32_bf16 v[168:171], v[84:87], a[212:215], v[168:171]
ds_read_b64_tr_b16 a[190:191], v43 offset:30720
v_mfma_f32_16x16x32_bf16 v[192:195], v[84:87], a[216:219], v[192:195]
v_mfma_f32_16x16x32_bf16 v[216:219], v[84:87], a[220:223], v[216:219]
s_waitcnt vmcnt(22)
v_mfma_f32_16x16x32_bf16 v[148:151], v[88:91], a[208:211], v[148:151]
v_mfma_f32_16x16x32_bf16 v[172:175], v[88:91], a[212:215], v[172:175]
v_mfma_f32_16x16x32_bf16 v[196:199], v[88:91], a[216:219], v[196:199]
v_mfma_f32_16x16x32_bf16 v[220:223], v[88:91], a[220:223], v[220:223]
s_waitcnt vmcnt(19)
v_mfma_f32_16x16x32_bf16 v[128:131], v[92:95], a[224:227], v[128:131]
ds_read_b64_tr_b16 a[192:193], v40 offset:32768
ds_read_b64_tr_b16 a[194:195], v40 offset:34816
ds_read_b64_tr_b16 a[196:197], v41 offset:32768
ds_read_b64_tr_b16 a[198:199], v41 offset:34816
v_mfma_f32_16x16x32_bf16 v[152:155], v[92:95], a[228:231], v[152:155]
ds_read_b64_tr_b16 a[200:201], v42 offset:32768
ds_read_b64_tr_b16 a[202:203], v42 offset:34816
ds_read_b64_tr_b16 a[204:205], v43 offset:32768
v_mfma_f32_16x16x32_bf16 v[176:179], v[92:95], a[232:235], v[176:179]
ds_read_b64_tr_b16 a[206:207], v43 offset:34816
ds_read_b64_tr_b16 a[208:209], v40 offset:36864
ds_read_b64_tr_b16 a[210:211], v40 offset:38912
ds_read_b64_tr_b16 a[212:213], v41 offset:36864
v_mfma_f32_16x16x32_bf16 v[200:203], v[92:95], a[236:239], v[200:203]
ds_read_b64_tr_b16 a[214:215], v41 offset:38912
ds_read_b64_tr_b16 a[216:217], v42 offset:36864
ds_read_b64_tr_b16 a[218:219], v42 offset:38912
s_waitcnt vmcnt(17)
v_mfma_f32_16x16x32_bf16 v[132:135], v[96:99], a[224:227], v[132:135]
ds_read_b64_tr_b16 a[220:221], v43 offset:36864
ds_read_b64_tr_b16 a[222:223], v43 offset:38912
v_mfma_f32_16x16x32_bf16 v[156:159], v[96:99], a[228:231], v[156:159]
v_mfma_f32_16x16x32_bf16 v[180:183], v[96:99], a[232:235], v[180:183]
v_mfma_f32_16x16x32_bf16 v[204:207], v[96:99], a[236:239], v[204:207]
s_waitcnt vmcnt(14)
v_mfma_f32_16x16x32_bf16 v[136:139], v[100:103], a[224:227], v[136:139]
v_mfma_f32_16x16x32_bf16 v[160:163], v[100:103], a[228:231], v[160:163]
v_mfma_f32_16x16x32_bf16 v[184:187], v[100:103], a[232:235], v[184:187]
v_mfma_f32_16x16x32_bf16 v[208:211], v[100:103], a[236:239], v[208:211]
s_waitcnt vmcnt(13)
v_mfma_f32_16x16x32_bf16 v[140:143], v[104:107], a[224:227], v[140:143]
s_mov_b32 s95, 0
s_waitcnt vmcnt(6)
v_cmp_ne_u64 vcc, v[34:35], v[26:27]
s_nop 3
s_cbranch_vccnz L_s3n_66
v_lshlrev_b32 v10, 3, v0
s_add_u32 s86, s57, 9306112
buffer_load_dwordx2 v[224:225], v10, s[20:23], s86 offen offset:0 sc1
buffer_load_dwordx2 v[226:227], v10, s[20:23], s86 offen offset:512 sc1
buffer_load_dwordx2 v[228:229], v10, s[20:23], s86 offen offset:1024 sc1
buffer_load_dwordx2 v[230:231], v10, s[20:23], s86 offen offset:1536 sc1
buffer_load_dwordx2 v[232:233], v10, s[20:23], s86 offen offset:2048 sc1
buffer_load_dwordx2 v[234:235], v10, s[20:23], s86 offen offset:2560 sc1
buffer_load_dwordx2 v[236:237], v10, s[20:23], s86 offen offset:3072 sc1
buffer_load_dwordx2 v[238:239], v10, s[20:23], s86 offen offset:3584 sc1
v_and_b32 v11, 56, v0
v_lshl_add_u32 v10, v11, 3, v10
s_lshl_b32 s0, s44, 10
s_add_u32 s86, s0, 9322496
buffer_load_dwordx2 v[240:241], v10, s[20:23], s86 offen sc1
s_mov_b32 s95, 1
L_s3n_66:
v_mfma_f32_16x16x32_bf16 v[164:167], v[104:107], a[228:231], v[164:167]
v_mfma_f32_16x16x32_bf16 v[188:191], v[104:107], a[232:235], v[188:191]
v_mfma_f32_16x16x32_bf16 v[212:215], v[104:107], a[236:239], v[212:215]
v_mfma_f32_16x16x32_bf16 v[144:147], v[108:111], a[224:227], v[144:147]
v_mfma_f32_16x16x32_bf16 v[168:171], v[108:111], a[228:231], v[168:171]
s_lshl_b32 s0, s47, 2
s_add_u32 s0, s0, s44
v_mfma_f32_16x16x32_bf16 v[192:195], v[108:111], a[232:235], v[192:195]
s_lshl_b32 s0, s0, 14
s_add_u32 s0, s0, 6029312
s_add_u32 s86, s0, 0
v_mfma_f32_16x16x32_bf16 v[216:219], v[108:111], a[236:239], v[216:219]
buffer_load_dwordx4 a[0:3], v32, s[20:23], s86 offen offset:0 sc1
v_mfma_f32_16x16x32_bf16 v[148:151], v[112:115], a[224:227], v[148:151]
buffer_load_dwordx4 a[4:7], v32, s[20:23], s86 offen offset:1024 sc1
v_mfma_f32_16x16x32_bf16 v[172:175], v[112:115], a[228:231], v[172:175]
v_mfma_f32_16x16x32_bf16 v[196:199], v[112:115], a[232:235], v[196:199]
buffer_load_dwordx4 a[8:11], v32, s[20:23], s86 offen offset:2048 sc1
v_mfma_f32_16x16x32_bf16 v[220:223], v[112:115], a[236:239], v[220:223]
buffer_load_dwordx4 a[12:15], v32, s[20:23], s86 offen offset:3072 sc1
s_waitcnt lgkmcnt(0)
s_barrier
v_mfma_f32_16x16x32_bf16 v[128:131], v[56:59], a[240:243], v[128:131]
s_add_u32 s86, s0, 4096
buffer_load_dwordx4 a[16:19], v32, s[20:23], s86 offen offset:0 sc1
v_mfma_f32_16x16x32_bf16 v[152:155], v[56:59], a[244:247], v[152:155]
v_mfma_f32_16x16x32_bf16 v[176:179], v[56:59], a[248:251], v[176:179]
buffer_load_dwordx4 a[20:23], v32, s[20:23], s86 offen offset:1024 sc1
v_mfma_f32_16x16x32_bf16 v[200:203], v[56:59], a[252:255], v[200:203]
buffer_load_dwordx4 a[24:27], v32, s[20:23], s86 offen offset:2048 sc1
v_mfma_f32_16x16x32_bf16 v[132:135], v[60:63], a[240:243], v[132:135]
v_mfma_f32_16x16x32_bf16 v[156:159], v[60:63], a[244:247], v[156:159]
buffer_load_dwordx4 a[28:31], v32, s[20:23], s86 offen offset:3072 sc1
v_mfma_f32_16x16x32_bf16 v[180:183], v[60:63], a[248:251], v[180:183]
v_mfma_f32_16x16x32_bf16 v[204:207], v[60:63], a[252:255], v[204:207]
v_mfma_f32_16x16x32_bf16 v[136:139], v[64:67], a[240:243], v[136:139]
v_mfma_f32_16x16x32_bf16 v[160:163], v[64:67], a[244:247], v[160:163]
v_mfma_f32_16x16x32_bf16 v[184:187], v[64:67], a[248:251], v[184:187]
v_mfma_f32_16x16x32_bf16 v[208:211], v[64:67], a[252:255], v[208:211]
v_mfma_f32_16x16x32_bf16 v[212:215], v[68:71], a[252:255], v[212:215]
s_waitcnt vmcnt(13)
v_mfma_f32_16x16x32_bf16 v[216:219], v[72:75], a[252:255], v[216:219]
s_waitcnt vmcnt(10)
v_mfma_f32_16x16x32_bf16 v[220:223], v[76:79], a[252:255], v[220:223]
v_mfma_f32_16x16x32_bf16 v[188:191], v[68:71], a[248:251], v[188:191]
v_mfma_f32_16x16x32_bf16 v[192:195], v[72:75], a[248:251], v[192:195]
v_mfma_f32_16x16x32_bf16 v[196:199], v[76:79], a[248:251], v[196:199]
v_mfma_f32_16x16x32_bf16 v[164:167], v[68:71], a[244:247], v[164:167]
v_mfma_f32_16x16x32_bf16 v[168:171], v[72:75], a[244:247], v[168:171]
v_mfma_f32_16x16x32_bf16 v[172:175], v[76:79], a[244:247], v[172:175]
v_mfma_f32_16x16x32_bf16 v[140:143], v[68:71], a[240:243], v[140:143]
v_mfma_f32_16x16x32_bf16 v[144:147], v[72:75], a[240:243], v[144:147]
v_mfma_f32_16x16x32_bf16 v[148:151], v[76:79], a[240:243], v[148:151]
s_branch L_join
L_light:
s_mul_i32 s90, s92, 90112
s_add_u32 s92, s92, 1
s_add_u32 s90, s90, s93
s_and_b32 s92, s92, 7
buffer_load_dwordx4 v[104:107], v33, s[20:23], s90 offen offset:0 sc1
buffer_load_dwordx4 v[108:111], v33, s[20:23], s90 offen offset:2048 sc1
buffer_load_dwordx4 v[112:115], v47, s[20:23], s90 offen offset:0 sc1
s_mov_b32 s15, 0
s_getpc_b64 s[10:11]
L_pcs_68:
s_add_u32 s10, s10, L_red-L_pcs_68
s_addc_u32 s11, s11, 0
s_waitcnt vmcnt(14)
v_mfma_f32_16x16x32_bf16 v[128:131], v[56:59], a[0:3], 0
s_lshl_b32 s87, s44, 2
s_add_u32 s87, s87, s47
s_add_u32 s87, s87, 3
v_mfma_f32_16x16x32_bf16 v[152:155], v[56:59], a[4:7], 0
s_mov_b64 exec, 1
buffer_store_dwordx2 v[26:27], v14, s[20:23], s98 offen sc1
s_mov_b64 exec, -1
v_mfma_f32_16x16x32_bf16 v[176:179], v[56:59], a[8:11], 0
s_and_b32 s87, s87, 15
v_mfma_f32_16x16x32_bf16 v[200:203], v[56:59], a[12:15], 0
buffer_load_dwordx4 v[56:59], v47, s[20:23], s90 offen offset:2048 sc1
s_waitcnt vmcnt(15)
v_mfma_f32_16x16x32_bf16 v[132:135], v[60:63], a[0:3], 0
s_lshl_b32 m0, s87, 12
s_add_u32 m0, m0, 73728
v_mfma_f32_16x16x32_bf16 v[156:159], v[60:63], a[4:7], 0
s_lshl_b32 s87, s87, 15
buffer_load_dwordx4 v28, s[24:27], s87 offen lds
v_mfma_f32_16x16x32_bf16 v[180:183], v[60:63], a[8:11], 0
v_mfma_f32_16x16x32_bf16 v[204:207], v[60:63], a[12:15], 0
buffer_load_dwordx4 v[60:63], v33, s[20:23], s90 offen offset:1024 sc1
s_waitcnt vmcnt(16)
v_mfma_f32_16x16x32_bf16 v[136:139], v[64:67], a[0:3], 0
buffer_load_dwordx4 v29, s[24:27], s87 offen offset:1024 lds
v_mfma_f32_16x16x32_bf16 v[160:163], v[64:67], a[4:7], 0
v_mfma_f32_16x16x32_bf16 v[184:187], v[64:67], a[8:11], 0
buffer_load_dwordx4 v30, s[24:27], s87 offen offset:2048 lds
v_mfma_f32_16x16x32_bf16 v[208:211], v[64:67], a[12:15], 0
buffer_load_dwordx4 v[64:67], v33, s[20:23], s90 offen offset:3072 sc1
s_waitcnt vmcnt(18)
v_mfma_f32_16x16x32_bf16 v[140:143], v[68:71], a[0:3], 0
v_mfma_f32_16x16x32_bf16 v[164:167], v[68:71], a[4:7], 0
buffer_load_dwordx4 v31, s[24:27], s87 offen offset:3072 lds
v_mfma_f32_16x16x32_bf16 v[188:191], v[68:71], a[8:11], 0
v_mfma_f32_16x16x32_bf16 v[212:215], v[68:71], a[12:15], 0
buffer_load_dwordx4 v[68:71], v47, s[20:23], s90 offen offset:1024 sc1
s_waitcnt vmcnt(19)
buffer_load_dwordx4 v[72:75], v47, s[20:23], s90 offen offset:3072 sc1
s_mul_i32 s90, s92, 90112
s_add_u32 s92, s92, 1
s_add_u32 s90, s90, s93
s_and_b32 s92, s92, 7
s_waitcnt vmcnt(19)
buffer_load_dwordx4 v[76:79], v33, s[20:23], s90 offen offset:0 sc1
s_waitcnt vmcnt(19)
v_mfma_f32_16x16x32_bf16 v[128:131], v[80:83], a[16:19], v[128:131]
v_mfma_f32_16x16x32_bf16 v[152:155], v[80:83], a[20:23], v[152:155]
v_mfma_f32_16x16x32_bf16 v[176:179], v[80:83], a[24:27], v[176:179]
v_mfma_f32_16x16x32_bf16 v[200:203], v[80:83], a[28:31], v[200:203]
buffer_load_dwordx4 v[80:83], v33, s[20:23], s90 offen offset:2048 sc1
s_waitcnt vmcnt(19)
v_mfma_f32_16x16x32_bf16 v[132:135], v[84:87], a[16:19], v[132:135]
v_mfma_f32_16x16x32_bf16 v[156:159], v[84:87], a[20:23], v[156:159]
v_mfma_f32_16x16x32_bf16 v[180:183], v[84:87], a[24:27], v[180:183]
v_mfma_f32_16x16x32_bf16 v[204:207], v[84:87], a[28:31], v[204:207]
buffer_load_dwordx4 v[84:87], v47, s[20:23], s90 offen offset:0 sc1
s_waitcnt vmcnt(19)
v_mfma_f32_16x16x32_bf16 v[136:139], v[88:91], a[16:19], v[136:139]
v_mfma_f32_16x16x32_bf16 v[160:163], v[88:91], a[20:23], v[160:163]
v_mfma_f32_16x16x32_bf16 v[184:187], v[88:91], a[24:27], v[184:187]
v_mfma_f32_16x16x32_bf16 v[208:211], v[88:91], a[28:31], v[208:211]
buffer_load_dwordx4 v[88:91], v47, s[20:23], s90 offen offset:2048 sc1
s_waitcnt vmcnt(19)
v_mfma_f32_16x16x32_bf16 v[140:143], v[92:95], a[16:19], v[140:143]
v_mfma_f32_16x16x32_bf16 v[164:167], v[92:95], a[20:23], v[164:167]
v_mfma_f32_16x16x32_bf16 v[188:191], v[92:95], a[24:27], v[188:191]
v_mfma_f32_16x16x32_bf16 v[212:215], v[92:95], a[28:31], v[212:215]
buffer_load_dwordx4 v[92:95], v33, s[20:23], s90 offen offset:1024 sc1
s_waitcnt vmcnt(19)
buffer_load_dwordx4 v[96:99], v33, s[20:23], s90 offen offset:3072 sc1
s_waitcnt vmcnt(19)
buffer_load_dwordx4 v[100:103], v47, s[20:23], s90 offen offset:1024 sc1
s_waitcnt vmcnt(19)
v_mfma_f32_16x16x32_bf16 v[128:131], v[104:107], a[32:35], v[128:131]
v_mfma_f32_16x16x32_bf16 v[152:155], v[104:107], a[36:39], v[152:155]
v_mfma_f32_16x16x32_bf16 v[176:179], v[104:107], a[40:43], v[176:179]
v_mfma_f32_16x16x32_bf16 v[200:203], v[104:107], a[44:47], v[200:203]
buffer_load_dwordx4 v[104:107], v47, s[20:23], s90 offen offset:3072 sc1
s_waitcnt vmcnt(19)
v_mfma_f32_16x16x32_bf16 v[132:135], v[108:111], a[32:35], v[132:135]
v_mfma_f32_16x16x32_bf16 v[156:159], v[108:111], a[36:39], v[156:159]
v_mfma_f32_16x16x32_bf16 v[180:183], v[108:111], a[40:43], v[180:183]
v_mfma_f32_16x16x32_bf16 v[204:207], v[108:111], a[44:47], v[204:207]
s_mul_i32 s90, s92, 90112
s_add_u32 s92, s92, 1
s_add_u32 s90, s90, s93
s_and_b32 s92, s92, 7
buffer_load_dwordx4 v[108:111], v33, s[20:23], s90 offen offset:0 sc1
s_waitcnt vmcnt(19)
v_mfma_f32_16x16x32_bf16 v[136:139], v[112:115], a[32:35], v[136:139]
v_mfma_f32_16x16x32_bf16 v[160:163], v[112:115], a[36:39], v[160:163]
s_cmp_gt_u32 s15, 3
s_cbranch_scc1 L_nr_69
s_swappc_b64 s[8:9], s[10:11]
L_nr_69:
v_mfma_f32_16x16x32_bf16 v[184:187], v[112:115], a[40:43], v[184:187]
v_mfma_f32_16x16x32_bf16 v[208:211], v[112:115], a[44:47], v[208:211]
buffer_load_dwordx4 v[112:115], v33, s[20:23], s90 offen offset:2048 sc1
s_waitcnt vmcnt(18)
v_mfma_f32_16x16x32_bf16 v[140:143], v[56:59], a[32:35], v[140:143]
v_mfma_f32_16x16x32_bf16 v[164:167], v[56:59], a[36:39], v[164:167]
v_mfma_f32_16x16x32_bf16 v[188:191], v[56:59], a[40:43], v[188:191]
v_mfma_f32_16x16x32_bf16 v[212:215], v[56:59], a[44:47], v[212:215]
buffer_load_dwordx4 v[56:59], v47, s[20:23], s90 offen offset:0 sc1
s_waitcnt vmcnt(17)
v_mfma_f32_16x16x32_bf16 v[128:131], v[60:63], a[48:51], v[128:131]
v_mfma_f32_16x16x32_bf16 v[152:155], v[60:63], a[52:55], v[152:155]
v_mfma_f32_16x16x32_bf16 v[176:179], v[60:63], a[56:59], v[176:179]
v_mfma_f32_16x16x32_bf16 v[200:203], v[60:63], a[60:63], v[200:203]
buffer_load_dwordx4 v[60:63], v47, s[20:23], s90 offen offset:2048 sc1
s_waitcnt vmcnt(15)
v_mfma_f32_16x16x32_bf16 v[132:135], v[64:67], a[48:51], v[132:135]
v_mfma_f32_16x16x32_bf16 v[156:159], v[64:67], a[52:55], v[156:159]
v_mfma_f32_16x16x32_bf16 v[180:183], v[64:67], a[56:59], v[180:183]
v_mfma_f32_16x16x32_bf16 v[204:207], v[64:67], a[60:63], v[204:207]
buffer_load_dwordx4 v[64:67], v33, s[20:23], s90 offen offset:1024 sc1
s_waitcnt vmcnt(14)
v_mfma_f32_16x16x32_bf16 v[136:139], v[68:71], a[48:51], v[136:139]
s_cmp_gt_u32 s15, 3
s_cbranch_scc1 L_nr_70
s_waitcnt vmcnt(4)
s_swappc_b64 s[8:9], s[10:11]
L_nr_70:
v_mfma_f32_16x16x32_bf16 v[160:163], v[68:71], a[52:55], v[160:163]
v_mfma_f32_16x16x32_bf16 v[184:187], v[68:71], a[56:59], v[184:187]
v_mfma_f32_16x16x32_bf16 v[208:211], v[68:71], a[60:63], v[208:211]
buffer_load_dwordx4 v[68:71], v33, s[20:23], s90 offen offset:3072 sc1
s_waitcnt vmcnt(14)
v_mfma_f32_16x16x32_bf16 v[140:143], v[72:75], a[48:51], v[140:143]
v_mfma_f32_16x16x32_bf16 v[164:167], v[72:75], a[52:55], v[164:167]
v_mfma_f32_16x16x32_bf16 v[188:191], v[72:75], a[56:59], v[188:191]
v_mfma_f32_16x16x32_bf16 v[212:215], v[72:75], a[60:63], v[212:215]
buffer_load_dwordx4 v[72:75], v47, s[20:23], s90 offen offset:1024 sc1
s_waitcnt vmcnt(14)
v_mfma_f32_16x16x32_bf16 v[128:131], v[76:79], a[64:67], v[128:131]
v_mfma_f32_16x16x32_bf16 v[152:155], v[76:79], a[68:71], v[152:155]
v_mfma_f32_16x16x32_bf16 v[176:179], v[76:79], a[72:75], v[176:179]
v_mfma_f32_16x16x32_bf16 v[200:203], v[76:79], a[76:79], v[200:203]
buffer_load_dwordx4 v[76:79], v47, s[20:23], s90 offen offset:3072 sc1
s_waitcnt vmcnt(14)
v_mfma_f32_16x16x32_bf16 v[132:135], v[80:83], a[64:67], v[132:135]
v_mfma_f32_16x16x32_bf16 v[156:159], v[80:83], a[68:71], v[156:159]
v_mfma_f32_16x16x32_bf16 v[180:183], v[80:83], a[72:75], v[180:183]
v_mfma_f32_16x16x32_bf16 v[204:207], v[80:83], a[76:79], v[204:207]
s_mul_i32 s90, s92, 90112
s_add_u32 s92, s92, 1
s_add_u32 s90, s90, s93
s_and_b32 s92, s92, 7
buffer_load_dwordx4 v[80:83], v33, s[20:23], s90 offen offset:0 sc1
s_waitcnt vmcnt(14)
v_mfma_f32_16x16x32_bf16 v[136:139], v[84:87], a[64:67], v[136:139]
v_mfma_f32_16x16x32_bf16 v[160:163], v[84:87], a[68:71], v[160:163]
s_cmp_gt_u32 s15, 3
s_cbranch_scc1 L_nr_71
s_waitcnt vmcnt(4)
s_swappc_b64 s[8:9], s[10:11]
L_nr_71:
v_mfma_f32_16x16x32_bf16 v[184:187], v[84:87], a[72:75], v[184:187]
v_mfma_f32_16x16x32_bf16 v[208:211], v[84:87], a[76:79], v[208:211]
buffer_load_dwordx4 v[84:87], v33, s[20:23], s90 offen offset:2048 sc1
s_waitcnt vmcnt(14)
v_mfma_f32_16x16x32_bf16 v[140:143], v[88:91], a[64:67], v[140:143]
v_mfma_f32_16x16x32_bf16 v[164:167], v[88:91], a[68:71], v[164:167]
v_mfma_f32_16x16x32_bf16 v[188:191], v[88:91], a[72:75], v[188:191]
v_mfma_f32_16x16x32_bf16 v[212:215], v[88:91], a[76:79], v[212:215]
buffer_load_dwordx4 v[88:91], v47, s[20:23], s90 offen offset:0 sc1
s_waitcnt vmcnt(14)
v_mfma_f32_16x16x32_bf16 v[128:131], v[92:95], a[80:83], v[128:131]
v_mfma_f32_16x16x32_bf16 v[152:155], v[92:95], a[84:87], v[152:155]
v_mfma_f32_16x16x32_bf16 v[176:179], v[92:95], a[88:91], v[176:179]
v_mfma_f32_16x16x32_bf16 v[200:203], v[92:95], a[92:95], v[200:203]
buffer_load_dwordx4 v[92:95], v47, s[20:23], s90 offen offset:2048 sc1
s_waitcnt vmcnt(14)
v_mfma_f32_16x16x32_bf16 v[132:135], v[96:99], a[80:83], v[132:135]
v_mfma_f32_16x16x32_bf16 v[156:159], v[96:99], a[84:87], v[156:159]
v_mfma_f32_16x16x32_bf16 v[180:183], v[96:99], a[88:91], v[180:183]
v_mfma_f32_16x16x32_bf16 v[204:207], v[96:99], a[92:95], v[204:207]
buffer_load_dwordx4 v[96:99], v33, s[20:23], s90 offen offset:1024 sc1
s_waitcnt vmcnt(14)
v_mfma_f32_16x16x32_bf16 v[136:139], v[100:103], a[80:83], v[136:139]
s_cmp_gt_u32 s15, 3
s_cbranch_scc1 L_nr_72
s_waitcnt vmcnt(4)
s_swappc_b64 s[8:9], s[10:11]
L_nr_72:
v_mfma_f32_16x16x32_bf16 v[160:163], v[100:103], a[84:87], v[160:163]
v_mfma_f32_16x16x32_bf16 v[184:187], v[100:103], a[88:91], v[184:187]
v_mfma_f32_16x16x32_bf16 v[208:211], v[100:103], a[92:95], v[208:211]
buffer_load_dwordx4 v[100:103], v33, s[20:23], s90 offen offset:3072 sc1
s_waitcnt vmcnt(14)
v_mfma_f32_16x16x32_bf16 v[140:143], v[104:107], a[80:83], v[140:143]
v_mfma_f32_16x16x32_bf16 v[164:167], v[104:107], a[84:87], v[164:167]
v_mfma_f32_16x16x32_bf16 v[188:191], v[104:107], a[88:91], v[188:191]
v_mfma_f32_16x16x32_bf16 v[212:215], v[104:107], a[92:95], v[212:215]
buffer_load_dwordx4 v[104:107], v47, s[20:23], s90 offen offset:1024 sc1
s_waitcnt lgkmcnt(0)
s_barrier
s_waitcnt vmcnt(14)
v_mfma_f32_16x16x32_bf16 v[128:131], v[108:111], a[96:99], v[128:131]
v_mfma_f32_16x16x32_bf16 v[152:155], v[108:111], a[100:103], v[152:155]
v_mfma_f32_16x16x32_bf16 v[176:179], v[108:111], a[104:107], v[176:179]
v_mfma_f32_16x16x32_bf16 v[200:203], v[108:111], a[108:111], v[200:203]
buffer_load_dwordx4 v[108:111], v47, s[20:23], s90 offen offset:3072 sc1
s_waitcnt vmcnt(14)
v_mfma_f32_16x16x32_bf16 v[132:135], v[112:115], a[96:99], v[132:135]
v_mfma_f32_16x16x32_bf16 v[156:159], v[112:115], a[100:103], v[156:159]
v_mfma_f32_16x16x32_bf16 v[180:183], v[112:115], a[104:107], v[180:183]
v_mfma_f32_16x16x32_bf16 v[204:207], v[112:115], a[108:111], v[204:207]
s_mul_i32 s90, s92, 90112
s_add_u32 s92, s92, 1
s_add_u32 s90, s90, s93
s_and_b32 s92, s92, 7
buffer_load_dwordx4 v[112:115], v33, s[20:23], s90 offen offset:0 sc1
s_waitcnt vmcnt(14)
v_mfma_f32_16x16x32_bf16 v[136:139], v[56:59], a[96:99], v[136:139]
v_mfma_f32_16x16x32_bf16 v[160:163], v[56:59], a[100:103], v[160:163]
s_cmp_gt_u32 s15, 3
s_cbranch_scc1 L_nr_73
s_waitcnt vmcnt(4)
s_swappc_b64 s[8:9], s[10:11]
L_nr_73:
v_mfma_f32_16x16x32_bf16 v[184:187], v[56:59], a[104:107], v[184:187]
ds_read_b64_tr_b16 a[64:65], v40 offset:0
ds_read_b64_tr_b16 a[66:67], v40 offset:2048
v_mfma_f32_16x16x32_bf16 v[208:211], v[56:59], a[108:111], v[208:211]
buffer_load_dwordx4 v[56:59], v33, s[20:23], s90 offen offset:2048 sc1
s_waitcnt vmcnt(14)
v_mfma_f32_16x16x32_bf16 v[140:143], v[60:63], a[96:99], v[140:143]
ds_read_b64_tr_b16 a[68:69], v41 offset:0
s_lshl_b32 s97, s47, 2
s_add_u32 s97, s97, s44
v_mfma_f32_16x16x32_bf16 v[164:167], v[60:63], a[100:103], v[164:167]
ds_read_b64_tr_b16 a[70:71], v41 offset:2048
s_mul_i32 s0, s97, 43
s_lshl_b32 s1, s88, 1
v_mfma_f32_16x16x32_bf16 v[188:191], v[60:63], a[104:107], v[188:191]
ds_read_b64_tr_b16 a[72:73], v42 offset:0
s_add_u32 s0, s0, s1
s_lshl_b32 s0, s0, 9
ds_read_b64_tr_b16 a[74:75], v42 offset:2048
v_mfma_f32_16x16x32_bf16 v[212:215], v[60:63], a[108:111], v[212:215]
buffer_load_dwordx4 v[60:63], v47, s[20:23], s90 offen offset:0 sc1
s_waitcnt vmcnt(14)
v_mfma_f32_16x16x32_bf16 v[128:131], v[64:67], a[112:115], v[128:131]
s_add_u32 s70, s0, 3145216
s_mul_i32 s0, s97, 22
ds_read_b64_tr_b16 a[76:77], v43 offset:0
v_mfma_f32_16x16x32_bf16 v[152:155], v[64:67], a[116:119], v[152:155]
s_add_u32 s0, s0, s88
s_lshl_b32 s0, s0, 10
ds_read_b64_tr_b16 a[78:79], v43 offset:2048
v_mfma_f32_16x16x32_bf16 v[176:179], v[64:67], a[120:123], v[176:179]
s_add_u32 s71, s0, 9437184
s_cmp_eq_u32 s89, 3
s_cselect_b32 s72, s71, 0x40000000
s_cmp_eq_u32 s48, 0
s_cselect_b32 s68, 0, -1
v_mfma_f32_16x16x32_bf16 v[200:203], v[64:67], a[124:127], v[200:203]
buffer_load_dwordx4 v[64:67], v47, s[20:23], s90 offen offset:2048 sc1
s_waitcnt vmcnt(14)
v_mfma_f32_16x16x32_bf16 v[132:135], v[68:71], a[112:115], v[132:135]
v_lshlrev_b32 v10, 1, v4
v_mfma_f32_16x16x32_bf16 v[156:159], v[68:71], a[116:119], v[156:159]
s_lshl_b32 s86, s97, 5
buffer_load_ushort v39, v10, s[36:39], s86 offen
v_mfma_f32_16x16x32_bf16 v[180:183], v[68:71], a[120:123], v[180:183]
s_xor_b32 s0, s44, 2
s_mul_i32 s0, s0, 12288
v_mfma_f32_16x16x32_bf16 v[204:207], v[68:71], a[124:127], v[204:207]
buffer_load_dwordx4 v[68:71], v33, s[20:23], s90 offen offset:1024 sc1
s_waitcnt vmcnt(15)
v_mfma_f32_16x16x32_bf16 v[136:139], v[72:75], a[112:115], v[136:139]
ds_read_b64_tr_b16 a[80:81], v40 offset:4096
ds_read_b64_tr_b16 a[82:83], v40 offset:6144
ds_read_b64_tr_b16 a[84:85], v41 offset:4096
v_mfma_f32_16x16x32_bf16 v[160:163], v[72:75], a[116:119], v[160:163]
s_cmp_gt_u32 s15, 3
s_cbranch_scc1 L_nr_74
s_waitcnt vmcnt(5)
s_swappc_b64 s[8:9], s[10:11]
L_nr_74:
v_mfma_f32_16x16x32_bf16 v[184:187], v[72:75], a[120:123], v[184:187]
s_add_u32 s0, s0, 65536
ds_read_b64_tr_b16 a[86:87], v41 offset:6144
v_add_u32 v20, s0, v32
v_mfma_f32_16x16x32_bf16 v[208:211], v[72:75], a[124:127], v[208:211]
buffer_load_dwordx4 v[72:75], v33, s[20:23], s90 offen offset:3072 sc1
s_waitcnt vmcnt(15)
v_mfma_f32_16x16x32_bf16 v[140:143], v[76:79], a[112:115], v[140:143]
s_xor_b32 s0, s44, 0
ds_read_b64_tr_b16 a[88:89], v42 offset:4096
s_mul_i32 s0, s0, 12288
v_mfma_f32_16x16x32_bf16 v[164:167], v[76:79], a[116:119], v[164:167]
s_add_u32 s0, s0, 65536
ds_read_b64_tr_b16 a[90:91], v42 offset:6144
v_add_u32 v21, s0, v32
v_mfma_f32_16x16x32_bf16 v[188:191], v[76:79], a[120:123], v[188:191]
s_xor_b32 s0, s44, 1
ds_read_b64_tr_b16 a[92:93], v43 offset:4096
s_mul_i32 s0, s0, 12288
s_add_u32 s0, s0, 65536
v_mfma_f32_16x16x32_bf16 v[212:215], v[76:79], a[124:127], v[212:215]
buffer_load_dwordx4 v[76:79], v47, s[20:23], s90 offen offset:1024 sc1
s_waitcnt vmcnt(15)
v_mfma_f32_16x16x32_bf16 v[128:131], v[80:83], a[128:131], v[128:131]
ds_read_b64_tr_b16 a[94:95], v43 offset:6144
v_add_u32 v22, s0, v32
v_mfma_f32_16x16x32_bf16 v[152:155], v[80:83], a[132:135], v[152:155]
s_lshl_b32 s87, s44, 2
s_lshl_b32 s97, s97, 10
s_add_u32 s73, s97, 12779520
s_add_u32 s87, s87, s47
v_mfma_f32_16x16x32_bf16 v[176:179], v[80:83], a[136:139], v[176:179]
s_lshl_b32 s1, s48, 7
s_add_u32 s98, s1, s73
s_add_u32 s87, s87, 0
v_mfma_f32_16x16x32_bf16 v[200:203], v[80:83], a[140:143], v[200:203]
buffer_load_dwordx4 v[80:83], v47, s[20:23], s90 offen offset:3072 sc1
s_waitcnt vmcnt(15)
v_mfma_f32_16x16x32_bf16 v[132:135], v[84:87], a[128:131], v[132:135]
s_lshl_b32 s0, s47, 2
s_add_u32 s74, s0, s44
s_and_b32 s87, s87, 15
v_mfma_f32_16x16x32_bf16 v[156:159], v[84:87], a[132:135], v[156:159]
v_lshlrev_b32 v52, 10, v4
v_lshl_add_u32 v52, v3, 3, v52
s_lshl_b32 m0, s87, 12
s_lshl_b32 s0, s74, 14
v_mfma_f32_16x16x32_bf16 v[180:183], v[84:87], a[136:139], v[180:183]
s_lshl_b32 s1, s48, 7
s_lshl_b32 s87, s87, 15
s_add_u32 s0, s0, s1
v_mfma_f32_16x16x32_bf16 v[204:207], v[84:87], a[140:143], v[204:207]
s_mul_i32 s90, s92, 90112
s_add_u32 s92, s92, 1
s_add_u32 s90, s90, s93
s_and_b32 s92, s92, 7
buffer_load_dwordx4 v[84:87], v33, s[20:23], s90 offen offset:0 sc1
s_waitcnt vmcnt(15)
v_mfma_f32_16x16x32_bf16 v[136:139], v[88:91], a[128:131], v[136:139]
v_mfma_f32_16x16x32_bf16 v[160:163], v[88:91], a[132:135], v[160:163]
s_cmp_gt_u32 s15, 3
s_cbranch_scc1 L_nr_75
s_waitcnt vmcnt(4)
s_swappc_b64 s[8:9], s[10:11]
L_nr_75:
v_mfma_f32_16x16x32_bf16 v[184:187], v[88:91], a[136:139], v[184:187]
s_sub_u32 s56, s87, 16384
s_cselect_b32 s56, 0x40000000, s56
v_mfma_f32_16x16x32_bf16 v[208:211], v[88:91], a[140:143], v[208:211]
buffer_load_dwordx4 v[88:91], v33, s[20:23], s90 offen offset:2048 sc1
s_waitcnt vmcnt(15)
v_mfma_f32_16x16x32_bf16 v[140:143], v[92:95], a[128:131], v[140:143]
buffer_load_dwordx4 v28, s[28:31], s56 offen lds
v_mfma_f32_16x16x32_bf16 v[164:167], v[92:95], a[132:135], v[164:167]
v_add_u32 v52, s0, v52
s_mul_i32 s74, s74, 22528
v_mfma_f32_16x16x32_bf16 v[188:191], v[92:95], a[136:139], v[188:191]
s_add_u32 s74, s74, 9437184
v_subrev_u32 v48, 73728, v40
v_subrev_u32 v49, 73728, v41
v_mfma_f32_16x16x32_bf16 v[212:215], v[92:95], a[140:143], v[212:215]
buffer_load_dwordx4 v[92:95], v47, s[20:23], s90 offen offset:0 sc1
s_waitcnt vmcnt(16)
v_mfma_f32_16x16x32_bf16 v[128:131], v[96:99], a[144:147], v[128:131]
v_subrev_u32 v50, 73728, v42
v_subrev_u32 v51, 73728, v43
v_add_u32 v16, 65536, v48
v_mfma_f32_16x16x32_bf16 v[152:155], v[96:99], a[148:151], v[152:155]
buffer_load_dwordx4 v29, s[28:31], s56 offen offset:1024 lds
v_mfma_f32_16x16x32_bf16 v[176:179], v[96:99], a[152:155], v[176:179]
v_add_u32 v17, 65536, v49
v_add_u32 v18, 65536, v50
v_add_u32 v19, 65536, v51
v_mfma_f32_16x16x32_bf16 v[200:203], v[96:99], a[156:159], v[200:203]
buffer_load_dwordx4 v[96:99], v47, s[20:23], s90 offen offset:2048 sc1
s_waitcnt vmcnt(17)
v_mfma_f32_16x16x32_bf16 v[132:135], v[100:103], a[144:147], v[132:135]
v_and_b32 v9, 1, v0
v_lshlrev_b32 v9, 6, v9
v_lshl_add_u32 v9, v3, 4, v9
v_mfma_f32_16x16x32_bf16 v[156:159], v[100:103], a[148:151], v[156:159]
v_add_u32 v53, 155648, v9
v_add_u32 v242, 139264, v32
s_add_u32 m0, m0, 2048
v_mfma_f32_16x16x32_bf16 v[180:183], v[100:103], a[152:155], v[180:183]
v_lshlrev_b32 v243, 7, v1
v_add_u32 v23, s57, v242
s_nop 0
v_lshlrev_b32 v10, 3, v0
v_mfma_f32_16x16x32_bf16 v[204:207], v[100:103], a[156:159], v[204:207]
buffer_load_dwordx4 v[100:103], v33, s[20:23], s90 offen offset:1024 sc1
s_waitcnt vmcnt(17)
v_mfma_f32_16x16x32_bf16 v[136:139], v[104:107], a[144:147], v[136:139]
s_cmp_gt_u32 s15, 3
s_cbranch_scc1 L_nr_76
s_waitcnt vmcnt(6)
s_swappc_b64 s[8:9], s[10:11]
L_nr_76:
v_mfma_f32_16x16x32_bf16 v[160:163], v[104:107], a[148:151], v[160:163]
s_lshl_b32 s0, s44, 9
s_add_u32 s0, s0, 155648
v_mfma_f32_16x16x32_bf16 v[184:187], v[104:107], a[152:155], v[184:187]
buffer_load_dwordx4 v28, s[28:31], s87 offen lds
v_mfma_f32_16x16x32_bf16 v[208:211], v[104:107], a[156:159], v[208:211]
buffer_load_dwordx4 v[104:107], v33, s[20:23], s90 offen offset:3072 sc1
s_waitcnt vmcnt(18)
v_mfma_f32_16x16x32_bf16 v[140:143], v[108:111], a[144:147], v[140:143]
v_add_u32 v38, s0, v10
v_lshrrev_b32 v11, 3, v0
v_mfma_f32_16x16x32_bf16 v[164:167], v[108:111], a[148:151], v[164:167]
v_lshlrev_b32 v11, 8, v11
v_bfe_u32 v12, v0, 2, 1
v_lshl_add_u32 v11, v12, 7, v11
v_mfma_f32_16x16x32_bf16 v[188:191], v[108:111], a[152:155], v[188:191]
buffer_load_dwordx4 v29, s[28:31], s87 offen offset:1024 lds
v_mfma_f32_16x16x32_bf16 v[212:215], v[108:111], a[156:159], v[212:215]
buffer_load_dwordx4 v[108:111], v47, s[20:23], s90 offen offset:1024 sc1
s_waitcnt vmcnt(19)
v_mfma_f32_16x16x32_bf16 v[128:131], v[112:115], a[160:163], v[128:131]
s_lshl_b32 s86, s47, 11
s_add_u32 s86, s86, 196608
v_mfma_f32_16x16x32_bf16 v[152:155], v[112:115], a[164:167], v[152:155]
buffer_load_dwordx2 v[34:35], v11, s[20:23], s86 offen sc1
v_mfma_f32_16x16x32_bf16 v[176:179], v[112:115], a[168:171], v[176:179]
s_lshl_b32 s87, s44, 2
s_add_u32 s87, s87, s47
s_add_u32 s87, s87, 1
v_mfma_f32_16x16x32_bf16 v[200:203], v[112:115], a[172:175], v[200:203]
buffer_load_dwordx4 v[112:115], v47, s[20:23], s90 offen offset:3072 sc1
s_waitcnt vmcnt(20)
v_mfma_f32_16x16x32_bf16 v[132:135], v[56:59], a[160:163], v[132:135]
s_and_b32 s87, s87, 15
s_lshl_b32 m0, s87, 12
s_lshl_b32 s87, s87, 15
v_mfma_f32_16x16x32_bf16 v[156:159], v[56:59], a[164:167], v[156:159]
s_sub_u32 s56, s87, 16384
s_cselect_b32 s56, 0x40000000, s56
v_mfma_f32_16x16x32_bf16 v[180:183], v[56:59], a[168:171], v[180:183]
buffer_load_dwordx4 v28, s[28:31], s56 offen lds
v_mfma_f32_16x16x32_bf16 v[204:207], v[56:59], a[172:175], v[204:207]
s_mul_i32 s90, s92, 90112
s_add_u32 s92, s92, 1
s_add_u32 s90, s90, s93
s_and_b32 s92, s92, 7
buffer_load_dwordx4 v[56:59], v33, s[20:23], s90 offen offset:0 sc1
s_waitcnt vmcnt(21)
v_mfma_f32_16x16x32_bf16 v[136:139], v[60:63], a[160:163], v[136:139]
v_mfma_f32_16x16x32_bf16 v[160:163], v[60:63], a[164:167], v[160:163]
v_mfma_f32_16x16x32_bf16 v[184:187], v[60:63], a[168:171], v[184:187]
s_cmp_gt_u32 s15, 3
s_cbranch_scc1 L_nr_77
s_waitcnt vmcnt(8)
s_swappc_b64 s[8:9], s[10:11]
L_nr_77:
v_mfma_f32_16x16x32_bf16 v[208:211], v[60:63], a[172:175], v[208:211]
buffer_load_dwordx4 v[60:63], v33, s[20:23], s90 offen offset:2048 sc1
s_waitcnt vmcnt(21)
v_mfma_f32_16x16x32_bf16 v[140:143], v[64:67], a[160:163], v[140:143]
buffer_load_dwordx4 v29, s[28:31], s56 offen offset:1024 lds
v_mfma_f32_16x16x32_bf16 v[164:167], v[64:67], a[164:167], v[164:167]
s_add_u32 m0, m0, 2048
s_nop 0
v_mfma_f32_16x16x32_bf16 v[188:191], v[64:67], a[168:171], v[188:191]
s_waitcnt vmcnt(5)
v_cmp_ne_u64 vcc, v[34:35], v[26:27]
s_nop 3
s_cbranch_vccz L_ok_79
s_mov_b32 s62, 4000
L_sp_78:
s_sleep 3
v_lshrrev_b32 v11, 3, v0
v_lshlrev_b32 v11, 8, v11
v_bfe_u32 v12, v0, 2, 1
v_lshl_add_u32 v11, v12, 7, v11
s_lshl_b32 s86, s47, 11
s_add_u32 s86, s86, 196608
buffer_load_dwordx2 v[34:35], v11, s[20:23], s86 offen sc1
s_waitcnt vmcnt(0)
v_cmp_ne_u64 vcc, v[34:35], v[26:27]
s_sub_u32 s62, s62, 1
s_cbranch_scc1 L_ok_79
s_nop 1
s_cbranch_vccnz L_sp_78
L_ok_79:
v_mfma_f32_16x16x32_bf16 v[212:215], v[64:67], a[172:175], v[212:215]
buffer_load_dwordx4 v[64:67], v47, s[20:23], s90 offen offset:0 sc1
v_mfma_f32_16x16x32_bf16 v[128:131], v[68:71], a[176:179], v[128:131]
v_mfma_f32_16x16x32_bf16 v[152:155], v[68:71], a[180:183], v[152:155]
v_mfma_f32_16x16x32_bf16 v[176:179], v[68:71], a[184:187], v[176:179]
v_mfma_f32_16x16x32_bf16 v[200:203], v[68:71], a[188:191], v[200:203]
buffer_load_dwordx4 v[68:71], v47, s[20:23], s90 offen offset:2048 sc1
v_mfma_f32_16x16x32_bf16 v[132:135], v[72:75], a[176:179], v[132:135]
v_mfma_f32_16x16x32_bf16 v[156:159], v[72:75], a[180:183], v[156:159]
v_lshlrev_b32 v10, 3, v0
v_mfma_f32_16x16x32_bf16 v[180:183], v[72:75], a[184:187], v[180:183]
buffer_load_dwordx4 v28, s[28:31], s87 offen lds
v_mfma_f32_16x16x32_bf16 v[204:207], v[72:75], a[188:191], v[204:207]
buffer_load_dwordx4 v[72:75], v33, s[20:23], s90 offen offset:1024 sc1
v_mfma_f32_16x16x32_bf16 v[136:139], v[76:79], a[176:179], v[136:139]
v_mfma_f32_16x16x32_bf16 v[160:163], v[76:79], a[180:183], v[160:163]
s_cmp_gt_u32 s15, 3
s_cbranch_scc1 L_nr_81
s_waitcnt vmcnt(6)
s_swappc_b64 s[8:9], s[10:11]
L_nr_81:
v_mfma_f32_16x16x32_bf16 v[184:187], v[76:79], a[184:187], v[184:187]
buffer_load_dwordx4 v29, s[28:31], s87 offen offset:1024 lds
v_mfma_f32_16x16x32_bf16 v[208:211], v[76:79], a[188:191], v[208:211]
buffer_load_dwordx4 v[76:79], v33, s[20:23], s90 offen offset:3072 sc1
v_mfma_f32_16x16x32_bf16 v[140:143], v[80:83], a[176:179], v[140:143]
s_lshl_b32 s87, s44, 2
s_add_u32 s87, s87, s47
v_mfma_f32_16x16x32_bf16 v[164:167], v[80:83], a[180:183], v[164:167]
buffer_load_dwordx2 v[116:117], v10, s[20:23], s70 offen offset:0 sc1
v_mfma_f32_16x16x32_bf16 v[188:191], v[80:83], a[184:187], v[188:191]
buffer_load_dwordx2 v[118:119], v10, s[20:23], s70 offen offset:512 sc1
v_mfma_f32_16x16x32_bf16 v[212:215], v[80:83], a[188:191], v[212:215]
buffer_load_dwordx4 v[80:83], v47, s[20:23], s90 offen offset:1024 sc1
v_mfma_f32_16x16x32_bf16 v[128:131], v[84:87], a[192:195], v[128:131]
s_add_u32 s87, s87, 2
v_mfma_f32_16x16x32_bf16 v[152:155], v[84:87], a[196:199], v[152:155]
buffer_load_dwordx2 v[120:121], v10, s[20:23], s70 offen offset:1024 sc1
v_mfma_f32_16x16x32_bf16 v[176:179], v[84:87], a[200:203], v[176:179]
s_and_b32 s87, s87, 15
s_lshl_b32 m0, s87, 12
s_lshl_b32 s87, s87, 15
v_mfma_f32_16x16x32_bf16 v[200:203], v[84:87], a[204:207], v[200:203]
buffer_load_dwordx4 v[84:87], v47, s[20:23], s90 offen offset:3072 sc1
v_mfma_f32_16x16x32_bf16 v[132:135], v[88:91], a[192:195], v[132:135]
buffer_load_dwordx2 v[122:123], v10, s[20:23], s70 offen offset:1536 sc1
v_mfma_f32_16x16x32_bf16 v[156:159], v[88:91], a[196:199], v[156:159]
s_sub_u32 s56, s87, 16384
s_cselect_b32 s56, 0x40000000, s56
v_mfma_f32_16x16x32_bf16 v[180:183], v[88:91], a[200:203], v[180:183]
buffer_load_dwordx2 v[124:125], v10, s[20:23], s70 offen offset:2048 sc1
v_mfma_f32_16x16x32_bf16 v[204:207], v[88:91], a[204:207], v[204:207]
buffer_load_dwordx2 v[126:127], v10, s[20:23], s70 offen offset:2560 sc1
v_mfma_f32_16x16x32_bf16 v[136:139], v[92:95], a[192:195], v[136:139]
v_mfma_f32_16x16x32_bf16 v[160:163], v[92:95], a[196:199], v[160:163]
buffer_load_dwordx4 v28, s[28:31], s56 offen lds
v_mfma_f32_16x16x32_bf16 v[184:187], v[92:95], a[200:203], v[184:187]
s_cmp_gt_u32 s15, 3
s_cbranch_scc1 L_nr_82
s_waitcnt vmcnt(11)
s_swappc_b64 s[8:9], s[10:11]
L_nr_82:
v_mfma_f32_16x16x32_bf16 v[208:211], v[92:95], a[204:207], v[208:211]
buffer_load_dwordx4 v29, s[28:31], s56 offen offset:1024 lds
v_mfma_f32_16x16x32_bf16 v[140:143], v[96:99], a[192:195], v[140:143]
s_add_u32 m0, m0, 2048
s_nop 0
v_mfma_f32_16x16x32_bf16 v[164:167], v[96:99], a[196:199], v[164:167]
buffer_load_dwordx4 v28, s[28:31], s87 offen lds
v_mfma_f32_16x16x32_bf16 v[188:191], v[96:99], a[200:203], v[188:191]
buffer_load_dwordx4 v29, s[28:31], s87 offen offset:1024 lds
v_mfma_f32_16x16x32_bf16 v[212:215], v[96:99], a[204:207], v[212:215]
s_lshl_b32 s87, s44, 2
s_add_u32 s87, s87, s47
v_mfma_f32_16x16x32_bf16 v[128:131], v[100:103], a[208:211], v[128:131]
s_mov_b32 s69, 4000
L_rf_83:
s_cmp_gt_u32 s15, 3
s_cbranch_scc1 L_rfe_84
s_waitcnt vmcnt(0)
s_swappc_b64 s[8:9], s[10:11]
s_sub_u32 s69, s69, 1
s_cmp_gt_u32 s69, 1
s_cbranch_scc1 L_rf_83
L_rfe_84:
v_mfma_f32_16x16x32_bf16 v[152:155], v[100:103], a[212:215], v[152:155]
v_mfma_f32_16x16x32_bf16 v[176:179], v[100:103], a[216:219], v[176:179]
s_add_u32 s87, s87, 3
s_and_b32 s87, s87, 15
v_mfma_f32_16x16x32_bf16 v[200:203], v[100:103], a[220:223], v[200:203]
s_lshl_b32 m0, s87, 12
s_lshl_b32 s87, s87, 15
v_lshrrev_b32 v11, 3, v0
v_lshlrev_b32 v11, 9, v11
v_mfma_f32_16x16x32_bf16 v[132:135], v[104:107], a[208:211], v[132:135]
s_sub_u32 s56, s87, 16384
s_cselect_b32 s56, 0x40000000, s56
v_bfe_u32 v12, v0, 1, 2
v_mfma_f32_16x16x32_bf16 v[156:159], v[104:107], a[212:215], v[156:159]
v_lshl_add_u32 v11, v12, 7, v11
s_lshl_b32 s86, s44, 12
s_add_u32 s86, s86, 40960
v_mfma_f32_16x16x32_bf16 v[180:183], v[104:107], a[216:219], v[180:183]
buffer_load_dwordx4 v28, s[28:31], s56 offen lds
v_mfma_f32_16x16x32_bf16 v[204:207], v[104:107], a[220:223], v[204:207]
s_waitcnt vmcnt(19)
buffer_load_dwordx2 v[34:35], v11, s[20:23], s86 offen sc1
v_mfma_f32_16x16x32_bf16 v[136:139], v[108:111], a[208:211], v[136:139]
s_cmp_gt_u32 s15, 3
s_cbranch_scc1 L_nr_85
s_waitcnt vmcnt(5)
s_swappc_b64 s[8:9], s[10:11]
L_nr_85:
v_mfma_f32_16x16x32_bf16 v[160:163], v[108:111], a[212:215], v[160:163]
v_mov_b32 v252, v25
v_mov_b32 v253, v25
v_mfma_f32_16x16x32_bf16 v[184:187], v[108:111], a[216:219], v[184:187]
buffer_load_dwordx4 v29, s[28:31], s56 offen offset:1024 lds
v_mfma_f32_16x16x32_bf16 v[208:211], v[108:111], a[220:223], v[208:211]
v_mov_b32 v254, v25
v_mov_b32 v255, v25
s_add_u32 m0, m0, 2048
v_mfma_f32_16x16x32_bf16 v[140:143], v[112:115], a[208:211], v[140:143]
buffer_load_dwordx2 v[244:245], v52, s[4:7], 0 offen offset:0
v_mfma_f32_16x16x32_bf16 v[164:167], v[112:115], a[212:215], v[164:167]
s_nop 0
v_mfma_f32_16x16x32_bf16 v[188:191], v[112:115], a[216:219], v[188:191]
buffer_load_dwordx2 v[246:247], v52, s[4:7], 0 offen offset:32
v_mfma_f32_16x16x32_bf16 v[212:215], v[112:115], a[220:223], v[212:215]
buffer_load_dwordx4 v28, s[28:31], s87 offen lds
v_mfma_f32_16x16x32_bf16 v[128:131], v[56:59], a[224:227], v[128:131]
v_mfma_f32_16x16x32_bf16 v[152:155], v[56:59], a[228:231], v[152:155]
buffer_load_dwordx2 v[248:249], v52, s[4:7], 0 offen offset:64
v_mfma_f32_16x16x32_bf16 v[176:179], v[56:59], a[232:235], v[176:179]
buffer_load_dwordx2 v[250:251], v52, s[4:7], 0 offen offset:96
v_mfma_f32_16x16x32_bf16 v[200:203], v[56:59], a[236:239], v[200:203]
v_mfma_f32_16x16x32_bf16 v[132:135], v[60:63], a[224:227], v[132:135]
buffer_load_dwordx4 v29, s[28:31], s87 offen offset:1024 lds
v_mfma_f32_16x16x32_bf16 v[156:159], v[60:63], a[228:231], v[156:159]
ds_read_b64_tr_b16 a[96:97], v40 offset:8192
ds_read_b64_tr_b16 a[98:99], v40 offset:10240
ds_read_b64_tr_b16 a[100:101], v41 offset:8192
v_mfma_f32_16x16x32_bf16 v[180:183], v[60:63], a[232:235], v[180:183]
ds_read_b64_tr_b16 a[102:103], v41 offset:10240
ds_read_b64_tr_b16 a[104:105], v42 offset:8192
ds_read_b64_tr_b16 a[106:107], v42 offset:10240
ds_read_b64_tr_b16 a[108:109], v43 offset:8192
v_mfma_f32_16x16x32_bf16 v[204:207], v[60:63], a[236:239], v[204:207]
ds_read_b64_tr_b16 a[110:111], v43 offset:10240
ds_read_b64_tr_b16 a[112:113], v40 offset:12288
ds_read_b64_tr_b16 a[114:115], v40 offset:14336
s_waitcnt vmcnt(26)
v_mfma_f32_16x16x32_bf16 v[136:139], v[64:67], a[224:227], v[136:139]
s_mov_b32 s95, 0
s_waitcnt vmcnt(7)
v_cmp_ne_u64 vcc, v[34:35], v[26:27]
s_nop 3
s_cbranch_vccnz L_s3n_86
v_lshlrev_b32 v10, 3, v0
s_add_u32 s86, s57, 9306112
buffer_load_dwordx2 v[224:225], v10, s[20:23], s86 offen offset:0 sc1
buffer_load_dwordx2 v[226:227], v10, s[20:23], s86 offen offset:512 sc1
buffer_load_dwordx2 v[228:229], v10, s[20:23], s86 offen offset:1024 sc1
buffer_load_dwordx2 v[230:231], v10, s[20:23], s86 offen offset:1536 sc1
buffer_load_dwordx2 v[232:233], v10, s[20:23], s86 offen offset:2048 sc1
buffer_load_dwordx2 v[234:235], v10, s[20:23], s86 offen offset:2560 sc1
buffer_load_dwordx2 v[236:237], v10, s[20:23], s86 offen offset:3072 sc1
buffer_load_dwordx2 v[238:239], v10, s[20:23], s86 offen offset:3584 sc1
v_and_b32 v11, 56, v0
v_lshl_add_u32 v10, v11, 3, v10
s_lshl_b32 s0, s44, 10
s_add_u32 s86, s0, 9322496
buffer_load_dwordx2 v[240:241], v10, s[20:23], s86 offen sc1
s_mov_b32 s95, 1
L_s3n_86:
v_mfma_f32_16x16x32_bf16 v[160:163], v[64:67], a[228:231], v[160:163]
v_mfma_f32_16x16x32_bf16 v[184:187], v[64:67], a[232:235], v[184:187]
v_mfma_f32_16x16x32_bf16 v[208:211], v[64:67], a[236:239], v[208:211]
v_mfma_f32_16x16x32_bf16 v[140:143], v[68:71], a[224:227], v[140:143]
v_mfma_f32_16x16x32_bf16 v[164:167], v[68:71], a[228:231], v[164:167]
ds_read_b64_tr_b16 a[116:117], v41 offset:12288
ds_read_b64_tr_b16 a[118:119], v41 offset:14336
v_mfma_f32_16x16x32_bf16 v[188:191], v[68:71], a[232:235], v[188:191]
ds_read_b64_tr_b16 a[120:121], v42 offset:12288
ds_read_b64_tr_b16 a[122:123], v42 offset:14336
ds_read_b64_tr_b16 a[124:125], v43 offset:12288
v_mfma_f32_16x16x32_bf16 v[212:215], v[68:71], a[236:239], v[212:215]
ds_read_b64_tr_b16 a[126:127], v43 offset:14336
ds_read_b64_tr_b16 a[128:129], v40 offset:16384
ds_read_b64_tr_b16 a[130:131], v40 offset:18432
ds_read_b64_tr_b16 a[132:133], v41 offset:16384
ds_read_b64_tr_b16 a[134:135], v41 offset:18432
ds_read_b64_tr_b16 a[136:137], v42 offset:16384
ds_read_b64_tr_b16 a[138:139], v42 offset:18432
ds_read_b64_tr_b16 a[140:141], v43 offset:16384
ds_read_b64_tr_b16 a[142:143], v43 offset:18432
ds_read_b64_tr_b16 a[144:145], v40 offset:20480
ds_read_b64_tr_b16 a[146:147], v40 offset:22528
ds_read_b64_tr_b16 a[148:149], v41 offset:20480
ds_read_b64_tr_b16 a[150:151], v41 offset:22528
ds_read_b64_tr_b16 a[152:153], v42 offset:20480
ds_read_b64_tr_b16 a[154:155], v42 offset:22528
ds_read_b64_tr_b16 a[156:157], v43 offset:20480
ds_read_b64_tr_b16 a[158:159], v43 offset:22528
ds_read_b64_tr_b16 a[160:161], v40 offset:24576
ds_read_b64_tr_b16 a[162:163], v40 offset:26624
ds_read_b64_tr_b16 a[164:165], v41 offset:24576
ds_read_b64_tr_b16 a[166:167], v41 offset:26624
ds_read_b64_tr_b16 a[168:169], v42 offset:24576
ds_read_b64_tr_b16 a[170:171], v42 offset:26624
ds_read_b64_tr_b16 a[172:173], v43 offset:24576
ds_read_b64_tr_b16 a[174:175], v43 offset:26624
ds_read_b64_tr_b16 a[176:177], v40 offset:28672
ds_read_b64_tr_b16 a[178:179], v40 offset:30720
ds_read_b64_tr_b16 a[180:181], v41 offset:28672
ds_read_b64_tr_b16 a[182:183], v41 offset:30720
ds_read_b64_tr_b16 a[184:185], v42 offset:28672
ds_read_b64_tr_b16 a[186:187], v42 offset:30720
ds_read_b64_tr_b16 a[188:189], v43 offset:28672
ds_read_b64_tr_b16 a[190:191], v43 offset:30720
ds_read_b64_tr_b16 a[192:193], v40 offset:32768
ds_read_b64_tr_b16 a[194:195], v40 offset:34816
ds_read_b64_tr_b16 a[196:197], v41 offset:32768
ds_read_b64_tr_b16 a[198:199], v41 offset:34816
ds_read_b64_tr_b16 a[200:201], v42 offset:32768
ds_read_b64_tr_b16 a[202:203], v42 offset:34816
ds_read_b64_tr_b16 a[204:205], v43 offset:32768
ds_read_b64_tr_b16 a[206:207], v43 offset:34816
ds_read_b64_tr_b16 a[208:209], v40 offset:36864
ds_read_b64_tr_b16 a[210:211], v40 offset:38912
ds_read_b64_tr_b16 a[212:213], v41 offset:36864
ds_read_b64_tr_b16 a[214:215], v41 offset:38912
ds_read_b64_tr_b16 a[216:217], v42 offset:36864
ds_read_b64_tr_b16 a[218:219], v42 offset:38912
ds_read_b64_tr_b16 a[220:221], v43 offset:36864
ds_read_b64_tr_b16 a[222:223], v43 offset:38912
s_waitcnt lgkmcnt(0)
s_barrier
v_mfma_f32_16x16x32_bf16 v[128:131], v[72:75], a[240:243], v[128:131]
s_lshl_b32 s0, s47, 2
s_add_u32 s0, s0, s44
s_lshl_b32 s0, s0, 14
s_add_u32 s0, s0, 6029312
v_mfma_f32_16x16x32_bf16 v[152:155], v[72:75], a[244:247], v[152:155]
s_add_u32 s86, s0, 0
v_mfma_f32_16x16x32_bf16 v[176:179], v[72:75], a[248:251], v[176:179]
buffer_load_dwordx4 a[0:3], v32, s[20:23], s86 offen offset:0 sc1
v_mfma_f32_16x16x32_bf16 v[200:203], v[72:75], a[252:255], v[200:203]
buffer_load_dwordx4 a[4:7], v32, s[20:23], s86 offen offset:1024 sc1
v_mfma_f32_16x16x32_bf16 v[132:135], v[76:79], a[240:243], v[132:135]
v_mfma_f32_16x16x32_bf16 v[156:159], v[76:79], a[244:247], v[156:159]
buffer_load_dwordx4 a[8:11], v32, s[20:23], s86 offen offset:2048 sc1
v_mfma_f32_16x16x32_bf16 v[180:183], v[76:79], a[248:251], v[180:183]
buffer_load_dwordx4 a[12:15], v32, s[20:23], s86 offen offset:3072 sc1
v_mfma_f32_16x16x32_bf16 v[204:207], v[76:79], a[252:255], v[204:207]
s_add_u32 s86, s0, 4096
v_mfma_f32_16x16x32_bf16 v[208:211], v[80:83], a[252:255], v[208:211]
buffer_load_dwordx4 a[16:19], v32, s[20:23], s86 offen offset:0 sc1
v_mfma_f32_16x16x32_bf16 v[212:215], v[84:87], a[252:255], v[212:215]
buffer_load_dwordx4 a[20:23], v32, s[20:23], s86 offen offset:1024 sc1
v_mfma_f32_16x16x32_bf16 v[184:187], v[80:83], a[248:251], v[184:187]
v_mfma_f32_16x16x32_bf16 v[188:191], v[84:87], a[248:251], v[188:191]
buffer_load_dwordx4 a[24:27], v32, s[20:23], s86 offen offset:2048 sc1
v_mfma_f32_16x16x32_bf16 v[160:163], v[80:83], a[244:247], v[160:163]
buffer_load_dwordx4 a[28:31], v32, s[20:23], s86 offen offset:3072 sc1
v_mfma_f32_16x16x32_bf16 v[164:167], v[84:87], a[244:247], v[164:167]
v_mfma_f32_16x16x32_bf16 v[136:139], v[80:83], a[240:243], v[136:139]
v_mfma_f32_16x16x32_bf16 v[140:143], v[84:87], a[240:243], v[140:143]
L_join:
ds_write_b128 v20, v[200:203] offset:6144
ds_write_b128 v20, v[204:207] offset:7168
ds_write_b128 v20, v[208:211] offset:8192
ds_write_b128 v20, v[212:215] offset:9216
ds_write_b128 v20, v[216:219] offset:10240
ds_write_b128 v20, v[220:223] offset:11264
ds_write_b128 v20, v[176:179] offset:0
ds_write_b128 v20, v[180:183] offset:1024
ds_write_b128 v20, v[184:187] offset:2048
ds_write_b128 v20, v[188:191] offset:3072
ds_write_b128 v20, v[192:195] offset:4096
ds_write_b128 v20, v[196:199] offset:5120
s_lshl_b32 s0, s47, 2
s_add_u32 s0, s0, s44
s_lshl_b32 s0, s0, 14
s_add_u32 s0, s0, 6029312
s_add_u32 s86, s0, 8192
buffer_load_dwordx4 a[32:35], v32, s[20:23], s86 offen offset:0 sc1
buffer_load_dwordx4 a[36:39], v32, s[20:23], s86 offen offset:1024 sc1
buffer_load_dwordx4 a[40:43], v32, s[20:23], s86 offen offset:2048 sc1
buffer_load_dwordx4 a[44:47], v32, s[20:23], s86 offen offset:3072 sc1
s_add_u32 s86, s0, 12288
buffer_load_dwordx4 a[48:51], v32, s[20:23], s86 offen offset:0 sc1
buffer_load_dwordx4 a[52:55], v32, s[20:23], s86 offen offset:1024 sc1
buffer_load_dwordx4 a[56:59], v32, s[20:23], s86 offen offset:2048 sc1
buffer_load_dwordx4 a[60:63], v32, s[20:23], s86 offen offset:3072 sc1
v_lshlrev_b32 v84, 16, v39
v_lshlrev_b32 v85, 16, v39
v_and_b32 v116, s68, v116
v_and_b32 v117, s68, v117
v_lshlrev_b32 v60, 16, v116
v_and_b32 v61, 0xffff0000, v116
v_lshlrev_b32 v62, 16, v117
v_and_b32 v63, 0xffff0000, v117
v_lshlrev_b32 v64, 16, v118
v_and_b32 v65, 0xffff0000, v118
v_lshlrev_b32 v66, 16, v119
v_and_b32 v67, 0xffff0000, v119
v_lshlrev_b32 v68, 16, v120
v_and_b32 v69, 0xffff0000, v120
v_lshlrev_b32 v70, 16, v121
v_and_b32 v71, 0xffff0000, v121
v_lshlrev_b32 v72, 16, v122
v_and_b32 v73, 0xffff0000, v122
v_lshlrev_b32 v74, 16, v123
v_and_b32 v75, 0xffff0000, v123
v_lshlrev_b32 v76, 16, v124
v_and_b32 v77, 0xffff0000, v124
v_lshlrev_b32 v78, 16, v125
v_and_b32 v79, 0xffff0000, v125
v_lshlrev_b32 v80, 16, v126
v_and_b32 v81, 0xffff0000, v126
v_lshlrev_b32 v82, 16, v127
v_and_b32 v83, 0xffff0000, v127
v_pk_add_f32 v[128:129], v[128:129], v[84:85]
v_pk_add_f32 v[130:131], v[130:131], v[84:85]
v_pk_add_f32 v[132:133], v[132:133], v[84:85]
v_pk_add_f32 v[134:135], v[134:135], v[84:85]
v_pk_add_f32 v[136:137], v[136:137], v[84:85]
v_pk_add_f32 v[138:139], v[138:139], v[84:85]
v_pk_add_f32 v[140:141], v[140:141], v[84:85]
v_pk_add_f32 v[142:143], v[142:143], v[84:85]
v_pk_add_f32 v[144:145], v[144:145], v[84:85]
v_pk_add_f32 v[146:147], v[146:147], v[84:85]
v_pk_add_f32 v[148:149], v[148:149], v[84:85]
v_pk_add_f32 v[150:151], v[150:151], v[84:85]
s_waitcnt lgkmcnt(0)
s_barrier
ds_read_b128 v[200:203], v21 offset:6144
ds_read_b128 v[204:207], v21 offset:7168
ds_read_b128 v[208:211], v21 offset:8192
ds_read_b128 v[212:215], v21 offset:9216
ds_read_b128 v[216:219], v21 offset:10240
ds_read_b128 v[220:223], v21 offset:11264
ds_read_b128 v[176:179], v21 offset:0
ds_read_b128 v[180:183], v21 offset:1024
ds_read_b128 v[184:187], v21 offset:2048
ds_read_b128 v[188:191], v21 offset:3072
ds_read_b128 v[192:195], v21 offset:4096
ds_read_b128 v[196:199], v21 offset:5120
s_waitcnt lgkmcnt(11)
v_pk_add_f32 v[152:153], v[152:153], v[200:201]
v_pk_add_f32 v[154:155], v[154:155], v[202:203]
s_waitcnt lgkmcnt(10)
v_pk_add_f32 v[156:157], v[156:157], v[204:205]
v_pk_add_f32 v[158:159], v[158:159], v[206:207]
ds_write_b128 v21, v[152:155] offset:0
ds_write_b128 v21, v[156:159] offset:1024
s_waitcnt lgkmcnt(11)
v_pk_add_f32 v[160:161], v[160:161], v[208:209]
v_pk_add_f32 v[162:163], v[162:163], v[210:211]
s_waitcnt lgkmcnt(10)
v_pk_add_f32 v[164:165], v[164:165], v[212:213]
v_pk_add_f32 v[166:167], v[166:167], v[214:215]
ds_write_b128 v21, v[160:163] offset:2048
ds_write_b128 v21, v[164:167] offset:3072
s_waitcnt lgkmcnt(11)
v_pk_add_f32 v[168:169], v[168:169], v[216:217]
v_pk_add_f32 v[170:171], v[170:171], v[218:219]
s_waitcnt lgkmcnt(10)
v_pk_add_f32 v[172:173], v[172:173], v[220:221]
v_pk_add_f32 v[174:175], v[174:175], v[222:223]
ds_write_b128 v21, v[168:171] offset:4096
ds_write_b128 v21, v[172:175] offset:5120
s_waitcnt lgkmcnt(11)
v_pk_add_f32 v[128:129], v[128:129], v[176:177]
v_pk_add_f32 v[130:131], v[130:131], v[178:179]
s_waitcnt lgkmcnt(10)
v_pk_add_f32 v[132:133], v[132:133], v[180:181]
v_pk_add_f32 v[134:135], v[134:135], v[182:183]
s_waitcnt lgkmcnt(9)
v_pk_add_f32 v[136:137], v[136:137], v[184:185]
v_pk_add_f32 v[138:139], v[138:139], v[186:187]
s_waitcnt lgkmcnt(8)
v_pk_add_f32 v[140:141], v[140:141], v[188:189]
v_pk_add_f32 v[142:143], v[142:143], v[190:191]
s_waitcnt lgkmcnt(7)
v_pk_add_f32 v[144:145], v[144:145], v[192:193]
v_pk_add_f32 v[146:147], v[146:147], v[194:195]
s_waitcnt lgkmcnt(6)
v_pk_add_f32 v[148:149], v[148:149], v[196:197]
v_pk_add_f32 v[150:151], v[150:151], v[198:199]
s_waitcnt lgkmcnt(0)
s_barrier
ds_read_b128 v[152:155], v22 offset:0
ds_read_b128 v[156:159], v22 offset:1024
ds_read_b128 v[160:163], v22 offset:2048
ds_read_b128 v[164:167], v22 offset:3072
ds_read_b128 v[168:171], v22 offset:4096
ds_read_b128 v[172:175], v22 offset:5120
s_waitcnt lgkmcnt(5)
v_pk_add_f32 v[128:129], v[128:129], v[152:153]
v_pk_add_f32 v[130:131], v[130:131], v[154:155]
s_waitcnt lgkmcnt(4)
v_pk_add_f32 v[132:133], v[132:133], v[156:157]
v_pk_add_f32 v[134:135], v[134:135], v[158:159]
v_pk_mul_f32 v[128:129], v[128:129], v[60:61]
v_pk_mul_f32 v[130:131], v[130:131], v[62:63]
v_pk_mul_f32 v[132:133], v[132:133], v[64:65]
v_pk_mul_f32 v[134:135], v[134:135], v[66:67]
v_cvt_pk_bf16_f32 v88, v128, v129
v_cvt_pk_bf16_f32 v89, v130, v131
v_cvt_pk_bf16_f32 v90, v132, v133
v_cvt_pk_bf16_f32 v91, v134, v135
buffer_store_dwordx4 v[88:91], v32, s[20:23], s71 offen offset:0 sc1
s_waitcnt lgkmcnt(3)
v_pk_add_f32 v[136:137], v[136:137], v[160:161]
v_pk_add_f32 v[138:139], v[138:139], v[162:163]
s_waitcnt lgkmcnt(2)
v_pk_add_f32 v[140:141], v[140:141], v[164:165]
v_pk_add_f32 v[142:143], v[142:143], v[166:167]
v_pk_mul_f32 v[136:137], v[136:137], v[68:69]
v_pk_mul_f32 v[138:139], v[138:139], v[70:71]
v_pk_mul_f32 v[140:141], v[140:141], v[72:73]
v_pk_mul_f32 v[142:143], v[142:143], v[74:75]
v_cvt_pk_bf16_f32 v92, v136, v137
v_cvt_pk_bf16_f32 v93, v138, v139
v_cvt_pk_bf16_f32 v94, v140, v141
v_cvt_pk_bf16_f32 v95, v142, v143
buffer_store_dwordx4 v[92:95], v32, s[20:23], s71 offen offset:1024 sc1
s_waitcnt lgkmcnt(1)
v_pk_add_f32 v[144:145], v[144:145], v[168:169]
v_pk_add_f32 v[146:147], v[146:147], v[170:171]
s_waitcnt lgkmcnt(0)
v_pk_add_f32 v[148:149], v[148:149], v[172:173]
v_pk_add_f32 v[150:151], v[150:151], v[174:175]
v_pk_mul_f32 v[144:145], v[144:145], v[76:77]
v_pk_mul_f32 v[146:147], v[146:147], v[78:79]
v_pk_mul_f32 v[148:149], v[148:149], v[80:81]
v_pk_mul_f32 v[150:151], v[150:151], v[82:83]
v_cvt_pk_bf16_f32 v96, v144, v145
v_cvt_pk_bf16_f32 v97, v146, v147
v_cvt_pk_bf16_f32 v98, v148, v149
v_cvt_pk_bf16_f32 v99, v150, v151
buffer_store_dwordx4 v[96:99], v32, s[20:23], s72 offen offset:2048 sc1
s_cmp_eq_u32 s95, 1
s_cbranch_scc1 L_s3d
s_waitcnt vmcnt(0)
s_mov_b64 exec, 1
buffer_store_dwordx2 v[26:27], v14, s[20:23], s98 offen sc1
s_mov_b64 exec, -1
v_lshrrev_b32 v11, 3, v0
v_lshlrev_b32 v11, 9, v11
v_bfe_u32 v12, v0, 1, 2
v_lshl_add_u32 v11, v12, 7, v11
s_lshl_b32 s86, s44, 12
s_add_u32 s86, s86, 40960
buffer_load_dwordx2 v[34:35], v11, s[20:23], s86 offen sc1
s_waitcnt vmcnt(0)
v_cmp_ne_u64 vcc, v[34:35], v[26:27]
s_nop 3
s_cbranch_vccz L_ok_90
s_mov_b32 s62, 4000
L_sp_89:
s_sleep 3
v_lshrrev_b32 v11, 3, v0
v_lshlrev_b32 v11, 9, v11
v_bfe_u32 v12, v0, 1, 2
v_lshl_add_u32 v11, v12, 7, v11
s_lshl_b32 s86, s44, 12
s_add_u32 s86, s86, 40960
buffer_load_dwordx2 v[34:35], v11, s[20:23], s86 offen sc1
s_waitcnt vmcnt(0)
v_cmp_ne_u64 vcc, v[34:35], v[26:27]
s_sub_u32 s62, s62, 1
s_cbranch_scc1 L_ok_90
s_nop 1
s_cbranch_vccnz L_sp_89
L_ok_90:
v_lshlrev_b32 v10, 3, v0
s_add_u32 s86, s57, 9306112
buffer_load_dwordx2 v[224:225], v10, s[20:23], s86 offen offset:0 sc1
buffer_load_dwordx2 v[226:227], v10, s[20:23], s86 offen offset:512 sc1
buffer_load_dwordx2 v[228:229], v10, s[20:23], s86 offen offset:1024 sc1
buffer_load_dwordx2 v[230:231], v10, s[20:23], s86 offen offset:1536 sc1
buffer_load_dwordx2 v[232:233], v10, s[20:23], s86 offen offset:2048 sc1
buffer_load_dwordx2 v[234:235], v10, s[20:23], s86 offen offset:2560 sc1
buffer_load_dwordx2 v[236:237], v10, s[20:23], s86 offen offset:3072 sc1
buffer_load_dwordx2 v[238:239], v10, s[20:23], s86 offen offset:3584 sc1
v_and_b32 v11, 56, v0
v_lshl_add_u32 v10, v11, 3, v10
s_lshl_b32 s0, s44, 10
s_add_u32 s86, s0, 9322496
buffer_load_dwordx2 v[240:241], v10, s[20:23], s86 offen sc1
s_waitcnt vmcnt(0)
L_s3d:
s_waitcnt vmcnt(3)
ds_write_b128 v23, v[224:227] offset:0
ds_write_b128 v23, v[228:231] offset:1024
ds_write_b128 v23, v[232:235] offset:2048
ds_write_b128 v23, v[236:239] offset:3072
ds_write_b64 v38, v[240:241]
s_waitcnt lgkmcnt(0)
s_barrier
ds_read_b128 v[196:199], v53 offset:0
ds_read_b128 v[184:187], v242 offset:0
ds_read_b128 v[200:203], v53 offset:128
ds_read_b128 v[188:191], v242 offset:1024
s_mov_b32 s99, 0
s_waitcnt lgkmcnt(3)
v_mfma_f32_16x16x32_bf16 v[216:219], v[196:199], a[0:3], v[252:255]
s_waitcnt lgkmcnt(2)
v_mfma_f32_16x16x16_bf16 v[208:211], v[184:185], a[0:1], 0
v_mfma_f32_16x16x16_bf16 v[212:215], v[186:187], a[2:3], 0
s_add_u32 m0, s59, 65536
s_lshl_b32 s87, s44, 16
s_add_u32 s87, s87, 507904
buffer_load_dwordx4 v28, s[28:31], s87 offen lds
buffer_load_dwordx4 v29, s[28:31], s87 offen offset:1024 lds
s_waitcnt lgkmcnt(1)
v_mfma_f32_16x16x32_bf16 v[176:179], v[200:203], a[4:7], v[252:255]
ds_read_b128 v[204:207], v53 offset:256
ds_read_b128 v[192:195], v242 offset:2048
v_rcp_f32 v160, v216
v_rcp_f32 v161, v217
v_mul_f32 v208, v208, v160
v_mul_f32 v209, v209, v160
s_waitcnt lgkmcnt(2)
v_mfma_f32_16x16x16_bf16 v[168:171], v[188:189], a[4:5], 0
v_mul_f32 v210, v210, v160
v_mul_f32 v211, v211, v160
v_mul_f32 v212, v212, v161
v_mul_f32 v213, v213, v161
v_mul_f32 v214, v214, v161
v_mul_f32 v215, v215, v161
v_cvt_pk_bf16_f32 v220, v208, v209
v_mfma_f32_16x16x16_bf16 v[172:175], v[190:191], a[6:7], 0
v_cvt_pk_bf16_f32 v221, v210, v211
v_cvt_pk_bf16_f32 v222, v212, v213
v_cvt_pk_bf16_f32 v223, v214, v215
ds_read_b64_tr_b16 a[224:225], v40 offset:40960
ds_read_b64_tr_b16 a[226:227], v40 offset:43008
ds_read_b64_tr_b16 a[228:229], v41 offset:40960
ds_read_b64_tr_b16 a[230:231], v41 offset:43008
buffer_load_dwordx4 v30, s[28:31], s87 offen offset:2048 lds
buffer_load_dwordx4 v31, s[28:31], s87 offen offset:3072 lds
s_add_u32 m0, s59, 69632
s_lshl_b32 s87, s44, 16
s_waitcnt lgkmcnt(5)
v_mfma_f32_16x16x32_bf16 v[216:219], v[204:207], a[8:11], v[252:255]
ds_read_b128 v[196:199], v53 offset:384
ds_read_b128 v[184:187], v242 offset:3072
s_waitcnt lgkmcnt(6)
v_mfma_f32_16x16x16_bf16 v[208:211], v[192:193], a[8:9], 0
v_rcp_f32 v160, v176
v_rcp_f32 v161, v177
v_mul_f32 v168, v168, v160
v_mfma_f32_16x16x16_bf16 v[212:215], v[194:195], a[10:11], 0
v_mul_f32 v169, v169, v160
v_mul_f32 v170, v170, v160
v_mul_f32 v171, v171, v160
v_mfma_f32_16x16x32_bf16 v[144:147], a[64:67], v[220:223], 0
v_mul_f32 v172, v172, v161
v_mul_f32 v173, v173, v161
v_mul_f32 v174, v174, v161
v_mfma_f32_16x16x32_bf16 v[148:151], a[68:71], v[220:223], 0
v_mul_f32 v175, v175, v161
v_cvt_pk_bf16_f32 v180, v168, v169
v_cvt_pk_bf16_f32 v181, v170, v171
v_mfma_f32_16x16x32_bf16 v[152:155], a[72:75], v[220:223], 0
v_cvt_pk_bf16_f32 v182, v172, v173
v_cvt_pk_bf16_f32 v183, v174, v175
ds_read_b64_tr_b16 a[232:233], v42 offset:40960
v_mfma_f32_16x16x32_bf16 v[156:159], a[76:79], v[220:223], 0
ds_read_b64_tr_b16 a[234:235], v42 offset:43008
ds_read_b64_tr_b16 a[236:237], v43 offset:40960
ds_read_b64_tr_b16 a[238:239], v43 offset:43008
s_add_u32 s87, s87, 540672
buffer_load_dwordx4 v28, s[28:31], s87 offen lds
buffer_load_dwordx4 v29, s[28:31], s87 offen offset:1024 lds
buffer_load_dwordx4 v30, s[28:31], s87 offen offset:2048 lds
s_waitcnt lgkmcnt(5)
v_mfma_f32_16x16x32_bf16 v[176:179], v[196:199], a[12:15], v[252:255]
ds_read_b128 v[200:203], v53 offset:512
ds_read_b128 v[188:191], v242 offset:4096
s_waitcnt lgkmcnt(6)
v_mfma_f32_16x16x16_bf16 v[168:171], v[184:185], a[12:13], 0
v_rcp_f32 v160, v216
v_rcp_f32 v161, v217
v_mul_f32 v208, v208, v160
v_mfma_f32_16x16x16_bf16 v[172:175], v[186:187], a[14:15], 0
v_mul_f32 v209, v209, v160
v_mul_f32 v210, v210, v160
v_mul_f32 v211, v211, v160
v_mfma_f32_16x16x32_bf16 v[144:147], a[80:83], v[180:183], v[144:147]
v_mul_f32 v212, v212, v161
v_mul_f32 v213, v213, v161
v_mul_f32 v214, v214, v161
v_mfma_f32_16x16x32_bf16 v[148:151], a[84:87], v[180:183], v[148:151]
v_mul_f32 v215, v215, v161
v_cvt_pk_bf16_f32 v220, v208, v209
v_cvt_pk_bf16_f32 v221, v210, v211
v_mfma_f32_16x16x32_bf16 v[152:155], a[88:91], v[180:183], v[152:155]
v_cvt_pk_bf16_f32 v222, v212, v213
v_cvt_pk_bf16_f32 v223, v214, v215
ds_read_b64_tr_b16 a[240:241], v40 offset:45056
v_mfma_f32_16x16x32_bf16 v[156:159], a[92:95], v[180:183], v[156:159]
ds_read_b64_tr_b16 a[242:243], v40 offset:47104
ds_read_b64_tr_b16 a[244:245], v41 offset:45056
ds_read_b64_tr_b16 a[246:247], v41 offset:47104
s_cmp_eq_u32 s95, 1
s_cbranch_scc0 L_arrd_92
s_waitcnt vmcnt(7)
s_mov_b64 exec, 1
buffer_store_dwordx2 v[26:27], v14, s[20:23], s98 offen sc1
s_mov_b64 exec, -1
L_arrd_92:
buffer_load_dwordx4 v31, s[28:31], s87 offen offset:3072 lds
s_waitcnt lgkmcnt(5)
v_mfma_f32_16x16x32_bf16 v[216:219], v[200:203], a[16:19], v[252:255]
ds_read_b128 v[204:207], v53 offset:640
ds_read_b128 v[192:195], v242 offset:5120
s_waitcnt lgkmcnt(6)
v_mfma_f32_16x16x16_bf16 v[208:211], v[188:189], a[16:17], 0
v_rcp_f32 v160, v176
v_rcp_f32 v161, v177
v_mul_f32 v168, v168, v160
v_mfma_f32_16x16x16_bf16 v[212:215], v[190:191], a[18:19], 0
v_mul_f32 v169, v169, v160
v_mul_f32 v170, v170, v160
v_mul_f32 v171, v171, v160
v_mfma_f32_16x16x32_bf16 v[144:147], a[96:99], v[220:223], v[144:147]
v_mul_f32 v172, v172, v161
v_mul_f32 v173, v173, v161
v_mul_f32 v174, v174, v161
v_mfma_f32_16x16x32_bf16 v[148:151], a[100:103], v[220:223], v[148:151]
v_mul_f32 v175, v175, v161
v_cvt_pk_bf16_f32 v180, v168, v169
v_cvt_pk_bf16_f32 v181, v170, v171
v_mfma_f32_16x16x32_bf16 v[152:155], a[104:107], v[220:223], v[152:155]
v_cvt_pk_bf16_f32 v182, v172, v173
v_cvt_pk_bf16_f32 v183, v174, v175
ds_read_b64_tr_b16 a[248:249], v42 offset:45056
v_mfma_f32_16x16x32_bf16 v[156:159], a[108:111], v[220:223], v[156:159]
ds_read_b64_tr_b16 a[250:251], v42 offset:47104
ds_read_b64_tr_b16 a[252:253], v43 offset:45056
ds_read_b64_tr_b16 a[254:255], v43 offset:47104
s_waitcnt lgkmcnt(5)
v_mfma_f32_16x16x32_bf16 v[176:179], v[204:207], a[20:23], v[252:255]
ds_read_b128 v[196:199], v53 offset:768
ds_read_b128 v[184:187], v242 offset:6144
s_waitcnt lgkmcnt(6)
v_mfma_f32_16x16x16_bf16 v[168:171], v[192:193], a[20:21], 0
v_rcp_f32 v160, v216
v_rcp_f32 v161, v217
v_mul_f32 v208, v208, v160
v_mfma_f32_16x16x16_bf16 v[172:175], v[194:195], a[22:23], 0
v_mul_f32 v209, v209, v160
v_mul_f32 v210, v210, v160
v_mul_f32 v211, v211, v160
v_mfma_f32_16x16x32_bf16 v[144:147], a[112:115], v[180:183], v[144:147]
v_mul_f32 v212, v212, v161
v_mul_f32 v213, v213, v161
v_mul_f32 v214, v214, v161
v_mfma_f32_16x16x32_bf16 v[148:151], a[116:119], v[180:183], v[148:151]
v_mul_f32 v215, v215, v161
v_cvt_pk_bf16_f32 v220, v208, v209
v_cvt_pk_bf16_f32 v221, v210, v211
v_mfma_f32_16x16x32_bf16 v[152:155], a[120:123], v[180:183], v[152:155]
v_cvt_pk_bf16_f32 v222, v212, v213
v_cvt_pk_bf16_f32 v223, v214, v215
ds_read_b64_tr_b16 a[64:65], v40 offset:49152
v_mfma_f32_16x16x32_bf16 v[156:159], a[124:127], v[180:183], v[156:159]
ds_read_b64_tr_b16 a[66:67], v40 offset:51200
ds_read_b64_tr_b16 a[68:69], v41 offset:49152
ds_read_b64_tr_b16 a[70:71], v41 offset:51200
s_waitcnt lgkmcnt(5)
v_mfma_f32_16x16x32_bf16 v[216:219], v[196:199], a[24:27], v[252:255]
ds_read_b128 v[200:203], v53 offset:896
ds_read_b128 v[188:191], v242 offset:7168
s_waitcnt lgkmcnt(6)
v_mfma_f32_16x16x16_bf16 v[208:211], v[184:185], a[24:25], 0
v_rcp_f32 v160, v176
v_rcp_f32 v161, v177
v_mul_f32 v168, v168, v160
v_mfma_f32_16x16x16_bf16 v[212:215], v[186:187], a[26:27], 0
v_mul_f32 v169, v169, v160
v_mul_f32 v170, v170, v160
v_mul_f32 v171, v171, v160
v_mfma_f32_16x16x32_bf16 v[144:147], a[128:131], v[220:223], v[144:147]
v_mul_f32 v172, v172, v161
v_mul_f32 v173, v173, v161
v_mul_f32 v174, v174, v161
v_mfma_f32_16x16x32_bf16 v[148:151], a[132:135], v[220:223], v[148:151]
v_mul_f32 v175, v175, v161
v_cvt_pk_bf16_f32 v180, v168, v169
v_cvt_pk_bf16_f32 v181, v170, v171
v_mfma_f32_16x16x32_bf16 v[152:155], a[136:139], v[220:223], v[152:155]
v_cvt_pk_bf16_f32 v182, v172, v173
v_cvt_pk_bf16_f32 v183, v174, v175
ds_read_b64_tr_b16 a[72:73], v42 offset:49152
v_mfma_f32_16x16x32_bf16 v[156:159], a[140:143], v[220:223], v[156:159]
ds_read_b64_tr_b16 a[74:75], v42 offset:51200
ds_read_b64_tr_b16 a[76:77], v43 offset:49152
ds_read_b64_tr_b16 a[78:79], v43 offset:51200
s_waitcnt lgkmcnt(5)
v_mfma_f32_16x16x32_bf16 v[176:179], v[200:203], a[28:31], v[252:255]
ds_read_b128 v[204:207], v53 offset:1024
ds_read_b128 v[192:195], v242 offset:8192
s_waitcnt lgkmcnt(6)
v_mfma_f32_16x16x16_bf16 v[168:171], v[188:189], a[28:29], 0
v_rcp_f32 v160, v216
v_rcp_f32 v161, v217
v_mul_f32 v208, v208, v160
v_mfma_f32_16x16x16_bf16 v[172:175], v[190:191], a[30:31], 0
v_mul_f32 v209, v209, v160
v_mul_f32 v210, v210, v160
v_mul_f32 v211, v211, v160
v_mfma_f32_16x16x32_bf16 v[144:147], a[144:147], v[180:183], v[144:147]
v_mul_f32 v212, v212, v161
v_mul_f32 v213, v213, v161
v_mul_f32 v214, v214, v161
v_mfma_f32_16x16x32_bf16 v[148:151], a[148:151], v[180:183], v[148:151]
v_mul_f32 v215, v215, v161
v_cvt_pk_bf16_f32 v220, v208, v209
v_cvt_pk_bf16_f32 v221, v210, v211
v_mfma_f32_16x16x32_bf16 v[152:155], a[152:155], v[180:183], v[152:155]
v_cvt_pk_bf16_f32 v222, v212, v213
v_cvt_pk_bf16_f32 v223, v214, v215
ds_read_b64_tr_b16 a[80:81], v40 offset:53248
v_mfma_f32_16x16x32_bf16 v[156:159], a[156:159], v[180:183], v[156:159]
ds_read_b64_tr_b16 a[82:83], v40 offset:55296
ds_read_b64_tr_b16 a[84:85], v41 offset:53248
ds_read_b64_tr_b16 a[86:87], v41 offset:55296
s_waitcnt lgkmcnt(5)
v_mfma_f32_16x16x32_bf16 v[216:219], v[204:207], a[32:35], v[252:255]
ds_read_b128 v[196:199], v53 offset:1152
ds_read_b128 v[184:187], v242 offset:9216
s_waitcnt lgkmcnt(6)
v_mfma_f32_16x16x16_bf16 v[208:211], v[192:193], a[32:33], 0
v_rcp_f32 v160, v176
v_rcp_f32 v161, v177
v_mul_f32 v168, v168, v160
v_mfma_f32_16x16x16_bf16 v[212:215], v[194:195], a[34:35], 0
v_mul_f32 v169, v169, v160
v_mul_f32 v170, v170, v160
v_mul_f32 v171, v171, v160
v_mfma_f32_16x16x32_bf16 v[144:147], a[160:163], v[220:223], v[144:147]
v_mul_f32 v172, v172, v161
v_mul_f32 v173, v173, v161
v_mul_f32 v174, v174, v161
v_mfma_f32_16x16x32_bf16 v[148:151], a[164:167], v[220:223], v[148:151]
v_mul_f32 v175, v175, v161
v_cvt_pk_bf16_f32 v180, v168, v169
v_cvt_pk_bf16_f32 v181, v170, v171
v_mfma_f32_16x16x32_bf16 v[152:155], a[168:171], v[220:223], v[152:155]
v_cvt_pk_bf16_f32 v182, v172, v173
v_cvt_pk_bf16_f32 v183, v174, v175
ds_read_b64_tr_b16 a[88:89], v42 offset:53248
v_mfma_f32_16x16x32_bf16 v[156:159], a[172:175], v[220:223], v[156:159]
ds_read_b64_tr_b16 a[90:91], v42 offset:55296
ds_read_b64_tr_b16 a[92:93], v43 offset:53248
ds_read_b64_tr_b16 a[94:95], v43 offset:55296
s_waitcnt lgkmcnt(5)
v_mfma_f32_16x16x32_bf16 v[176:179], v[196:199], a[36:39], v[252:255]
ds_read_b128 v[200:203], v53 offset:1280
ds_read_b128 v[188:191], v242 offset:10240
s_waitcnt lgkmcnt(6)
v_mfma_f32_16x16x16_bf16 v[168:171], v[184:185], a[36:37], 0
v_rcp_f32 v160, v216
v_rcp_f32 v161, v217
v_mul_f32 v208, v208, v160
v_mfma_f32_16x16x16_bf16 v[172:175], v[186:187], a[38:39], 0
v_mul_f32 v209, v209, v160
v_mul_f32 v210, v210, v160
v_mul_f32 v211, v211, v160
v_mfma_f32_16x16x32_bf16 v[144:147], a[176:179], v[180:183], v[144:147]
v_mul_f32 v212, v212, v161
v_mul_f32 v213, v213, v161
v_mul_f32 v214, v214, v161
v_mfma_f32_16x16x32_bf16 v[148:151], a[180:183], v[180:183], v[148:151]
v_mul_f32 v215, v215, v161
v_cvt_pk_bf16_f32 v220, v208, v209
v_cvt_pk_bf16_f32 v221, v210, v211
v_mfma_f32_16x16x32_bf16 v[152:155], a[184:187], v[180:183], v[152:155]
v_cvt_pk_bf16_f32 v222, v212, v213
v_cvt_pk_bf16_f32 v223, v214, v215
ds_read_b64_tr_b16 a[96:97], v40 offset:57344
v_mfma_f32_16x16x32_bf16 v[156:159], a[188:191], v[180:183], v[156:159]
ds_read_b64_tr_b16 a[98:99], v40 offset:59392
ds_read_b64_tr_b16 a[100:101], v41 offset:57344
ds_read_b64_tr_b16 a[102:103], v41 offset:59392
s_cmp_lg_u32 s99, 0
s_cbranch_scc1 L_np_94
buffer_load_dwordx2 v[34:35], v243, s[20:23], s73 offen sc1
L_np_94:
s_waitcnt lgkmcnt(5)
v_mfma_f32_16x16x32_bf16 v[216:219], v[200:203], a[40:43], v[252:255]
ds_read_b128 v[204:207], v53 offset:1408
ds_read_b128 v[192:195], v242 offset:11264
v_rcp_f32 v160, v176
v_rcp_f32 v161, v177
s_waitcnt lgkmcnt(6)
v_mfma_f32_16x16x16_bf16 v[208:211], v[188:189], a[40:41], 0
v_mul_f32 v168, v168, v160
v_mul_f32 v169, v169, v160
v_mul_f32 v170, v170, v160
v_mul_f32 v171, v171, v160
v_mfma_f32_16x16x16_bf16 v[212:215], v[190:191], a[42:43], 0
v_mul_f32 v172, v172, v161
v_mul_f32 v173, v173, v161
v_mul_f32 v174, v174, v161
v_mul_f32 v175, v175, v161
v_mfma_f32_16x16x32_bf16 v[144:147], a[192:195], v[220:223], v[144:147]
v_cvt_pk_bf16_f32 v180, v168, v169
v_cvt_pk_bf16_f32 v181, v170, v171
v_cvt_pk_bf16_f32 v182, v172, v173
v_cvt_pk_bf16_f32 v183, v174, v175
v_mfma_f32_16x16x32_bf16 v[148:151], a[196:199], v[220:223], v[148:151]
ds_read_b64_tr_b16 a[104:105], v42 offset:57344
ds_read_b64_tr_b16 a[106:107], v42 offset:59392
ds_read_b64_tr_b16 a[108:109], v43 offset:57344
ds_read_b64_tr_b16 a[110:111], v43 offset:59392
v_mfma_f32_16x16x32_bf16 v[152:155], a[200:203], v[220:223], v[152:155]
ds_read_b64_tr_b16 a[128:129], v48 offset:0
ds_read_b64_tr_b16 a[130:131], v48 offset:2048
ds_read_b64_tr_b16 a[132:133], v49 offset:0
ds_read_b64_tr_b16 a[134:135], v49 offset:2048
v_mfma_f32_16x16x32_bf16 v[156:159], a[204:207], v[220:223], v[156:159]
ds_read_b64_tr_b16 a[136:137], v50 offset:0
ds_read_b64_tr_b16 a[138:139], v50 offset:2048
ds_read_b64_tr_b16 a[140:141], v51 offset:0
ds_read_b64_tr_b16 a[142:143], v51 offset:2048
s_waitcnt lgkmcnt(13)
v_mfma_f32_16x16x32_bf16 v[176:179], v[204:207], a[44:47], v[252:255]
ds_read_b128 v[196:199], v53 offset:1536
ds_read_b128 v[184:187], v242 offset:12288
v_rcp_f32 v160, v216
v_rcp_f32 v161, v217
s_waitcnt lgkmcnt(14)
v_mfma_f32_16x16x16_bf16 v[168:171], v[192:193], a[44:45], 0
v_mul_f32 v208, v208, v160
v_mul_f32 v209, v209, v160
v_mul_f32 v210, v210, v160
v_mul_f32 v211, v211, v160
v_mfma_f32_16x16x16_bf16 v[172:175], v[194:195], a[46:47], 0
v_mul_f32 v212, v212, v161
v_mul_f32 v213, v213, v161
v_mul_f32 v214, v214, v161
v_mul_f32 v215, v215, v161
v_mfma_f32_16x16x32_bf16 v[144:147], a[208:211], v[180:183], v[144:147]
v_cvt_pk_bf16_f32 v220, v208, v209
v_cvt_pk_bf16_f32 v221, v210, v211
v_cvt_pk_bf16_f32 v222, v212, v213
v_cvt_pk_bf16_f32 v223, v214, v215
v_mfma_f32_16x16x32_bf16 v[148:151], a[212:215], v[180:183], v[148:151]
ds_read_b64_tr_b16 a[112:113], v40 offset:61440
ds_read_b64_tr_b16 a[114:115], v40 offset:63488
ds_read_b64_tr_b16 a[116:117], v41 offset:61440
ds_read_b64_tr_b16 a[118:119], v41 offset:63488
v_mfma_f32_16x16x32_bf16 v[152:155], a[216:219], v[180:183], v[152:155]
ds_read_b64_tr_b16 a[144:145], v48 offset:4096
ds_read_b64_tr_b16 a[146:147], v48 offset:6144
ds_read_b64_tr_b16 a[148:149], v49 offset:4096
ds_read_b64_tr_b16 a[150:151], v49 offset:6144
v_mfma_f32_16x16x32_bf16 v[156:159], a[220:223], v[180:183], v[156:159]
ds_read_b64_tr_b16 a[152:153], v50 offset:4096
ds_read_b64_tr_b16 a[154:155], v50 offset:6144
ds_read_b64_tr_b16 a[156:157], v51 offset:4096
ds_read_b64_tr_b16 a[158:159], v51 offset:6144
s_cmp_lg_u32 s99, 0
s_cbranch_scc1 L_np_95
buffer_load_dwordx2 v[36:37], v243, s[20:23], s73 offen sc1
L_np_95:
s_waitcnt lgkmcnt(13)
v_mfma_f32_16x16x32_bf16 v[216:219], v[196:199], a[48:51], v[252:255]
ds_read_b128 v[200:203], v53 offset:1664
ds_read_b128 v[188:191], v242 offset:13312
v_rcp_f32 v160, v176
v_rcp_f32 v161, v177
s_waitcnt lgkmcnt(14)
v_mfma_f32_16x16x16_bf16 v[208:211], v[184:185], a[48:49], 0
v_mul_f32 v168, v168, v160
v_mul_f32 v169, v169, v160
v_mul_f32 v170, v170, v160
v_mul_f32 v171, v171, v160
v_mfma_f32_16x16x16_bf16 v[212:215], v[186:187], a[50:51], 0
v_mul_f32 v172, v172, v161
v_mul_f32 v173, v173, v161
v_mul_f32 v174, v174, v161
v_mul_f32 v175, v175, v161
v_mfma_f32_16x16x32_bf16 v[144:147], a[224:227], v[220:223], v[144:147]
v_cvt_pk_bf16_f32 v180, v168, v169
v_cvt_pk_bf16_f32 v181, v170, v171
v_cvt_pk_bf16_f32 v182, v172, v173
v_cvt_pk_bf16_f32 v183, v174, v175
v_mfma_f32_16x16x32_bf16 v[148:151], a[228:231], v[220:223], v[148:151]
ds_read_b64_tr_b16 a[120:121], v42 offset:61440
ds_read_b64_tr_b16 a[122:123], v42 offset:63488
ds_read_b64_tr_b16 a[124:125], v43 offset:61440
ds_read_b64_tr_b16 a[126:127], v43 offset:63488
v_mfma_f32_16x16x32_bf16 v[152:155], a[232:235], v[220:223], v[152:155]
ds_read_b64_tr_b16 a[160:161], v48 offset:8192
ds_read_b64_tr_b16 a[162:163], v48 offset:10240
ds_read_b64_tr_b16 a[164:165], v49 offset:8192
ds_read_b64_tr_b16 a[166:167], v49 offset:10240
v_mfma_f32_16x16x32_bf16 v[156:159], a[236:239], v[220:223], v[156:159]
ds_read_b64_tr_b16 a[168:169], v50 offset:8192
ds_read_b64_tr_b16 a[170:171], v50 offset:10240
ds_read_b64_tr_b16 a[172:173], v51 offset:8192
ds_read_b64_tr_b16 a[174:175], v51 offset:10240
s_cmp_lg_u32 s99, 0
s_cbranch_scc1 L_np_96
s_waitcnt vmcnt(1)
v_cmp_ne_u64 vcc, v[34:35], v[26:27]
s_nop 3
s_cbranch_vccnz L_np_96
s_add_u32 s63, s74, 0
buffer_load_dwordx4 v[56:59], v32, s[20:23], s63 offen offset:0 sc1
buffer_load_dwordx4 v[60:63], v32, s[20:23], s63 offen offset:1024 sc1
buffer_load_dwordx4 v[64:67], v32, s[20:23], s63 offen offset:2048 sc1
buffer_load_dwordx4 v[68:71], v32, s[20:23], s63 offen offset:3072 sc1
s_add_u32 s63, s74, 4096
buffer_load_dwordx4 v[72:75], v32, s[20:23], s63 offen offset:0 sc1
buffer_load_dwordx4 v[76:79], v32, s[20:23], s63 offen offset:1024 sc1
buffer_load_dwordx4 v[80:83], v32, s[20:23], s63 offen offset:2048 sc1
buffer_load_dwordx4 v[84:87], v32, s[20:23], s63 offen offset:3072 sc1
s_add_u32 s63, s74, 8192
buffer_load_dwordx4 v[88:91], v32, s[20:23], s63 offen offset:0 sc1
buffer_load_dwordx4 v[92:95], v32, s[20:23], s63 offen offset:1024 sc1
buffer_load_dwordx4 v[96:99], v32, s[20:23], s63 offen offset:2048 sc1
buffer_load_dwordx4 v[100:103], v32, s[20:23], s63 offen offset:3072 sc1
s_mov_b32 s99, 12
L_np_96:
s_waitcnt lgkmcnt(13)
v_mfma_f32_16x16x32_bf16 v[176:179], v[200:203], a[52:55], v[252:255]
ds_read_b128 v[204:207], v53 offset:1792
ds_read_b128 v[192:195], v242 offset:14336
v_rcp_f32 v160, v216
s_waitcnt lgkmcnt(14)
v_mfma_f32_16x16x16_bf16 v[168:171], v[188:189], a[52:53], 0
v_rcp_f32 v161, v217
v_mul_f32 v208, v208, v160
v_mul_f32 v209, v209, v160
v_mfma_f32_16x16x16_bf16 v[172:175], v[190:191], a[54:55], 0
v_mul_f32 v210, v210, v160
v_mul_f32 v211, v211, v160
v_mul_f32 v212, v212, v161
v_mul_f32 v213, v213, v161
v_mfma_f32_16x16x32_bf16 v[144:147], a[240:243], v[180:183], v[144:147]
v_mul_f32 v214, v214, v161
v_mul_f32 v215, v215, v161
v_cvt_pk_bf16_f32 v220, v208, v209
v_mfma_f32_16x16x32_bf16 v[148:151], a[244:247], v[180:183], v[148:151]
v_cvt_pk_bf16_f32 v221, v210, v211
v_cvt_pk_bf16_f32 v222, v212, v213
v_cvt_pk_bf16_f32 v223, v214, v215
ds_read_b64_tr_b16 a[176:177], v48 offset:12288
v_mfma_f32_16x16x32_bf16 v[152:155], a[248:251], v[180:183], v[152:155]
ds_read_b64_tr_b16 a[178:179], v48 offset:14336
ds_read_b64_tr_b16 a[180:181], v49 offset:12288
ds_read_b64_tr_b16 a[182:183], v49 offset:14336
v_mfma_f32_16x16x32_bf16 v[156:159], a[252:255], v[180:183], v[156:159]
ds_read_b64_tr_b16 a[184:185], v50 offset:12288
ds_read_b64_tr_b16 a[186:187], v50 offset:14336
ds_read_b64_tr_b16 a[188:189], v51 offset:12288
ds_read_b64_tr_b16 a[190:191], v51 offset:14336
s_cmp_lg_u32 s99, 0
s_cbranch_scc1 L_np_97
buffer_load_dwordx2 v[34:35], v243, s[20:23], s73 offen sc1
L_np_97:
s_waitcnt lgkmcnt(9)
v_mfma_f32_16x16x32_bf16 v[216:219], v[204:207], a[56:59], v[252:255]
ds_read_b128 v[196:199], v53 offset:1920
ds_read_b128 v[184:187], v242 offset:15360
v_rcp_f32 v160, v176
s_waitcnt lgkmcnt(10)
v_mfma_f32_16x16x16_bf16 v[208:211], v[192:193], a[56:57], 0
v_rcp_f32 v161, v177
v_mul_f32 v168, v168, v160
v_mul_f32 v169, v169, v160
v_mfma_f32_16x16x16_bf16 v[212:215], v[194:195], a[58:59], 0
v_mul_f32 v170, v170, v160
v_mul_f32 v171, v171, v160
v_mul_f32 v172, v172, v161
v_mul_f32 v173, v173, v161
v_mfma_f32_16x16x32_bf16 v[144:147], a[64:67], v[220:223], v[144:147]
v_mul_f32 v174, v174, v161
v_mul_f32 v175, v175, v161
v_cvt_pk_bf16_f32 v180, v168, v169
v_mfma_f32_16x16x32_bf16 v[148:151], a[68:71], v[220:223], v[148:151]
v_cvt_pk_bf16_f32 v181, v170, v171
v_cvt_pk_bf16_f32 v182, v172, v173
v_cvt_pk_bf16_f32 v183, v174, v175
ds_read_b64_tr_b16 a[192:193], v48 offset:16384
v_mfma_f32_16x16x32_bf16 v[152:155], a[72:75], v[220:223], v[152:155]
ds_read_b64_tr_b16 a[194:195], v48 offset:18432
ds_read_b64_tr_b16 a[196:197], v49 offset:16384
ds_read_b64_tr_b16 a[198:199], v49 offset:18432
v_mfma_f32_16x16x32_bf16 v[156:159], a[76:79], v[220:223], v[156:159]
ds_read_b64_tr_b16 a[200:201], v50 offset:16384
ds_read_b64_tr_b16 a[202:203], v50 offset:18432
ds_read_b64_tr_b16 a[204:205], v51 offset:16384
ds_read_b64_tr_b16 a[206:207], v51 offset:18432
s_cmp_lg_u32 s99, 0
s_cbranch_scc1 L_np_98
s_waitcnt vmcnt(1)
v_cmp_ne_u64 vcc, v[36:37], v[26:27]
s_nop 3
s_cbranch_vccnz L_np_98
s_add_u32 s63, s74, 0
buffer_load_dwordx4 v[56:59], v32, s[20:23], s63 offen offset:0 sc1
buffer_load_dwordx4 v[60:63], v32, s[20:23], s63 offen offset:1024 sc1
buffer_load_dwordx4 v[64:67], v32, s[20:23], s63 offen offset:2048 sc1
buffer_load_dwordx4 v[68:71], v32, s[20:23], s63 offen offset:3072 sc1
s_add_u32 s63, s74, 4096
buffer_load_dwordx4 v[72:75], v32, s[20:23], s63 offen offset:0 sc1
buffer_load_dwordx4 v[76:79], v32, s[20:23], s63 offen offset:1024 sc1
buffer_load_dwordx4 v[80:83], v32, s[20:23], s63 offen offset:2048 sc1
buffer_load_dwordx4 v[84:87], v32, s[20:23], s63 offen offset:3072 sc1
s_add_u32 s63, s74, 8192
buffer_load_dwordx4 v[88:91], v32, s[20:23], s63 offen offset:0 sc1
buffer_load_dwordx4 v[92:95], v32, s[20:23], s63 offen offset:1024 sc1
buffer_load_dwordx4 v[96:99], v32, s[20:23], s63 offen offset:2048 sc1
buffer_load_dwordx4 v[100:103], v32, s[20:23], s63 offen offset:3072 sc1
s_mov_b32 s99, 14
L_np_98:
s_waitcnt lgkmcnt(9)
v_mfma_f32_16x16x32_bf16 v[176:179], v[196:199], a[60:63], v[252:255]
v_rcp_f32 v160, v216
v_rcp_f32 v161, v217
v_mul_f32 v208, v208, v160
s_waitcnt lgkmcnt(8)
v_mfma_f32_16x16x16_bf16 v[168:171], v[184:185], a[60:61], 0
v_mul_f32 v209, v209, v160
v_mul_f32 v210, v210, v160
v_mul_f32 v211, v211, v160
v_mfma_f32_16x16x16_bf16 v[172:175], v[186:187], a[62:63], 0
v_mul_f32 v212, v212, v161
v_mul_f32 v213, v213, v161
v_mul_f32 v214, v214, v161
v_mfma_f32_16x16x32_bf16 v[144:147], a[80:83], v[180:183], v[144:147]
v_mul_f32 v215, v215, v161
v_cvt_pk_bf16_f32 v220, v208, v209
v_cvt_pk_bf16_f32 v221, v210, v211
v_mfma_f32_16x16x32_bf16 v[148:151], a[84:87], v[180:183], v[148:151]
v_cvt_pk_bf16_f32 v222, v212, v213
v_cvt_pk_bf16_f32 v223, v214, v215
ds_read_b64_tr_b16 a[208:209], v48 offset:20480
v_mfma_f32_16x16x32_bf16 v[152:155], a[88:91], v[180:183], v[152:155]
ds_read_b64_tr_b16 a[210:211], v48 offset:22528
ds_read_b64_tr_b16 a[212:213], v49 offset:20480
ds_read_b64_tr_b16 a[214:215], v49 offset:22528
v_mfma_f32_16x16x32_bf16 v[156:159], a[92:95], v[180:183], v[156:159]
ds_read_b64_tr_b16 a[216:217], v50 offset:20480
ds_read_b64_tr_b16 a[218:219], v50 offset:22528
ds_read_b64_tr_b16 a[220:221], v51 offset:20480
ds_read_b64_tr_b16 a[222:223], v51 offset:22528
v_mfma_f32_16x16x32_bf16 v[144:147], a[96:99], v[220:223], v[144:147]
v_rcp_f32 v160, v176
v_rcp_f32 v161, v177
v_mul_f32 v168, v168, v160
v_mul_f32 v169, v169, v160
v_mul_f32 v170, v170, v160
v_mfma_f32_16x16x32_bf16 v[148:151], a[100:103], v[220:223], v[148:151]
v_mul_f32 v171, v171, v160
v_mul_f32 v172, v172, v161
v_mul_f32 v173, v173, v161
v_mul_f32 v174, v174, v161
v_mul_f32 v175, v175, v161
v_cvt_pk_bf16_f32 v180, v168, v169
v_mfma_f32_16x16x32_bf16 v[152:155], a[104:107], v[220:223], v[152:155]
v_cvt_pk_bf16_f32 v181, v170, v171
v_cvt_pk_bf16_f32 v182, v172, v173
v_cvt_pk_bf16_f32 v183, v174, v175
ds_read_b64_tr_b16 a[224:225], v48 offset:24576
ds_read_b64_tr_b16 a[226:227], v48 offset:26624
v_mfma_f32_16x16x32_bf16 v[156:159], a[108:111], v[220:223], v[156:159]
ds_read_b64_tr_b16 a[228:229], v49 offset:24576
ds_read_b64_tr_b16 a[230:231], v49 offset:26624
ds_read_b64_tr_b16 a[232:233], v50 offset:24576
ds_read_b64_tr_b16 a[234:235], v50 offset:26624
ds_read_b64_tr_b16 a[236:237], v51 offset:24576
ds_read_b64_tr_b16 a[238:239], v51 offset:26624
s_cmp_lg_u32 s99, 0
s_cbranch_scc1 L_np_99
s_waitcnt vmcnt(0)
v_cmp_ne_u64 vcc, v[34:35], v[26:27]
s_nop 3
s_cbranch_vccnz L_np_99
s_add_u32 s63, s74, 0
buffer_load_dwordx4 v[56:59], v32, s[20:23], s63 offen offset:0 sc1
buffer_load_dwordx4 v[60:63], v32, s[20:23], s63 offen offset:1024 sc1
buffer_load_dwordx4 v[64:67], v32, s[20:23], s63 offen offset:2048 sc1
buffer_load_dwordx4 v[68:71], v32, s[20:23], s63 offen offset:3072 sc1
s_add_u32 s63, s74, 4096
buffer_load_dwordx4 v[72:75], v32, s[20:23], s63 offen offset:0 sc1
buffer_load_dwordx4 v[76:79], v32, s[20:23], s63 offen offset:1024 sc1
buffer_load_dwordx4 v[80:83], v32, s[20:23], s63 offen offset:2048 sc1
buffer_load_dwordx4 v[84:87], v32, s[20:23], s63 offen offset:3072 sc1
s_add_u32 s63, s74, 8192
buffer_load_dwordx4 v[88:91], v32, s[20:23], s63 offen offset:0 sc1
buffer_load_dwordx4 v[92:95], v32, s[20:23], s63 offen offset:1024 sc1
buffer_load_dwordx4 v[96:99], v32, s[20:23], s63 offen offset:2048 sc1
buffer_load_dwordx4 v[100:103], v32, s[20:23], s63 offen offset:3072 sc1
s_mov_b32 s99, 16
L_np_99:
s_cmp_eq_u32 s99, 12
s_cbranch_scc0 L_hr_100
s_add_u32 s63, s74, 12288
buffer_load_dwordx4 v[104:107], v32, s[20:23], s63 offen offset:0 sc1
buffer_load_dwordx4 v[108:111], v32, s[20:23], s63 offen offset:1024 sc1
buffer_load_dwordx4 v[112:115], v32, s[20:23], s63 offen offset:2048 sc1
buffer_load_dwordx4 v[116:119], v32, s[20:23], s63 offen offset:3072 sc1
s_add_u32 s63, s74, 16384
buffer_load_dwordx4 v[120:123], v32, s[20:23], s63 offen offset:0 sc1
buffer_load_dwordx4 v[124:127], v32, s[20:23], s63 offen offset:1024 sc1
buffer_load_dwordx4 v[128:131], v32, s[20:23], s63 offen offset:2048 sc1
buffer_load_dwordx4 v[132:135], v32, s[20:23], s63 offen offset:3072 sc1
s_add_u32 s63, s74, 20480
buffer_load_dwordx4 v[136:139], v32, s[20:23], s63 offen offset:0 sc1
buffer_load_dwordx4 v[140:143], v32, s[20:23], s63 offen offset:1024 sc1
s_mov_b32 s99, 99
L_hr_100:
v_mfma_f32_16x16x32_bf16 v[144:147], a[112:115], v[180:183], v[144:147]
ds_read_b64_tr_b16 a[240:241], v48 offset:28672
ds_read_b64_tr_b16 a[242:243], v48 offset:30720
v_mfma_f32_16x16x32_bf16 v[148:151], a[116:119], v[180:183], v[148:151]
ds_read_b64_tr_b16 a[244:245], v49 offset:28672
ds_read_b64_tr_b16 a[246:247], v49 offset:30720
v_mfma_f32_16x16x32_bf16 v[152:155], a[120:123], v[180:183], v[152:155]
ds_read_b64_tr_b16 a[248:249], v50 offset:28672
ds_read_b64_tr_b16 a[250:251], v50 offset:30720
v_mfma_f32_16x16x32_bf16 v[156:159], a[124:127], v[180:183], v[156:159]
ds_read_b64_tr_b16 a[252:253], v51 offset:28672
ds_read_b64_tr_b16 a[254:255], v51 offset:30720
s_sub_u32 s53, s99, 1
s_cmp_lt_u32 s53, 31
s_cbranch_scc0 L_hr_101
s_add_u32 s63, s74, 12288
buffer_load_dwordx4 v[104:107], v32, s[20:23], s63 offen offset:0 sc1
buffer_load_dwordx4 v[108:111], v32, s[20:23], s63 offen offset:1024 sc1
buffer_load_dwordx4 v[112:115], v32, s[20:23], s63 offen offset:2048 sc1
buffer_load_dwordx4 v[116:119], v32, s[20:23], s63 offen offset:3072 sc1
s_add_u32 s63, s74, 16384
buffer_load_dwordx4 v[120:123], v32, s[20:23], s63 offen offset:0 sc1
buffer_load_dwordx4 v[124:127], v32, s[20:23], s63 offen offset:1024 sc1
buffer_load_dwordx4 v[128:131], v32, s[20:23], s63 offen offset:2048 sc1
buffer_load_dwordx4 v[132:135], v32, s[20:23], s63 offen offset:3072 sc1
s_add_u32 s63, s74, 20480
buffer_load_dwordx4 v[136:139], v32, s[20:23], s63 offen offset:0 sc1
buffer_load_dwordx4 v[140:143], v32, s[20:23], s63 offen offset:1024 sc1
s_mov_b32 s99, 99
L_hr_101:
s_cmp_lg_u32 s99, 0
s_cbranch_scc1 L_hdone
buffer_load_dwordx2 v[34:35], v243, s[20:23], s73 offen sc1
s_waitcnt vmcnt(0)
v_cmp_ne_u64 vcc, v[34:35], v[26:27]
s_nop 3
s_cbranch_vccz L_ok_104
s_mov_b32 s62, 4000
L_sp_103:
s_sleep 3
buffer_load_dwordx2 v[34:35], v243, s[20:23], s73 offen sc1
s_waitcnt vmcnt(0)
v_cmp_ne_u64 vcc, v[34:35], v[26:27]
s_sub_u32 s62, s62, 1
s_cbranch_scc1 L_ok_104
s_nop 1
s_cbranch_vccnz L_sp_103
L_ok_104:
s_add_u32 s63, s74, 0
buffer_load_dwordx4 v[56:59], v32, s[20:23], s63 offen offset:0 sc1
buffer_load_dwordx4 v[60:63], v32, s[20:23], s63 offen offset:1024 sc1
buffer_load_dwordx4 v[64:67], v32, s[20:23], s63 offen offset:2048 sc1
buffer_load_dwordx4 v[68:71], v32, s[20:23], s63 offen offset:3072 sc1
s_add_u32 s63, s74, 4096
buffer_load_dwordx4 v[72:75], v32, s[20:23], s63 offen offset:0 sc1
buffer_load_dwordx4 v[76:79], v32, s[20:23], s63 offen offset:1024 sc1
buffer_load_dwordx4 v[80:83], v32, s[20:23], s63 offen offset:2048 sc1
buffer_load_dwordx4 v[84:87], v32, s[20:23], s63 offen offset:3072 sc1
s_add_u32 s63, s74, 8192
buffer_load_dwordx4 v[88:91], v32, s[20:23], s63 offen offset:0 sc1
buffer_load_dwordx4 v[92:95], v32, s[20:23], s63 offen offset:1024 sc1
buffer_load_dwordx4 v[96:99], v32, s[20:23], s63 offen offset:2048 sc1
buffer_load_dwordx4 v[100:103], v32, s[20:23], s63 offen offset:3072 sc1
s_add_u32 s63, s74, 12288
buffer_load_dwordx4 v[104:107], v32, s[20:23], s63 offen offset:0 sc1
buffer_load_dwordx4 v[108:111], v32, s[20:23], s63 offen offset:1024 sc1
buffer_load_dwordx4 v[112:115], v32, s[20:23], s63 offen offset:2048 sc1
buffer_load_dwordx4 v[116:119], v32, s[20:23], s63 offen offset:3072 sc1
s_add_u32 s63, s74, 16384
buffer_load_dwordx4 v[120:123], v32, s[20:23], s63 offen offset:0 sc1
buffer_load_dwordx4 v[124:127], v32, s[20:23], s63 offen offset:1024 sc1
buffer_load_dwordx4 v[128:131], v32, s[20:23], s63 offen offset:2048 sc1
buffer_load_dwordx4 v[132:135], v32, s[20:23], s63 offen offset:3072 sc1
s_add_u32 s63, s74, 20480
buffer_load_dwordx4 v[136:139], v32, s[20:23], s63 offen offset:0 sc1
buffer_load_dwordx4 v[140:143], v32, s[20:23], s63 offen offset:1024 sc1
L_hdone:
s_barrier
s_waitcnt vmcnt(21)
v_mfma_f32_16x16x32_bf16 v[168:171], a[128:131], v[56:59], 0
ds_read_b64_tr_b16 a[0:1], v48 offset:32768
ds_read_b64_tr_b16 a[2:3], v48 offset:34816
v_mfma_f32_16x16x32_bf16 v[172:175], a[132:135], v[56:59], 0
ds_read_b64_tr_b16 a[4:5], v49 offset:32768
ds_read_b64_tr_b16 a[6:7], v49 offset:34816
v_mfma_f32_16x16x32_bf16 v[176:179], a[136:139], v[56:59], 0
ds_read_b64_tr_b16 a[8:9], v50 offset:32768
ds_read_b64_tr_b16 a[10:11], v50 offset:34816
v_mfma_f32_16x16x32_bf16 v[180:183], a[140:143], v[56:59], 0
ds_read_b64_tr_b16 a[12:13], v51 offset:32768
ds_read_b64_tr_b16 a[14:15], v51 offset:34816
s_waitcnt vmcnt(20)
v_mfma_f32_16x16x32_bf16 v[168:171], a[144:147], v[60:63], v[168:171]
ds_read_b64_tr_b16 a[16:17], v48 offset:36864
ds_read_b64_tr_b16 a[18:19], v48 offset:38912
v_mfma_f32_16x16x32_bf16 v[172:175], a[148:151], v[60:63], v[172:175]
ds_read_b64_tr_b16 a[20:21], v49 offset:36864
ds_read_b64_tr_b16 a[22:23], v49 offset:38912
v_mfma_f32_16x16x32_bf16 v[176:179], a[152:155], v[60:63], v[176:179]
ds_read_b64_tr_b16 a[24:25], v50 offset:36864
ds_read_b64_tr_b16 a[26:27], v50 offset:38912
v_mfma_f32_16x16x32_bf16 v[180:183], a[156:159], v[60:63], v[180:183]
ds_read_b64_tr_b16 a[28:29], v51 offset:36864
ds_read_b64_tr_b16 a[30:31], v51 offset:38912
s_waitcnt vmcnt(19)
v_mfma_f32_16x16x32_bf16 v[168:171], a[160:163], v[64:67], v[168:171]
ds_read_b64_tr_b16 a[32:33], v48 offset:40960
ds_read_b64_tr_b16 a[34:35], v48 offset:43008
v_mfma_f32_16x16x32_bf16 v[172:175], a[164:167], v[64:67], v[172:175]
ds_read_b64_tr_b16 a[36:37], v49 offset:40960
ds_read_b64_tr_b16 a[38:39], v49 offset:43008
v_mfma_f32_16x16x32_bf16 v[176:179], a[168:171], v[64:67], v[176:179]
ds_read_b64_tr_b16 a[40:41], v50 offset:40960
ds_read_b64_tr_b16 a[42:43], v50 offset:43008
v_mfma_f32_16x16x32_bf16 v[180:183], a[172:175], v[64:67], v[180:183]
ds_read_b64_tr_b16 a[44:45], v51 offset:40960
ds_read_b64_tr_b16 a[46:47], v51 offset:43008
s_waitcnt vmcnt(18)
v_mfma_f32_16x16x32_bf16 v[168:171], a[176:179], v[68:71], v[168:171]
ds_read_b64_tr_b16 a[48:49], v48 offset:45056
ds_read_b64_tr_b16 a[50:51], v48 offset:47104
v_mfma_f32_16x16x32_bf16 v[172:175], a[180:183], v[68:71], v[172:175]
ds_read_b64_tr_b16 a[52:53], v49 offset:45056
ds_read_b64_tr_b16 a[54:55], v49 offset:47104
v_mfma_f32_16x16x32_bf16 v[176:179], a[184:187], v[68:71], v[176:179]
ds_read_b64_tr_b16 a[56:57], v50 offset:45056
ds_read_b64_tr_b16 a[58:59], v50 offset:47104
v_mfma_f32_16x16x32_bf16 v[180:183], a[188:191], v[68:71], v[180:183]
ds_read_b64_tr_b16 a[60:61], v51 offset:45056
ds_read_b64_tr_b16 a[62:63], v51 offset:47104
s_waitcnt vmcnt(17)
s_waitcnt lgkmcnt(15)
v_mfma_f32_16x16x32_bf16 v[168:171], a[192:195], v[72:75], v[168:171]
ds_read_b64_tr_b16 a[128:129], v48 offset:49152
ds_read_b64_tr_b16 a[130:131], v48 offset:51200
s_waitcnt lgkmcnt(15)
v_mfma_f32_16x16x32_bf16 v[172:175], a[196:199], v[72:75], v[172:175]
ds_read_b64_tr_b16 a[132:133], v49 offset:49152
ds_read_b64_tr_b16 a[134:135], v49 offset:51200
s_waitcnt lgkmcnt(15)
v_mfma_f32_16x16x32_bf16 v[176:179], a[200:203], v[72:75], v[176:179]
ds_read_b64_tr_b16 a[136:137], v50 offset:49152
ds_read_b64_tr_b16 a[138:139], v50 offset:51200
s_waitcnt lgkmcnt(15)
v_mfma_f32_16x16x32_bf16 v[180:183], a[204:207], v[72:75], v[180:183]
ds_read_b64_tr_b16 a[140:141], v51 offset:49152
ds_read_b64_tr_b16 a[142:143], v51 offset:51200
s_waitcnt vmcnt(16)
s_waitcnt lgkmcnt(15)
v_mfma_f32_16x16x32_bf16 v[168:171], a[208:211], v[76:79], v[168:171]
ds_read_b64_tr_b16 a[144:145], v48 offset:53248
ds_read_b64_tr_b16 a[146:147], v48 offset:55296
s_waitcnt lgkmcnt(15)
v_mfma_f32_16x16x32_bf16 v[172:175], a[212:215], v[76:79], v[172:175]
ds_read_b64_tr_b16 a[148:149], v49 offset:53248
ds_read_b64_tr_b16 a[150:151], v49 offset:55296
s_waitcnt lgkmcnt(15)
v_mfma_f32_16x16x32_bf16 v[176:179], a[216:219], v[76:79], v[176:179]
ds_read_b64_tr_b16 a[152:153], v50 offset:53248
ds_read_b64_tr_b16 a[154:155], v50 offset:55296
s_waitcnt lgkmcnt(15)
v_mfma_f32_16x16x32_bf16 v[180:183], a[220:223], v[76:79], v[180:183]
ds_read_b64_tr_b16 a[156:157], v51 offset:53248
ds_read_b64_tr_b16 a[158:159], v51 offset:55296
s_waitcnt vmcnt(15)
s_waitcnt lgkmcnt(15)
v_mfma_f32_16x16x32_bf16 v[168:171], a[224:227], v[80:83], v[168:171]
ds_read_b64_tr_b16 a[160:161], v48 offset:57344
ds_read_b64_tr_b16 a[162:163], v48 offset:59392
s_waitcnt lgkmcnt(15)
v_mfma_f32_16x16x32_bf16 v[172:175], a[228:231], v[80:83], v[172:175]
ds_read_b64_tr_b16 a[164:165], v49 offset:57344
ds_read_b64_tr_b16 a[166:167], v49 offset:59392
s_waitcnt lgkmcnt(15)
v_mfma_f32_16x16x32_bf16 v[176:179], a[232:235], v[80:83], v[176:179]
ds_read_b64_tr_b16 a[168:169], v50 offset:57344
ds_read_b64_tr_b16 a[170:171], v50 offset:59392
s_waitcnt lgkmcnt(15)
v_mfma_f32_16x16x32_bf16 v[180:183], a[236:239], v[80:83], v[180:183]
ds_read_b64_tr_b16 a[172:173], v51 offset:57344
ds_read_b64_tr_b16 a[174:175], v51 offset:59392
s_waitcnt vmcnt(14)
s_waitcnt lgkmcnt(15)
v_mfma_f32_16x16x32_bf16 v[168:171], a[240:243], v[84:87], v[168:171]
ds_read_b64_tr_b16 a[176:177], v48 offset:61440
ds_read_b64_tr_b16 a[178:179], v48 offset:63488
s_waitcnt lgkmcnt(15)
v_mfma_f32_16x16x32_bf16 v[172:175], a[244:247], v[84:87], v[172:175]
ds_read_b64_tr_b16 a[180:181], v49 offset:61440
ds_read_b64_tr_b16 a[182:183], v49 offset:63488
s_waitcnt lgkmcnt(15)
v_mfma_f32_16x16x32_bf16 v[176:179], a[248:251], v[84:87], v[176:179]
ds_read_b64_tr_b16 a[184:185], v50 offset:61440
ds_read_b64_tr_b16 a[186:187], v50 offset:63488
s_waitcnt lgkmcnt(15)
v_mfma_f32_16x16x32_bf16 v[180:183], a[252:255], v[84:87], v[180:183]
ds_read_b64_tr_b16 a[188:189], v51 offset:61440
ds_read_b64_tr_b16 a[190:191], v51 offset:63488
s_waitcnt vmcnt(13)
s_waitcnt lgkmcnt(15)
v_mfma_f32_16x16x32_bf16 v[168:171], a[0:3], v[88:91], v[168:171]
ds_read_b64_tr_b16 a[192:193], v16 offset:0
ds_read_b64_tr_b16 a[194:195], v16 offset:2048
s_waitcnt lgkmcnt(15)
v_mfma_f32_16x16x32_bf16 v[172:175], a[4:7], v[88:91], v[172:175]
ds_read_b64_tr_b16 a[196:197], v17 offset:0
ds_read_b64_tr_b16 a[198:199], v17 offset:2048
s_waitcnt lgkmcnt(15)
v_mfma_f32_16x16x32_bf16 v[176:179], a[8:11], v[88:91], v[176:179]
ds_read_b64_tr_b16 a[200:201], v18 offset:0
ds_read_b64_tr_b16 a[202:203], v18 offset:2048
s_waitcnt lgkmcnt(15)
v_mfma_f32_16x16x32_bf16 v[180:183], a[12:15], v[88:91], v[180:183]
ds_read_b64_tr_b16 a[204:205], v19 offset:0
ds_read_b64_tr_b16 a[206:207], v19 offset:2048
s_waitcnt vmcnt(12)
s_waitcnt lgkmcnt(15)
v_mfma_f32_16x16x32_bf16 v[168:171], a[16:19], v[92:95], v[168:171]
ds_read_b64_tr_b16 a[208:209], v16 offset:4096
ds_read_b64_tr_b16 a[210:211], v16 offset:6144
s_waitcnt lgkmcnt(15)
v_mfma_f32_16x16x32_bf16 v[172:175], a[20:23], v[92:95], v[172:175]
ds_read_b64_tr_b16 a[212:213], v17 offset:4096
ds_read_b64_tr_b16 a[214:215], v17 offset:6144
s_waitcnt lgkmcnt(15)
v_mfma_f32_16x16x32_bf16 v[176:179], a[24:27], v[92:95], v[176:179]
ds_read_b64_tr_b16 a[216:217], v18 offset:4096
ds_read_b64_tr_b16 a[218:219], v18 offset:6144
s_waitcnt lgkmcnt(15)
v_mfma_f32_16x16x32_bf16 v[180:183], a[28:31], v[92:95], v[180:183]
ds_read_b64_tr_b16 a[220:221], v19 offset:4096
ds_read_b64_tr_b16 a[222:223], v19 offset:6144
s_waitcnt vmcnt(11)
s_waitcnt lgkmcnt(15)
v_mfma_f32_16x16x32_bf16 v[168:171], a[32:35], v[96:99], v[168:171]
ds_read_b64_tr_b16 a[224:225], v16 offset:8192
ds_read_b64_tr_b16 a[226:227], v16 offset:10240
s_waitcnt lgkmcnt(15)
v_mfma_f32_16x16x32_bf16 v[172:175], a[36:39], v[96:99], v[172:175]
ds_read_b64_tr_b16 a[228:229], v17 offset:8192
ds_read_b64_tr_b16 a[230:231], v17 offset:10240
s_waitcnt lgkmcnt(15)
v_mfma_f32_16x16x32_bf16 v[176:179], a[40:43], v[96:99], v[176:179]
ds_read_b64_tr_b16 a[232:233], v18 offset:8192
ds_read_b64_tr_b16 a[234:235], v18 offset:10240
s_waitcnt lgkmcnt(15)
v_mfma_f32_16x16x32_bf16 v[180:183], a[44:47], v[96:99], v[180:183]
ds_read_b64_tr_b16 a[236:237], v19 offset:8192
ds_read_b64_tr_b16 a[238:239], v19 offset:10240
s_waitcnt vmcnt(10)
s_waitcnt lgkmcnt(15)
v_mfma_f32_16x16x32_bf16 v[168:171], a[48:51], v[100:103], v[168:171]
ds_read_b64_tr_b16 a[240:241], v16 offset:12288
ds_read_b64_tr_b16 a[242:243], v16 offset:14336
s_waitcnt lgkmcnt(15)
v_mfma_f32_16x16x32_bf16 v[172:175], a[52:55], v[100:103], v[172:175]
ds_read_b64_tr_b16 a[244:245], v17 offset:12288
ds_read_b64_tr_b16 a[246:247], v17 offset:14336
s_waitcnt lgkmcnt(15)
v_mfma_f32_16x16x32_bf16 v[176:179], a[56:59], v[100:103], v[176:179]
ds_read_b64_tr_b16 a[248:249], v18 offset:12288
ds_read_b64_tr_b16 a[250:251], v18 offset:14336
s_waitcnt lgkmcnt(15)
v_mfma_f32_16x16x32_bf16 v[180:183], a[60:63], v[100:103], v[180:183]
ds_read_b64_tr_b16 a[252:253], v19 offset:12288
ds_read_b64_tr_b16 a[254:255], v19 offset:14336
s_waitcnt vmcnt(9)
s_waitcnt lgkmcnt(15)
v_mfma_f32_16x16x32_bf16 v[168:171], a[128:131], v[104:107], v[168:171]
ds_read_b64_tr_b16 a[0:1], v16 offset:16384
ds_read_b64_tr_b16 a[2:3], v16 offset:18432
s_waitcnt lgkmcnt(15)
v_mfma_f32_16x16x32_bf16 v[172:175], a[132:135], v[104:107], v[172:175]
ds_read_b64_tr_b16 a[4:5], v17 offset:16384
ds_read_b64_tr_b16 a[6:7], v17 offset:18432
s_waitcnt lgkmcnt(15)
v_mfma_f32_16x16x32_bf16 v[176:179], a[136:139], v[104:107], v[176:179]
ds_read_b64_tr_b16 a[8:9], v18 offset:16384
ds_read_b64_tr_b16 a[10:11], v18 offset:18432
s_waitcnt lgkmcnt(15)
v_mfma_f32_16x16x32_bf16 v[180:183], a[140:143], v[104:107], v[180:183]
ds_read_b64_tr_b16 a[12:13], v19 offset:16384
ds_read_b64_tr_b16 a[14:15], v19 offset:18432
s_waitcnt vmcnt(8)
s_waitcnt lgkmcnt(15)
v_mfma_f32_16x16x32_bf16 v[168:171], a[144:147], v[108:111], v[168:171]
ds_read_b64_tr_b16 a[16:17], v16 offset:20480
ds_read_b64_tr_b16 a[18:19], v16 offset:22528
s_waitcnt lgkmcnt(15)
v_mfma_f32_16x16x32_bf16 v[172:175], a[148:151], v[108:111], v[172:175]
ds_read_b64_tr_b16 a[20:21], v17 offset:20480
ds_read_b64_tr_b16 a[22:23], v17 offset:22528
s_waitcnt lgkmcnt(15)
v_mfma_f32_16x16x32_bf16 v[176:179], a[152:155], v[108:111], v[176:179]
ds_read_b64_tr_b16 a[24:25], v18 offset:20480
ds_read_b64_tr_b16 a[26:27], v18 offset:22528
s_waitcnt lgkmcnt(15)
v_mfma_f32_16x16x32_bf16 v[180:183], a[156:159], v[108:111], v[180:183]
ds_read_b64_tr_b16 a[28:29], v19 offset:20480
ds_read_b64_tr_b16 a[30:31], v19 offset:22528
v_lshlrev_b32 v200, 16, v244
s_waitcnt vmcnt(7)
s_waitcnt lgkmcnt(15)
v_mfma_f32_16x16x32_bf16 v[168:171], a[160:163], v[112:115], v[168:171]
v_and_b32 v201, 0xffff0000, v244
s_waitcnt lgkmcnt(15)
v_mfma_f32_16x16x32_bf16 v[172:175], a[164:167], v[112:115], v[172:175]
v_lshlrev_b32 v202, 16, v245
s_waitcnt lgkmcnt(15)
v_mfma_f32_16x16x32_bf16 v[176:179], a[168:171], v[112:115], v[176:179]
v_and_b32 v203, 0xffff0000, v245
s_waitcnt lgkmcnt(15)
v_mfma_f32_16x16x32_bf16 v[180:183], a[172:175], v[112:115], v[180:183]
v_lshlrev_b32 v204, 16, v246
s_waitcnt vmcnt(6)
s_waitcnt lgkmcnt(15)
v_mfma_f32_16x16x32_bf16 v[168:171], a[176:179], v[116:119], v[168:171]
v_and_b32 v205, 0xffff0000, v246
s_waitcnt lgkmcnt(15)
v_mfma_f32_16x16x32_bf16 v[172:175], a[180:183], v[116:119], v[172:175]
v_lshlrev_b32 v206, 16, v247
s_waitcnt lgkmcnt(15)
v_mfma_f32_16x16x32_bf16 v[176:179], a[184:187], v[116:119], v[176:179]
v_and_b32 v207, 0xffff0000, v247
s_waitcnt lgkmcnt(15)
v_mfma_f32_16x16x32_bf16 v[180:183], a[188:191], v[116:119], v[180:183]
v_lshlrev_b32 v208, 16, v248
s_waitcnt vmcnt(5)
s_waitcnt lgkmcnt(15)
v_mfma_f32_16x16x32_bf16 v[168:171], a[192:195], v[120:123], v[168:171]
v_and_b32 v209, 0xffff0000, v248
s_waitcnt lgkmcnt(15)
v_mfma_f32_16x16x32_bf16 v[172:175], a[196:199], v[120:123], v[172:175]
v_lshlrev_b32 v210, 16, v249
s_waitcnt lgkmcnt(15)
v_mfma_f32_16x16x32_bf16 v[176:179], a[200:203], v[120:123], v[176:179]
v_and_b32 v211, 0xffff0000, v249
s_waitcnt lgkmcnt(15)
v_mfma_f32_16x16x32_bf16 v[180:183], a[204:207], v[120:123], v[180:183]
v_lshlrev_b32 v212, 16, v250
s_waitcnt vmcnt(4)
s_waitcnt lgkmcnt(15)
v_mfma_f32_16x16x32_bf16 v[168:171], a[208:211], v[124:127], v[168:171]
v_and_b32 v213, 0xffff0000, v250
s_waitcnt lgkmcnt(15)
v_mfma_f32_16x16x32_bf16 v[172:175], a[212:215], v[124:127], v[172:175]
v_lshlrev_b32 v214, 16, v251
s_waitcnt lgkmcnt(15)
v_mfma_f32_16x16x32_bf16 v[176:179], a[216:219], v[124:127], v[176:179]
v_and_b32 v215, 0xffff0000, v251
s_waitcnt lgkmcnt(15)
v_mfma_f32_16x16x32_bf16 v[180:183], a[220:223], v[124:127], v[180:183]
s_waitcnt vmcnt(3)
s_waitcnt lgkmcnt(15)
v_mfma_f32_16x16x32_bf16 v[168:171], a[224:227], v[128:131], v[168:171]
s_waitcnt lgkmcnt(15)
v_mfma_f32_16x16x32_bf16 v[172:175], a[228:231], v[128:131], v[172:175]
s_waitcnt lgkmcnt(15)
v_mfma_f32_16x16x32_bf16 v[176:179], a[232:235], v[128:131], v[176:179]
s_waitcnt lgkmcnt(15)
v_mfma_f32_16x16x32_bf16 v[180:183], a[236:239], v[128:131], v[180:183]
s_waitcnt vmcnt(2)
s_waitcnt lgkmcnt(15)
v_mfma_f32_16x16x32_bf16 v[168:171], a[240:243], v[132:135], v[168:171]
s_waitcnt lgkmcnt(15)
v_mfma_f32_16x16x32_bf16 v[172:175], a[244:247], v[132:135], v[172:175]
s_waitcnt lgkmcnt(15)
v_mfma_f32_16x16x32_bf16 v[176:179], a[248:251], v[132:135], v[176:179]
s_waitcnt lgkmcnt(15)
v_mfma_f32_16x16x32_bf16 v[180:183], a[252:255], v[132:135], v[180:183]
s_waitcnt vmcnt(1)
s_waitcnt lgkmcnt(14)
v_mfma_f32_16x16x32_bf16 v[168:171], a[0:3], v[136:139], v[168:171]
s_waitcnt lgkmcnt(12)
v_mfma_f32_16x16x32_bf16 v[172:175], a[4:7], v[136:139], v[172:175]
s_waitcnt lgkmcnt(10)
v_mfma_f32_16x16x32_bf16 v[176:179], a[8:11], v[136:139], v[176:179]
s_waitcnt lgkmcnt(8)
v_mfma_f32_16x16x32_bf16 v[180:183], a[12:15], v[136:139], v[180:183]
s_waitcnt vmcnt(0)
s_waitcnt lgkmcnt(6)
v_mfma_f32_16x16x32_bf16 v[168:171], a[16:19], v[140:143], v[168:171]
s_waitcnt lgkmcnt(4)
v_mfma_f32_16x16x32_bf16 v[172:175], a[20:23], v[140:143], v[172:175]
s_waitcnt lgkmcnt(2)
v_mfma_f32_16x16x32_bf16 v[176:179], a[24:27], v[140:143], v[176:179]
s_waitcnt lgkmcnt(0)
v_mfma_f32_16x16x32_bf16 v[180:183], a[28:31], v[140:143], v[180:183]
s_nop 1
v_pk_mul_f32 v[184:185], v[168:169], v[24:25] op_sel:[0,0] op_sel_hi:[1,0] neg_lo:[0,1] neg_hi:[0,1]
v_pk_mul_f32 v[186:187], v[170:171], v[24:25] op_sel:[0,0] op_sel_hi:[1,0] neg_lo:[0,1] neg_hi:[0,1]
v_pk_mul_f32 v[188:189], v[172:173], v[24:25] op_sel:[0,0] op_sel_hi:[1,0] neg_lo:[0,1] neg_hi:[0,1]
v_pk_mul_f32 v[190:191], v[174:175], v[24:25] op_sel:[0,0] op_sel_hi:[1,0] neg_lo:[0,1] neg_hi:[0,1]
v_pk_mul_f32 v[192:193], v[176:177], v[24:25] op_sel:[0,0] op_sel_hi:[1,0] neg_lo:[0,1] neg_hi:[0,1]
v_pk_mul_f32 v[194:195], v[178:179], v[24:25] op_sel:[0,0] op_sel_hi:[1,0] neg_lo:[0,1] neg_hi:[0,1]
v_pk_mul_f32 v[196:197], v[180:181], v[24:25] op_sel:[0,0] op_sel_hi:[1,0] neg_lo:[0,1] neg_hi:[0,1]
v_pk_mul_f32 v[198:199], v[182:183], v[24:25] op_sel:[0,0] op_sel_hi:[1,0] neg_lo:[0,1] neg_hi:[0,1]
v_exp_f32 v184, v184
v_exp_f32 v185, v185
v_exp_f32 v186, v186
v_exp_f32 v187, v187
v_exp_f32 v188, v188
v_exp_f32 v189, v189
v_exp_f32 v190, v190
v_exp_f32 v191, v191
v_exp_f32 v192, v192
v_exp_f32 v193, v193
v_exp_f32 v194, v194
v_exp_f32 v195, v195
v_exp_f32 v196, v196
v_exp_f32 v197, v197
v_exp_f32 v198, v198
v_exp_f32 v199, v199
v_pk_mul_f32 v[168:169], v[168:169], v[144:145]
v_pk_mul_f32 v[170:171], v[170:171], v[146:147]
v_pk_mul_f32 v[172:173], v[172:173], v[148:149]
v_pk_mul_f32 v[174:175], v[174:175], v[150:151]
v_pk_mul_f32 v[176:177], v[176:177], v[152:153]
v_pk_mul_f32 v[178:179], v[178:179], v[154:155]
v_pk_mul_f32 v[180:181], v[180:181], v[156:157]
v_pk_mul_f32 v[182:183], v[182:183], v[158:159]
v_pk_add_f32 v[184:185], v[184:185], 1.0 op_sel_hi:[1,0]
v_pk_add_f32 v[186:187], v[186:187], 1.0 op_sel_hi:[1,0]
v_pk_add_f32 v[188:189], v[188:189], 1.0 op_sel_hi:[1,0]
v_pk_add_f32 v[190:191], v[190:191], 1.0 op_sel_hi:[1,0]
v_pk_add_f32 v[192:193], v[192:193], 1.0 op_sel_hi:[1,0]
v_pk_add_f32 v[194:195], v[194:195], 1.0 op_sel_hi:[1,0]
v_pk_add_f32 v[196:197], v[196:197], 1.0 op_sel_hi:[1,0]
v_pk_add_f32 v[198:199], v[198:199], 1.0 op_sel_hi:[1,0]
v_rcp_f32 v184, v184
v_rcp_f32 v185, v185
v_rcp_f32 v186, v186
v_rcp_f32 v187, v187
v_rcp_f32 v188, v188
v_rcp_f32 v189, v189
v_rcp_f32 v190, v190
v_rcp_f32 v191, v191
v_rcp_f32 v192, v192
v_rcp_f32 v193, v193
v_rcp_f32 v194, v194
v_rcp_f32 v195, v195
v_rcp_f32 v196, v196
v_rcp_f32 v197, v197
v_rcp_f32 v198, v198
v_rcp_f32 v199, v199
v_pk_fma_f32 v[184:185], v[184:185], v[168:169], v[200:201]
v_pk_fma_f32 v[186:187], v[186:187], v[170:171], v[202:203]
v_cvt_pk_bf16_f32 v244, v184, v185
v_cvt_pk_bf16_f32 v245, v186, v187
buffer_store_dwordx2 v[244:245], v52, s[32:35], 0 offen offset:0
v_pk_fma_f32 v[188:189], v[188:189], v[172:173], v[204:205]
v_pk_fma_f32 v[190:191], v[190:191], v[174:175], v[206:207]
v_cvt_pk_bf16_f32 v246, v188, v189
v_cvt_pk_bf16_f32 v247, v190, v191
buffer_store_dwordx2 v[246:247], v52, s[32:35], 0 offen offset:32
v_pk_fma_f32 v[192:193], v[192:193], v[176:177], v[208:209]
v_pk_fma_f32 v[194:195], v[194:195], v[178:179], v[210:211]
v_cvt_pk_bf16_f32 v248, v192, v193
v_cvt_pk_bf16_f32 v249, v194, v195
buffer_store_dwordx2 v[248:249], v52, s[32:35], 0 offen offset:64
v_pk_fma_f32 v[196:197], v[196:197], v[180:181], v[212:213]
v_pk_fma_f32 v[198:199], v[198:199], v[182:183], v[214:215]
v_cvt_pk_bf16_f32 v250, v196, v197
v_cvt_pk_bf16_f32 v251, v198, v199
buffer_store_dwordx2 v[250:251], v52, s[32:35], 0 offen offset:96
s_or_b32 s56, s2, s44
s_cmp_eq_u32 s56, 0
s_cbranch_scc0 L_noclr
v_mov_b32 v5, 0
v_mov_b32 v6, 0
v_mov_b32 v7, 0
s_mov_b64 exec, 1
buffer_store_dwordx2 v[6:7], v14, s[40:43], 0 offen sc1
s_mov_b64 exec, -1
L_noclr:
s_endpgm
L_red:
s_cmp_eq_u32 s15, 2
s_cbranch_scc1 L_red2
s_cmp_eq_u32 s15, 3
s_cbranch_scc1 L_red3
s_cmp_eq_u32 s15, 0
s_cbranch_scc1 L_redp
v_cmp_ne_u64 vcc, v[252:253], v[26:27]
s_nop 3
s_cbranch_vccz L_red1
L_redp:
s_lshr_b32 s12, s47, 1
s_lshl_b32 s12, s12, 12
s_add_u32 s12, s12, 12713984
v_lshrrev_b32 v54, 2, v0
v_lshlrev_b32 v54, 8, v54
v_bfe_u32 v244, v0, 1, 1
v_lshl_add_u32 v54, v244, 7, v54
buffer_load_dwordx2 v[252:253], v54, s[20:23], s12 offen sc1
s_mov_b32 s15, 1
s_setpc_b64 s[8:9]
L_red1:
v_lshlrev_b32 v54, 13, v3
v_lshl_add_u32 v54, v4, 4, v54
s_lshl_b32 s12, s47, 15
s_lshl_b32 s13, s44, 8
s_add_u32 s12, s12, s13
s_add_u32 s12, s12, 8126464
s_add_u32 s14, s12, 4096
buffer_load_dwordx4 a[0:3], v54, s[20:23], s12 offen offset:0 sc1
buffer_load_dwordx4 a[4:7], v54, s[20:23], s12 offen offset:1024 sc1
buffer_load_dwordx4 a[8:11], v54, s[20:23], s12 offen offset:2048 sc1
buffer_load_dwordx4 a[12:15], v54, s[20:23], s12 offen offset:3072 sc1
buffer_load_dwordx4 a[16:19], v54, s[20:23], s14 offen offset:0 sc1
buffer_load_dwordx4 a[20:23], v54, s[20:23], s14 offen offset:1024 sc1
buffer_load_dwordx4 a[24:27], v54, s[20:23], s14 offen offset:2048 sc1
buffer_load_dwordx4 a[28:31], v54, s[20:23], s14 offen offset:3072 sc1
v_and_b32 v54, 31, v0
v_lshlrev_b32 v54, 7, v54
v_lshrrev_b32 v244, 5, v0
v_lshl_add_u32 v54, v244, 5, v54
s_lshl_b32 s12, s47, 12
s_add_u32 s12, s12, 9175040
s_cmp_eq_u32 s44, 0
s_cselect_b32 s12, s12, 0x40000000
buffer_load_dwordx4 a[32:35], v54, s[20:23], s12 offen sc1
buffer_load_dwordx4 a[36:39], v54, s[20:23], s12 offen offset:16 sc1
s_mov_b32 s15, 2
s_setpc_b64 s[8:9]
L_red2:
v_accvgpr_read_b32 v244, a0
v_accvgpr_read_b32 v245, a1
v_accvgpr_read_b32 v246, a2
v_accvgpr_read_b32 v247, a3
v_accvgpr_read_b32 v248, a4
v_accvgpr_read_b32 v249, a5
v_accvgpr_read_b32 v250, a6
v_accvgpr_read_b32 v251, a7
v_add_f32 v244, v244, v248
v_add_f32 v245, v245, v249
v_add_f32 v246, v246, v250
v_add_f32 v247, v247, v251
v_accvgpr_read_b32 v248, a8
v_accvgpr_read_b32 v249, a9
v_accvgpr_read_b32 v250, a10
v_accvgpr_read_b32 v251, a11
v_add_f32 v244, v244, v248
v_add_f32 v245, v245, v249
v_add_f32 v246, v246, v250
v_add_f32 v247, v247, v251
v_accvgpr_read_b32 v248, a12
v_accvgpr_read_b32 v249, a13
v_accvgpr_read_b32 v250, a14
v_accvgpr_read_b32 v251, a15
v_add_f32 v244, v244, v248
v_add_f32 v245, v245, v249
v_add_f32 v246, v246, v250
v_add_f32 v247, v247, v251
v_accvgpr_read_b32 v248, a16
v_accvgpr_read_b32 v249, a17
v_accvgpr_read_b32 v250, a18
v_accvgpr_read_b32 v251, a19
v_add_f32 v244, v244, v248
v_add_f32 v245, v245, v249
v_add_f32 v246, v246, v250
v_add_f32 v247, v247, v251
v_accvgpr_read_b32 v248, a20
v_accvgpr_read_b32 v249, a21
v_accvgpr_read_b32 v250, a22
v_accvgpr_read_b32 v251, a23
v_add_f32 v244, v244, v248
v_add_f32 v245, v245, v249
v_add_f32 v246, v246, v250
v_add_f32 v247, v247, v251
v_accvgpr_read_b32 v248, a24
v_accvgpr_read_b32 v249, a25
v_accvgpr_read_b32 v250, a26
v_accvgpr_read_b32 v251, a27
v_add_f32 v244, v244, v248
v_add_f32 v245, v245, v249
v_add_f32 v246, v246, v250
v_add_f32 v247, v247, v251
v_accvgpr_read_b32 v248, a28
v_accvgpr_read_b32 v249, a29
v_accvgpr_read_b32 v250, a30
v_accvgpr_read_b32 v251, a31
v_add_f32 v244, v244, v248
v_add_f32 v245, v245, v249
v_add_f32 v246, v246, v250
v_add_f32 v247, v247, v251
v_mov_b32 v248, v244
v_mov_b32 v249, v245
v_mov_b32 v250, v246
v_mov_b32 v251, v247
v_permlane16_swap_b32 v244, v248
v_permlane16_swap_b32 v245, v249
v_permlane16_swap_b32 v246, v250
v_permlane16_swap_b32 v247, v251
v_add_f32 v244, v244, v248
v_add_f32 v245, v245, v249
v_add_f32 v246, v246, v250
v_add_f32 v247, v247, v251
v_mov_b32 v248, v244
v_mov_b32 v249, v245
v_mov_b32 v250, v246
v_mov_b32 v251, v247
v_permlane32_swap_b32 v244, v248
v_permlane32_swap_b32 v245, v249
v_permlane32_swap_b32 v246, v250
v_permlane32_swap_b32 v247, v251
v_add_f32 v244, v244, v248
v_add_f32 v245, v245, v249
v_add_f32 v246, v246, v250
v_add_f32 v247, v247, v251
v_cvt_pk_bf16_f32 v254, v244, v245
v_cvt_pk_bf16_f32 v255, v246, v247
s_lshl_b32 s12, s47, 9
s_lshl_b32 s14, s44, 7
s_add_u32 s12, s12, s14
s_add_u32 s12, s12, 9306112
v_lshlrev_b32 v54, 3, v0
s_mov_b32 exec_lo, 0xffff
s_mov_b32 exec_hi, 0
buffer_store_dwordx2 v[254:255], v54, s[20:23], s12 offen sc1
s_mov_b64 exec, -1
s_cmp_eq_u32 s44, 0
s_cbranch_scc0 L_redz
v_accvgpr_read_b32 v244, a32
v_accvgpr_read_b32 v245, a33
v_accvgpr_read_b32 v246, a34
v_accvgpr_read_b32 v247, a35
v_accvgpr_read_b32 v248, a36
v_accvgpr_read_b32 v249, a37
v_accvgpr_read_b32 v250, a38
v_accvgpr_read_b32 v251, a39
v_add_f32_dpp v244, v244, v244 row_ror:8 row_mask:0xf bank_mask:0xf
v_add_f32_dpp v245, v245, v245 row_ror:8 row_mask:0xf bank_mask:0xf
v_add_f32_dpp v246, v246, v246 row_ror:8 row_mask:0xf bank_mask:0xf
v_add_f32_dpp v247, v247, v247 row_ror:8 row_mask:0xf bank_mask:0xf
v_add_f32_dpp v248, v248, v248 row_ror:8 row_mask:0xf bank_mask:0xf
v_add_f32_dpp v249, v249, v249 row_ror:8 row_mask:0xf bank_mask:0xf
v_add_f32_dpp v250, v250, v250 row_ror:8 row_mask:0xf bank_mask:0xf
v_add_f32_dpp v251, v251, v251 row_ror:8 row_mask:0xf bank_mask:0xf
v_add_f32_dpp v244, v244, v244 row_ror:4 row_mask:0xf bank_mask:0xf
v_add_f32_dpp v245, v245, v245 row_ror:4 row_mask:0xf bank_mask:0xf
v_add_f32_dpp v246, v246, v246 row_ror:4 row_mask:0xf bank_mask:0xf
v_add_f32_dpp v247, v247, v247 row_ror:4 row_mask:0xf bank_mask:0xf
v_add_f32_dpp v248, v248, v248 row_ror:4 row_mask:0xf bank_mask:0xf
v_add_f32_dpp v249, v249, v249 row_ror:4 row_mask:0xf bank_mask:0xf
v_add_f32_dpp v250, v250, v250 row_ror:4 row_mask:0xf bank_mask:0xf
v_add_f32_dpp v251, v251, v251 row_ror:4 row_mask:0xf bank_mask:0xf
v_add_f32_dpp v244, v244, v244 row_ror:2 row_mask:0xf bank_mask:0xf
v_add_f32_dpp v245, v245, v245 row_ror:2 row_mask:0xf bank_mask:0xf
v_add_f32_dpp v246, v246, v246 row_ror:2 row_mask:0xf bank_mask:0xf
v_add_f32_dpp v247, v247, v247 row_ror:2 row_mask:0xf bank_mask:0xf
v_add_f32_dpp v248, v248, v248 row_ror:2 row_mask:0xf bank_mask:0xf
v_add_f32_dpp v249, v249, v249 row_ror:2 row_mask:0xf bank_mask:0xf
v_add_f32_dpp v250, v250, v250 row_ror:2 row_mask:0xf bank_mask:0xf
v_add_f32_dpp v251, v251, v251 row_ror:2 row_mask:0xf bank_mask:0xf
v_add_f32_dpp v244, v244, v244 row_ror:1 row_mask:0xf bank_mask:0xf
v_add_f32_dpp v245, v245, v245 row_ror:1 row_mask:0xf bank_mask:0xf
v_add_f32_dpp v246, v246, v246 row_ror:1 row_mask:0xf bank_mask:0xf
v_add_f32_dpp v247, v247, v247 row_ror:1 row_mask:0xf bank_mask:0xf
v_add_f32_dpp v248, v248, v248 row_ror:1 row_mask:0xf bank_mask:0xf
v_add_f32_dpp v249, v249, v249 row_ror:1 row_mask:0xf bank_mask:0xf
v_add_f32_dpp v250, v250, v250 row_ror:1 row_mask:0xf bank_mask:0xf
v_add_f32_dpp v251, v251, v251 row_ror:1 row_mask:0xf bank_mask:0xf
v_mov_b32 v252, v244
s_nop 1
v_permlane16_swap_b32 v244, v252
v_add_f32 v244, v244, v252
v_mov_b32 v252, v245
s_nop 1
v_permlane16_swap_b32 v245, v252
v_add_f32 v245, v245, v252
v_mov_b32 v252, v246
s_nop 1
v_permlane16_swap_b32 v246, v252
v_add_f32 v246, v246, v252
v_mov_b32 v252, v247
s_nop 1
v_permlane16_swap_b32 v247, v252
v_add_f32 v247, v247, v252
v_mov_b32 v252, v248
s_nop 1
v_permlane16_swap_b32 v248, v252
v_add_f32 v248, v248, v252
v_mov_b32 v252, v249
s_nop 1
v_permlane16_swap_b32 v249, v252
v_add_f32 v249, v249, v252
v_mov_b32 v252, v250
s_nop 1
v_permlane16_swap_b32 v250, v252
v_add_f32 v250, v250, v252
v_mov_b32 v252, v251
s_nop 1
v_permlane16_swap_b32 v251, v252
v_add_f32 v251, v251, v252
v_cvt_pk_bf16_f32 v244, v244, v245
v_cvt_pk_bf16_f32 v245, v246, v247
v_cvt_pk_bf16_f32 v246, v248, v249
v_cvt_pk_bf16_f32 v247, v250, v251
v_and_b32 v54, 1, v0
v_cmp_eq_u32 vcc, 1, v54
s_nop 1
v_cndmask_b32 v248, v244, v246, vcc
v_cndmask_b32 v249, v245, v247, vcc
s_and_b32 s13, s47, 1
s_cmp_eq_u32 s13, 0
s_cselect_b32 s14, -1, 0
s_not_b32 s13, s14
v_and_b32 v244, s14, v248
v_and_b32 v245, s14, v249
v_and_b32 v246, s13, v248
v_and_b32 v247, s13, v249
v_lshrrev_b32 v248, 5, v0
v_lshl_add_u32 v54, v248, 1, v54
v_and_b32 v248, 2, v0
v_lshl_add_u32 v54, v248, 1, v54
v_lshlrev_b32 v54, 4, v54
s_lshl_b32 s12, s47, 7
s_add_u32 s12, s12, 9322496
s_mov_b32 exec_lo, 15
s_mov_b32 exec_hi, 15
buffer_store_dwordx4 v[244:247], v54, s[20:23], s12 offen sc1
s_mov_b64 exec, -1
L_redz:
s_mov_b32 s15, 3
s_setpc_b64 s[8:9]
L_red3:
s_lshl_b32 s12, s47, 2
s_add_u32 s12, s12, s44
s_lshl_b32 s12, s12, 7
s_add_u32 s12, s12, 40960
s_mov_b64 exec, 1
buffer_store_dwordx2 v[26:27], v14, s[20:23], s12 offen sc1
s_mov_b64 exec, -1
s_mov_b32 s15, 4
s_setpc_b64 s[8:9]
L_end:
s_endpgm
.section .rodata,"a"
.p2align 6
.amdhsa_kernel recurrent_scan__linear_attn_block__mixer_gmlp__prompt_kernel
  .amdhsa_next_free_vgpr 512
  .amdhsa_next_free_sgpr 102
  .amdhsa_accum_offset 256
  .amdhsa_group_segment_fixed_size 0
  .amdhsa_kernarg_size 88
  .amdhsa_user_sgpr_count 2
  .amdhsa_user_sgpr_kernarg_segment_ptr 1
  .amdhsa_system_sgpr_workgroup_id_x 1
.end_amdhsa_kernel
```
